```python
import torch

def _softmax(x, axis=-1):
    return torch.softmax(x, dim=axis)
def _gelu(x):
    return torch.nn.functional.gelu(x, approximate="tanh")
def _silu(x):
    return torch.nn.functional.silu(x)
def _sigmoid(x):
    return torch.sigmoid(x)
def _layernorm(x, axis=-1, eps=1e-5):
    m = x.mean(dim=axis, keepdim=True)
    v = x.var(dim=axis, keepdim=True, unbiased=False)
    return (x - m) / torch.sqrt(v + eps)
def _scatter_add(tgt, idx, src, axis=0):
    return tgt.clone().index_add_(axis, idx, src)
def _segment_sum(src, seg, n):
    out = torch.zeros((n,) + src.shape[1:], dtype=src.dtype)
    return out.index_add_(0, seg, src)
def _pad(x, pw):
    flat = tuple(v for pair in reversed(pw) for v in pair)
    return torch.nn.functional.pad(x, flat)

kernel_name = 'interleave_layers__spectral_fnet__dense_activation_squared_relu__prompt'

def setup_inputs():

    _w = (lambda a: (lambda t: t.to(torch.bfloat16) if t.is_floating_point() else t)(torch.as_tensor(a)))
    def _A_setup():
        B, S, D = 1, 2048, 640
        ns = torch.arange(S)[:, None] * torch.arange(S)[None, :]
        nd = torch.arange(D)[:, None] * torch.arange(D)[None, :]
        Ws_re = torch.cos(-2.0 * torch.pi * ns / S).to(float)
        Ws_im = torch.sin(-2.0 * torch.pi * ns / S).to(float)
        Wd_re = torch.cos(-2.0 * torch.pi * nd / D).to(float)
        Wd_im = torch.sin(-2.0 * torch.pi * nd / D).to(float)
        return {
            "x": _w((lambda *s: torch.randn(*s, dtype=torch.bfloat16) * 0.05)(B, S, D)),
            "dft_seq_re": _w(Ws_re),
            "dft_seq_im": _w(Ws_im),
            "dft_hid_re": _w(Wd_re),
            "dft_hid_im": _w(Wd_im),
        }
    _A_in = _A_setup()

    def _B_setup():
        B, S, D, F = 1, 2048, 640, 1728
        return {
            "x": _w((lambda *s: torch.randn(*s, dtype=torch.bfloat16) * 0.05)(B, S, D)),
            "w1": _w((lambda *s: torch.randn(*s, dtype=torch.bfloat16) * 0.4)(D, F)),
            "b1": _w((lambda *s: torch.randn(*s, dtype=torch.bfloat16) * 0.4)(F)),
            "w2": _w((lambda *s: torch.randn(*s, dtype=torch.bfloat16) * 0.4)(F, D)),
            "b2": _w((lambda *s: torch.randn(*s, dtype=torch.bfloat16) * 0.4)(D)),
        }
    _B_in = _B_setup()

    return {
        "A_x": _A_in["x"],
        "A_dft_seq_re": _A_in["dft_seq_re"],
        "A_dft_seq_im": _A_in["dft_seq_im"],
        "A_dft_hid_re": _A_in["dft_hid_re"],
        "A_dft_hid_im": _A_in["dft_hid_im"],
        "B_x": _B_in["x"],
        "B_w1": _B_in["w1"],
        "B_b1": _B_in["b1"],
        "B_w2": _B_in["w2"],
        "B_b2": _B_in["b2"],
    }

def reference(A_x, A_dft_seq_re, A_dft_seq_im, A_dft_hid_re, A_dft_hid_im, B_x, B_w1, B_b1, B_w2, B_b2):
    def _A_ref(x, dft_seq_re, dft_seq_im, dft_hid_re, dft_hid_im):
        a = torch.einsum("bsd,ed->bse", x, dft_hid_re)
        b = torch.einsum("bsd,ed->bse", x, dft_hid_im)
        y = torch.einsum("ts,bse->bte", dft_seq_re, a) - torch.einsum("ts,bse->bte", dft_seq_im, b)
        return y

    def _B_ref(x, w1, b1, w2, b2):
        h = torch.einsum("bsd,df->bsf", x, w1) + b1
        zero = torch.zeros_like(h)
        r = torch.where(h > zero, h, zero)
        h = r * r
        out = torch.einsum("bsf,fd->bsd", h, w2) + b2
        return out

    x = A_x
    x = x + _A_ref(_layernorm(x, axis=-1), A_dft_seq_re, A_dft_seq_im, A_dft_hid_re, A_dft_hid_im)
    x = x + _B_ref(_layernorm(x, axis=-1), B_w1, B_b1, B_w2, B_b2)
    x = x + _A_ref(_layernorm(x, axis=-1), A_dft_seq_re, A_dft_seq_im, A_dft_hid_re, A_dft_hid_im)
    x = x + _B_ref(_layernorm(x, axis=-1), B_w1, B_b1, B_w2, B_b2)
    return x
```

```asm
; @launch grid=(256,1,1) block=(256,1,1) lds=163840
.amdgcn_target "amdgcn-amd-amdhsa--gfx950"
.text
.globl interleave_layers__spectral_fnet__dense_activation_squared_relu__prompt_kernel
.p2align 8
.type interleave_layers__spectral_fnet__dense_activation_squared_relu__prompt_kernel,@function
interleave_layers__spectral_fnet__dense_activation_squared_relu__prompt_kernel:
    s_cmp_ge_u32 s2, 256
    s_cbranch_scc1 L_interleave_layers__spectral_fnet__dense_activation_squared_relu__prompt_kernel_end
    s_load_dwordx2 s[20:21], s[0:1], 0
    s_load_dwordx8 s[24:31], s[0:1], 48
    s_load_dwordx4 s[32:35], s[0:1], 80
    s_load_dwordx2 s[36:37], s[0:1], 96
    v_lshrrev_b32 v1, 6, v0
    v_and_b32 v0, 63, v0
    v_readfirstlane_b32 s3, v1
    s_and_b32 s4, s2, 7
    s_lshr_b32 s5, s2, 3
    s_getpc_b64 s[6:7]
L_inte_pc_1:
    s_add_u32 s6, s6, dft_tables-L_inte_pc_1
    s_addc_u32 s7, s7, 0
    s_lshr_b32 s50, s5, 2
    s_lshl_b32 s50, s50, 3
    s_add_u32 s50, s50, s4
    s_and_b32 s51, s5, 3
    s_cmp_le_u32 s50, 40
    s_cselect_b32 s68, 1, 0
    v_mov_b32 v68, 0x7f000000
    v_mov_b32 v69, 0x7f000000
    s_mov_b32 s22, 0
    s_mov_b32 s38, 126
    s_mov_b32 s61, 0
    s_mov_b32 s15, 0x00020000
    s_cmp_lt_u32 s2, 128
    s_cbranch_scc0 L_inte_nx_2
    s_mov_b32 s62, 0
    s_mov_b32 s23, 0
    s_mov_b32 s60, s2
    s_lshr_b32 s40, s2, 5
    s_lshl_b32 s40, s40, 9
    s_and_b32 s41, s2, 31
    s_add_u32 s40, s40, s41
    s_and_b32 s41, s3, 1
    s_lshl_b32 s41, s41, 8
    s_add_u32 s40, s40, s41
    s_lshr_b32 s41, s3, 1
    s_lshl_b32 s41, s41, 5
    s_add_u32 s40, s40, s41
    s_mul_i32 s40, s40, 1280
    s_mul_i32 s42, s3, 5120
    s_mov_b32 s43, 81920
    s_mov_b32 s44, 4
    s_mov_b32 s45, 256
    s_waitcnt lgkmcnt(0)
    s_mov_b32 s12, s20
    s_mov_b32 s13, s21
    s_mov_b32 s14, 2621440
    s_branch L_inte_issue_7
L_inte_nx_2:
    s_mov_b32 s23, 1
    s_mov_b32 s44, 3
    s_mov_b32 s14, 2211840
    s_cmp_eq_u32 s68, 0
    s_cbranch_scc0 L_inte_col_3
    s_sub_u32 s60, s5, 20
    s_mul_i32 s60, s60, 7
    s_add_u32 s60, s60, s4
    s_sub_u32 s60, s60, 1
    s_sub_u32 s41, s2, 164
    s_cmp_lt_u32 s2, 192
    s_cselect_b32 s60, s60, s41
    s_mov_b32 s22, s60
    s_mov_b32 s38, s60
    s_cmp_lt_u32 s60, 54
    s_cbranch_scc0 L_inte_w2_4
    s_mov_b32 s62, 1
    s_and_b32 s40, s60, 1
    s_lshl_b32 s40, s40, 2
    s_add_u32 s40, s40, s3
    s_mul_i32 s40, s40, 34560
    s_lshr_b32 s41, s60, 1
    s_lshl_b32 s41, s41, 7
    s_add_u32 s40, s40, s41
    s_mul_i32 s42, s3, 10240
    s_mov_b32 s43, 276480
    s_mov_b32 s45, 3456
    s_waitcnt lgkmcnt(0)
    s_mov_b32 s12, s24
    s_mov_b32 s13, s25
    s_branch L_inte_issue_7
L_inte_w2_4:
    s_mov_b32 s62, 2
    s_sub_u32 s60, s60, 54
    s_mul_i32 s42, s3, 10240
    s_cmp_lt_u32 s60, 36
    s_cbranch_scc1 L_inte_w2c_6
    s_sub_u32 s60, s60, 36
    s_mul_i32 s60, s60, 3
    s_branch L_inte_half_5
L_inte_col_3:
    s_mov_b32 s62, 4
    s_sub_u32 s60, s2, 128
    s_cmp_eq_u32 s60, 3
    s_cbranch_scc1 L_inte_none_9
    s_cmp_eq_u32 s60, 0
    s_cselect_b32 s23, 2, 1
    s_cbranch_scc1 L_inte_none_9
    s_add_u32 s41, s5, 12
    s_cmp_lt_u32 s2, 160
    s_cselect_b32 s60, s60, s41
L_inte_half_5:
    s_mov_b32 s62, 3
    s_add_u32 s38, s60, 90
    s_and_b32 s61, s60, 1
    s_lshr_b32 s60, s60, 1
    s_add_u32 s60, s60, 36
    s_mul_i32 s42, s3, 5120
L_inte_w2c_6:
    s_mul_i32 s40, s60, 40960
    s_mul_i32 s41, s3, 10240
    s_add_u32 s40, s40, s41
    s_mul_i32 s41, s61, 640
    s_add_u32 s40, s40, s41
    s_mov_b32 s43, 1280
    s_mov_b32 s45, 128
    s_waitcnt lgkmcnt(0)
    s_mov_b32 s12, s28
    s_mov_b32 s13, s29
L_inte_issue_7:
    v_lshrrev_b32 v1, s44, v0
    v_lshlrev_b32 v2, s44, v1
    v_sub_u32 v2, v0, v2
    v_mul_lo_u32 v1, v1, s43
    v_lshl_add_u32 v1, v2, 4, v1
    s_add_u32 m0, s42, 0
    s_nop 0
    buffer_load_dwordx4 v1, s[12:15], s40 offen lds
    s_add_u32 m0, s42, 1024
    s_add_u32 s40, s40, s45
    buffer_load_dwordx4 v1, s[12:15], s40 offen lds
    s_add_u32 m0, s42, 2048
    s_add_u32 s40, s40, s45
    buffer_load_dwordx4 v1, s[12:15], s40 offen lds
    s_add_u32 m0, s42, 3072
    s_add_u32 s40, s40, s45
    buffer_load_dwordx4 v1, s[12:15], s40 offen lds
    s_add_u32 m0, s42, 4096
    s_add_u32 s40, s40, s45
    buffer_load_dwordx4 v1, s[12:15], s40 offen lds
    s_add_u32 s41, s62, -1
    s_cmp_lt_u32 s41, 2
    s_cbranch_scc0 L_inte_none_9
    s_add_u32 m0, s42, 5120
    s_add_u32 s40, s40, s45
    buffer_load_dwordx4 v1, s[12:15], s40 offen lds
    s_add_u32 m0, s42, 6144
    s_add_u32 s40, s40, s45
    buffer_load_dwordx4 v1, s[12:15], s40 offen lds
    s_add_u32 m0, s42, 7168
    s_add_u32 s40, s40, s45
    buffer_load_dwordx4 v1, s[12:15], s40 offen lds
    s_add_u32 m0, s42, 8192
    s_add_u32 s40, s40, s45
    buffer_load_dwordx4 v1, s[12:15], s40 offen lds
    s_add_u32 m0, s42, 9216
    s_add_u32 s40, s40, s45
    buffer_load_dwordx4 v1, s[12:15], s40 offen lds
L_inte_none_9:
    s_waitcnt lgkmcnt(0)
    s_mov_b32 s8, s36
    s_mov_b32 s9, s37
    s_mov_b32 s10, 0x2720000
    s_mov_b32 s11, 0x00020000
    s_cmp_eq_u32 s62, 0
    s_cbranch_scc0 L_inte_j1_10
    s_lshl_b32 s41, s3, 2
    v_lshlrev_b32 v4, 4, v0
    s_lshl_b32 s50, s3, 10
    v_add_u32 v6, s50, v4
    v_add_u32 v6, 0x0, v6
    v_mov_b32 v7, 0
    v_lshl_add_u64 v[6:7], v[6:7], 0, s[6:7]
    s_mov_b32 s52, 4096
    s_mov_b32 s53, 0
    s_add_u32 m0, s50, 49152
    s_nop 0
    global_load_lds_dwordx4 v[6:7], off
    s_add_u32 m0, s50, 53248
    v_lshl_add_u64 v[6:7], v[6:7], 0, s[52:53]
    global_load_lds_dwordx4 v[6:7], off
    s_add_u32 m0, s50, 57344
    v_lshl_add_u64 v[6:7], v[6:7], 0, s[52:53]
    global_load_lds_dwordx4 v[6:7], off
    s_add_u32 m0, s50, 61440
    v_lshl_add_u64 v[6:7], v[6:7], 0, s[52:53]
    global_load_lds_dwordx4 v[6:7], off
    v_and_b32 v1, 3, v0
    v_lshrrev_b32 v2, 4, v0
    v_bfe_u32 v3, v0, 2, 2
    v_mul_u32_u24 v11, 80, v3
    v_lshl_add_u32 v11, v2, 2, v11
    v_lshl_add_u32 v10, v1, 8, s42
    v_add_u32 v9, 0, v11
    v_lshrrev_b32 v8, 7, v9
    v_and_b32 v9, 127, v9
    v_lshl_add_u32 v64, v8, 10, v10
    v_lshl_add_u32 v64, v9, 1, v64
    v_add_u32 v9, 320, v11
    v_lshrrev_b32 v8, 7, v9
    v_and_b32 v9, 127, v9
    v_lshl_add_u32 v65, v8, 10, v10
    v_lshl_add_u32 v65, v9, 1, v65
    v_add_u32 v9, 16, v11
    v_lshrrev_b32 v8, 7, v9
    v_and_b32 v9, 127, v9
    v_lshl_add_u32 v66, v8, 10, v10
    v_lshl_add_u32 v66, v9, 1, v66
    v_add_u32 v9, 336, v11
    v_lshrrev_b32 v8, 7, v9
    v_and_b32 v9, 127, v9
    v_lshl_add_u32 v67, v8, 10, v10
    v_lshl_add_u32 v67, v9, 1, v67
    v_add_u32 v9, 32, v11
    v_lshrrev_b32 v8, 7, v9
    v_and_b32 v9, 127, v9
    v_lshl_add_u32 v68, v8, 10, v10
    v_lshl_add_u32 v68, v9, 1, v68
    v_add_u32 v9, 352, v11
    v_lshrrev_b32 v8, 7, v9
    v_and_b32 v9, 127, v9
    v_lshl_add_u32 v69, v8, 10, v10
    v_lshl_add_u32 v69, v9, 1, v69
    v_add_u32 v9, 48, v11
    v_lshrrev_b32 v8, 7, v9
    v_and_b32 v9, 127, v9
    v_lshl_add_u32 v70, v8, 10, v10
    v_lshl_add_u32 v70, v9, 1, v70
    v_add_u32 v9, 368, v11
    v_lshrrev_b32 v8, 7, v9
    v_and_b32 v9, 127, v9
    v_lshl_add_u32 v71, v8, 10, v10
    v_lshl_add_u32 v71, v9, 1, v71
    v_add_u32 v9, 64, v11
    v_lshrrev_b32 v8, 7, v9
    v_and_b32 v9, 127, v9
    v_lshl_add_u32 v72, v8, 10, v10
    v_lshl_add_u32 v72, v9, 1, v72
    v_add_u32 v9, 384, v11
    v_lshrrev_b32 v8, 7, v9
    v_and_b32 v9, 127, v9
    v_lshl_add_u32 v73, v8, 10, v10
    v_lshl_add_u32 v73, v9, 1, v73
    v_lshl_add_u32 v12, v2, 2, v1
    v_add_u32 v13, s41, v3
    v_mul_u32_u24 v14, 288, v12
    v_lshl_add_u32 v14, v13, 4, v14
    v_add_u32 v14, 20480, v14
    v_lshlrev_b32 v15, 9, v12
    v_lshl_add_u32 v15, v13, 4, v15
    s_lshr_b32 s44, s60, 1
    s_mul_i32 s44, s44, 40960
    s_and_b32 s45, s60, 1
    s_lshl_b32 s45, s45, 8
    s_add_u32 s44, s44, s45
    s_add_u32 s44, s44, 0x0
    v_and_b32 v1, 15, v0
    v_lshlrev_b32 v1, 4, v1
    s_mul_i32 s47, s3, 576
    s_add_u32 s47, s47, 20480
    v_mul_u32_u24 v5, 2304, v2
    v_add3_u32 v5, v5, v1, s47
    v_lshrrev_b32 v3, 5, v0
    v_mul_u32_u24 v6, 2304, v3
    v_bfe_u32 v3, v0, 4, 1
    v_lshl_add_u32 v6, v3, 3, v6
    v_add3_u32 v6, v6, v1, s47
    v_bfe_u32 v7, v0, 1, 3
    v_lshlrev_b32 v7, 16, v7
    v_and_b32 v8, 1, v0
    v_lshl_add_u32 v7, v8, 5, v7
    v_lshrrev_b32 v8, 4, v0
    v_lshl_add_u32 v7, v8, 3, v7
    s_lshl_b32 s48, s3, 8
    s_add_u32 s48, s48, s60
    s_lshl_b32 s48, s48, 6
    s_add_u32 s48, s48, 0xa00000
    s_waitcnt vmcnt(4)
    ds_read_b64_tr_b16 v[20:21], v64
    ds_read_b64_tr_b16 v[22:23], v65
    ds_read_b64_tr_b16 v[24:25], v66
    ds_read_b64_tr_b16 v[26:27], v67
    ds_read_b64_tr_b16 v[28:29], v68
    ds_read_b64_tr_b16 v[30:31], v69
    ds_read_b64_tr_b16 v[32:33], v70
    ds_read_b64_tr_b16 v[34:35], v71
    ds_read_b64_tr_b16 v[36:37], v72
    ds_read_b64_tr_b16 v[38:39], v73
    v_mov_b32 v16, 0
    v_mov_b32 v17, 0
    s_mov_b32 s46, 0x3f803f80
    s_waitcnt lgkmcnt(8)
    ds_write_b128 v14, v[20:23] offset:0
    s_waitcnt lgkmcnt(7)
    ds_write_b128 v14, v[24:27] offset:4608
    s_waitcnt lgkmcnt(6)
    ds_write_b128 v14, v[28:31] offset:9216
    s_waitcnt lgkmcnt(5)
    ds_write_b128 v14, v[32:35] offset:13824
    s_waitcnt lgkmcnt(4)
    ds_write_b128 v14, v[36:39] offset:18432
    v_dot2c_f32_bf16 v16, s46, v20
    v_dot2c_f32_bf16 v17, v20, v20
    v_dot2c_f32_bf16 v16, s46, v21
    v_dot2c_f32_bf16 v17, v21, v21
    v_dot2c_f32_bf16 v16, s46, v22
    v_dot2c_f32_bf16 v17, v22, v22
    v_dot2c_f32_bf16 v16, s46, v23
    v_dot2c_f32_bf16 v17, v23, v23
    v_dot2c_f32_bf16 v16, s46, v24
    v_dot2c_f32_bf16 v17, v24, v24
    v_dot2c_f32_bf16 v16, s46, v25
    v_dot2c_f32_bf16 v17, v25, v25
    v_dot2c_f32_bf16 v16, s46, v26
    v_dot2c_f32_bf16 v17, v26, v26
    v_dot2c_f32_bf16 v16, s46, v27
    v_dot2c_f32_bf16 v17, v27, v27
    v_dot2c_f32_bf16 v16, s46, v28
    v_dot2c_f32_bf16 v17, v28, v28
    v_dot2c_f32_bf16 v16, s46, v29
    v_dot2c_f32_bf16 v17, v29, v29
    v_dot2c_f32_bf16 v16, s46, v30
    v_dot2c_f32_bf16 v17, v30, v30
    v_dot2c_f32_bf16 v16, s46, v31
    v_dot2c_f32_bf16 v17, v31, v31
    v_dot2c_f32_bf16 v16, s46, v32
    v_dot2c_f32_bf16 v17, v32, v32
    v_dot2c_f32_bf16 v16, s46, v33
    v_dot2c_f32_bf16 v17, v33, v33
    v_dot2c_f32_bf16 v16, s46, v34
    v_dot2c_f32_bf16 v17, v34, v34
    v_dot2c_f32_bf16 v16, s46, v35
    v_dot2c_f32_bf16 v17, v35, v35
    v_dot2c_f32_bf16 v16, s46, v36
    v_dot2c_f32_bf16 v17, v36, v36
    v_dot2c_f32_bf16 v16, s46, v37
    v_dot2c_f32_bf16 v17, v37, v37
    v_dot2c_f32_bf16 v16, s46, v38
    v_dot2c_f32_bf16 v17, v38, v38
    v_dot2c_f32_bf16 v16, s46, v39
    v_dot2c_f32_bf16 v17, v39, v39
    s_nop 1
    v_add_f32_dpp v16, v16, v16 quad_perm:[1,0,3,2] row_mask:0xf bank_mask:0xf
    v_add_f32_dpp v17, v17, v17 quad_perm:[1,0,3,2] row_mask:0xf bank_mask:0xf
    s_nop 0
    v_add_f32_dpp v16, v16, v16 quad_perm:[2,3,0,1] row_mask:0xf bank_mask:0xf
    v_add_f32_dpp v17, v17, v17 quad_perm:[2,3,0,1] row_mask:0xf bank_mask:0xf
    v_mov_b32 v60, v16
    v_mov_b32 v61, v17
    s_nop 0
    v_permlane16_swap_b32 v16, v60
    v_permlane16_swap_b32 v17, v61
    v_add_f32 v16, v16, v60
    v_add_f32 v17, v17, v61
    v_mov_b32 v60, v16
    v_mov_b32 v61, v17
    s_nop 0
    v_permlane32_swap_b32 v16, v60
    v_permlane32_swap_b32 v17, v61
    v_add_f32 v16, v16, v60
    v_add_f32 v17, v17, v61
    v_mul_f32 v16, 0x3acccccd, v16
    v_mul_f32 v17, 0x3acccccd, v17
    v_fma_f32 v17, -v16, v16, v17
    v_max_f32 v17, 0, v17
    v_add_f32 v17, 0x3727c5ac, v17
    v_rsq_f32 v17, v17
    v_lshlrev_b32 v13, 2, v13
    ds_write_b32 v13, v16 offset:45120
    ds_write_b32 v13, v17 offset:45056
    s_waitcnt vmcnt(0) lgkmcnt(0)
    s_barrier
    ds_read_b128 v[40:43], v5 offset:0
    ds_read_b128 v[44:47], v5 offset:9216
    ds_read_b64 v[48:49], v6 offset:18432
    ds_read_b128 v[50:53], v5 offset:288
    ds_read_b128 v[54:57], v5 offset:9504
    ds_read_b64 v[58:59], v6 offset:18720
    ds_read_b128 v[80:83], v4 offset:49152
    ds_read_b128 v[88:91], v4 offset:51200
    ds_read_b128 v[96:99], v4 offset:53248
    ds_read_b128 v[104:107], v4 offset:55296
    ds_read_b128 v[112:115], v4 offset:57344
    ds_read_b128 v[84:87], v4 offset:50176
    ds_read_b128 v[92:95], v4 offset:52224
    ds_read_b128 v[100:103], v4 offset:54272
    ds_read_b128 v[108:111], v4 offset:56320
    ds_read_b128 v[116:119], v4 offset:58368
    ds_read_b128 v[120:123], v4 offset:59392
    ds_read_b128 v[124:127], v4 offset:60416
    ds_read_b128 v[128:131], v4 offset:61440
    v_lshlrev_b32 v2, 4, v2
    ds_read_b128 v[60:63], v2 offset:45056
    ds_read_b128 v[64:67], v2 offset:45120
    v_and_b32 v68, 15, v0
    v_cmp_eq_u32 vcc, 0, v68
    v_mov_b32 v69, 0xc2a00000
    s_nop 0
    v_cndmask_b32 v68, 0, v69, vcc
    s_waitcnt lgkmcnt(14)
    v_mfma_f32_16x16x32_bf16 v[140:143], v[40:43], v[80:83], 0
    s_waitcnt lgkmcnt(13)
    v_mfma_f32_16x16x32_bf16 v[144:147], v[40:43], v[88:91], 0
    s_waitcnt lgkmcnt(12)
    v_mfma_f32_16x16x32_bf16 v[148:151], v[40:43], v[96:99], 0
    s_waitcnt lgkmcnt(11)
    v_mfma_f32_16x16x32_bf16 v[152:155], v[40:43], v[104:107], 0
    s_waitcnt lgkmcnt(10)
    v_mfma_f32_16x16x32_bf16 v[156:159], v[40:43], v[112:115], 0
    s_waitcnt lgkmcnt(9)
    v_mfma_f32_16x16x32_bf16 v[140:143], v[44:47], v[84:87], v[140:143]
    s_waitcnt lgkmcnt(8)
    v_mfma_f32_16x16x32_bf16 v[144:147], v[44:47], v[92:95], v[144:147]
    s_waitcnt lgkmcnt(7)
    v_mfma_f32_16x16x32_bf16 v[148:151], v[44:47], v[100:103], v[148:151]
    s_waitcnt lgkmcnt(6)
    v_mfma_f32_16x16x32_bf16 v[152:155], v[44:47], v[108:111], v[152:155]
    s_waitcnt lgkmcnt(5)
    v_mfma_f32_16x16x32_bf16 v[156:159], v[44:47], v[116:119], v[156:159]
    s_waitcnt lgkmcnt(4)
    v_mfma_f32_16x16x16_bf16 v[140:143], v[48:49], v[120:121], v[140:143]
    v_mfma_f32_16x16x16_bf16 v[144:147], v[48:49], v[122:123], v[144:147]
    s_waitcnt lgkmcnt(3)
    v_mfma_f32_16x16x16_bf16 v[148:151], v[48:49], v[124:125], v[148:151]
    v_mfma_f32_16x16x16_bf16 v[152:155], v[48:49], v[126:127], v[152:155]
    s_waitcnt lgkmcnt(2)
    v_mfma_f32_16x16x16_bf16 v[156:159], v[48:49], v[128:129], v[156:159]
    v_mfma_f32_16x16x32_bf16 v[160:163], v[50:53], v[80:83], 0
    v_mfma_f32_16x16x32_bf16 v[164:167], v[50:53], v[88:91], 0
    v_mfma_f32_16x16x32_bf16 v[168:171], v[50:53], v[96:99], 0
    v_mfma_f32_16x16x32_bf16 v[172:175], v[50:53], v[104:107], 0
    v_mfma_f32_16x16x32_bf16 v[176:179], v[50:53], v[112:115], 0
    v_mfma_f32_16x16x32_bf16 v[160:163], v[54:57], v[84:87], v[160:163]
    v_mfma_f32_16x16x32_bf16 v[164:167], v[54:57], v[92:95], v[164:167]
    v_mfma_f32_16x16x32_bf16 v[168:171], v[54:57], v[100:103], v[168:171]
    v_mfma_f32_16x16x32_bf16 v[172:175], v[54:57], v[108:111], v[172:175]
    v_mfma_f32_16x16x32_bf16 v[176:179], v[54:57], v[116:119], v[176:179]
    v_mfma_f32_16x16x16_bf16 v[160:163], v[58:59], v[120:121], v[160:163]
    v_mfma_f32_16x16x16_bf16 v[164:167], v[58:59], v[122:123], v[164:167]
    v_mfma_f32_16x16x16_bf16 v[168:171], v[58:59], v[124:125], v[168:171]
    v_mfma_f32_16x16x16_bf16 v[172:175], v[58:59], v[126:127], v[172:175]
    v_mfma_f32_16x16x16_bf16 v[176:179], v[58:59], v[128:129], v[176:179]
    s_waitcnt lgkmcnt(0)
    v_pk_fma_f32 v[140:141], v[64:65], v[68:69], v[140:141] op_sel_hi:[1,0,1]
    v_pk_fma_f32 v[142:143], v[66:67], v[68:69], v[142:143] op_sel_hi:[1,0,1]
    v_pk_mul_f32 v[140:141], v[140:141], v[60:61]
    v_pk_mul_f32 v[142:143], v[142:143], v[62:63]
    v_pk_mul_f32 v[144:145], v[144:145], v[60:61]
    v_pk_mul_f32 v[146:147], v[146:147], v[62:63]
    v_pk_mul_f32 v[148:149], v[148:149], v[60:61]
    v_pk_mul_f32 v[150:151], v[150:151], v[62:63]
    v_pk_mul_f32 v[152:153], v[152:153], v[60:61]
    v_pk_mul_f32 v[154:155], v[154:155], v[62:63]
    v_pk_mul_f32 v[156:157], v[156:157], v[60:61]
    v_pk_mul_f32 v[158:159], v[158:159], v[62:63]
    v_cvt_pk_bf16_f32 v140, v140, v141
    v_cvt_pk_bf16_f32 v141, v142, v143
    buffer_store_dwordx2 v[140:141], v7, s[8:11], s48 offen sc1
    v_cvt_pk_bf16_f32 v144, v144, v145
    v_cvt_pk_bf16_f32 v145, v146, v147
    s_add_u32 s49, s48, 0x80000
    buffer_store_dwordx2 v[144:145], v7, s[8:11], s49 offen sc1
    v_cvt_pk_bf16_f32 v148, v148, v149
    v_cvt_pk_bf16_f32 v149, v150, v151
    s_add_u32 s49, s48, 0x100000
    buffer_store_dwordx2 v[148:149], v7, s[8:11], s49 offen sc1
    v_cvt_pk_bf16_f32 v152, v152, v153
    v_cvt_pk_bf16_f32 v153, v154, v155
    s_add_u32 s49, s48, 0x180000
    buffer_store_dwordx2 v[152:153], v7, s[8:11], s49 offen sc1
    v_cvt_pk_bf16_f32 v156, v156, v157
    v_cvt_pk_bf16_f32 v157, v158, v159
    s_add_u32 s49, s48, 0x200000
    buffer_store_dwordx2 v[156:157], v7, s[8:11], s49 offen sc1
    s_add_u32 s48, s48, 8192
    v_pk_fma_f32 v[160:161], v[64:65], v[68:69], v[160:161] op_sel_hi:[1,0,1]
    v_pk_fma_f32 v[162:163], v[66:67], v[68:69], v[162:163] op_sel_hi:[1,0,1]
    v_pk_mul_f32 v[160:161], v[160:161], v[60:61]
    v_pk_mul_f32 v[162:163], v[162:163], v[62:63]
    v_pk_mul_f32 v[164:165], v[164:165], v[60:61]
    v_pk_mul_f32 v[166:167], v[166:167], v[62:63]
    v_pk_mul_f32 v[168:169], v[168:169], v[60:61]
    v_pk_mul_f32 v[170:171], v[170:171], v[62:63]
    v_pk_mul_f32 v[172:173], v[172:173], v[60:61]
    v_pk_mul_f32 v[174:175], v[174:175], v[62:63]
    v_pk_mul_f32 v[176:177], v[176:177], v[60:61]
    v_pk_mul_f32 v[178:179], v[178:179], v[62:63]
    v_cvt_pk_bf16_f32 v160, v160, v161
    v_cvt_pk_bf16_f32 v161, v162, v163
    buffer_store_dwordx2 v[160:161], v7, s[8:11], s48 offen sc1
    v_cvt_pk_bf16_f32 v164, v164, v165
    v_cvt_pk_bf16_f32 v165, v166, v167
    s_add_u32 s49, s48, 0x80000
    buffer_store_dwordx2 v[164:165], v7, s[8:11], s49 offen sc1
    v_cvt_pk_bf16_f32 v168, v168, v169
    v_cvt_pk_bf16_f32 v169, v170, v171
    s_add_u32 s49, s48, 0x100000
    buffer_store_dwordx2 v[168:169], v7, s[8:11], s49 offen sc1
    v_cvt_pk_bf16_f32 v172, v172, v173
    v_cvt_pk_bf16_f32 v173, v174, v175
    s_add_u32 s49, s48, 0x180000
    buffer_store_dwordx2 v[172:173], v7, s[8:11], s49 offen sc1
    v_cvt_pk_bf16_f32 v176, v176, v177
    v_cvt_pk_bf16_f32 v177, v178, v179
    s_add_u32 s49, s48, 0x200000
    buffer_store_dwordx2 v[176:177], v7, s[8:11], s49 offen sc1
    buffer_store_dwordx4 v[20:23], v15, s[8:11], s44 offen sc1
    s_add_u32 s44, s44, 8192
    buffer_store_dwordx4 v[24:27], v15, s[8:11], s44 offen sc1
    s_add_u32 s44, s44, 8192
    buffer_store_dwordx4 v[28:31], v15, s[8:11], s44 offen sc1
    s_add_u32 s44, s44, 8192
    buffer_store_dwordx4 v[32:35], v15, s[8:11], s44 offen sc1
    s_add_u32 s44, s44, 8192
    buffer_store_dwordx4 v[36:39], v15, s[8:11], s44 offen sc1
    s_nop 1
    s_branch L_inte_join_14
L_inte_j1_10:
    s_sub_u32 s53, s5, 16
    s_lshl_b32 s53, s53, 2
    s_add_u32 s53, s53, s3
    s_lshl_b32 s53, s53, 12
    s_cmp_lt_u32 s53, dft_end-interleave_layers__spectral_fnet__dense_activation_squared_relu__prompt_kernel-4096
    s_cbranch_scc0 L_inte_notouch_15
    s_sub_u32 s54, s6, dft_tables-interleave_layers__spectral_fnet__dense_activation_squared_relu__prompt_kernel
    s_subb_u32 s55, s7, 0
    v_lshl_add_u32 v2, v0, 6, s53
    v_mov_b32 v3, 0
    v_lshl_add_u64 v[2:3], v[2:3], 0, s[54:55]
    global_load_dword v255, v[2:3], off
L_inte_notouch_15:
    s_cmp_eq_u32 s62, 1
    s_cbranch_scc0 L_inte_j2_11
    s_mov_b32 s16, s26
    s_mov_b32 s17, s27
    s_mov_b32 s18, 0xd80
    s_mov_b32 s19, 0x00020000
    s_lshr_b32 s39, s60, 1
    s_and_b32 s47, s60, 1
    s_lshl_b32 s41, s39, 7
    v_lshrrev_b32 v2, 4, v0
    v_and_b32 v3, 3, v0
    v_bfe_u32 v4, v0, 2, 2
    s_lshr_b32 s43, s3, 1
    s_and_b32 s44, s3, 1
    s_lshl_b32 s45, s43, 5
    s_lshl_b32 s46, s44, 2
    s_add_u32 s45, s45, s46
    s_mov_b32 s46, 8
    v_lshlrev_b32 v11, 4, v0
    s_sub_u32 s52, s39, 16
    s_lshl_b32 s52, s52, 1
    s_add_u32 s52, s52, s43
    s_lshl_b32 s53, s43, 1
    s_cmp_lt_u32 s39, 16
    s_cselect_b32 s52, s39, s52
    s_cselect_b32 s53, s53, 4
    s_add_u32 s53, s53, s44
    s_mul_i32 s52, s52, 151552
    s_add_u32 s52, s52, 0x1c80000
    s_mul_i32 s54, s53, 20480
    s_add_u32 s54, s54, s52
    s_add_u32 s54, s54, 27648
    s_lshl_b32 s55, s53, 10
    s_add_u32 s55, s55, s52
    s_add_u32 s55, s55, 1024
    s_cmp_lt_u32 s39, 24
    s_cbranch_scc1 L_inte_ready_17
    s_lshl_b32 s45, s3, 4
    s_mov_b32 s46, 4
    s_sub_u32 s53, s39, 24
    s_lshl_b32 s53, s53, 2
    s_add_u32 s53, s53, s3
    s_lshl_b32 s53, s53, 2
    v_add_u32 v5, s53, v4
    v_mul_u32_u24 v6, 43, v5
    v_lshrrev_b32 v6, 7, v6
    v_mul_u32_u24 v7, 3, v6
    v_sub_u32 v5, v5, v7
    s_mov_b32 s53, 151552
    v_mul_lo_u32 v6, v6, s53
    v_lshl_add_u32 v5, v5, 2, v3
    v_lshl_add_u32 v5, v2, 4, v5
    v_lshl_add_u32 v11, v5, 4, v6
    s_mov_b32 s54, 0x1c81c00
    s_mov_b32 s55, 0x1c80000
    s_nop 2
L_inte_ready_17:
    s_mul_i32 s53, s47, 10240
    s_add_u32 s54, s54, s53
    v_mul_lo_u32 v5, v3, s46
    v_add_lshl_u32 v5, v5, s45, 1
    v_lshl_add_u32 v10, v2, 10, v5
    v_lshl_add_u32 v10, v4, 7, v10
    v_mul_lo_u32 v5, v4, s46
    v_add_u32 v5, s45, v5
    v_add_lshl_u32 v5, v5, v3, 1
    buffer_load_ushort v18, v5, s[16:19], s41 offen
    s_lshl_b32 s53, s3, 2
    v_add_u32 v5, s53, v2
    v_lshlrev_b32 v6, 10, v5
    v_lshl_add_u32 v6, v4, 8, v6
    v_lshl_add_u32 v6, v3, 4, v6
    v_cmp_gt_u32 vcc, 10, v5
    v_mov_b32 v7, 0x7f000000
    s_nop 0
    v_cndmask_b32 v6, v7, v6, vcc
    s_mul_i32 s53, s47, 10240
    s_add_u32 s53, s53, s52
    s_add_u32 s53, s53, 7360
    s_cmp_lt_u32 s39, 16
    s_cselect_b32 s53, s53, 0x7f000000
    v_mov_b32 v64, 0x3f803f80
    v_mov_b32 v65, 0x3f803f80
    v_mov_b32 v66, 0x3f803f80
    v_mov_b32 v67, 0x3f803f80
    buffer_store_dwordx4 v[64:67], v6, s[8:11], s53 offen sc1
    v_mov_b32 v16, 0
    v_mov_b32 v17, 0
    s_mov_b32 s53, 0x3f803f80
    s_waitcnt vmcnt(2)
    s_barrier
    ds_read_b64_tr_b16 v[20:21], v10 offset:0
    ds_read_b64_tr_b16 v[22:23], v10 offset:512
    ds_read_b64_tr_b16 v[24:25], v10 offset:4096
    ds_read_b64_tr_b16 v[26:27], v10 offset:4608
    ds_read_b64_tr_b16 v[28:29], v10 offset:8192
    ds_read_b64_tr_b16 v[30:31], v10 offset:8704
    ds_read_b64_tr_b16 v[32:33], v10 offset:12288
    ds_read_b64_tr_b16 v[34:35], v10 offset:12800
    ds_read_b64_tr_b16 v[36:37], v10 offset:16384
    ds_read_b64_tr_b16 v[38:39], v10 offset:16896
    ds_read_b64_tr_b16 v[40:41], v10 offset:20480
    ds_read_b64_tr_b16 v[42:43], v10 offset:20992
    ds_read_b64_tr_b16 v[44:45], v10 offset:24576
    ds_read_b64_tr_b16 v[46:47], v10 offset:25088
    ds_read_b64_tr_b16 v[48:49], v10 offset:28672
    ds_read_b64_tr_b16 v[50:51], v10 offset:29184
    ds_read_b64_tr_b16 v[52:53], v10 offset:32768
    ds_read_b64_tr_b16 v[54:55], v10 offset:33280
    ds_read_b64_tr_b16 v[56:57], v10 offset:36864
    ds_read_b64_tr_b16 v[58:59], v10 offset:37376
    s_waitcnt lgkmcnt(15)
    buffer_store_dwordx4 v[20:23], v11, s[8:11], s54 offen offset:0 sc1
    v_dot2c_f32_bf16 v16, s53, v20
    v_dot2c_f32_bf16 v17, s53, v21
    v_dot2c_f32_bf16 v16, s53, v22
    v_dot2c_f32_bf16 v17, s53, v23
    buffer_store_dwordx4 v[24:27], v11, s[8:11], s54 offen offset:1024 sc1
    v_dot2c_f32_bf16 v16, s53, v24
    v_dot2c_f32_bf16 v17, s53, v25
    v_dot2c_f32_bf16 v16, s53, v26
    v_dot2c_f32_bf16 v17, s53, v27
    s_waitcnt lgkmcnt(14)
    buffer_store_dwordx4 v[28:31], v11, s[8:11], s54 offen offset:2048 sc1
    v_dot2c_f32_bf16 v16, s53, v28
    v_dot2c_f32_bf16 v17, s53, v29
    v_dot2c_f32_bf16 v16, s53, v30
    v_dot2c_f32_bf16 v17, s53, v31
    s_waitcnt lgkmcnt(12)
    buffer_store_dwordx4 v[32:35], v11, s[8:11], s54 offen offset:3072 sc1
    v_dot2c_f32_bf16 v16, s53, v32
    v_dot2c_f32_bf16 v17, s53, v33
    v_dot2c_f32_bf16 v16, s53, v34
    v_dot2c_f32_bf16 v17, s53, v35
    s_add_u32 s54, s54, 4096
    s_waitcnt lgkmcnt(10)
    buffer_store_dwordx4 v[36:39], v11, s[8:11], s54 offen offset:0 sc1
    v_dot2c_f32_bf16 v16, s53, v36
    v_dot2c_f32_bf16 v17, s53, v37
    v_dot2c_f32_bf16 v16, s53, v38
    v_dot2c_f32_bf16 v17, s53, v39
    s_waitcnt lgkmcnt(8)
    buffer_store_dwordx4 v[40:43], v11, s[8:11], s54 offen offset:1024 sc1
    v_dot2c_f32_bf16 v16, s53, v40
    v_dot2c_f32_bf16 v17, s53, v41
    v_dot2c_f32_bf16 v16, s53, v42
    v_dot2c_f32_bf16 v17, s53, v43
    s_waitcnt lgkmcnt(6)
    buffer_store_dwordx4 v[44:47], v11, s[8:11], s54 offen offset:2048 sc1
    v_dot2c_f32_bf16 v16, s53, v44
    v_dot2c_f32_bf16 v17, s53, v45
    v_dot2c_f32_bf16 v16, s53, v46
    v_dot2c_f32_bf16 v17, s53, v47
    s_waitcnt lgkmcnt(4)
    buffer_store_dwordx4 v[48:51], v11, s[8:11], s54 offen offset:3072 sc1
    v_dot2c_f32_bf16 v16, s53, v48
    v_dot2c_f32_bf16 v17, s53, v49
    v_dot2c_f32_bf16 v16, s53, v50
    v_dot2c_f32_bf16 v17, s53, v51
    s_add_u32 s54, s54, 4096
    s_waitcnt lgkmcnt(2)
    buffer_store_dwordx4 v[52:55], v11, s[8:11], s54 offen offset:0 sc1
    v_dot2c_f32_bf16 v16, s53, v52
    v_dot2c_f32_bf16 v17, s53, v53
    v_dot2c_f32_bf16 v16, s53, v54
    v_dot2c_f32_bf16 v17, s53, v55
    s_waitcnt lgkmcnt(0)
    buffer_store_dwordx4 v[56:59], v11, s[8:11], s54 offen offset:1024 sc1
    v_dot2c_f32_bf16 v16, s53, v56
    v_dot2c_f32_bf16 v17, s53, v57
    v_dot2c_f32_bf16 v16, s53, v58
    v_dot2c_f32_bf16 v17, s53, v59
    s_nop 2
    v_add_f32 v60, v16, v17
    v_mov_b32 v62, v60
    s_nop 1
    v_permlane16_swap_b32 v60, v62
    v_add_f32 v60, v60, v62
    v_mov_b32 v62, v60
    s_nop 1
    v_permlane32_swap_b32 v60, v62
    v_add_f32 v60, v60, v62
    s_cmp_eq_u32 s47, 0
    s_cselect_b32 s52, -1, 0
    v_cvt_pk_bf16_f32 v61, v60, v60
    v_lshlrev_b32 v62, 16, v61
    v_sub_f32 v62, v60, v62
    s_waitcnt vmcnt(11)
    v_and_b32 v70, s52, v18
    v_lshlrev_b32 v63, 16, v70
    v_cvt_pk_bf16_f32 v68, v60, v62
    v_cvt_pk_bf16_f32 v69, v60, v63
    v_mov_b32 v71, 0
    v_cmp_gt_u32 vcc, 32, v0
    s_nop 1
    v_cndmask_b32 v68, 0, v68, vcc
    v_cndmask_b32 v69, 0, v69, vcc
    v_cndmask_b32 v70, 0, v70, vcc
    s_xor_b32 s52, s52, 0xffff0000
    s_mov_b32 exec_lo, s52
    s_mov_b32 exec_hi, s52
    buffer_store_dwordx4 v[68:71], v11, s[8:11], s55 offen sc1
    s_mov_b64 exec, -1
    s_nop 0
    s_branch L_inte_join_14
L_inte_j2_11:
    s_cmp_eq_u32 s62, 2
    s_cbranch_scc0 L_inte_j3_12
    v_lshrrev_b32 v2, 4, v0
    v_and_b32 v3, 3, v0
    v_bfe_u32 v4, v0, 2, 2
    v_mul_u32_u24 v5, 80, v2
    v_lshl_add_u32 v5, v3, 2, v5
    v_lshl_add_u32 v10, v4, 7, s42
    v_add_u32 v9, 0, v5
    v_lshrrev_b32 v8, 6, v9
    v_and_b32 v9, 63, v9
    v_lshl_add_u32 v70, v8, 10, v10
    v_lshl_add_u32 v70, v9, 1, v70
    v_add_u32 v9, 16, v5
    v_lshrrev_b32 v8, 6, v9
    v_and_b32 v9, 63, v9
    v_lshl_add_u32 v71, v8, 10, v10
    v_lshl_add_u32 v71, v9, 1, v71
    v_add_u32 v9, 32, v5
    v_lshrrev_b32 v8, 6, v9
    v_and_b32 v9, 63, v9
    v_lshl_add_u32 v72, v8, 10, v10
    v_lshl_add_u32 v72, v9, 1, v72
    v_add_u32 v9, 48, v5
    v_lshrrev_b32 v8, 6, v9
    v_and_b32 v9, 63, v9
    v_lshl_add_u32 v73, v8, 10, v10
    v_lshl_add_u32 v73, v9, 1, v73
    v_add_u32 v9, 64, v5
    v_lshrrev_b32 v8, 6, v9
    v_and_b32 v9, 63, v9
    v_lshl_add_u32 v74, v8, 10, v10
    v_lshl_add_u32 v74, v9, 1, v74
    v_add_u32 v9, 320, v5
    v_lshrrev_b32 v8, 6, v9
    v_and_b32 v9, 63, v9
    v_lshl_add_u32 v75, v8, 10, v10
    v_lshl_add_u32 v75, v9, 1, v75
    v_add_u32 v9, 336, v5
    v_lshrrev_b32 v8, 6, v9
    v_and_b32 v9, 63, v9
    v_lshl_add_u32 v76, v8, 10, v10
    v_lshl_add_u32 v76, v9, 1, v76
    v_add_u32 v9, 352, v5
    v_lshrrev_b32 v8, 6, v9
    v_and_b32 v9, 63, v9
    v_lshl_add_u32 v77, v8, 10, v10
    v_lshl_add_u32 v77, v9, 1, v77
    v_add_u32 v9, 368, v5
    v_lshrrev_b32 v8, 6, v9
    v_and_b32 v9, 63, v9
    v_lshl_add_u32 v78, v8, 10, v10
    v_lshl_add_u32 v78, v9, 1, v78
    v_add_u32 v9, 384, v5
    v_lshrrev_b32 v8, 6, v9
    v_and_b32 v9, 63, v9
    v_lshl_add_u32 v79, v8, 10, v10
    v_lshl_add_u32 v79, v9, 1, v79
    s_mov_b32 s43, 276480
    s_lshl_b32 s44, s3, 8
    v_bfe_u32 v6, v0, 3, 1
    v_and_b32 v7, 7, v0
    v_mul_lo_u32 v7, v7, s43
    v_add_u32 v7, s44, v7
    v_lshl_add_u32 v7, v2, 4, v7
    v_lshl_add_u32 v11, v6, 6, v7
    v_lshl_add_u32 v12, v6, 7, v7
    v_add_u32 v12, 4096, v12
    v_mul_lo_u32 v8, v2, s43
    v_add_u32 v8, s44, v8
    v_bfe_u32 v5, v0, 2, 1
    v_lshl_add_u32 v68, v5, 10, v8
    v_lshl_add_u32 v68, v6, 6, v68
    v_lshl_add_u32 v68, v3, 4, v68
    v_and_b32 v5, 15, v0
    v_lshl_add_u32 v69, v5, 4, v8
    v_add_u32 v69, 4096, v69
    s_mul_i32 s45, s60, 5120
    s_add_u32 s46, s45, 0x1f00000
    s_add_u32 s47, s45, 0x2120000
    s_add_u32 s48, s45, 0x222e000
    s_waitcnt vmcnt(0)
    ds_read_b64_tr_b16 v[24:25], v70 offset:0
    ds_read_b64_tr_b16 v[26:27], v70 offset:512
    ds_read_b64_tr_b16 v[28:29], v71 offset:0
    ds_read_b64_tr_b16 v[30:31], v71 offset:512
    ds_read_b64_tr_b16 v[32:33], v72 offset:0
    ds_read_b64_tr_b16 v[34:35], v72 offset:512
    ds_read_b64_tr_b16 v[36:37], v73 offset:0
    ds_read_b64_tr_b16 v[38:39], v73 offset:512
    ds_read_b64_tr_b16 v[40:41], v74 offset:0
    ds_read_b64_tr_b16 v[42:43], v74 offset:512
    ds_read_b64_tr_b16 v[44:45], v75 offset:0
    ds_read_b64_tr_b16 v[46:47], v75 offset:512
    ds_read_b64_tr_b16 v[48:49], v76 offset:0
    ds_read_b64_tr_b16 v[50:51], v76 offset:512
    ds_read_b64_tr_b16 v[52:53], v77 offset:0
    ds_read_b64_tr_b16 v[54:55], v77 offset:512
    ds_read_b64_tr_b16 v[56:57], v78 offset:0
    ds_read_b64_tr_b16 v[58:59], v78 offset:512
    ds_read_b64_tr_b16 v[60:61], v79 offset:0
    ds_read_b64_tr_b16 v[62:63], v79 offset:512
    s_waitcnt lgkmcnt(15)
    buffer_store_dwordx4 v[24:27], v11, s[8:11], s46 offen offset:0 sc1
    buffer_store_dwordx4 v[28:31], v11, s[8:11], s46 offen offset:128 sc1
    s_waitcnt lgkmcnt(14)
    buffer_store_dwordx4 v[32:35], v11, s[8:11], s46 offen offset:2048 sc1
    s_waitcnt lgkmcnt(12)
    buffer_store_dwordx4 v[36:39], v11, s[8:11], s46 offen offset:2176 sc1
    s_waitcnt lgkmcnt(10)
    buffer_store_dwordx4 v[40:43], v12, s[8:11], s46 offen offset:0 sc1
    s_waitcnt lgkmcnt(8)
    buffer_store_dwordx4 v[44:47], v11, s[8:11], s46 offen offset:1024 sc1
    s_waitcnt lgkmcnt(6)
    buffer_store_dwordx4 v[48:51], v11, s[8:11], s46 offen offset:1152 sc1
    s_waitcnt lgkmcnt(4)
    buffer_store_dwordx4 v[52:55], v11, s[8:11], s46 offen offset:3072 sc1
    s_waitcnt lgkmcnt(2)
    buffer_store_dwordx4 v[56:59], v11, s[8:11], s46 offen offset:3200 sc1
    s_waitcnt lgkmcnt(0)
    buffer_store_dwordx4 v[60:63], v12, s[8:11], s46 offen offset:64 sc1
    s_nop 1
    s_branch L_inte_join_14
L_inte_j3_12:
    s_cmp_eq_u32 s62, 3
    s_cbranch_scc0 L_inte_j4_13
    v_lshrrev_b32 v2, 4, v0
    v_and_b32 v3, 3, v0
    v_bfe_u32 v4, v0, 2, 2
    v_mul_u32_u24 v5, 80, v2
    v_lshl_add_u32 v5, v3, 2, v5
    v_lshl_add_u32 v10, v4, 7, s42
    v_add_u32 v9, 0, v5
    v_lshrrev_b32 v8, 6, v9
    v_and_b32 v9, 63, v9
    v_lshl_add_u32 v70, v8, 10, v10
    v_lshl_add_u32 v70, v9, 1, v70
    v_add_u32 v9, 16, v5
    v_lshrrev_b32 v8, 6, v9
    v_and_b32 v9, 63, v9
    v_lshl_add_u32 v71, v8, 10, v10
    v_lshl_add_u32 v71, v9, 1, v71
    v_add_u32 v9, 32, v5
    v_lshrrev_b32 v8, 6, v9
    v_and_b32 v9, 63, v9
    v_lshl_add_u32 v72, v8, 10, v10
    v_lshl_add_u32 v72, v9, 1, v72
    v_add_u32 v9, 48, v5
    v_lshrrev_b32 v8, 6, v9
    v_and_b32 v9, 63, v9
    v_lshl_add_u32 v73, v8, 10, v10
    v_lshl_add_u32 v73, v9, 1, v73
    v_add_u32 v9, 64, v5
    v_lshrrev_b32 v8, 6, v9
    v_and_b32 v9, 63, v9
    v_lshl_add_u32 v74, v8, 10, v10
    v_lshl_add_u32 v74, v9, 1, v74
    s_mov_b32 s43, 276480
    s_lshl_b32 s44, s3, 8
    v_bfe_u32 v6, v0, 3, 1
    v_and_b32 v7, 7, v0
    v_mul_lo_u32 v7, v7, s43
    v_add_u32 v7, s44, v7
    v_lshl_add_u32 v7, v2, 4, v7
    v_lshl_add_u32 v11, v6, 6, v7
    v_lshl_add_u32 v12, v6, 7, v7
    v_add_u32 v12, 4096, v12
    v_mul_lo_u32 v8, v2, s43
    v_add_u32 v8, s44, v8
    v_bfe_u32 v5, v0, 2, 1
    v_lshl_add_u32 v68, v5, 10, v8
    v_lshl_add_u32 v68, v6, 6, v68
    v_lshl_add_u32 v68, v3, 4, v68
    v_and_b32 v5, 15, v0
    v_lshl_add_u32 v69, v5, 4, v8
    v_add_u32 v69, 4096, v69
    s_mul_i32 s45, s60, 5120
    s_add_u32 s46, s45, 0x1f00000
    s_mul_i32 s47, s61, 1105920
    s_add_u32 s47, s47, s45
    s_add_u32 s47, s47, 0x2120000
    s_lshl_b32 s48, s61, 6
    s_add_u32 s48, s48, s46
    s_lshl_b32 s43, s61, 10
    s_add_u32 s46, s46, s43
    s_waitcnt vmcnt(0)
    ds_read_b64_tr_b16 v[24:25], v70 offset:0
    ds_read_b64_tr_b16 v[26:27], v70 offset:512
    ds_read_b64_tr_b16 v[28:29], v71 offset:0
    ds_read_b64_tr_b16 v[30:31], v71 offset:512
    ds_read_b64_tr_b16 v[32:33], v72 offset:0
    ds_read_b64_tr_b16 v[34:35], v72 offset:512
    ds_read_b64_tr_b16 v[36:37], v73 offset:0
    ds_read_b64_tr_b16 v[38:39], v73 offset:512
    ds_read_b64_tr_b16 v[40:41], v74 offset:0
    ds_read_b64_tr_b16 v[42:43], v74 offset:512
    s_waitcnt lgkmcnt(8)
    buffer_store_dwordx4 v[24:27], v11, s[8:11], s46 offen offset:0 sc1
    s_waitcnt lgkmcnt(6)
    buffer_store_dwordx4 v[28:31], v11, s[8:11], s46 offen offset:128 sc1
    s_waitcnt lgkmcnt(4)
    buffer_store_dwordx4 v[32:35], v11, s[8:11], s46 offen offset:2048 sc1
    s_waitcnt lgkmcnt(2)
    buffer_store_dwordx4 v[36:39], v11, s[8:11], s46 offen offset:2176 sc1
    s_waitcnt lgkmcnt(0)
    buffer_store_dwordx4 v[40:43], v12, s[8:11], s48 offen sc1
    buffer_store_dwordx4 v[24:27], v68, s[8:11], s47 offen offset:0 sc1
    buffer_store_dwordx4 v[28:31], v68, s[8:11], s47 offen offset:128 sc1
    buffer_store_dwordx4 v[32:35], v68, s[8:11], s47 offen offset:2048 sc1
    buffer_store_dwordx4 v[36:39], v68, s[8:11], s47 offen offset:2176 sc1
    buffer_store_dwordx4 v[40:43], v69, s[8:11], s47 offen sc1
    s_nop 1
    s_branch L_inte_join_14
L_inte_j4_13:
    s_lshl_b32 s40, s3, 6
    v_add_u32 v1, s40, v0
    s_nop 4
    s_cmp_eq_u32 s60, 0
    s_cbranch_scc0 L_inte_j1_19
    v_mov_b32 v4, 0
    v_mov_b32 v5, 0
    v_mov_b32 v6, 0
    v_mov_b32 v7, 0
    v_lshlrev_b32 v2, 8, v1
    s_mov_b32 s42, 0x2350000
    buffer_store_dword v4, v2, s[8:11], s42 offen sc1
    v_lshlrev_b32 v2, 4, v1
    s_mov_b32 s42, 0x2344000
    buffer_store_dwordx4 v[4:7], v2, s[8:11], s42 offen sc1
    s_mov_b32 s42, 0x2345000
    buffer_store_dwordx4 v[4:7], v2, s[8:11], s42 offen sc1
    s_mov_b32 s42, 0x2346000
    buffer_store_dwordx4 v[4:7], v2, s[8:11], s42 offen sc1
    s_mov_b32 s42, 0x2347000
    buffer_store_dwordx4 v[4:7], v2, s[8:11], s42 offen sc1
    s_mov_b32 s16, s34
    s_mov_b32 s17, s35
    s_mov_b32 s18, 0x100
    s_mov_b32 s19, 0x00020000
    v_mov_b32 v8, 1
    s_waitcnt vmcnt(0)
    s_barrier
    s_mov_b64 exec, 1
    buffer_store_dword v8, off, s[16:19], 0 sc1
    s_mov_b64 exec, -1
    s_branch L_inte_done_18
L_inte_j1_19:
    s_cmp_eq_u32 s60, 3
    s_cbranch_scc0 L_inte_done_18
    s_mov_b32 s12, s30
    s_mov_b32 s13, s31
    s_mov_b32 s14, 0x500
    s_mov_b32 s15, 0x00020000
    s_mov_b32 s43, 0x2348000
    v_add_u32 v8, 0, v1
    v_mul_u32_u24 v9, 3277, v8
    v_lshrrev_b32 v9, 16, v9
    v_mul_u32_u24 v10, 20, v9
    v_sub_u32 v10, v8, v10
    v_and_b32 v11, 3, v9
    v_bfe_u32 v12, v9, 2, 3
    v_lshrrev_b32 v13, 3, v10
    v_lshl_add_u32 v13, v13, 2, v11
    v_and_b32 v14, 7, v10
    v_lshrrev_b32 v15, 1, v11
    v_add_u32 v15, 8, v15
    v_and_b32 v16, 1, v11
    v_and_b32 v17, 3, v10
    v_lshl_add_u32 v16, v16, 2, v17
    v_cmp_gt_u32 vcc, 16, v10
    s_nop 1
    v_cndmask_b32 v13, v15, v13, vcc
    v_cndmask_b32 v14, v16, v14, vcc
    v_cmp_gt_u32 vcc, 32, v9
    s_nop 1
    v_cndmask_b32 v15, v14, v12, vcc
    v_cndmask_b32 v16, v12, v14, vcc
    v_mul_u32_u24 v16, 80, v16
    v_lshl_add_u32 v16, v13, 3, v16
    v_add_lshl_u32 v16, v16, v15, 1
    buffer_load_ushort v70, v16, s[12:15], 0 offen
    v_add_u32 v8, 256, v1
    v_mul_u32_u24 v9, 3277, v8
    v_lshrrev_b32 v9, 16, v9
    v_mul_u32_u24 v10, 20, v9
    v_sub_u32 v10, v8, v10
    v_and_b32 v11, 3, v9
    v_bfe_u32 v12, v9, 2, 3
    v_lshrrev_b32 v13, 3, v10
    v_lshl_add_u32 v13, v13, 2, v11
    v_and_b32 v14, 7, v10
    v_lshrrev_b32 v15, 1, v11
    v_add_u32 v15, 8, v15
    v_and_b32 v16, 1, v11
    v_and_b32 v17, 3, v10
    v_lshl_add_u32 v16, v16, 2, v17
    v_cmp_gt_u32 vcc, 16, v10
    s_nop 1
    v_cndmask_b32 v13, v15, v13, vcc
    v_cndmask_b32 v14, v16, v14, vcc
    v_cmp_gt_u32 vcc, 32, v9
    s_nop 1
    v_cndmask_b32 v15, v14, v12, vcc
    v_cndmask_b32 v16, v12, v14, vcc
    v_mul_u32_u24 v16, 80, v16
    v_lshl_add_u32 v16, v13, 3, v16
    v_add_lshl_u32 v16, v16, v15, 1
    buffer_load_ushort v71, v16, s[12:15], 0 offen
    v_add_u32 v8, 512, v1
    v_mul_u32_u24 v9, 3277, v8
    v_lshrrev_b32 v9, 16, v9
    v_mul_u32_u24 v10, 20, v9
    v_sub_u32 v10, v8, v10
    v_and_b32 v11, 3, v9
    v_bfe_u32 v12, v9, 2, 3
    v_lshrrev_b32 v13, 3, v10
    v_lshl_add_u32 v13, v13, 2, v11
    v_and_b32 v14, 7, v10
    v_lshrrev_b32 v15, 1, v11
    v_add_u32 v15, 8, v15
    v_and_b32 v16, 1, v11
    v_and_b32 v17, 3, v10
    v_lshl_add_u32 v16, v16, 2, v17
    v_cmp_gt_u32 vcc, 16, v10
    s_nop 1
    v_cndmask_b32 v13, v15, v13, vcc
    v_cndmask_b32 v14, v16, v14, vcc
    v_cmp_gt_u32 vcc, 32, v9
    s_nop 1
    v_cndmask_b32 v15, v14, v12, vcc
    v_cndmask_b32 v16, v12, v14, vcc
    v_mul_u32_u24 v16, 80, v16
    v_lshl_add_u32 v16, v13, 3, v16
    v_add_lshl_u32 v16, v16, v15, 1
    buffer_load_ushort v72, v16, s[12:15], 0 offen
    v_add_u32 v8, 768, v1
    v_mul_u32_u24 v9, 3277, v8
    v_lshrrev_b32 v9, 16, v9
    v_mul_u32_u24 v10, 20, v9
    v_sub_u32 v10, v8, v10
    v_and_b32 v11, 3, v9
    v_bfe_u32 v12, v9, 2, 3
    v_lshrrev_b32 v13, 3, v10
    v_lshl_add_u32 v13, v13, 2, v11
    v_and_b32 v14, 7, v10
    v_lshrrev_b32 v15, 1, v11
    v_add_u32 v15, 8, v15
    v_and_b32 v16, 1, v11
    v_and_b32 v17, 3, v10
    v_lshl_add_u32 v16, v16, 2, v17
    v_cmp_gt_u32 vcc, 16, v10
    s_nop 1
    v_cndmask_b32 v13, v15, v13, vcc
    v_cndmask_b32 v14, v16, v14, vcc
    v_cmp_gt_u32 vcc, 32, v9
    s_nop 1
    v_cndmask_b32 v15, v14, v12, vcc
    v_cndmask_b32 v16, v12, v14, vcc
    v_mul_u32_u24 v16, 80, v16
    v_lshl_add_u32 v16, v13, 3, v16
    v_add_lshl_u32 v16, v16, v15, 1
    buffer_load_ushort v73, v16, s[12:15], 0 offen
    v_add_u32 v8, 1024, v1
    v_mul_u32_u24 v9, 3277, v8
    v_lshrrev_b32 v9, 16, v9
    v_mul_u32_u24 v10, 20, v9
    v_sub_u32 v10, v8, v10
    v_and_b32 v11, 3, v9
    v_bfe_u32 v12, v9, 2, 3
    v_lshrrev_b32 v13, 3, v10
    v_lshl_add_u32 v13, v13, 2, v11
    v_and_b32 v14, 7, v10
    v_lshrrev_b32 v15, 1, v11
    v_add_u32 v15, 8, v15
    v_and_b32 v16, 1, v11
    v_and_b32 v17, 3, v10
    v_lshl_add_u32 v16, v16, 2, v17
    v_cmp_gt_u32 vcc, 16, v10
    s_nop 1
    v_cndmask_b32 v13, v15, v13, vcc
    v_cndmask_b32 v14, v16, v14, vcc
    v_cmp_gt_u32 vcc, 32, v9
    s_nop 1
    v_cndmask_b32 v15, v14, v12, vcc
    v_cndmask_b32 v16, v12, v14, vcc
    v_mul_u32_u24 v16, 80, v16
    v_lshl_add_u32 v16, v13, 3, v16
    v_add_lshl_u32 v16, v16, v15, 1
    buffer_load_ushort v74, v16, s[12:15], 0 offen
    v_lshlrev_b32 v8, 2, v1
    s_waitcnt vmcnt(4)
    v_lshlrev_b32 v70, 16, v70
    buffer_store_dword v70, v8, s[8:11], s43 offen offset:0 sc1
    s_waitcnt vmcnt(4)
    v_lshlrev_b32 v71, 16, v71
    buffer_store_dword v71, v8, s[8:11], s43 offen offset:1024 sc1
    s_waitcnt vmcnt(4)
    v_lshlrev_b32 v72, 16, v72
    buffer_store_dword v72, v8, s[8:11], s43 offen offset:2048 sc1
    s_waitcnt vmcnt(4)
    v_lshlrev_b32 v73, 16, v73
    buffer_store_dword v73, v8, s[8:11], s43 offen offset:3072 sc1
    s_waitcnt vmcnt(4)
    v_lshlrev_b32 v74, 16, v74
    s_add_u32 s43, s43, 4096
    buffer_store_dword v74, v8, s[8:11], s43 offen offset:0 sc1
    s_nop 2
L_inte_done_18:
L_inte_join_14:
    s_lshr_b32 s70, s4, 1
    s_lshl_b32 s70, s70, 2
    s_lshr_b32 s88, s5, 3
    s_add_u32 s70, s70, s88
    s_and_b32 s88, s4, 1
    s_and_b32 s89, s5, 7
    s_lshl_b32 s71, s88, 3
    s_add_u32 s71, s71, s89
    s_lshr_b32 s72, s89, 2
    s_and_b32 s73, s89, 3
    s_lshl_b32 s88, s88, 2
    s_add_u32 s73, s73, s88
    s_mov_b32 s88, 0
    s_lshl_b32 s39, s88, 12
    s_mul_i32 s43, s88, 5120
    s_mov_b32 s88, 1
    s_lshl_b32 s40, s88, 12
    s_mul_i32 s44, s88, 5120
    s_mov_b32 s88, 2
    s_lshl_b32 s41, s88, 12
    s_mul_i32 s45, s88, 5120
    s_mov_b32 s88, 3
    s_lshl_b32 s42, s88, 12
    s_mul_i32 s46, s88, 5120
    s_mul_i32 s75, s71, 151552
    s_lshl_b32 s69, s3, 10
    s_add_u32 s75, s75, s69
    s_add_u32 s75, s75, 0x1c80000
    s_lshr_b32 s50, s5, 2
    s_lshl_b32 s50, s50, 3
    s_add_u32 s50, s50, s4
    s_and_b32 s51, s5, 3
    s_cmp_le_u32 s50, 40
    s_cselect_b32 s68, 1, 0
    s_lshl_b32 s88, s70, 2
    s_add_u32 s88, s88, s3
    s_mul_i32 s74, s88, 40960
    s_add_u32 s74, s74, 0x280000
    s_lshr_b32 s89, s88, 1
    s_mul_i32 s77, s89, 221184
    s_and_b32 s90, s3, 1
    s_lshl_b32 s90, s90, 11
    s_add_u32 s77, s77, s90
    s_add_u32 s77, s77, 0xf00000
    s_lshl_b32 s90, s71, 13
    s_add_u32 s76, s77, s90
    s_lshl_b32 s89, s70, 1
    s_add_u32 s89, s89, s72
    s_mul_i32 s89, s89, 221184
    s_add_u32 s89, s89, 0xf00000
    s_mul_i32 s88, s3, 32768
    s_add_u32 s80, s89, s88
    s_add_u32 s24, s80, 4096
    s_mul_i32 s88, s3, 4096
    s_add_u32 s88, s88, 196608
    s_add_u32 s81, s89, s88
    s_and_b32 s88, s3, 1
    s_mul_i32 s88, s88, 4096
    s_add_u32 s88, s88, 212992
    s_add_u32 s82, s89, s88
    s_mul_i32 s88, s3, 16384
    s_add_u32 s88, s88, 131072
    s_add_u32 s83, s89, s88
    s_mul_i32 s89, s73, 276480
    s_add_u32 s89, s89, 0x1f00000
    s_mul_i32 s88, s3, 40960
    s_add_u32 s84, s89, s88
    s_add_u32 s25, s84, 5120
    s_mul_i32 s88, s3, 5120
    s_add_u32 s88, s88, 245760
    s_add_u32 s85, s89, s88
    s_and_b32 s88, s3, 1
    s_mul_i32 s88, s88, 5120
    s_add_u32 s88, s88, 266240
    s_add_u32 s86, s89, s88
    s_mul_i32 s88, s3, 20480
    s_add_u32 s88, s88, 163840
    s_add_u32 s87, s89, s88
    s_cmp_eq_u32 s68, 0
    s_cbranch_scc1 L_inte_idle_20
    v_lshlrev_b32 v15, 4, v0
    s_cmp_eq_u32 s50, 0
    s_cselect_b32 s52, 41, s50
    s_lshl_b32 s52, s52, 10
    s_add_u32 s52, s52, 41984
    s_lshl_b32 s53, s51, 11
    s_add_u32 s53, s53, 12288
    s_mov_b32 s54, 18432
    s_lshl_b32 s55, s3, 1
    s_add_u32 s55, s55, 0
    s_min_u32 s55, s55, 6
    s_cmp_lt_u32 s55, 3
    s_cselect_b32 s56, s53, s54
    s_cmp_eq_u32 s55, 0
    s_cselect_b32 s56, s52, s56
    s_lshl_b32 s55, s55, 10
    s_add_u32 s56, s56, s55
    v_add_u32 v16, s56, v15
    v_mov_b32 v17, 0
    v_lshl_add_u64 v[16:17], v[16:17], 0, s[6:7]
    s_add_u32 m0, s55, 152064
    s_nop 0
    global_load_lds_dwordx4 v[16:17], off
    s_lshl_b32 s55, s3, 1
    s_add_u32 s55, s55, 1
    s_min_u32 s55, s55, 6
    s_cmp_lt_u32 s55, 3
    s_cselect_b32 s56, s53, s54
    s_cmp_eq_u32 s55, 0
    s_cselect_b32 s56, s52, s56
    s_lshl_b32 s55, s55, 10
    s_add_u32 s56, s56, s55
    v_add_u32 v16, s56, v15
    v_mov_b32 v17, 0
    v_lshl_add_u64 v[16:17], v[16:17], 0, s[6:7]
    s_add_u32 m0, s55, 152064
    s_nop 0
    global_load_lds_dwordx4 v[16:17], off
    s_lshl_b32 s60, s3, 10
    s_add_u32 s60, s60, 0x2340000
    s_cmp_eq_u32 s50, 40
    s_cselect_b32 s61, 0, s50
    s_cmp_eq_u32 s50, 0
    s_cselect_b32 s62, 0, s61
    s_lshl_b32 s62, s62, 16
    s_lshl_b32 s63, s3, 9
    s_add_u32 s62, s62, s63
    s_add_u32 s62, s62, 0xa00000
    s_lshl_b32 s63, s50, 9
    s_add_u32 s64, s63, 0x0
    s_add_u32 s66, s63, 0x280000
    s_sub_u32 s65, 0xa000, s63
    s_sub_u32 s67, 0x28a000, s63
    s_cmp_eq_u32 s61, 0
    s_cselect_b32 s65, 0x7f000000, s65
    s_cselect_b32 s67, 0x7f000000, s67
    s_lshl_b32 s52, s51, 2
    s_add_u32 s52, s52, s3
    s_lshl_b32 s52, s52, 10
    v_lshrrev_b32 v34, 5, v0
    v_and_b32 v35, 15, v0
    v_lshl_add_u32 v34, v34, 4, v35
    v_lshl_add_u32 v34, v34, 3, s52
    v_add_u32 v38, 0x6400, v34
    v_mov_b32 v39, 0
    v_lshl_add_u64 v[38:39], v[38:39], 0, s[6:7]
    global_load_dwordx2 v[104:105], v[38:39], off offset:0
    global_load_dwordx2 v[106:107], v[38:39], off offset:256
    global_load_dwordx2 v[108:109], v[38:39], off offset:512
    global_load_dwordx2 v[110:111], v[38:39], off offset:768
    s_mul_i32 s58, s3, 18432
    s_add_u32 s58, s58, 68608
    s_lshl_b32 s59, s3, 11
    s_add_u32 s59, s59, 142336
    v_lshrrev_b32 v42, 4, v0
    v_lshrrev_b32 v43, 5, v0
    v_bfe_u32 v44, v0, 4, 1
    v_bfe_u32 v45, v0, 3, 1
    v_bfe_u32 v46, v0, 2, 1
    v_and_b32 v47, 3, v0
    v_lshl_add_u32 v1, v43, 1, v45
    v_mul_u32_u24 v1, 1152, v1
    v_lshl_add_u32 v1, v44, 6, v1
    v_lshl_add_u32 v1, v46, 5, v1
    v_lshl_add_u32 v1, v47, 3, v1
    v_add_u32 v10, s58, v1
    v_lshlrev_b32 v1, 6, v45
    v_lshl_add_u32 v1, v42, 4, v1
    v_add_u32 v11, s59, v1
    v_lshl_add_u32 v12, v0, 3, s59
    v_and_b32 v1, 31, v0
    v_lshlrev_b32 v1, 4, v1
    v_lshl_add_u32 v14, v43, 13, v1
    v_lshlrev_b32 v1, 11, v44
    v_bfe_u32 v34, v0, 2, 2
    v_lshl_add_u32 v1, v34, 9, v1
    v_lshl_add_u32 v1, v43, 8, v1
    v_lshl_add_u32 v1, v47, 6, v1
    v_add_u32 v1, s58, v1
    v_bfe_u32 v35, v0, 1, 2
    v_xor_b32 v36, 0, v35
    v_lshl_add_u32 v4, v36, 4, v1
    v_xor_b32 v36, 1, v35
    v_lshl_add_u32 v5, v36, 4, v1
    v_xor_b32 v36, 2, v35
    v_lshl_add_u32 v6, v36, 4, v1
    v_xor_b32 v36, 3, v35
    v_lshl_add_u32 v7, v36, 4, v1
    v_mul_u32_u24 v1, 18432, v43
    v_lshl_add_u32 v1, v44, 8, v1
    v_lshl_add_u32 v1, v34, 6, v1
    s_lshl_b32 s52, s3, 1
    v_add_u32 v36, s52, v45
    v_and_b32 v36, 3, v36
    v_xor_b32 v36, v36, v47
    v_lshl_add_u32 v1, v36, 4, v1
    s_lshl_b32 s52, s3, 9
    s_add_u32 s52, s52, 68608
    v_add_u32 v13, s52, v1
    s_lshl_b32 s52, s3, 4
    s_add_u32 s52, s52, s51
    v_and_b32 v34, 15, v0
    v_lshlrev_b32 v34, 6, v34
    v_lshl_add_u32 v34, v42, 2, v34
    v_add_u32 v34, s52, v34
    v_lshrrev_b32 v1, 9, v34
    v_bfe_u32 v2, v34, 1, 4
    v_lshl_add_u32 v2, v1, 4, v2
    v_mul_u32_u24 v2, 40960, v2
    v_and_b32 v1, 1, v34
    v_lshl_add_u32 v2, v1, 8, v2
    v_bfe_u32 v1, v34, 5, 1
    v_lshl_add_u32 v2, v1, 7, v2
    v_bfe_u32 v1, v34, 6, 3
    v_lshl_add_u32 v2, v1, 4, v2
    v_add_u32 v3, 1310720, v2
    v_sub_u32 v35, 2048, v34
    v_and_b32 v35, 2047, v35
    v_lshrrev_b32 v1, 9, v35
    v_bfe_u32 v8, v35, 1, 4
    v_lshl_add_u32 v8, v1, 4, v8
    v_mul_u32_u24 v8, 40960, v8
    v_and_b32 v1, 1, v35
    v_lshl_add_u32 v8, v1, 8, v8
    v_bfe_u32 v1, v35, 5, 1
    v_lshl_add_u32 v8, v1, 7, v8
    v_bfe_u32 v1, v35, 6, 3
    v_lshl_add_u32 v8, v1, 4, v8
    v_sub_u32 v35, 1024, v34
    v_and_b32 v35, 2047, v35
    v_lshrrev_b32 v1, 9, v35
    v_bfe_u32 v9, v35, 1, 4
    v_lshl_add_u32 v9, v1, 4, v9
    v_mul_u32_u24 v9, 40960, v9
    v_and_b32 v1, 1, v35
    v_lshl_add_u32 v9, v1, 8, v9
    v_bfe_u32 v1, v35, 5, 1
    v_lshl_add_u32 v9, v1, 7, v9
    v_bfe_u32 v1, v35, 6, 3
    v_lshl_add_u32 v9, v1, 4, v9
    v_lshlrev_b32 v1, 4, v0
    s_waitcnt vmcnt(4)
    s_barrier
    s_nop 2
    s_cmp_eq_u32 s3, 0
    s_cbranch_scc0 L_inte_others_22
    s_mov_b32 s16, s34
    s_mov_b32 s17, s35
    s_mov_b32 s18, 0x100
    s_mov_b32 s19, 0x00020000
    s_mov_b32 s91, 0
L_inte_again_26:
    buffer_load_dword v16, off, s[16:19], 0 sc1
    s_add_u32 s91, s91, 1
    s_waitcnt vmcnt(0)
    v_readfirstlane_b32 s88, v16
    s_cmp_ge_u32 s91, 500000
    s_cbranch_scc1 L_inte_ok_27
    s_nop 1
    s_cmp_eq_u32 s88, 1
    s_cbranch_scc0 L_inte_again_26
L_inte_ok_27:
    s_cmp_eq_u32 s23, 0
    s_cbranch_scc0 L_inte_wjob_24
    s_and_b32 s89, s2, 15
    s_cmp_lt_u32 s89, 0
    s_cselect_b32 s90, 9, 8
    s_add_u32 s89, s89, 0
    s_lshl_b32 s88, s89, 8
    s_add_u32 s88, s88, 0x2350000
    v_mov_b32 v16, 1
    v_mov_b32 v17, 1
    s_mov_b64 exec, 1
    buffer_atomic_add v16, off, s[8:11], s88 sc0 sc1
    s_waitcnt vmcnt(0)
    v_readfirstlane_b32 s91, v16
    s_add_u32 s88, s88, 4096
    s_nop 2
    s_add_u32 s91, s91, 1
    s_cmp_eq_u32 s91, s90
    s_cbranch_scc0 L_inte_notlast_28
    buffer_store_dword v17, off, s[8:11], s88 sc1
L_inte_notlast_28:
    s_mov_b64 exec, -1
    s_branch L_inte_nojob_25
L_inte_wjob_24:
    s_cmp_eq_u32 s23, 2
    s_cbranch_scc1 L_inte_nojob_25
    s_and_b32 s89, s38, 15
    s_cmp_lt_u32 s89, 15
    s_cselect_b32 s90, 8, 7
    s_add_u32 s89, s89, 128
    s_lshl_b32 s88, s89, 8
    s_add_u32 s88, s88, 0x2350000
    v_mov_b32 v16, 1
    v_mov_b32 v17, 1
    s_mov_b64 exec, 1
    buffer_atomic_add v16, off, s[8:11], s88 sc0 sc1
    s_waitcnt vmcnt(0)
    v_readfirstlane_b32 s91, v16
    s_add_u32 s88, s88, 4096
    s_nop 2
    s_add_u32 s91, s91, 1
    s_cmp_eq_u32 s91, s90
    s_cbranch_scc0 L_inte_notlast_29
    buffer_store_dword v17, off, s[8:11], s88 sc1
L_inte_notlast_29:
    s_mov_b64 exec, -1
L_inte_nojob_25:
    v_and_b32 v18, 15, v0
    v_lshlrev_b32 v18, 8, v18
    v_add_u32 v18, 0x2351000, v18
    buffer_load_dword v19, v18, s[8:11], 0 offen sc1
    v_mov_b32 v64, 0
    v_mov_b32 v65, 0
    v_mov_b32 v66, 0
    v_mov_b32 v67, 0
    v_mov_b32 v68, 0
    v_mov_b32 v69, 0
    v_mov_b32 v70, 0
    v_mov_b32 v71, 0
    v_mov_b32 v72, 0
    v_mov_b32 v73, 0
    v_mov_b32 v74, 0
    v_mov_b32 v75, 0
    v_mov_b32 v76, 0
    v_mov_b32 v77, 0
    v_mov_b32 v78, 0
    v_mov_b32 v79, 0
    v_mov_b32 v80, 0
    v_mov_b32 v81, 0
    v_mov_b32 v82, 0
    v_mov_b32 v83, 0
    v_mov_b32 v84, 0
    v_mov_b32 v85, 0
    v_mov_b32 v86, 0
    v_mov_b32 v87, 0
    v_mov_b32 v88, 0
    v_mov_b32 v89, 0
    v_mov_b32 v90, 0
    v_mov_b32 v91, 0
    v_mov_b32 v92, 0
    v_mov_b32 v93, 0
    v_mov_b32 v94, 0
    v_mov_b32 v95, 0
    v_lshrrev_b32 v26, 5, v0
    v_and_b32 v27, 7, v0
    v_lshlrev_b32 v26, 7, v26
    v_lshl_add_u32 v26, v27, 4, v26
    s_mul_i32 s53, s51, 0
    s_add_u32 s53, s53, 0
    s_and_b32 s53, s53, 3
    s_lshl_b32 s53, s53, 8
    s_add_u32 s53, s53, 152064
    v_add_u32 v28, s53, v26
    s_mul_i32 s53, s51, 0
    s_add_u32 s53, s53, 1
    s_and_b32 s53, s53, 3
    s_lshl_b32 s53, s53, 8
    s_add_u32 s53, s53, 152064
    v_add_u32 v29, s53, v26
    s_mul_i32 s53, s51, 1
    s_add_u32 s53, s53, 0
    s_and_b32 s53, s53, 3
    s_lshl_b32 s53, s53, 8
    s_add_u32 s53, s53, 152064
    v_add_u32 v30, s53, v26
    s_mul_i32 s53, s51, 1
    s_add_u32 s53, s53, 1
    s_and_b32 s53, s53, 3
    s_lshl_b32 s53, s53, 8
    s_add_u32 s53, s53, 152064
    v_add_u32 v31, s53, v26
    s_mul_i32 s53, s51, 2
    s_add_u32 s53, s53, 0
    s_and_b32 s53, s53, 3
    s_lshl_b32 s53, s53, 8
    s_add_u32 s53, s53, 152064
    v_add_u32 v32, s53, v26
    s_mul_i32 s53, s51, 2
    s_add_u32 s53, s53, 1
    s_and_b32 s53, s53, 3
    s_lshl_b32 s53, s53, 8
    s_add_u32 s53, s53, 152064
    v_add_u32 v33, s53, v26
    s_mul_i32 s53, s51, 3
    s_add_u32 s53, s53, 0
    s_and_b32 s53, s53, 3
    s_lshl_b32 s53, s53, 8
    s_add_u32 s53, s53, 152064
    v_add_u32 v34, s53, v26
    s_mul_i32 s53, s51, 3
    s_add_u32 s53, s53, 1
    s_and_b32 s53, s53, 3
    s_lshl_b32 s53, s53, 8
    s_add_u32 s53, s53, 152064
    v_add_u32 v35, s53, v26
    v_add_u32 v27, 153088, v15
    s_mov_b32 exec_lo, 0xff0000ff
    s_mov_b32 exec_hi, 0xff0000ff
    ds_read_b128 v[64:67], v28
    ds_read_b128 v[68:71], v29
    ds_read_b128 v[72:75], v30
    ds_read_b128 v[76:79], v31
    ds_read_b128 v[80:83], v32
    ds_read_b128 v[84:87], v33
    ds_read_b128 v[88:91], v34
    ds_read_b128 v[92:95], v35
    s_mov_b64 exec, -1
    ds_read_b128 v[96:99], v27 offset:0
    ds_read_b128 v[100:103], v27 offset:1024
    ds_read_b128 v[112:115], v27 offset:2048
    ds_read_b128 v[116:119], v27 offset:3072
    ds_read_b128 v[120:123], v27 offset:4096
    ds_read_b128 v[124:127], v27 offset:5120
    s_mov_b32 s91, 0
    s_waitcnt vmcnt(0)
    v_cmp_eq_u32 vcc, 0, v19
    s_nop 3
    s_cmp_eq_u64 vcc, 0
    s_cbranch_scc1 L_inte_ok_31
L_inte_again_30:
    buffer_load_dword v19, v18, s[8:11], 0 offen sc1
    s_add_u32 s91, s91, 1
    s_waitcnt vmcnt(0)
    v_cmp_eq_u32 vcc, 0, v19
    s_cmp_ge_u32 s91, 500000
    s_cbranch_scc1 L_inte_ok_31
    s_nop 1
    s_cmp_eq_u64 vcc, 0
    s_cbranch_scc0 L_inte_again_30
L_inte_ok_31:
    s_waitcnt lgkmcnt(0)
    s_branch L_inte_join_23
L_inte_others_22:
    v_mov_b32 v64, 0
    v_mov_b32 v65, 0
    v_mov_b32 v66, 0
    v_mov_b32 v67, 0
    v_mov_b32 v68, 0
    v_mov_b32 v69, 0
    v_mov_b32 v70, 0
    v_mov_b32 v71, 0
    v_mov_b32 v72, 0
    v_mov_b32 v73, 0
    v_mov_b32 v74, 0
    v_mov_b32 v75, 0
    v_mov_b32 v76, 0
    v_mov_b32 v77, 0
    v_mov_b32 v78, 0
    v_mov_b32 v79, 0
    v_mov_b32 v80, 0
    v_mov_b32 v81, 0
    v_mov_b32 v82, 0
    v_mov_b32 v83, 0
    v_mov_b32 v84, 0
    v_mov_b32 v85, 0
    v_mov_b32 v86, 0
    v_mov_b32 v87, 0
    v_mov_b32 v88, 0
    v_mov_b32 v89, 0
    v_mov_b32 v90, 0
    v_mov_b32 v91, 0
    v_mov_b32 v92, 0
    v_mov_b32 v93, 0
    v_mov_b32 v94, 0
    v_mov_b32 v95, 0
    v_lshrrev_b32 v26, 5, v0
    v_and_b32 v27, 7, v0
    v_lshlrev_b32 v26, 7, v26
    v_lshl_add_u32 v26, v27, 4, v26
    s_mul_i32 s53, s51, 0
    s_add_u32 s53, s53, 0
    s_and_b32 s53, s53, 3
    s_lshl_b32 s53, s53, 8
    s_add_u32 s53, s53, 152064
    v_add_u32 v28, s53, v26
    s_mul_i32 s53, s51, 0
    s_add_u32 s53, s53, 1
    s_and_b32 s53, s53, 3
    s_lshl_b32 s53, s53, 8
    s_add_u32 s53, s53, 152064
    v_add_u32 v29, s53, v26
    s_mul_i32 s53, s51, 1
    s_add_u32 s53, s53, 0
    s_and_b32 s53, s53, 3
    s_lshl_b32 s53, s53, 8
    s_add_u32 s53, s53, 152064
    v_add_u32 v30, s53, v26
    s_mul_i32 s53, s51, 1
    s_add_u32 s53, s53, 1
    s_and_b32 s53, s53, 3
    s_lshl_b32 s53, s53, 8
    s_add_u32 s53, s53, 152064
    v_add_u32 v31, s53, v26
    s_mul_i32 s53, s51, 2
    s_add_u32 s53, s53, 0
    s_and_b32 s53, s53, 3
    s_lshl_b32 s53, s53, 8
    s_add_u32 s53, s53, 152064
    v_add_u32 v32, s53, v26
    s_mul_i32 s53, s51, 2
    s_add_u32 s53, s53, 1
    s_and_b32 s53, s53, 3
    s_lshl_b32 s53, s53, 8
    s_add_u32 s53, s53, 152064
    v_add_u32 v33, s53, v26
    s_mul_i32 s53, s51, 3
    s_add_u32 s53, s53, 0
    s_and_b32 s53, s53, 3
    s_lshl_b32 s53, s53, 8
    s_add_u32 s53, s53, 152064
    v_add_u32 v34, s53, v26
    s_mul_i32 s53, s51, 3
    s_add_u32 s53, s53, 1
    s_and_b32 s53, s53, 3
    s_lshl_b32 s53, s53, 8
    s_add_u32 s53, s53, 152064
    v_add_u32 v35, s53, v26
    v_add_u32 v27, 153088, v15
    s_mov_b32 exec_lo, 0xff0000ff
    s_mov_b32 exec_hi, 0xff0000ff
    ds_read_b128 v[64:67], v28
    ds_read_b128 v[68:71], v29
    ds_read_b128 v[72:75], v30
    ds_read_b128 v[76:79], v31
    ds_read_b128 v[80:83], v32
    ds_read_b128 v[84:87], v33
    ds_read_b128 v[88:91], v34
    ds_read_b128 v[92:95], v35
    s_mov_b64 exec, -1
    ds_read_b128 v[96:99], v27 offset:0
    ds_read_b128 v[100:103], v27 offset:1024
    ds_read_b128 v[112:115], v27 offset:2048
    ds_read_b128 v[116:119], v27 offset:3072
    ds_read_b128 v[120:123], v27 offset:4096
    ds_read_b128 v[124:127], v27 offset:5120
    s_waitcnt lgkmcnt(0)
L_inte_join_23:
    s_barrier
    s_add_u32 m0, s58, 0
    s_add_u32 s63, s62, 0
    buffer_load_dwordx4 v14, s[8:11], s63 offen sc1 lds
    s_add_u32 m0, s58, 1152
    s_add_u32 s63, s62, 16384
    buffer_load_dwordx4 v14, s[8:11], s63 offen sc1 lds
    s_add_u32 m0, s58, 2304
    s_add_u32 s63, s62, 32768
    buffer_load_dwordx4 v14, s[8:11], s63 offen sc1 lds
    s_add_u32 m0, s58, 3456
    s_add_u32 s63, s62, 49152
    buffer_load_dwordx4 v14, s[8:11], s63 offen sc1 lds
    s_add_u32 m0, s58, 4608
    s_add_u32 s63, s62, 2048
    buffer_load_dwordx4 v14, s[8:11], s63 offen sc1 lds
    s_add_u32 m0, s58, 5760
    s_add_u32 s63, s62, 18432
    buffer_load_dwordx4 v14, s[8:11], s63 offen sc1 lds
    s_add_u32 m0, s58, 6912
    s_add_u32 s63, s62, 34816
    buffer_load_dwordx4 v14, s[8:11], s63 offen sc1 lds
    s_add_u32 m0, s58, 8064
    s_add_u32 s63, s62, 51200
    buffer_load_dwordx4 v14, s[8:11], s63 offen sc1 lds
    s_add_u32 m0, s58, 9216
    s_add_u32 s63, s62, 4096
    buffer_load_dwordx4 v14, s[8:11], s63 offen sc1 lds
    s_add_u32 m0, s58, 10368
    s_add_u32 s63, s62, 20480
    buffer_load_dwordx4 v14, s[8:11], s63 offen sc1 lds
    s_add_u32 m0, s58, 11520
    s_add_u32 s63, s62, 36864
    buffer_load_dwordx4 v14, s[8:11], s63 offen sc1 lds
    s_add_u32 m0, s58, 12672
    s_add_u32 s63, s62, 53248
    buffer_load_dwordx4 v14, s[8:11], s63 offen sc1 lds
    s_add_u32 m0, s58, 13824
    s_add_u32 s63, s62, 6144
    buffer_load_dwordx4 v14, s[8:11], s63 offen sc1 lds
    s_add_u32 m0, s58, 14976
    s_add_u32 s63, s62, 22528
    buffer_load_dwordx4 v14, s[8:11], s63 offen sc1 lds
    s_add_u32 m0, s58, 16128
    s_add_u32 s63, s62, 38912
    buffer_load_dwordx4 v14, s[8:11], s63 offen sc1 lds
    s_add_u32 m0, s58, 17280
    s_add_u32 s63, s62, 55296
    buffer_load_dwordx4 v14, s[8:11], s63 offen sc1 lds
    s_waitcnt vmcnt(12)
    ds_read_b64_tr_b16 v[160:161], v10 offset:0
    ds_read_b64_tr_b16 v[162:163], v10 offset:512
    ds_read_b64_tr_b16 v[164:165], v10 offset:128
    ds_read_b64_tr_b16 v[166:167], v10 offset:640
    ds_read_b64_tr_b16 v[168:169], v10 offset:256
    ds_read_b64_tr_b16 v[170:171], v10 offset:768
    ds_read_b64_tr_b16 v[172:173], v10 offset:384
    ds_read_b64_tr_b16 v[174:175], v10 offset:896
    s_waitcnt lgkmcnt(6)
    v_mfma_f32_16x16x32_bf16 v[16:19], v[160:163], v[64:67], 0
    v_mfma_f32_16x16x32_bf16 v[20:23], v[160:163], v[68:71], 0
    s_waitcnt lgkmcnt(4)
    v_mfma_f32_16x16x32_bf16 v[24:27], v[164:167], v[64:67], 0
    v_mfma_f32_16x16x32_bf16 v[28:31], v[164:167], v[68:71], 0
    s_waitcnt lgkmcnt(2)
    v_mfma_f32_16x16x32_bf16 v[32:35], v[168:171], v[64:67], 0
    v_mfma_f32_16x16x32_bf16 v[36:39], v[168:171], v[68:71], 0
    s_waitcnt lgkmcnt(0)
    v_mfma_f32_16x16x32_bf16 v[40:43], v[172:175], v[64:67], 0
    v_mfma_f32_16x16x32_bf16 v[44:47], v[172:175], v[68:71], 0
    buffer_load_dwordx4 v[48:51], v2, s[8:11], s64 offen sc1
    buffer_load_dwordx4 v[52:55], v3, s[8:11], s64 offen sc1
    s_waitcnt vmcnt(10)
    ds_read_b64_tr_b16 v[176:177], v10 offset:4608
    ds_read_b64_tr_b16 v[178:179], v10 offset:5120
    ds_read_b64_tr_b16 v[180:181], v10 offset:4736
    ds_read_b64_tr_b16 v[182:183], v10 offset:5248
    ds_read_b64_tr_b16 v[184:185], v10 offset:4864
    ds_read_b64_tr_b16 v[186:187], v10 offset:5376
    ds_read_b64_tr_b16 v[188:189], v10 offset:4992
    ds_read_b64_tr_b16 v[190:191], v10 offset:5504
    s_waitcnt lgkmcnt(6)
    v_mfma_f32_16x16x32_bf16 v[16:19], v[176:179], v[72:75], v[16:19]
    v_mfma_f32_16x16x32_bf16 v[20:23], v[176:179], v[76:79], v[20:23]
    s_waitcnt lgkmcnt(4)
    v_mfma_f32_16x16x32_bf16 v[24:27], v[180:183], v[72:75], v[24:27]
    v_mfma_f32_16x16x32_bf16 v[28:31], v[180:183], v[76:79], v[28:31]
    s_waitcnt lgkmcnt(2)
    v_mfma_f32_16x16x32_bf16 v[32:35], v[184:187], v[72:75], v[32:35]
    v_mfma_f32_16x16x32_bf16 v[36:39], v[184:187], v[76:79], v[36:39]
    s_waitcnt lgkmcnt(0)
    v_mfma_f32_16x16x32_bf16 v[40:43], v[188:191], v[72:75], v[40:43]
    v_mfma_f32_16x16x32_bf16 v[44:47], v[188:191], v[76:79], v[44:47]
    buffer_load_dwordx4 v[56:59], v8, s[8:11], s65 offen sc1
    buffer_load_dwordx4 v[60:63], v9, s[8:11], s65 offen sc1
    s_waitcnt vmcnt(8)
    ds_read_b64_tr_b16 v[160:161], v10 offset:9216
    ds_read_b64_tr_b16 v[162:163], v10 offset:9728
    ds_read_b64_tr_b16 v[164:165], v10 offset:9344
    ds_read_b64_tr_b16 v[166:167], v10 offset:9856
    ds_read_b64_tr_b16 v[168:169], v10 offset:9472
    ds_read_b64_tr_b16 v[170:171], v10 offset:9984
    ds_read_b64_tr_b16 v[172:173], v10 offset:9600
    ds_read_b64_tr_b16 v[174:175], v10 offset:10112
    s_waitcnt lgkmcnt(6)
    v_mfma_f32_16x16x32_bf16 v[16:19], v[160:163], v[80:83], v[16:19]
    v_mfma_f32_16x16x32_bf16 v[20:23], v[160:163], v[84:87], v[20:23]
    s_waitcnt lgkmcnt(4)
    v_mfma_f32_16x16x32_bf16 v[24:27], v[164:167], v[80:83], v[24:27]
    v_mfma_f32_16x16x32_bf16 v[28:31], v[164:167], v[84:87], v[28:31]
    s_waitcnt lgkmcnt(2)
    v_mfma_f32_16x16x32_bf16 v[32:35], v[168:171], v[80:83], v[32:35]
    v_mfma_f32_16x16x32_bf16 v[36:39], v[168:171], v[84:87], v[36:39]
    s_waitcnt lgkmcnt(0)
    v_mfma_f32_16x16x32_bf16 v[40:43], v[172:175], v[80:83], v[40:43]
    v_mfma_f32_16x16x32_bf16 v[44:47], v[172:175], v[84:87], v[44:47]
    s_waitcnt vmcnt(4)
    ds_read_b64_tr_b16 v[176:177], v10 offset:13824
    ds_read_b64_tr_b16 v[178:179], v10 offset:14336
    ds_read_b64_tr_b16 v[180:181], v10 offset:13952
    ds_read_b64_tr_b16 v[182:183], v10 offset:14464
    ds_read_b64_tr_b16 v[184:185], v10 offset:14080
    ds_read_b64_tr_b16 v[186:187], v10 offset:14592
    ds_read_b64_tr_b16 v[188:189], v10 offset:14208
    ds_read_b64_tr_b16 v[190:191], v10 offset:14720
    s_waitcnt lgkmcnt(6)
    v_mfma_f32_16x16x32_bf16 v[16:19], v[176:179], v[88:91], v[16:19]
    v_mfma_f32_16x16x32_bf16 v[20:23], v[176:179], v[92:95], v[20:23]
    s_waitcnt lgkmcnt(4)
    v_mfma_f32_16x16x32_bf16 v[24:27], v[180:183], v[88:91], v[24:27]
    v_mfma_f32_16x16x32_bf16 v[28:31], v[180:183], v[92:95], v[28:31]
    s_waitcnt lgkmcnt(2)
    v_mfma_f32_16x16x32_bf16 v[32:35], v[184:187], v[88:91], v[32:35]
    v_mfma_f32_16x16x32_bf16 v[36:39], v[184:187], v[92:95], v[36:39]
    s_waitcnt lgkmcnt(0)
    v_mfma_f32_16x16x32_bf16 v[40:43], v[188:191], v[88:91], v[40:43]
    v_mfma_f32_16x16x32_bf16 v[44:47], v[188:191], v[92:95], v[44:47]
    v_cvt_pk_bf16_f32 v160, v16, v20
    v_cvt_pk_bf16_f32 v161, v17, v21
    v_cvt_pk_bf16_f32 v162, v18, v22
    v_cvt_pk_bf16_f32 v163, v19, v23
    s_nop 1
    v_mfma_f32_16x16x32_bf16 v[192:195], v[160:163], v[96:99], 0
    v_mfma_f32_16x16x32_bf16 v[196:199], v[160:163], v[100:103], 0
    v_cvt_pk_bf16_f32 v164, v24, v28
    v_cvt_pk_bf16_f32 v165, v25, v29
    v_cvt_pk_bf16_f32 v166, v26, v30
    v_cvt_pk_bf16_f32 v167, v27, v31
    s_nop 1
    v_mfma_f32_16x16x32_bf16 v[200:203], v[164:167], v[96:99], 0
    v_mfma_f32_16x16x32_bf16 v[204:207], v[164:167], v[100:103], 0
    v_cvt_pk_bf16_f32 v168, v32, v36
    v_cvt_pk_bf16_f32 v169, v33, v37
    v_cvt_pk_bf16_f32 v170, v34, v38
    v_cvt_pk_bf16_f32 v171, v35, v39
    s_nop 1
    v_mfma_f32_16x16x32_bf16 v[208:211], v[168:171], v[96:99], 0
    v_mfma_f32_16x16x32_bf16 v[212:215], v[168:171], v[100:103], 0
    v_cvt_pk_bf16_f32 v172, v40, v44
    v_cvt_pk_bf16_f32 v173, v41, v45
    v_cvt_pk_bf16_f32 v174, v42, v46
    v_cvt_pk_bf16_f32 v175, v43, v47
    s_nop 1
    v_mfma_f32_16x16x32_bf16 v[216:219], v[172:175], v[96:99], 0
    v_mfma_f32_16x16x32_bf16 v[220:223], v[172:175], v[100:103], 0
    v_pk_mul_f32 v[128:129], v[192:193], v[104:105] op_sel:[0,0] op_sel_hi:[0,1]
    v_pk_mul_f32 v[130:131], v[192:193], v[104:105] op_sel:[1,0] op_sel_hi:[1,1]
    v_pk_mul_f32 v[132:133], v[194:195], v[104:105] op_sel:[0,0] op_sel_hi:[0,1]
    v_pk_mul_f32 v[134:135], v[194:195], v[104:105] op_sel:[1,0] op_sel_hi:[1,1]
    v_pk_fma_f32 v[128:129], v[196:197], v[104:105], v[128:129] op_sel:[0,1,0] op_sel_hi:[0,0,1] neg_lo:[1,0,0]
    v_pk_fma_f32 v[130:131], v[196:197], v[104:105], v[130:131] op_sel:[1,1,0] op_sel_hi:[1,0,1] neg_lo:[1,0,0]
    v_pk_fma_f32 v[132:133], v[198:199], v[104:105], v[132:133] op_sel:[0,1,0] op_sel_hi:[0,0,1] neg_lo:[1,0,0]
    v_pk_fma_f32 v[134:135], v[198:199], v[104:105], v[134:135] op_sel:[1,1,0] op_sel_hi:[1,0,1] neg_lo:[1,0,0]
    v_cvt_pk_bf16_f32 v16, v128, v129
    v_cvt_pk_bf16_f32 v20, v130, v131
    v_cvt_pk_bf16_f32 v24, v132, v133
    v_cvt_pk_bf16_f32 v28, v134, v135
    v_pk_mul_f32 v[136:137], v[200:201], v[106:107] op_sel:[0,0] op_sel_hi:[0,1]
    v_pk_mul_f32 v[138:139], v[200:201], v[106:107] op_sel:[1,0] op_sel_hi:[1,1]
    v_pk_mul_f32 v[140:141], v[202:203], v[106:107] op_sel:[0,0] op_sel_hi:[0,1]
    v_pk_mul_f32 v[142:143], v[202:203], v[106:107] op_sel:[1,0] op_sel_hi:[1,1]
    v_pk_fma_f32 v[136:137], v[204:205], v[106:107], v[136:137] op_sel:[0,1,0] op_sel_hi:[0,0,1] neg_lo:[1,0,0]
    v_pk_fma_f32 v[138:139], v[204:205], v[106:107], v[138:139] op_sel:[1,1,0] op_sel_hi:[1,0,1] neg_lo:[1,0,0]
    v_pk_fma_f32 v[140:141], v[206:207], v[106:107], v[140:141] op_sel:[0,1,0] op_sel_hi:[0,0,1] neg_lo:[1,0,0]
    v_pk_fma_f32 v[142:143], v[206:207], v[106:107], v[142:143] op_sel:[1,1,0] op_sel_hi:[1,0,1] neg_lo:[1,0,0]
    v_cvt_pk_bf16_f32 v17, v136, v137
    v_cvt_pk_bf16_f32 v21, v138, v139
    v_cvt_pk_bf16_f32 v25, v140, v141
    v_cvt_pk_bf16_f32 v29, v142, v143
    v_pk_mul_f32 v[144:145], v[208:209], v[108:109] op_sel:[0,0] op_sel_hi:[0,1]
    v_pk_mul_f32 v[146:147], v[208:209], v[108:109] op_sel:[1,0] op_sel_hi:[1,1]
    v_pk_mul_f32 v[148:149], v[210:211], v[108:109] op_sel:[0,0] op_sel_hi:[0,1]
    v_pk_mul_f32 v[150:151], v[210:211], v[108:109] op_sel:[1,0] op_sel_hi:[1,1]
    v_pk_fma_f32 v[144:145], v[212:213], v[108:109], v[144:145] op_sel:[0,1,0] op_sel_hi:[0,0,1] neg_lo:[1,0,0]
    v_pk_fma_f32 v[146:147], v[212:213], v[108:109], v[146:147] op_sel:[1,1,0] op_sel_hi:[1,0,1] neg_lo:[1,0,0]
    v_pk_fma_f32 v[148:149], v[214:215], v[108:109], v[148:149] op_sel:[0,1,0] op_sel_hi:[0,0,1] neg_lo:[1,0,0]
    v_pk_fma_f32 v[150:151], v[214:215], v[108:109], v[150:151] op_sel:[1,1,0] op_sel_hi:[1,0,1] neg_lo:[1,0,0]
    v_cvt_pk_bf16_f32 v18, v144, v145
    v_cvt_pk_bf16_f32 v22, v146, v147
    v_cvt_pk_bf16_f32 v26, v148, v149
    v_cvt_pk_bf16_f32 v30, v150, v151
    v_pk_mul_f32 v[152:153], v[216:217], v[110:111] op_sel:[0,0] op_sel_hi:[0,1]
    v_pk_mul_f32 v[154:155], v[216:217], v[110:111] op_sel:[1,0] op_sel_hi:[1,1]
    v_pk_mul_f32 v[156:157], v[218:219], v[110:111] op_sel:[0,0] op_sel_hi:[0,1]
    v_pk_mul_f32 v[158:159], v[218:219], v[110:111] op_sel:[1,0] op_sel_hi:[1,1]
    v_pk_fma_f32 v[152:153], v[220:221], v[110:111], v[152:153] op_sel:[0,1,0] op_sel_hi:[0,0,1] neg_lo:[1,0,0]
    v_pk_fma_f32 v[154:155], v[220:221], v[110:111], v[154:155] op_sel:[1,1,0] op_sel_hi:[1,0,1] neg_lo:[1,0,0]
    v_pk_fma_f32 v[156:157], v[222:223], v[110:111], v[156:157] op_sel:[0,1,0] op_sel_hi:[0,0,1] neg_lo:[1,0,0]
    v_pk_fma_f32 v[158:159], v[222:223], v[110:111], v[158:159] op_sel:[1,1,0] op_sel_hi:[1,0,1] neg_lo:[1,0,0]
    v_cvt_pk_bf16_f32 v19, v152, v153
    v_cvt_pk_bf16_f32 v23, v154, v155
    v_cvt_pk_bf16_f32 v27, v156, v157
    v_cvt_pk_bf16_f32 v31, v158, v159
    ds_write_b128 v4, v[16:19]
    ds_write_b128 v5, v[20:23]
    ds_write_b128 v6, v[24:27]
    ds_write_b128 v7, v[28:31]
    s_waitcnt vmcnt(3)
    v_lshlrev_b32 v64, 16, v48
    v_and_b32 v65, 0xffff0000, v48
    v_lshlrev_b32 v66, 16, v49
    v_and_b32 v67, 0xffff0000, v49
    v_lshlrev_b32 v68, 16, v50
    v_and_b32 v69, 0xffff0000, v50
    v_lshlrev_b32 v70, 16, v51
    v_and_b32 v71, 0xffff0000, v51
    s_waitcnt vmcnt(2)
    v_lshlrev_b32 v72, 16, v52
    v_and_b32 v73, 0xffff0000, v52
    v_lshlrev_b32 v74, 16, v53
    v_and_b32 v75, 0xffff0000, v53
    v_lshlrev_b32 v76, 16, v54
    v_and_b32 v77, 0xffff0000, v54
    v_lshlrev_b32 v78, 16, v55
    v_and_b32 v79, 0xffff0000, v55
    s_waitcnt vmcnt(1)
    v_lshlrev_b32 v87, 16, v56
    v_and_b32 v86, 0xffff0000, v56
    v_lshlrev_b32 v85, 16, v57
    v_and_b32 v84, 0xffff0000, v57
    v_lshlrev_b32 v83, 16, v58
    v_and_b32 v82, 0xffff0000, v58
    v_lshlrev_b32 v81, 16, v59
    v_and_b32 v80, 0xffff0000, v59
    s_waitcnt vmcnt(0)
    v_lshlrev_b32 v95, 16, v60
    v_and_b32 v94, 0xffff0000, v60
    v_lshlrev_b32 v93, 16, v61
    v_and_b32 v92, 0xffff0000, v61
    v_lshlrev_b32 v91, 16, v62
    v_and_b32 v90, 0xffff0000, v62
    v_lshlrev_b32 v89, 16, v63
    v_and_b32 v88, 0xffff0000, v63
    s_waitcnt lgkmcnt(0)
    s_barrier
    ds_read_b128 v[160:163], v13 offset:0
    ds_read_b128 v[164:167], v13 offset:36864
    ds_read_b128 v[168:171], v13 offset:2048
    ds_read_b128 v[172:175], v13 offset:38912
    s_waitcnt lgkmcnt(3)
    v_mfma_f32_16x16x32_bf16 v[192:195], v[160:163], v[112:115], v[64:67]
    s_waitcnt lgkmcnt(1)
    v_mfma_f32_16x16x32_bf16 v[196:199], v[168:171], v[112:115], v[68:71]
    v_mfma_f32_16x16x32_bf16 v[200:203], v[160:163], v[116:119], v[72:75]
    v_mfma_f32_16x16x32_bf16 v[204:207], v[168:171], v[116:119], v[76:79]
    v_mfma_f32_16x16x32_bf16 v[208:211], v[160:163], v[112:115], v[80:83]
    v_mfma_f32_16x16x32_bf16 v[212:215], v[168:171], v[112:115], v[84:87]
    v_mfma_f32_16x16x32_bf16 v[216:219], v[160:163], v[116:119], v[88:91]
    v_mfma_f32_16x16x32_bf16 v[220:223], v[168:171], v[116:119], v[92:95]
    v_mfma_f32_16x16x32_bf16 v[192:195], v[164:167], v[120:123], v[192:195]
    s_waitcnt lgkmcnt(0)
    v_mfma_f32_16x16x32_bf16 v[196:199], v[172:175], v[120:123], v[196:199]
    v_mfma_f32_16x16x32_bf16 v[200:203], v[164:167], v[124:127], v[200:203]
    v_mfma_f32_16x16x32_bf16 v[204:207], v[172:175], v[124:127], v[204:207]
    v_mfma_f32_16x16x32_bf16 v[208:211], v[164:167], v[120:123], v[208:211]
    v_mfma_f32_16x16x32_bf16 v[212:215], v[172:175], v[120:123], v[212:215]
    v_mfma_f32_16x16x32_bf16 v[216:219], v[164:167], v[124:127], v[216:219]
    v_mfma_f32_16x16x32_bf16 v[220:223], v[172:175], v[124:127], v[220:223]
    s_barrier
    v_cvt_pk_bf16_f32 v224, v192, v193
    v_cvt_pk_bf16_f32 v225, v194, v195
    v_cvt_pk_bf16_f32 v226, v196, v197
    v_cvt_pk_bf16_f32 v227, v198, v199
    buffer_store_dwordx4 v[224:227], v2, s[8:11], s66 offen sc1
    v_cvt_pk_bf16_f32 v228, v200, v201
    v_cvt_pk_bf16_f32 v229, v202, v203
    v_cvt_pk_bf16_f32 v230, v204, v205
    v_cvt_pk_bf16_f32 v231, v206, v207
    buffer_store_dwordx4 v[228:231], v3, s[8:11], s66 offen sc1
    v_cvt_pk_bf16_f32 v232, v215, v214
    v_cvt_pk_bf16_f32 v233, v213, v212
    v_cvt_pk_bf16_f32 v234, v211, v210
    v_cvt_pk_bf16_f32 v235, v209, v208
    buffer_store_dwordx4 v[232:235], v8, s[8:11], s67 offen sc1
    v_cvt_pk_bf16_f32 v236, v223, v222
    v_cvt_pk_bf16_f32 v237, v221, v220
    v_cvt_pk_bf16_f32 v238, v219, v218
    v_cvt_pk_bf16_f32 v239, v217, v216
    buffer_store_dwordx4 v[236:239], v9, s[8:11], s67 offen sc1
    v_and_b32 v22, 15, v0
    v_lshlrev_b32 v22, 8, v22
    v_add_u32 v22, 0x2359000, v22
    buffer_load_dword v23, v22, s[8:11], 0 offen sc1
    v_lshlrev_b32 v1, 4, v0
    v_add_u32 v2, 27648, v1
    v_add_u32 v3, 68608, v1
    v_add_u32 v4, 109568, v1
    v_and_b32 v16, 15, v0
    v_lshrrev_b32 v17, 4, v0
    v_lshlrev_b32 v18, 4, v16
    v_lshl_add_u32 v5, v17, 9, v18
    s_mul_i32 s88, s71, 3
    v_add_u32 v19, s88, v17
    v_and_b32 v20, 1, v19
    v_lshl_add_u32 v18, v20, 3, v18
    v_bfe_u32 v20, v19, 1, 2
    v_lshl_add_u32 v18, v20, 8, v18
    v_lshrrev_b32 v20, 3, v19
    v_add_u32 v20, 48, v20
    v_lshl_add_u32 v18, v20, 12, v18
    v_add_u32 v19, 1, v17
    v_lshrrev_b32 v19, 2, v19
    v_lshl_add_u32 v6, v19, 30, v18
    v_lshrrev_b32 v19, 2, v16
    v_lshl_add_u32 v19, v19, 4, v16
    v_lshlrev_b32 v7, 2, v19
    v_add_lshl_u32 v10, v16, 48, 2
    s_lshl_b32 s88, s3, 7
    s_add_u32 s88, s88, 151552
    v_lshl_add_u32 v11, v16, 2, s88
    v_min_u32 v16, 1, v0
    v_lshlrev_b32 v8, 30, v16
    v_mov_b32 v9, 1
    s_mov_b32 s92, 0x22222222
    s_mov_b32 s93, 0x22222222
    s_mov_b32 s94, 0x44444444
    s_mov_b32 s95, 0x44444444
    s_mov_b32 s96, 0x88888888
    s_mov_b32 s97, 0x88888888
    s_add_u32 s88, s3, 1
    s_and_b32 s88, s88, 3
    s_lshl_b32 s88, s88, 10
    v_add_u32 v12, s88, v1
    s_add_u32 s88, s3, 2
    s_and_b32 s88, s88, 3
    s_lshl_b32 s88, s88, 10
    v_add_u32 v13, s88, v1
    s_add_u32 s88, s3, 3
    s_and_b32 s88, s88, 3
    s_lshl_b32 s88, s88, 10
    v_add_u32 v14, s88, v1
    s_add_u32 s88, s3, 4
    s_and_b32 s88, s88, 3
    s_lshl_b32 s88, s88, 10
    v_add_u32 v15, s88, v1
    s_waitcnt vmcnt(1)
    s_barrier
    s_nop 2
    s_cmp_eq_u32 s3, 0
    s_cbranch_scc0 L_inte_others_32
    s_and_b32 s89, s2, 15
    s_cmp_lt_u32 s89, 0
    s_cselect_b32 s90, 17, 16
    s_add_u32 s89, s89, 32
    s_lshl_b32 s88, s89, 8
    s_add_u32 s88, s88, 0x2350000
    v_mov_b32 v16, 1
    v_mov_b32 v17, 1
    s_mov_b64 exec, 1
    buffer_atomic_add v16, off, s[8:11], s88 sc0 sc1
    s_waitcnt vmcnt(0)
    v_readfirstlane_b32 s91, v16
    s_add_u32 s88, s88, 4096
    s_nop 2
    s_add_u32 s91, s91, 1
    s_cmp_eq_u32 s91, s90
    s_cbranch_scc0 L_inte_notlast_34
    buffer_store_dword v17, off, s[8:11], s88 sc1
L_inte_notlast_34:
    s_mov_b64 exec, -1
    s_mov_b32 s91, 0
    v_cmp_eq_u32 vcc, 0, v23
    s_nop 3
    s_cmp_eq_u64 vcc, 0
    s_cbranch_scc1 L_inte_ok_36
L_inte_again_35:
    buffer_load_dword v23, v22, s[8:11], 0 offen sc1
    s_add_u32 s91, s91, 1
    s_waitcnt vmcnt(0)
    v_cmp_eq_u32 vcc, 0, v23
    s_cmp_ge_u32 s91, 500000
    s_cbranch_scc1 L_inte_ok_36
    s_nop 1
    s_cmp_eq_u64 vcc, 0
    s_cbranch_scc0 L_inte_again_35
L_inte_ok_36:
    s_lshl1_add_u32 s89, s43, s84
    buffer_load_dwordx4 a[0:3], v1, s[8:11], s89 offen offset:0
    buffer_load_dwordx4 a[4:7], v1, s[8:11], s89 offen offset:1024
    buffer_load_dwordx4 a[8:11], v1, s[8:11], s89 offen offset:2048
    buffer_load_dwordx4 a[12:15], v1, s[8:11], s89 offen offset:3072
    s_add_u32 s89, s89, 4096
    buffer_load_dwordx4 a[16:19], v1, s[8:11], s89 offen offset:0
    s_lshl1_add_u32 s89, s44, s84
    buffer_load_dwordx4 a[20:23], v1, s[8:11], s89 offen offset:0
    buffer_load_dwordx4 a[24:27], v1, s[8:11], s89 offen offset:1024
    buffer_load_dwordx4 a[28:31], v1, s[8:11], s89 offen offset:2048
    buffer_load_dwordx4 a[32:35], v1, s[8:11], s89 offen offset:3072
    s_add_u32 s89, s89, 4096
    buffer_load_dwordx4 a[36:39], v1, s[8:11], s89 offen offset:0
    s_lshl1_add_u32 s89, s45, s84
    buffer_load_dwordx4 a[40:43], v1, s[8:11], s89 offen offset:0
    buffer_load_dwordx4 a[44:47], v1, s[8:11], s89 offen offset:1024
    buffer_load_dwordx4 a[48:51], v1, s[8:11], s89 offen offset:2048
    buffer_load_dwordx4 a[52:55], v1, s[8:11], s89 offen offset:3072
    s_add_u32 s89, s89, 4096
    buffer_load_dwordx4 a[56:59], v1, s[8:11], s89 offen offset:0
    s_lshl1_add_u32 s89, s46, s84
    buffer_load_dwordx4 a[60:63], v1, s[8:11], s89 offen offset:0
    buffer_load_dwordx4 a[64:67], v1, s[8:11], s89 offen offset:1024
    buffer_load_dwordx4 a[68:71], v1, s[8:11], s89 offen offset:2048
    buffer_load_dwordx4 a[72:75], v1, s[8:11], s89 offen offset:3072
    s_add_u32 s89, s89, 4096
    buffer_load_dwordx4 a[76:79], v1, s[8:11], s89 offen offset:0
    s_mov_b32 s89, s85
    buffer_load_dwordx4 a[80:83], v1, s[8:11], s89 offen offset:0
    buffer_load_dwordx4 a[84:87], v1, s[8:11], s89 offen offset:1024
    buffer_load_dwordx4 a[88:91], v1, s[8:11], s89 offen offset:2048
    buffer_load_dwordx4 a[92:95], v1, s[8:11], s89 offen offset:3072
    s_add_u32 s89, s89, 4096
    buffer_load_dwordx4 a[96:99], v1, s[8:11], s89 offen offset:0
    s_mov_b32 s89, s86
    buffer_load_dwordx4 a[100:103], v1, s[8:11], s89 offen offset:0
    buffer_load_dwordx4 a[104:107], v1, s[8:11], s89 offen offset:1024
    buffer_load_dwordx4 a[108:111], v1, s[8:11], s89 offen offset:2048
    buffer_load_dwordx4 a[112:115], v1, s[8:11], s89 offen offset:3072
    s_add_u32 s89, s89, 4096
    buffer_load_dwordx4 a[116:119], v1, s[8:11], s89 offen offset:0
    v_and_b32 v18, 15, v0
    v_lshlrev_b32 v18, 8, v18
    v_add_u32 v18, 0x2353000, v18
    buffer_load_dword v19, v18, s[8:11], 0 offen sc1
    s_mov_b32 s91, 0
    s_waitcnt vmcnt(0)
    v_cmp_eq_u32 vcc, 0, v19
    s_nop 3
    s_cmp_eq_u64 vcc, 0
    s_cbranch_scc1 L_inte_ok_38
L_inte_again_37:
    buffer_load_dword v19, v18, s[8:11], 0 offen sc1
    s_add_u32 s91, s91, 1
    s_waitcnt vmcnt(0)
    v_cmp_eq_u32 vcc, 0, v19
    s_cmp_ge_u32 s91, 500000
    s_cbranch_scc1 L_inte_ok_38
    s_nop 1
    s_cmp_eq_u64 vcc, 0
    s_cbranch_scc0 L_inte_again_37
L_inte_ok_38:
    s_branch L_inte_join_33
L_inte_others_32:
    s_mov_b32 s91, 0
    s_waitcnt vmcnt(0)
    v_cmp_eq_u32 vcc, 0, v23
    s_nop 3
    s_cmp_eq_u64 vcc, 0
    s_cbranch_scc1 L_inte_ok_40
L_inte_again_39:
    buffer_load_dword v23, v22, s[8:11], 0 offen sc1
    s_add_u32 s91, s91, 1
    s_waitcnt vmcnt(0)
    v_cmp_eq_u32 vcc, 0, v23
    s_cmp_ge_u32 s91, 500000
    s_cbranch_scc1 L_inte_ok_40
    s_nop 1
    s_cmp_eq_u64 vcc, 0
    s_cbranch_scc0 L_inte_again_39
L_inte_ok_40:
    s_add_u32 s89, s75, -1024
    s_add_u32 s88, s69, -1024
    s_add_u32 m0, s88, 0
    s_nop 0
    buffer_load_dwordx4 v1, s[8:11], s89 offen lds
    s_add_u32 m0, s88, 3072
    s_add_u32 s89, s89, 3072
    buffer_load_dwordx4 v1, s[8:11], s89 offen lds
    s_add_u32 m0, s88, 6144
    s_add_u32 s89, s89, 3072
    buffer_load_dwordx4 v1, s[8:11], s89 offen lds
    s_add_u32 m0, s88, 9216
    s_add_u32 s89, s89, 3072
    buffer_load_dwordx4 v1, s[8:11], s89 offen lds
    s_add_u32 m0, s88, 12288
    s_add_u32 s89, s89, 3072
    buffer_load_dwordx4 v1, s[8:11], s89 offen lds
    s_add_u32 m0, s88, 15360
    s_add_u32 s89, s89, 3072
    buffer_load_dwordx4 v1, s[8:11], s89 offen lds
    s_add_u32 m0, s88, 18432
    s_add_u32 s89, s89, 3072
    buffer_load_dwordx4 v1, s[8:11], s89 offen lds
    s_add_u32 m0, s88, 21504
    s_add_u32 s89, s89, 3072
    buffer_load_dwordx4 v1, s[8:11], s89 offen lds
    s_add_u32 m0, s88, 24576
    s_add_u32 s89, s89, 3072
    buffer_load_dwordx4 v1, s[8:11], s89 offen lds
    s_add_u32 m0, s88, 27648
    s_add_u32 s89, s89, 3072
    buffer_load_dwordx4 v1, s[8:11], s89 offen lds
    s_add_u32 m0, s88, 30720
    s_add_u32 s89, s89, 3072
    buffer_load_dwordx4 v1, s[8:11], s89 offen lds
    s_add_u32 m0, s88, 33792
    s_add_u32 s89, s89, 3072
    buffer_load_dwordx4 v1, s[8:11], s89 offen lds
    s_add_u32 m0, s88, 36864
    s_add_u32 s89, s89, 3072
    buffer_load_dwordx4 v1, s[8:11], s89 offen lds
    s_add_u32 m0, s88, 39936
    s_add_u32 s89, s89, 3072
    buffer_load_dwordx4 v1, s[8:11], s89 offen lds
    s_add_u32 m0, s88, 43008
    s_add_u32 s89, s89, 3072
    buffer_load_dwordx4 v1, s[8:11], s89 offen lds
    s_add_u32 m0, s88, 46080
    s_add_u32 s89, s89, 3072
    buffer_load_dwordx4 v1, s[8:11], s89 offen lds
    s_add_u32 m0, s88, 49152
    s_add_u32 s89, s89, 3072
    buffer_load_dwordx4 v1, s[8:11], s89 offen lds
    s_add_u32 m0, s88, 52224
    s_add_u32 s89, s89, 3072
    buffer_load_dwordx4 v1, s[8:11], s89 offen lds
    s_add_u32 m0, s88, 55296
    s_add_u32 s89, s89, 3072
    buffer_load_dwordx4 v1, s[8:11], s89 offen lds
    s_add_u32 m0, s88, 58368
    s_add_u32 s89, s89, 3072
    buffer_load_dwordx4 v1, s[8:11], s89 offen lds
    s_add_u32 m0, s88, 61440
    s_add_u32 s89, s89, 3072
    buffer_load_dwordx4 v1, s[8:11], s89 offen lds
    s_add_u32 m0, s88, 64512
    s_add_u32 s89, s89, 3072
    buffer_load_dwordx4 v1, s[8:11], s89 offen lds
    s_add_u32 m0, s88, 67584
    s_add_u32 s89, s89, 3072
    buffer_load_dwordx4 v1, s[8:11], s89 offen lds
    s_add_u32 m0, s88, 70656
    s_add_u32 s89, s89, 3072
    buffer_load_dwordx4 v1, s[8:11], s89 offen lds
    s_add_u32 m0, s88, 73728
    s_add_u32 s89, s89, 3072
    buffer_load_dwordx4 v1, s[8:11], s89 offen lds
    s_add_u32 m0, s88, 76800
    s_add_u32 s89, s89, 3072
    buffer_load_dwordx4 v1, s[8:11], s89 offen lds
    s_add_u32 m0, s88, 79872
    s_add_u32 s89, s89, 3072
    buffer_load_dwordx4 v1, s[8:11], s89 offen lds
    s_add_u32 m0, s88, 82944
    s_add_u32 s89, s89, 3072
    buffer_load_dwordx4 v1, s[8:11], s89 offen lds
    s_add_u32 m0, s88, 86016
    s_add_u32 s89, s89, 3072
    buffer_load_dwordx4 v1, s[8:11], s89 offen lds
    s_add_u32 m0, s88, 89088
    s_add_u32 s89, s89, 3072
    buffer_load_dwordx4 v1, s[8:11], s89 offen lds
    s_add_u32 m0, s88, 92160
    s_add_u32 s89, s89, 3072
    buffer_load_dwordx4 v1, s[8:11], s89 offen lds
    s_add_u32 m0, s88, 95232
    s_add_u32 s89, s89, 3072
    buffer_load_dwordx4 v1, s[8:11], s89 offen lds
    s_add_u32 m0, s88, 98304
    s_add_u32 s89, s89, 3072
    buffer_load_dwordx4 v1, s[8:11], s89 offen lds
    s_add_u32 m0, s88, 101376
    s_add_u32 s89, s89, 3072
    buffer_load_dwordx4 v1, s[8:11], s89 offen lds
    s_add_u32 m0, s88, 104448
    s_add_u32 s89, s89, 3072
    buffer_load_dwordx4 v1, s[8:11], s89 offen lds
    s_add_u32 m0, s88, 107520
    s_add_u32 s89, s89, 3072
    buffer_load_dwordx4 v1, s[8:11], s89 offen lds
    s_add_u32 m0, s88, 110592
    s_add_u32 s89, s89, 3072
    buffer_load_dwordx4 v1, s[8:11], s89 offen lds
    s_add_u32 m0, s88, 113664
    s_add_u32 s89, s89, 3072
    buffer_load_dwordx4 v1, s[8:11], s89 offen lds
    s_add_u32 m0, s88, 116736
    s_add_u32 s89, s89, 3072
    buffer_load_dwordx4 v1, s[8:11], s89 offen lds
    s_add_u32 m0, s88, 119808
    s_add_u32 s89, s89, 3072
    buffer_load_dwordx4 v1, s[8:11], s89 offen lds
    s_add_u32 m0, s88, 122880
    s_add_u32 s89, s89, 3072
    buffer_load_dwordx4 v1, s[8:11], s89 offen lds
    s_add_u32 m0, s88, 125952
    s_add_u32 s89, s89, 3072
    buffer_load_dwordx4 v1, s[8:11], s89 offen lds
    s_add_u32 m0, s88, 129024
    s_add_u32 s89, s89, 3072
    buffer_load_dwordx4 v1, s[8:11], s89 offen lds
    s_add_u32 m0, s88, 132096
    s_add_u32 s89, s89, 3072
    buffer_load_dwordx4 v1, s[8:11], s89 offen lds
    s_add_u32 m0, s88, 135168
    s_add_u32 s89, s89, 3072
    buffer_load_dwordx4 v1, s[8:11], s89 offen lds
    s_add_u32 m0, s88, 138240
    s_add_u32 s89, s89, 3072
    buffer_load_dwordx4 v1, s[8:11], s89 offen lds
    s_add_u32 m0, s88, 141312
    s_add_u32 s89, s89, 3072
    buffer_load_dwordx4 v1, s[8:11], s89 offen lds
    s_add_u32 m0, s88, 144384
    s_add_u32 s89, s89, 3072
    buffer_load_dwordx4 v1, s[8:11], s89 offen lds
    s_add_u32 m0, s88, 147456
    s_add_u32 s89, s89, 3072
    buffer_load_dwordx4 v1, s[8:11], s89 offen lds
    s_lshl1_add_u32 s89, s43, s84
    buffer_load_dwordx4 a[0:3], v1, s[8:11], s89 offen offset:0
    buffer_load_dwordx4 a[4:7], v1, s[8:11], s89 offen offset:1024
    buffer_load_dwordx4 a[8:11], v1, s[8:11], s89 offen offset:2048
    buffer_load_dwordx4 a[12:15], v1, s[8:11], s89 offen offset:3072
    s_add_u32 s89, s89, 4096
    buffer_load_dwordx4 a[16:19], v1, s[8:11], s89 offen offset:0
    s_lshl1_add_u32 s89, s44, s84
    buffer_load_dwordx4 a[20:23], v1, s[8:11], s89 offen offset:0
    buffer_load_dwordx4 a[24:27], v1, s[8:11], s89 offen offset:1024
    buffer_load_dwordx4 a[28:31], v1, s[8:11], s89 offen offset:2048
    buffer_load_dwordx4 a[32:35], v1, s[8:11], s89 offen offset:3072
    s_add_u32 s89, s89, 4096
    buffer_load_dwordx4 a[36:39], v1, s[8:11], s89 offen offset:0
    s_lshl1_add_u32 s89, s45, s84
    buffer_load_dwordx4 a[40:43], v1, s[8:11], s89 offen offset:0
    buffer_load_dwordx4 a[44:47], v1, s[8:11], s89 offen offset:1024
    buffer_load_dwordx4 a[48:51], v1, s[8:11], s89 offen offset:2048
    buffer_load_dwordx4 a[52:55], v1, s[8:11], s89 offen offset:3072
    s_add_u32 s89, s89, 4096
    buffer_load_dwordx4 a[56:59], v1, s[8:11], s89 offen offset:0
    s_lshl1_add_u32 s89, s46, s84
    buffer_load_dwordx4 a[60:63], v1, s[8:11], s89 offen offset:0
    buffer_load_dwordx4 a[64:67], v1, s[8:11], s89 offen offset:1024
    buffer_load_dwordx4 a[68:71], v1, s[8:11], s89 offen offset:2048
    buffer_load_dwordx4 a[72:75], v1, s[8:11], s89 offen offset:3072
    s_add_u32 s89, s89, 4096
    buffer_load_dwordx4 a[76:79], v1, s[8:11], s89 offen offset:0
    s_mov_b32 s89, s85
    buffer_load_dwordx4 a[80:83], v1, s[8:11], s89 offen offset:0
    buffer_load_dwordx4 a[84:87], v1, s[8:11], s89 offen offset:1024
    buffer_load_dwordx4 a[88:91], v1, s[8:11], s89 offen offset:2048
    buffer_load_dwordx4 a[92:95], v1, s[8:11], s89 offen offset:3072
    s_add_u32 s89, s89, 4096
    buffer_load_dwordx4 a[96:99], v1, s[8:11], s89 offen offset:0
    s_mov_b32 s89, s86
    buffer_load_dwordx4 a[100:103], v1, s[8:11], s89 offen offset:0
    buffer_load_dwordx4 a[104:107], v1, s[8:11], s89 offen offset:1024
    buffer_load_dwordx4 a[108:111], v1, s[8:11], s89 offen offset:2048
    buffer_load_dwordx4 a[112:115], v1, s[8:11], s89 offen offset:3072
    s_add_u32 s89, s89, 4096
    buffer_load_dwordx4 a[116:119], v1, s[8:11], s89 offen offset:0
L_inte_join_33:
    s_barrier
    s_branch L_inte_go_21
L_inte_idle_20:
    s_waitcnt vmcnt(0)
    s_barrier
    s_cmp_eq_u32 s3, 0
    s_cbranch_scc0 L_inte_others_41
    s_mov_b32 s16, s34
    s_mov_b32 s17, s35
    s_mov_b32 s18, 0x100
    s_mov_b32 s19, 0x00020000
    s_mov_b32 s91, 0
L_inte_again_45:
    buffer_load_dword v16, off, s[16:19], 0 sc1
    s_add_u32 s91, s91, 1
    s_waitcnt vmcnt(0)
    v_readfirstlane_b32 s88, v16
    s_cmp_ge_u32 s91, 500000
    s_cbranch_scc1 L_inte_ok_46
    s_nop 1
    s_cmp_eq_u32 s88, 1
    s_cbranch_scc0 L_inte_again_45
L_inte_ok_46:
    s_cmp_eq_u32 s23, 0
    s_cbranch_scc0 L_inte_wjob_43
    s_and_b32 s89, s2, 15
    s_cmp_lt_u32 s89, 0
    s_cselect_b32 s90, 9, 8
    s_add_u32 s89, s89, 0
    s_lshl_b32 s88, s89, 8
    s_add_u32 s88, s88, 0x2350000
    v_mov_b32 v16, 1
    v_mov_b32 v17, 1
    s_mov_b64 exec, 1
    buffer_atomic_add v16, off, s[8:11], s88 sc0 sc1
    s_waitcnt vmcnt(0)
    v_readfirstlane_b32 s91, v16
    s_add_u32 s88, s88, 4096
    s_nop 2
    s_add_u32 s91, s91, 1
    s_cmp_eq_u32 s91, s90
    s_cbranch_scc0 L_inte_notlast_47
    buffer_store_dword v17, off, s[8:11], s88 sc1
L_inte_notlast_47:
    s_mov_b64 exec, -1
    s_branch L_inte_nojob_44
L_inte_wjob_43:
    s_cmp_eq_u32 s23, 2
    s_cbranch_scc1 L_inte_nojob_44
    s_and_b32 s89, s38, 15
    s_cmp_lt_u32 s89, 15
    s_cselect_b32 s90, 8, 7
    s_add_u32 s89, s89, 128
    s_lshl_b32 s88, s89, 8
    s_add_u32 s88, s88, 0x2350000
    v_mov_b32 v16, 1
    v_mov_b32 v17, 1
    s_mov_b64 exec, 1
    buffer_atomic_add v16, off, s[8:11], s88 sc0 sc1
    s_waitcnt vmcnt(0)
    v_readfirstlane_b32 s91, v16
    s_add_u32 s88, s88, 4096
    s_nop 2
    s_add_u32 s91, s91, 1
    s_cmp_eq_u32 s91, s90
    s_cbranch_scc0 L_inte_notlast_48
    buffer_store_dword v17, off, s[8:11], s88 sc1
L_inte_notlast_48:
    s_mov_b64 exec, -1
L_inte_nojob_44:
    s_branch L_inte_join_42
L_inte_others_41:
L_inte_join_42:
    s_barrier
    v_lshlrev_b32 v1, 4, v0
    v_add_u32 v2, 27648, v1
    v_add_u32 v3, 68608, v1
    v_add_u32 v4, 109568, v1
    v_and_b32 v16, 15, v0
    v_lshrrev_b32 v17, 4, v0
    v_lshlrev_b32 v18, 4, v16
    v_lshl_add_u32 v5, v17, 9, v18
    s_mul_i32 s88, s71, 3
    v_add_u32 v19, s88, v17
    v_and_b32 v20, 1, v19
    v_lshl_add_u32 v18, v20, 3, v18
    v_bfe_u32 v20, v19, 1, 2
    v_lshl_add_u32 v18, v20, 8, v18
    v_lshrrev_b32 v20, 3, v19
    v_add_u32 v20, 48, v20
    v_lshl_add_u32 v18, v20, 12, v18
    v_add_u32 v19, 1, v17
    v_lshrrev_b32 v19, 2, v19
    v_lshl_add_u32 v6, v19, 30, v18
    v_lshrrev_b32 v19, 2, v16
    v_lshl_add_u32 v19, v19, 4, v16
    v_lshlrev_b32 v7, 2, v19
    v_add_lshl_u32 v10, v16, 48, 2
    s_lshl_b32 s88, s3, 7
    s_add_u32 s88, s88, 151552
    v_lshl_add_u32 v11, v16, 2, s88
    v_min_u32 v16, 1, v0
    v_lshlrev_b32 v8, 30, v16
    v_mov_b32 v9, 1
    s_mov_b32 s92, 0x22222222
    s_mov_b32 s93, 0x22222222
    s_mov_b32 s94, 0x44444444
    s_mov_b32 s95, 0x44444444
    s_mov_b32 s96, 0x88888888
    s_mov_b32 s97, 0x88888888
    s_add_u32 s88, s3, 1
    s_and_b32 s88, s88, 3
    s_lshl_b32 s88, s88, 10
    v_add_u32 v12, s88, v1
    s_add_u32 s88, s3, 2
    s_and_b32 s88, s88, 3
    s_lshl_b32 s88, s88, 10
    v_add_u32 v13, s88, v1
    s_add_u32 s88, s3, 3
    s_and_b32 s88, s88, 3
    s_lshl_b32 s88, s88, 10
    v_add_u32 v14, s88, v1
    s_add_u32 s88, s3, 4
    s_and_b32 s88, s88, 3
    s_lshl_b32 s88, s88, 10
    v_add_u32 v15, s88, v1
    s_sub_u32 s88, s22, 54
    s_cmp_lt_u32 s88, 36
    s_cbranch_scc0 L_inte_nosecond_49
    buffer_store_dwordx4 v[24:27], v68, s[8:11], s47 offen offset:0 sc1
    buffer_store_dwordx4 v[28:31], v68, s[8:11], s47 offen offset:128 sc1
    buffer_store_dwordx4 v[32:35], v68, s[8:11], s47 offen offset:2048 sc1
    buffer_store_dwordx4 v[36:39], v68, s[8:11], s47 offen offset:2176 sc1
    buffer_store_dwordx4 v[40:43], v69, s[8:11], s47 offen sc1
    buffer_store_dwordx4 v[44:47], v68, s[8:11], s48 offen offset:0 sc1
    buffer_store_dwordx4 v[48:51], v68, s[8:11], s48 offen offset:128 sc1
    buffer_store_dwordx4 v[52:55], v68, s[8:11], s48 offen offset:2048 sc1
    buffer_store_dwordx4 v[56:59], v68, s[8:11], s48 offen offset:2176 sc1
    buffer_store_dwordx4 v[60:63], v69, s[8:11], s48 offen sc1
    s_nop 1
L_inte_nosecond_49:
    v_mov_b32 v64, -1
    v_mov_b32 v65, -1
    v_mov_b32 v66, -1
    v_mov_b32 v67, -1
    s_add_u32 s12, s36, 0xf00000
    s_addc_u32 s13, s37, 0
    s_mov_b32 s14, 7077888
    s_mov_b32 s15, 0x00020000
    s_lshl_b32 s90, s22, 2
    s_add_u32 s90, s90, s3
    s_sub_u32 s89, s90, 216
    s_max_i32 s89, s89, 0
    s_min_u32 s89, s89, 144
    s_mul_i32 s90, s90, 23
    s_mul_i32 s89, s89, 10
    s_sub_u32 s90, s90, s89
    s_lshl_b32 s90, s90, 10
    buffer_store_dwordx4 v[64:67], v1, s[12:15], s90 offen offset:0 sc1
    buffer_store_dwordx4 v[64:67], v1, s[12:15], s90 offen offset:1024 sc1
    buffer_store_dwordx4 v[64:67], v1, s[12:15], s90 offen offset:2048 sc1
    buffer_store_dwordx4 v[64:67], v1, s[12:15], s90 offen offset:3072 sc1
    s_add_u32 s90, s90, 4096
    buffer_store_dwordx4 v[64:67], v1, s[12:15], s90 offen offset:0 sc1
    buffer_store_dwordx4 v[64:67], v1, s[12:15], s90 offen offset:1024 sc1
    buffer_store_dwordx4 v[64:67], v1, s[12:15], s90 offen offset:2048 sc1
    buffer_store_dwordx4 v[64:67], v1, s[12:15], s90 offen offset:3072 sc1
    s_add_u32 s90, s90, 4096
    buffer_store_dwordx4 v[64:67], v1, s[12:15], s90 offen offset:0 sc1
    buffer_store_dwordx4 v[64:67], v1, s[12:15], s90 offen offset:1024 sc1
    buffer_store_dwordx4 v[64:67], v1, s[12:15], s90 offen offset:2048 sc1
    buffer_store_dwordx4 v[64:67], v1, s[12:15], s90 offen offset:3072 sc1
    s_add_u32 s90, s90, 4096
    buffer_store_dwordx4 v[64:67], v1, s[12:15], s90 offen offset:0 sc1
    s_sub_u32 s88, s22, 54
    s_cmp_lt_u32 s88, 36
    s_cbranch_scc1 L_inte_marked_50
    buffer_store_dwordx4 v[64:67], v1, s[12:15], s90 offen offset:1024 sc1
    buffer_store_dwordx4 v[64:67], v1, s[12:15], s90 offen offset:2048 sc1
    buffer_store_dwordx4 v[64:67], v1, s[12:15], s90 offen offset:3072 sc1
    s_add_u32 s90, s90, 4096
    buffer_store_dwordx4 v[64:67], v1, s[12:15], s90 offen offset:0 sc1
    buffer_store_dwordx4 v[64:67], v1, s[12:15], s90 offen offset:1024 sc1
    buffer_store_dwordx4 v[64:67], v1, s[12:15], s90 offen offset:2048 sc1
    buffer_store_dwordx4 v[64:67], v1, s[12:15], s90 offen offset:3072 sc1
    s_add_u32 s90, s90, 4096
    buffer_store_dwordx4 v[64:67], v1, s[12:15], s90 offen offset:0 sc1
    buffer_store_dwordx4 v[64:67], v1, s[12:15], s90 offen offset:1024 sc1
    buffer_store_dwordx4 v[64:67], v1, s[12:15], s90 offen offset:2048 sc1
L_inte_marked_50:
    v_and_b32 v22, 15, v0
    v_lshlrev_b32 v22, 8, v22
    v_add_u32 v22, 0x2359000, v22
    buffer_load_dword v23, v22, s[8:11], 0 offen sc1
    s_waitcnt vmcnt(0)
    s_mov_b32 s91, 0
    v_cmp_eq_u32 vcc, 0, v23
    s_nop 3
    s_cmp_eq_u64 vcc, 0
    s_cbranch_scc1 L_inte_ok_52
L_inte_again_51:
    buffer_load_dword v23, v22, s[8:11], 0 offen sc1
    s_add_u32 s91, s91, 1
    s_waitcnt vmcnt(0)
    v_cmp_eq_u32 vcc, 0, v23
    s_cmp_ge_u32 s91, 500000
    s_cbranch_scc1 L_inte_ok_52
    s_nop 1
    s_cmp_eq_u64 vcc, 0
    s_cbranch_scc0 L_inte_again_51
L_inte_ok_52:
    s_barrier
    s_cmp_eq_u32 s3, 0
    s_cbranch_scc0 L_inte_others_53
    s_and_b32 s89, s2, 15
    s_cmp_lt_u32 s89, 0
    s_cselect_b32 s90, 17, 16
    s_add_u32 s89, s89, 32
    s_lshl_b32 s88, s89, 8
    s_add_u32 s88, s88, 0x2350000
    v_mov_b32 v16, 1
    v_mov_b32 v17, 1
    s_mov_b64 exec, 1
    buffer_atomic_add v16, off, s[8:11], s88 sc0 sc1
    s_waitcnt vmcnt(0)
    v_readfirstlane_b32 s91, v16
    s_add_u32 s88, s88, 4096
    s_nop 2
    s_add_u32 s91, s91, 1
    s_cmp_eq_u32 s91, s90
    s_cbranch_scc0 L_inte_notlast_55
    buffer_store_dword v17, off, s[8:11], s88 sc1
L_inte_notlast_55:
    s_mov_b64 exec, -1
    s_branch L_inte_join_54
L_inte_others_53:
    s_add_u32 s89, s75, -1024
    s_add_u32 s88, s69, -1024
    s_add_u32 m0, s88, 0
    s_nop 0
    buffer_load_dwordx4 v1, s[8:11], s89 offen lds
    s_add_u32 m0, s88, 3072
    s_add_u32 s89, s89, 3072
    buffer_load_dwordx4 v1, s[8:11], s89 offen lds
    s_add_u32 m0, s88, 6144
    s_add_u32 s89, s89, 3072
    buffer_load_dwordx4 v1, s[8:11], s89 offen lds
    s_add_u32 m0, s88, 9216
    s_add_u32 s89, s89, 3072
    buffer_load_dwordx4 v1, s[8:11], s89 offen lds
    s_add_u32 m0, s88, 12288
    s_add_u32 s89, s89, 3072
    buffer_load_dwordx4 v1, s[8:11], s89 offen lds
    s_add_u32 m0, s88, 15360
    s_add_u32 s89, s89, 3072
    buffer_load_dwordx4 v1, s[8:11], s89 offen lds
    s_add_u32 m0, s88, 18432
    s_add_u32 s89, s89, 3072
    buffer_load_dwordx4 v1, s[8:11], s89 offen lds
    s_add_u32 m0, s88, 21504
    s_add_u32 s89, s89, 3072
    buffer_load_dwordx4 v1, s[8:11], s89 offen lds
    s_add_u32 m0, s88, 24576
    s_add_u32 s89, s89, 3072
    buffer_load_dwordx4 v1, s[8:11], s89 offen lds
    s_add_u32 m0, s88, 27648
    s_add_u32 s89, s89, 3072
    buffer_load_dwordx4 v1, s[8:11], s89 offen lds
    s_add_u32 m0, s88, 30720
    s_add_u32 s89, s89, 3072
    buffer_load_dwordx4 v1, s[8:11], s89 offen lds
    s_add_u32 m0, s88, 33792
    s_add_u32 s89, s89, 3072
    buffer_load_dwordx4 v1, s[8:11], s89 offen lds
    s_add_u32 m0, s88, 36864
    s_add_u32 s89, s89, 3072
    buffer_load_dwordx4 v1, s[8:11], s89 offen lds
    s_add_u32 m0, s88, 39936
    s_add_u32 s89, s89, 3072
    buffer_load_dwordx4 v1, s[8:11], s89 offen lds
    s_add_u32 m0, s88, 43008
    s_add_u32 s89, s89, 3072
    buffer_load_dwordx4 v1, s[8:11], s89 offen lds
    s_add_u32 m0, s88, 46080
    s_add_u32 s89, s89, 3072
    buffer_load_dwordx4 v1, s[8:11], s89 offen lds
    s_add_u32 m0, s88, 49152
    s_add_u32 s89, s89, 3072
    buffer_load_dwordx4 v1, s[8:11], s89 offen lds
    s_add_u32 m0, s88, 52224
    s_add_u32 s89, s89, 3072
    buffer_load_dwordx4 v1, s[8:11], s89 offen lds
    s_add_u32 m0, s88, 55296
    s_add_u32 s89, s89, 3072
    buffer_load_dwordx4 v1, s[8:11], s89 offen lds
    s_add_u32 m0, s88, 58368
    s_add_u32 s89, s89, 3072
    buffer_load_dwordx4 v1, s[8:11], s89 offen lds
    s_add_u32 m0, s88, 61440
    s_add_u32 s89, s89, 3072
    buffer_load_dwordx4 v1, s[8:11], s89 offen lds
    s_add_u32 m0, s88, 64512
    s_add_u32 s89, s89, 3072
    buffer_load_dwordx4 v1, s[8:11], s89 offen lds
    s_add_u32 m0, s88, 67584
    s_add_u32 s89, s89, 3072
    buffer_load_dwordx4 v1, s[8:11], s89 offen lds
    s_add_u32 m0, s88, 70656
    s_add_u32 s89, s89, 3072
    buffer_load_dwordx4 v1, s[8:11], s89 offen lds
    s_add_u32 m0, s88, 73728
    s_add_u32 s89, s89, 3072
    buffer_load_dwordx4 v1, s[8:11], s89 offen lds
    s_add_u32 m0, s88, 76800
    s_add_u32 s89, s89, 3072
    buffer_load_dwordx4 v1, s[8:11], s89 offen lds
    s_add_u32 m0, s88, 79872
    s_add_u32 s89, s89, 3072
    buffer_load_dwordx4 v1, s[8:11], s89 offen lds
    s_add_u32 m0, s88, 82944
    s_add_u32 s89, s89, 3072
    buffer_load_dwordx4 v1, s[8:11], s89 offen lds
    s_add_u32 m0, s88, 86016
    s_add_u32 s89, s89, 3072
    buffer_load_dwordx4 v1, s[8:11], s89 offen lds
    s_add_u32 m0, s88, 89088
    s_add_u32 s89, s89, 3072
    buffer_load_dwordx4 v1, s[8:11], s89 offen lds
    s_add_u32 m0, s88, 92160
    s_add_u32 s89, s89, 3072
    buffer_load_dwordx4 v1, s[8:11], s89 offen lds
    s_add_u32 m0, s88, 95232
    s_add_u32 s89, s89, 3072
    buffer_load_dwordx4 v1, s[8:11], s89 offen lds
    s_add_u32 m0, s88, 98304
    s_add_u32 s89, s89, 3072
    buffer_load_dwordx4 v1, s[8:11], s89 offen lds
    s_add_u32 m0, s88, 101376
    s_add_u32 s89, s89, 3072
    buffer_load_dwordx4 v1, s[8:11], s89 offen lds
    s_add_u32 m0, s88, 104448
    s_add_u32 s89, s89, 3072
    buffer_load_dwordx4 v1, s[8:11], s89 offen lds
    s_add_u32 m0, s88, 107520
    s_add_u32 s89, s89, 3072
    buffer_load_dwordx4 v1, s[8:11], s89 offen lds
    s_add_u32 m0, s88, 110592
    s_add_u32 s89, s89, 3072
    buffer_load_dwordx4 v1, s[8:11], s89 offen lds
    s_add_u32 m0, s88, 113664
    s_add_u32 s89, s89, 3072
    buffer_load_dwordx4 v1, s[8:11], s89 offen lds
    s_add_u32 m0, s88, 116736
    s_add_u32 s89, s89, 3072
    buffer_load_dwordx4 v1, s[8:11], s89 offen lds
    s_add_u32 m0, s88, 119808
    s_add_u32 s89, s89, 3072
    buffer_load_dwordx4 v1, s[8:11], s89 offen lds
    s_add_u32 m0, s88, 122880
    s_add_u32 s89, s89, 3072
    buffer_load_dwordx4 v1, s[8:11], s89 offen lds
    s_add_u32 m0, s88, 125952
    s_add_u32 s89, s89, 3072
    buffer_load_dwordx4 v1, s[8:11], s89 offen lds
    s_add_u32 m0, s88, 129024
    s_add_u32 s89, s89, 3072
    buffer_load_dwordx4 v1, s[8:11], s89 offen lds
    s_add_u32 m0, s88, 132096
    s_add_u32 s89, s89, 3072
    buffer_load_dwordx4 v1, s[8:11], s89 offen lds
    s_add_u32 m0, s88, 135168
    s_add_u32 s89, s89, 3072
    buffer_load_dwordx4 v1, s[8:11], s89 offen lds
    s_add_u32 m0, s88, 138240
    s_add_u32 s89, s89, 3072
    buffer_load_dwordx4 v1, s[8:11], s89 offen lds
    s_add_u32 m0, s88, 141312
    s_add_u32 s89, s89, 3072
    buffer_load_dwordx4 v1, s[8:11], s89 offen lds
    s_add_u32 m0, s88, 144384
    s_add_u32 s89, s89, 3072
    buffer_load_dwordx4 v1, s[8:11], s89 offen lds
    s_add_u32 m0, s88, 147456
    s_add_u32 s89, s89, 3072
    buffer_load_dwordx4 v1, s[8:11], s89 offen lds
L_inte_join_54:
    s_barrier
    s_lshl1_add_u32 s89, s43, s84
    buffer_load_dwordx4 a[0:3], v1, s[8:11], s89 offen offset:0
    buffer_load_dwordx4 a[4:7], v1, s[8:11], s89 offen offset:1024
    buffer_load_dwordx4 a[8:11], v1, s[8:11], s89 offen offset:2048
    buffer_load_dwordx4 a[12:15], v1, s[8:11], s89 offen offset:3072
    s_add_u32 s89, s89, 4096
    buffer_load_dwordx4 a[16:19], v1, s[8:11], s89 offen offset:0
    s_lshl1_add_u32 s89, s44, s84
    buffer_load_dwordx4 a[20:23], v1, s[8:11], s89 offen offset:0
    buffer_load_dwordx4 a[24:27], v1, s[8:11], s89 offen offset:1024
    buffer_load_dwordx4 a[28:31], v1, s[8:11], s89 offen offset:2048
    buffer_load_dwordx4 a[32:35], v1, s[8:11], s89 offen offset:3072
    s_add_u32 s89, s89, 4096
    buffer_load_dwordx4 a[36:39], v1, s[8:11], s89 offen offset:0
    s_lshl1_add_u32 s89, s45, s84
    buffer_load_dwordx4 a[40:43], v1, s[8:11], s89 offen offset:0
    buffer_load_dwordx4 a[44:47], v1, s[8:11], s89 offen offset:1024
    buffer_load_dwordx4 a[48:51], v1, s[8:11], s89 offen offset:2048
    buffer_load_dwordx4 a[52:55], v1, s[8:11], s89 offen offset:3072
    s_add_u32 s89, s89, 4096
    buffer_load_dwordx4 a[56:59], v1, s[8:11], s89 offen offset:0
    s_lshl1_add_u32 s89, s46, s84
    buffer_load_dwordx4 a[60:63], v1, s[8:11], s89 offen offset:0
    buffer_load_dwordx4 a[64:67], v1, s[8:11], s89 offen offset:1024
    buffer_load_dwordx4 a[68:71], v1, s[8:11], s89 offen offset:2048
    buffer_load_dwordx4 a[72:75], v1, s[8:11], s89 offen offset:3072
    s_add_u32 s89, s89, 4096
    buffer_load_dwordx4 a[76:79], v1, s[8:11], s89 offen offset:0
    s_mov_b32 s89, s85
    buffer_load_dwordx4 a[80:83], v1, s[8:11], s89 offen offset:0
    buffer_load_dwordx4 a[84:87], v1, s[8:11], s89 offen offset:1024
    buffer_load_dwordx4 a[88:91], v1, s[8:11], s89 offen offset:2048
    buffer_load_dwordx4 a[92:95], v1, s[8:11], s89 offen offset:3072
    s_add_u32 s89, s89, 4096
    buffer_load_dwordx4 a[96:99], v1, s[8:11], s89 offen offset:0
    s_mov_b32 s89, s86
    buffer_load_dwordx4 a[100:103], v1, s[8:11], s89 offen offset:0
    buffer_load_dwordx4 a[104:107], v1, s[8:11], s89 offen offset:1024
    buffer_load_dwordx4 a[108:111], v1, s[8:11], s89 offen offset:2048
    buffer_load_dwordx4 a[112:115], v1, s[8:11], s89 offen offset:3072
    s_add_u32 s89, s89, 4096
    buffer_load_dwordx4 a[116:119], v1, s[8:11], s89 offen offset:0
    s_cmp_eq_u32 s3, 0
    s_cbranch_scc0 L_inte_others_56
    v_and_b32 v18, 15, v0
    v_lshlrev_b32 v18, 8, v18
    v_add_u32 v18, 0x2353000, v18
    buffer_load_dword v19, v18, s[8:11], 0 offen sc1
    s_mov_b32 s91, 0
    s_waitcnt vmcnt(0)
    v_cmp_eq_u32 vcc, 0, v19
    s_nop 3
    s_cmp_eq_u64 vcc, 0
    s_cbranch_scc1 L_inte_ok_59
L_inte_again_58:
    buffer_load_dword v19, v18, s[8:11], 0 offen sc1
    s_add_u32 s91, s91, 1
    s_waitcnt vmcnt(0)
    v_cmp_eq_u32 vcc, 0, v19
    s_cmp_ge_u32 s91, 500000
    s_cbranch_scc1 L_inte_ok_59
    s_nop 1
    s_cmp_eq_u64 vcc, 0
    s_cbranch_scc0 L_inte_again_58
L_inte_ok_59:
    s_branch L_inte_join_57
L_inte_others_56:
L_inte_join_57:
    s_barrier
L_inte_go_21:
L_go0:
    s_mov_b32 s52, s74
    buffer_load_dwordx4 v[96:99], v5, s[8:11], s74 offen offset:0 sc1
    buffer_load_dwordx4 v[100:103], v5, s[8:11], s74 offen offset:256 sc1
    buffer_load_dwordx4 v[104:107], v5, s[8:11], s74 offen offset:2048 sc1
    buffer_load_dwordx4 v[108:111], v5, s[8:11], s74 offen offset:2304 sc1
    s_add_u32 s74, s74, 4096
    buffer_load_dwordx4 v[112:115], v5, s[8:11], s74 offen offset:0 sc1
    buffer_load_dwordx4 v[116:119], v5, s[8:11], s74 offen offset:256 sc1
    buffer_load_dwordx4 v[120:123], v5, s[8:11], s74 offen offset:2048 sc1
    buffer_load_dwordx4 v[124:127], v5, s[8:11], s74 offen offset:2304 sc1
    s_add_u32 s74, s74, 4096
    buffer_load_dwordx4 v[128:131], v5, s[8:11], s74 offen offset:0 sc1
    buffer_load_dwordx4 v[132:135], v5, s[8:11], s74 offen offset:256 sc1
    buffer_load_dwordx4 v[136:139], v5, s[8:11], s74 offen offset:2048 sc1
    buffer_load_dwordx4 v[140:143], v5, s[8:11], s74 offen offset:2304 sc1
    s_add_u32 s74, s74, 4096
    buffer_load_dwordx4 v[144:147], v5, s[8:11], s74 offen offset:0 sc1
    buffer_load_dwordx4 v[148:151], v5, s[8:11], s74 offen offset:256 sc1
    s_waitcnt vmcnt(12)
    s_barrier
    ds_read_b128 a[220:223], v1 offset:7168
    ds_read_b128 a[224:227], v2 offset:0
    ds_read_b128 a[228:231], v2 offset:20480
    ds_read_b128 a[232:235], v1 offset:8192
    ds_read_b128 a[236:239], v2 offset:1024
    ds_read_b128 a[240:243], v2 offset:21504
    s_waitcnt lgkmcnt(3)
    v_mfma_f32_16x16x32_bf16 v[64:67], a[220:223], v[96:99], 0
    ds_read_b128 a[244:247], v1 offset:9216
    v_mfma_f32_16x16x32_bf16 v[68:71], a[220:223], v[100:103], 0
    buffer_load_dwordx4 v[152:155], v5, s[8:11], s74 offen offset:2048 sc1
    v_mfma_f32_16x16x32_bf16 v[32:35], a[224:227], v[96:99], 0
    ds_read_b128 a[248:251], v2 offset:2048
    v_mfma_f32_16x16x32_bf16 v[40:43], a[224:227], v[100:103], 0
    v_mfma_f32_16x16x32_bf16 v[36:39], a[228:231], v[96:99], 0
    ds_read_b128 a[252:255], v2 offset:22528
    v_mfma_f32_16x16x32_bf16 v[44:47], a[228:231], v[100:103], 0
    buffer_load_dwordx4 v[156:159], v5, s[8:11], s74 offen offset:2304 sc1
    v_mfma_f32_16x16x32_bf16 v[72:75], v[96:99], v[96:99], 0
    ds_read_b128 a[220:223], v1 offset:10240
    v_mfma_f32_16x16x32_bf16 v[76:79], v[100:103], v[100:103], 0
    s_waitcnt vmcnt(12)
    s_waitcnt lgkmcnt(4)
    v_mfma_f32_16x16x32_bf16 v[64:67], a[232:235], v[104:107], v[64:67]
    ds_read_b128 a[224:227], v2 offset:3072
    v_mfma_f32_16x16x32_bf16 v[68:71], a[232:235], v[108:111], v[68:71]
    s_add_u32 s74, s74, 4096
    buffer_load_dwordx4 v[160:163], v5, s[8:11], s74 offen offset:0 sc1
    v_mfma_f32_16x16x32_bf16 v[32:35], a[236:239], v[104:107], v[32:35]
    ds_read_b128 a[228:231], v2 offset:23552
    v_mfma_f32_16x16x32_bf16 v[40:43], a[236:239], v[108:111], v[40:43]
    v_mfma_f32_16x16x32_bf16 v[36:39], a[240:243], v[104:107], v[36:39]
    ds_read_b128 a[232:235], v1 offset:11264
    v_mfma_f32_16x16x32_bf16 v[44:47], a[240:243], v[108:111], v[44:47]
    buffer_load_dwordx4 v[164:167], v5, s[8:11], s74 offen offset:256 sc1
    v_mfma_f32_16x16x32_bf16 v[72:75], v[104:107], v[104:107], v[72:75]
    ds_read_b128 a[236:239], v2 offset:4096
    v_mfma_f32_16x16x32_bf16 v[76:79], v[108:111], v[108:111], v[76:79]
    s_waitcnt vmcnt(12)
    s_waitcnt lgkmcnt(5)
    v_mfma_f32_16x16x32_bf16 v[64:67], a[244:247], v[112:115], v[64:67]
    ds_read_b128 a[240:243], v2 offset:24576
    v_mfma_f32_16x16x32_bf16 v[68:71], a[244:247], v[116:119], v[68:71]
    buffer_load_dwordx4 v[168:171], v5, s[8:11], s74 offen offset:2048 sc1
    v_mfma_f32_16x16x32_bf16 v[32:35], a[248:251], v[112:115], v[32:35]
    ds_read_b128 a[244:247], v1 offset:12288
    v_mfma_f32_16x16x32_bf16 v[40:43], a[248:251], v[116:119], v[40:43]
    v_mfma_f32_16x16x32_bf16 v[36:39], a[252:255], v[112:115], v[36:39]
    ds_read_b128 a[248:251], v2 offset:5120
    v_mfma_f32_16x16x32_bf16 v[44:47], a[252:255], v[116:119], v[44:47]
    buffer_load_dwordx4 v[172:175], v5, s[8:11], s74 offen offset:2304 sc1
    v_mfma_f32_16x16x32_bf16 v[72:75], v[112:115], v[112:115], v[72:75]
    ds_read_b128 a[252:255], v2 offset:25600
    v_mfma_f32_16x16x32_bf16 v[76:79], v[116:119], v[116:119], v[76:79]
    s_waitcnt vmcnt(12)
    s_waitcnt lgkmcnt(6)
    v_mfma_f32_16x16x32_bf16 v[64:67], a[220:223], v[120:123], v[64:67]
    v_mfma_f32_16x16x32_bf16 v[68:71], a[220:223], v[124:127], v[68:71]
    s_add_u32 s74, s74, 4096
    buffer_load_dwordx4 v[176:179], v5, s[8:11], s74 offen offset:0 sc1
    v_mfma_f32_16x16x32_bf16 v[32:35], a[224:227], v[120:123], v[32:35]
    ds_read_b128 a[220:223], v1 offset:13312
    v_mfma_f32_16x16x32_bf16 v[40:43], a[224:227], v[124:127], v[40:43]
    v_mfma_f32_16x16x32_bf16 v[36:39], a[228:231], v[120:123], v[36:39]
    ds_read_b128 a[224:227], v2 offset:6144
    v_mfma_f32_16x16x32_bf16 v[44:47], a[228:231], v[124:127], v[44:47]
    buffer_load_dwordx4 v[180:183], v5, s[8:11], s74 offen offset:256 sc1
    v_mfma_f32_16x16x32_bf16 v[72:75], v[120:123], v[120:123], v[72:75]
    ds_read_b128 a[228:231], v2 offset:26624
    v_mfma_f32_16x16x32_bf16 v[76:79], v[124:127], v[124:127], v[76:79]
    s_waitcnt vmcnt(12)
    s_waitcnt lgkmcnt(6)
    v_mfma_f32_16x16x32_bf16 v[64:67], a[232:235], v[128:131], v[64:67]
    v_mfma_f32_16x16x32_bf16 v[68:71], a[232:235], v[132:135], v[68:71]
    buffer_load_dwordx4 v[184:187], v5, s[8:11], s74 offen offset:2048 sc1
    v_mfma_f32_16x16x32_bf16 v[32:35], a[236:239], v[128:131], v[32:35]
    ds_read_b128 a[232:235], v1 offset:14336
    v_mfma_f32_16x16x32_bf16 v[40:43], a[236:239], v[132:135], v[40:43]
    v_mfma_f32_16x16x32_bf16 v[36:39], a[240:243], v[128:131], v[36:39]
    ds_read_b128 a[236:239], v2 offset:7168
    v_mfma_f32_16x16x32_bf16 v[44:47], a[240:243], v[132:135], v[44:47]
    buffer_load_dwordx4 v[188:191], v5, s[8:11], s74 offen offset:2304 sc1
    v_mfma_f32_16x16x32_bf16 v[72:75], v[128:131], v[128:131], v[72:75]
    ds_read_b128 a[240:243], v2 offset:27648
    v_mfma_f32_16x16x32_bf16 v[76:79], v[132:135], v[132:135], v[76:79]
    s_waitcnt vmcnt(12)
    s_waitcnt lgkmcnt(6)
    v_mfma_f32_16x16x32_bf16 v[64:67], a[244:247], v[136:139], v[64:67]
    v_mfma_f32_16x16x32_bf16 v[68:71], a[244:247], v[140:143], v[68:71]
    s_add_u32 s74, s74, 4096
    buffer_load_dwordx4 v[192:195], v5, s[8:11], s74 offen offset:0 sc1
    v_mfma_f32_16x16x32_bf16 v[32:35], a[248:251], v[136:139], v[32:35]
    ds_read_b128 a[244:247], v1 offset:15360
    v_mfma_f32_16x16x32_bf16 v[40:43], a[248:251], v[140:143], v[40:43]
    v_mfma_f32_16x16x32_bf16 v[36:39], a[252:255], v[136:139], v[36:39]
    ds_read_b128 a[248:251], v2 offset:8192
    v_mfma_f32_16x16x32_bf16 v[44:47], a[252:255], v[140:143], v[44:47]
    buffer_load_dwordx4 v[196:199], v5, s[8:11], s74 offen offset:256 sc1
    v_mfma_f32_16x16x32_bf16 v[72:75], v[136:139], v[136:139], v[72:75]
    ds_read_b128 a[252:255], v2 offset:28672
    v_mfma_f32_16x16x32_bf16 v[76:79], v[140:143], v[140:143], v[76:79]
    s_waitcnt vmcnt(12)
    s_waitcnt lgkmcnt(6)
    v_mfma_f32_16x16x32_bf16 v[64:67], a[220:223], v[144:147], v[64:67]
    v_mfma_f32_16x16x32_bf16 v[68:71], a[220:223], v[148:151], v[68:71]
    buffer_load_dwordx4 v[200:203], v5, s[8:11], s74 offen offset:2048 sc1
    v_mfma_f32_16x16x32_bf16 v[32:35], a[224:227], v[144:147], v[32:35]
    ds_read_b128 a[220:223], v1 offset:16384
    v_mfma_f32_16x16x32_bf16 v[40:43], a[224:227], v[148:151], v[40:43]
    v_mfma_f32_16x16x32_bf16 v[36:39], a[228:231], v[144:147], v[36:39]
    ds_read_b128 a[224:227], v2 offset:9216
    v_mfma_f32_16x16x32_bf16 v[44:47], a[228:231], v[148:151], v[44:47]
    buffer_load_dwordx4 v[204:207], v5, s[8:11], s74 offen offset:2304 sc1
    v_mfma_f32_16x16x32_bf16 v[72:75], v[144:147], v[144:147], v[72:75]
    ds_read_b128 a[228:231], v2 offset:29696
    v_mfma_f32_16x16x32_bf16 v[76:79], v[148:151], v[148:151], v[76:79]
    s_waitcnt vmcnt(12)
    s_waitcnt lgkmcnt(6)
    v_mfma_f32_16x16x32_bf16 v[64:67], a[232:235], v[152:155], v[64:67]
    v_mfma_f32_16x16x32_bf16 v[68:71], a[232:235], v[156:159], v[68:71]
    s_add_u32 s74, s74, 4096
    buffer_load_dwordx4 v[208:211], v5, s[8:11], s74 offen offset:0 sc1
    v_mfma_f32_16x16x32_bf16 v[32:35], a[236:239], v[152:155], v[32:35]
    ds_read_b128 a[232:235], v1 offset:17408
    v_mfma_f32_16x16x32_bf16 v[40:43], a[236:239], v[156:159], v[40:43]
    v_mfma_f32_16x16x32_bf16 v[36:39], a[240:243], v[152:155], v[36:39]
    ds_read_b128 a[236:239], v2 offset:10240
    v_mfma_f32_16x16x32_bf16 v[44:47], a[240:243], v[156:159], v[44:47]
    buffer_load_dwordx4 v[212:215], v5, s[8:11], s74 offen offset:256 sc1
    v_mfma_f32_16x16x32_bf16 v[72:75], v[152:155], v[152:155], v[72:75]
    ds_read_b128 a[240:243], v2 offset:30720
    v_mfma_f32_16x16x32_bf16 v[76:79], v[156:159], v[156:159], v[76:79]
    s_waitcnt vmcnt(12)
    s_waitcnt lgkmcnt(6)
    v_mfma_f32_16x16x32_bf16 v[64:67], a[244:247], v[160:163], v[64:67]
    v_mfma_f32_16x16x32_bf16 v[68:71], a[244:247], v[164:167], v[68:71]
    buffer_load_dwordx4 v[216:219], v5, s[8:11], s74 offen offset:2048 sc1
    v_mfma_f32_16x16x32_bf16 v[32:35], a[248:251], v[160:163], v[32:35]
    ds_read_b128 a[244:247], v1 offset:18432
    v_mfma_f32_16x16x32_bf16 v[40:43], a[248:251], v[164:167], v[40:43]
    v_mfma_f32_16x16x32_bf16 v[36:39], a[252:255], v[160:163], v[36:39]
    ds_read_b128 a[248:251], v2 offset:11264
    v_mfma_f32_16x16x32_bf16 v[44:47], a[252:255], v[164:167], v[44:47]
    buffer_load_dwordx4 v[220:223], v5, s[8:11], s74 offen offset:2304 sc1
    v_mfma_f32_16x16x32_bf16 v[72:75], v[160:163], v[160:163], v[72:75]
    ds_read_b128 a[252:255], v2 offset:31744
    v_mfma_f32_16x16x32_bf16 v[76:79], v[164:167], v[164:167], v[76:79]
    s_waitcnt vmcnt(12)
    s_waitcnt lgkmcnt(6)
    v_mfma_f32_16x16x32_bf16 v[64:67], a[220:223], v[168:171], v[64:67]
    v_mfma_f32_16x16x32_bf16 v[68:71], a[220:223], v[172:175], v[68:71]
    s_add_u32 s74, s74, 4096
    buffer_load_dwordx4 v[224:227], v5, s[8:11], s74 offen offset:0 sc1
    v_mfma_f32_16x16x32_bf16 v[32:35], a[224:227], v[168:171], v[32:35]
    ds_read_b128 a[220:223], v1 offset:19456
    v_mfma_f32_16x16x32_bf16 v[40:43], a[224:227], v[172:175], v[40:43]
    v_mfma_f32_16x16x32_bf16 v[36:39], a[228:231], v[168:171], v[36:39]
    ds_read_b128 a[224:227], v2 offset:12288
    v_mfma_f32_16x16x32_bf16 v[44:47], a[228:231], v[172:175], v[44:47]
    buffer_load_dwordx4 v[228:231], v5, s[8:11], s74 offen offset:256 sc1
    v_mfma_f32_16x16x32_bf16 v[72:75], v[168:171], v[168:171], v[72:75]
    ds_read_b128 a[228:231], v2 offset:32768
    v_mfma_f32_16x16x32_bf16 v[76:79], v[172:175], v[172:175], v[76:79]
    s_waitcnt vmcnt(12)
    s_waitcnt lgkmcnt(6)
    v_mfma_f32_16x16x32_bf16 v[64:67], a[232:235], v[176:179], v[64:67]
    v_mfma_f32_16x16x32_bf16 v[68:71], a[232:235], v[180:183], v[68:71]
    buffer_load_dwordx4 v[232:235], v5, s[8:11], s74 offen offset:2048 sc1
    v_mfma_f32_16x16x32_bf16 v[32:35], a[236:239], v[176:179], v[32:35]
    ds_read_b128 a[232:235], v1 offset:20480
    v_mfma_f32_16x16x32_bf16 v[40:43], a[236:239], v[180:183], v[40:43]
    v_mfma_f32_16x16x32_bf16 v[36:39], a[240:243], v[176:179], v[36:39]
    ds_read_b128 a[236:239], v2 offset:13312
    v_mfma_f32_16x16x32_bf16 v[44:47], a[240:243], v[180:183], v[44:47]
    buffer_load_dwordx4 v[236:239], v5, s[8:11], s74 offen offset:2304 sc1
    v_mfma_f32_16x16x32_bf16 v[72:75], v[176:179], v[176:179], v[72:75]
    ds_read_b128 a[240:243], v2 offset:33792
    v_mfma_f32_16x16x32_bf16 v[76:79], v[180:183], v[180:183], v[76:79]
    s_waitcnt vmcnt(12)
    s_waitcnt lgkmcnt(6)
    v_mfma_f32_16x16x32_bf16 v[64:67], a[244:247], v[184:187], v[64:67]
    v_mfma_f32_16x16x32_bf16 v[68:71], a[244:247], v[188:191], v[68:71]
    s_add_u32 s74, s74, 4096
    buffer_load_dwordx4 v[240:243], v5, s[8:11], s74 offen offset:0 sc1
    v_mfma_f32_16x16x32_bf16 v[32:35], a[248:251], v[184:187], v[32:35]
    ds_read_b128 a[244:247], v1 offset:21504
    v_mfma_f32_16x16x32_bf16 v[40:43], a[248:251], v[188:191], v[40:43]
    v_mfma_f32_16x16x32_bf16 v[36:39], a[252:255], v[184:187], v[36:39]
    ds_read_b128 a[248:251], v2 offset:14336
    v_mfma_f32_16x16x32_bf16 v[44:47], a[252:255], v[188:191], v[44:47]
    buffer_load_dwordx4 v[244:247], v5, s[8:11], s74 offen offset:256 sc1
    v_mfma_f32_16x16x32_bf16 v[72:75], v[184:187], v[184:187], v[72:75]
    ds_read_b128 a[252:255], v2 offset:34816
    v_mfma_f32_16x16x32_bf16 v[76:79], v[188:191], v[188:191], v[76:79]
    s_waitcnt vmcnt(12)
    s_waitcnt lgkmcnt(6)
    v_mfma_f32_16x16x32_bf16 v[64:67], a[220:223], v[192:195], v[64:67]
    v_mfma_f32_16x16x32_bf16 v[68:71], a[220:223], v[196:199], v[68:71]
    buffer_load_dwordx4 v[248:251], v5, s[8:11], s74 offen offset:2048 sc1
    v_mfma_f32_16x16x32_bf16 v[32:35], a[224:227], v[192:195], v[32:35]
    ds_read_b128 a[220:223], v1 offset:22528
    v_mfma_f32_16x16x32_bf16 v[40:43], a[224:227], v[196:199], v[40:43]
    v_mfma_f32_16x16x32_bf16 v[36:39], a[228:231], v[192:195], v[36:39]
    ds_read_b128 a[224:227], v2 offset:15360
    v_mfma_f32_16x16x32_bf16 v[44:47], a[228:231], v[196:199], v[44:47]
    buffer_load_dwordx4 v[252:255], v5, s[8:11], s74 offen offset:2304 sc1
    v_mfma_f32_16x16x32_bf16 v[72:75], v[192:195], v[192:195], v[72:75]
    ds_read_b128 a[228:231], v2 offset:35840
    v_mfma_f32_16x16x32_bf16 v[76:79], v[196:199], v[196:199], v[76:79]
    s_waitcnt vmcnt(12)
    s_waitcnt lgkmcnt(6)
    v_mfma_f32_16x16x32_bf16 v[64:67], a[232:235], v[200:203], v[64:67]
    s_lshl1_add_u32 s89, s43, s25
    buffer_load_dwordx4 a[120:123], v1, s[8:11], s89 offen offset:0
    v_mfma_f32_16x16x32_bf16 v[68:71], a[232:235], v[204:207], v[68:71]
    v_mfma_f32_16x16x32_bf16 v[32:35], a[236:239], v[200:203], v[32:35]
    ds_read_b128 a[232:235], v1 offset:23552
    v_mfma_f32_16x16x32_bf16 v[40:43], a[236:239], v[204:207], v[40:43]
    v_mfma_f32_16x16x32_bf16 v[36:39], a[240:243], v[200:203], v[36:39]
    ds_read_b128 a[236:239], v2 offset:16384
    buffer_load_dwordx4 a[124:127], v1, s[8:11], s89 offen offset:1024
    v_mfma_f32_16x16x32_bf16 v[44:47], a[240:243], v[204:207], v[44:47]
    v_mfma_f32_16x16x32_bf16 v[72:75], v[200:203], v[200:203], v[72:75]
    ds_read_b128 a[240:243], v2 offset:36864
    v_mfma_f32_16x16x32_bf16 v[76:79], v[204:207], v[204:207], v[76:79]
    s_waitcnt vmcnt(12)
    s_waitcnt lgkmcnt(6)
    v_mfma_f32_16x16x32_bf16 v[64:67], a[244:247], v[208:211], v[64:67]
    buffer_load_dwordx4 a[128:131], v1, s[8:11], s89 offen offset:2048
    v_mfma_f32_16x16x32_bf16 v[68:71], a[244:247], v[212:215], v[68:71]
    v_mfma_f32_16x16x32_bf16 v[32:35], a[248:251], v[208:211], v[32:35]
    ds_read_b128 a[244:247], v1 offset:24576
    v_mfma_f32_16x16x32_bf16 v[40:43], a[248:251], v[212:215], v[40:43]
    v_mfma_f32_16x16x32_bf16 v[36:39], a[252:255], v[208:211], v[36:39]
    ds_read_b128 a[248:251], v2 offset:17408
    buffer_load_dwordx4 a[132:135], v1, s[8:11], s89 offen offset:3072
    v_mfma_f32_16x16x32_bf16 v[44:47], a[252:255], v[212:215], v[44:47]
    v_mfma_f32_16x16x32_bf16 v[72:75], v[208:211], v[208:211], v[72:75]
    ds_read_b128 a[252:255], v2 offset:37888
    v_mfma_f32_16x16x32_bf16 v[76:79], v[212:215], v[212:215], v[76:79]
    s_waitcnt vmcnt(12)
    s_waitcnt lgkmcnt(6)
    v_mfma_f32_16x16x32_bf16 v[64:67], a[220:223], v[216:219], v[64:67]
    s_add_u32 s89, s89, 4096
    buffer_load_dwordx4 a[136:139], v1, s[8:11], s89 offen offset:0
    v_mfma_f32_16x16x32_bf16 v[68:71], a[220:223], v[220:223], v[68:71]
    v_mfma_f32_16x16x32_bf16 v[32:35], a[224:227], v[216:219], v[32:35]
    ds_read_b128 a[220:223], v1 offset:25600
    v_mfma_f32_16x16x32_bf16 v[40:43], a[224:227], v[220:223], v[40:43]
    v_mfma_f32_16x16x32_bf16 v[36:39], a[228:231], v[216:219], v[36:39]
    ds_read_b128 a[224:227], v2 offset:18432
    s_lshl1_add_u32 s89, s44, s25
    buffer_load_dwordx4 a[140:143], v1, s[8:11], s89 offen offset:0
    v_mfma_f32_16x16x32_bf16 v[44:47], a[228:231], v[220:223], v[44:47]
    v_mfma_f32_16x16x32_bf16 v[72:75], v[216:219], v[216:219], v[72:75]
    ds_read_b128 a[228:231], v2 offset:38912
    v_mfma_f32_16x16x32_bf16 v[76:79], v[220:223], v[220:223], v[76:79]
    s_waitcnt vmcnt(12)
    s_waitcnt lgkmcnt(6)
    v_mfma_f32_16x16x32_bf16 v[64:67], a[232:235], v[224:227], v[64:67]
    buffer_load_dwordx4 a[144:147], v1, s[8:11], s89 offen offset:1024
    v_mfma_f32_16x16x32_bf16 v[68:71], a[232:235], v[228:231], v[68:71]
    v_mfma_f32_16x16x32_bf16 v[32:35], a[236:239], v[224:227], v[32:35]
    ds_read_b128 a[232:235], v1 offset:26624
    v_mfma_f32_16x16x32_bf16 v[40:43], a[236:239], v[228:231], v[40:43]
    v_mfma_f32_16x16x32_bf16 v[36:39], a[240:243], v[224:227], v[36:39]
    ds_read_b128 a[236:239], v2 offset:19456
    buffer_load_dwordx4 a[148:151], v1, s[8:11], s89 offen offset:2048
    v_mfma_f32_16x16x32_bf16 v[44:47], a[240:243], v[228:231], v[44:47]
    v_mfma_f32_16x16x32_bf16 v[72:75], v[224:227], v[224:227], v[72:75]
    ds_read_b128 a[240:243], v2 offset:39936
    v_mfma_f32_16x16x32_bf16 v[76:79], v[228:231], v[228:231], v[76:79]
    s_waitcnt vmcnt(12)
    s_waitcnt lgkmcnt(6)
    v_mfma_f32_16x16x32_bf16 v[64:67], a[244:247], v[232:235], v[64:67]
    buffer_load_dwordx4 a[152:155], v1, s[8:11], s89 offen offset:3072
    v_mfma_f32_16x16x32_bf16 v[68:71], a[244:247], v[236:239], v[68:71]
    v_mfma_f32_16x16x32_bf16 v[32:35], a[248:251], v[232:235], v[32:35]
    ds_read_b128 a[244:247], v3 offset:0
    v_mfma_f32_16x16x32_bf16 v[40:43], a[248:251], v[236:239], v[40:43]
    v_mfma_f32_16x16x32_bf16 v[36:39], a[252:255], v[232:235], v[36:39]
    ds_read_b128 a[248:251], v3 offset:20480
    s_add_u32 s89, s89, 4096
    buffer_load_dwordx4 a[156:159], v1, s[8:11], s89 offen offset:0
    v_mfma_f32_16x16x32_bf16 v[44:47], a[252:255], v[236:239], v[44:47]
    v_mfma_f32_16x16x32_bf16 v[72:75], v[232:235], v[232:235], v[72:75]
    ds_read_b128 a[252:255], v3 offset:1024
    v_mfma_f32_16x16x32_bf16 v[76:79], v[236:239], v[236:239], v[76:79]
    s_waitcnt vmcnt(12)
    s_waitcnt lgkmcnt(6)
    v_mfma_f32_16x16x32_bf16 v[64:67], a[220:223], v[240:243], v[64:67]
    s_lshl1_add_u32 s89, s45, s25
    buffer_load_dwordx4 a[160:163], v1, s[8:11], s89 offen offset:0
    v_mfma_f32_16x16x32_bf16 v[68:71], a[220:223], v[244:247], v[68:71]
    v_mfma_f32_16x16x32_bf16 v[32:35], a[224:227], v[240:243], v[32:35]
    ds_read_b128 a[220:223], v3 offset:21504
    v_mfma_f32_16x16x32_bf16 v[40:43], a[224:227], v[244:247], v[40:43]
    v_mfma_f32_16x16x32_bf16 v[36:39], a[228:231], v[240:243], v[36:39]
    ds_read_b128 a[224:227], v3 offset:2048
    buffer_load_dwordx4 a[164:167], v1, s[8:11], s89 offen offset:1024
    v_mfma_f32_16x16x32_bf16 v[44:47], a[228:231], v[244:247], v[44:47]
    v_mfma_f32_16x16x32_bf16 v[72:75], v[240:243], v[240:243], v[72:75]
    ds_read_b128 a[228:231], v3 offset:22528
    v_mfma_f32_16x16x32_bf16 v[76:79], v[244:247], v[244:247], v[76:79]
    s_waitcnt vmcnt(12)
    s_waitcnt lgkmcnt(6)
    v_mfma_f32_16x16x32_bf16 v[64:67], a[232:235], v[248:251], v[64:67]
    buffer_load_dwordx4 a[168:171], v1, s[8:11], s89 offen offset:2048
    v_mfma_f32_16x16x32_bf16 v[68:71], a[232:235], v[252:255], v[68:71]
    v_mfma_f32_16x16x32_bf16 v[32:35], a[236:239], v[248:251], v[32:35]
    ds_read_b128 a[232:235], v3 offset:3072
    v_mfma_f32_16x16x32_bf16 v[40:43], a[236:239], v[252:255], v[40:43]
    v_mfma_f32_16x16x32_bf16 v[36:39], a[240:243], v[248:251], v[36:39]
    ds_read_b128 a[236:239], v3 offset:23552
    buffer_load_dwordx4 a[172:175], v1, s[8:11], s89 offen offset:3072
    v_mfma_f32_16x16x32_bf16 v[44:47], a[240:243], v[252:255], v[44:47]
    v_mfma_f32_16x16x32_bf16 v[72:75], v[248:251], v[248:251], v[72:75]
    ds_read_b128 a[240:243], v3 offset:4096
    v_mfma_f32_16x16x32_bf16 v[76:79], v[252:255], v[252:255], v[76:79]
    s_waitcnt lgkmcnt(5)
    v_mfma_f32_16x16x32_bf16 v[48:51], a[244:247], v[96:99], 0
    s_add_u32 s89, s89, 4096
    buffer_load_dwordx4 a[176:179], v1, s[8:11], s89 offen offset:0
    v_mfma_f32_16x16x32_bf16 v[56:59], a[244:247], v[100:103], 0
    v_mfma_f32_16x16x32_bf16 v[52:55], a[248:251], v[96:99], 0
    ds_read_b128 a[244:247], v3 offset:24576
    v_mfma_f32_16x16x32_bf16 v[60:63], a[248:251], v[100:103], 0
    ds_bpermute_b32 v24, v10, v64
    ds_bpermute_b32 v28, v10, v68
    v_cndmask_b32 v72, v72, v73, s[92:93]
    v_mfma_f32_16x16x32_bf16 v[48:51], a[252:255], v[104:107], v[48:51]
    ds_read_b128 a[248:251], v3 offset:5120
    v_cndmask_b32 v76, v76, v77, s[92:93]
    v_cndmask_b32 v72, v72, v74, s[94:95]
    s_lshl1_add_u32 s89, s46, s25
    buffer_load_dwordx4 a[180:183], v1, s[8:11], s89 offen offset:0
    v_mfma_f32_16x16x32_bf16 v[56:59], a[252:255], v[108:111], v[56:59]
    v_cndmask_b32 v76, v76, v78, s[94:95]
    v_cndmask_b32 v72, v72, v75, s[96:97]
    v_mfma_f32_16x16x32_bf16 v[52:55], a[220:223], v[104:107], v[52:55]
    ds_read_b128 a[252:255], v3 offset:25600
    v_cndmask_b32 v76, v76, v79, s[96:97]
    ds_bpermute_b32 v73, v7, v72
    v_mfma_f32_16x16x32_bf16 v[60:63], a[220:223], v[108:111], v[60:63]
    ds_bpermute_b32 v77, v7, v76
    v_mov_b32 v19, 0
    v_mov_b32 v23, 0
    s_waitcnt lgkmcnt(8)
    v_mfma_f32_16x16x32_bf16 v[48:51], a[224:227], v[112:115], v[48:51]
    ds_read_b128 a[220:223], v1 offset:1024
    s_waitcnt lgkmcnt(6)
    v_mul_f32 v24, 0xbacccccd, v24
    s_waitcnt lgkmcnt(5)
    v_mul_f32 v28, 0xbacccccd, v28
    buffer_load_dwordx4 a[184:187], v1, s[8:11], s89 offen offset:1024
    v_mfma_f32_16x16x32_bf16 v[56:59], a[224:227], v[116:119], v[56:59]
    v_cvt_pk_bf16_f32 v16, v24, v24
    v_cvt_pk_bf16_f32 v20, v28, v28
    v_mfma_f32_16x16x32_bf16 v[52:55], a[228:231], v[112:115], v[52:55]
    ds_read_b128 a[224:227], v1 offset:2048
    v_lshlrev_b32 v25, 16, v16
    v_lshlrev_b32 v29, 16, v20
    v_mfma_f32_16x16x32_bf16 v[60:63], a[228:231], v[116:119], v[60:63]
    v_sub_f32 v25, v24, v25
    v_sub_f32 v29, v28, v29
    v_mfma_f32_16x16x32_bf16 v[48:51], a[232:235], v[120:123], v[48:51]
    ds_read_b128 a[228:231], v1 offset:0
    s_waitcnt lgkmcnt(4)
    v_mul_f32 v72, 0x3acccccd, v73
    s_waitcnt lgkmcnt(3)
    v_mul_f32 v76, 0x3acccccd, v77
    v_fma_f32 v72, -v24, v24, v72
    buffer_load_dwordx4 a[188:191], v1, s[8:11], s89 offen offset:2048
    v_mfma_f32_16x16x32_bf16 v[56:59], a[232:235], v[124:127], v[56:59]
    v_fma_f32 v76, -v28, v28, v76
    v_max_f32 v72, 0, v72
    v_mfma_f32_16x16x32_bf16 v[52:55], a[236:239], v[120:123], v[52:55]
    ds_read_b128 a[232:235], v3 offset:6144
    v_max_f32 v76, 0, v76
    v_add_f32 v72, 0x3727c5ac, v72
    v_mfma_f32_16x16x32_bf16 v[60:63], a[236:239], v[124:127], v[60:63]
    v_add_f32 v76, 0x3727c5ac, v76
    v_sqrt_f32 v26, v72
    v_mfma_f32_16x16x32_bf16 v[48:51], a[240:243], v[128:131], v[48:51]
    ds_read_b128 a[236:239], v3 offset:26624
    v_sqrt_f32 v30, v76
    v_rcp_f32 v72, v72
    buffer_load_dwordx4 a[192:195], v1, s[8:11], s89 offen offset:3072
    v_mfma_f32_16x16x32_bf16 v[56:59], a[240:243], v[132:135], v[56:59]
    v_rcp_f32 v76, v76
    v_cvt_pk_bf16_f32 v17, v25, v26
    v_cvt_pk_bf16_f32 v21, v29, v30
    v_mfma_f32_16x16x32_bf16 v[52:55], a[244:247], v[128:131], v[52:55]
    ds_read_b128 a[240:243], v3 offset:7168
    v_and_b32 v27, 0xffff0000, v17
    v_and_b32 v31, 0xffff0000, v21
    v_mfma_f32_16x16x32_bf16 v[60:63], a[244:247], v[132:135], v[60:63]
    v_sub_f32 v27, v26, v27
    v_sub_f32 v31, v30, v31
    v_mfma_f32_16x16x32_bf16 v[48:51], a[248:251], v[136:139], v[48:51]
    ds_read_b128 a[244:247], v3 offset:27648
    v_cvt_pk_bf16_f32 v18, v27, 0
    v_cvt_pk_bf16_f32 v22, v31, 0
    s_add_u32 s89, s89, 4096
    buffer_load_dwordx4 a[196:199], v1, s[8:11], s89 offen offset:0
    v_mfma_f32_16x16x32_bf16 v[56:59], a[248:251], v[140:143], v[56:59]
    ds_write_b32 v11, v72 offset:0
    ds_write_b32 v11, v76 offset:64
    v_mfma_f32_16x16x32_bf16 v[52:55], a[252:255], v[136:139], v[52:55]
    ds_read_b128 a[248:251], v3 offset:8192
    v_mfma_f32_16x16x32_bf16 v[60:63], a[252:255], v[140:143], v[60:63]
    s_waitcnt lgkmcnt(7)
    v_mfma_f32_16x16x32_bf16 v[32:35], a[220:223], v[16:19], v[32:35]
    ds_read_b128 a[252:255], v3 offset:28672
    s_add_u32 s89, s43, s87
    buffer_load_dwordx4 a[200:203], v1, s[8:11], s89 offen offset:0
    v_mfma_f32_16x16x32_bf16 v[40:43], a[220:223], v[20:23], v[40:43]
    v_mfma_f32_16x16x32_bf16 v[36:39], a[224:227], v[16:19], v[36:39]
    ds_read_b128 a[220:223], v3 offset:9216
    v_mfma_f32_16x16x32_bf16 v[44:47], a[224:227], v[20:23], v[44:47]
    v_mfma_f32_16x16x32_bf16 v[64:67], a[228:231], v[16:19], v[64:67]
    ds_read_b128 a[224:227], v3 offset:29696
    buffer_load_dwordx4 a[204:207], v1, s[8:11], s89 offen offset:1024
    v_mfma_f32_16x16x32_bf16 v[68:71], a[228:231], v[20:23], v[68:71]
    s_waitcnt lgkmcnt(6)
    v_mfma_f32_16x16x32_bf16 v[48:51], a[232:235], v[144:147], v[48:51]
    ds_read_b128 a[228:231], v3 offset:10240
    v_mfma_f32_16x16x32_bf16 v[56:59], a[232:235], v[148:151], v[56:59]
    v_mfma_f32_16x16x32_bf16 v[52:55], a[236:239], v[144:147], v[52:55]
    ds_read_b128 a[232:235], v3 offset:30720
    v_mul_f32 v32, v32, |v32|
    v_mul_f32 v33, v33, |v33|
    buffer_load_dwordx4 a[208:211], v1, s[8:11], s89 offen offset:2048
    v_mfma_f32_16x16x32_bf16 v[60:63], a[236:239], v[148:151], v[60:63]
    v_mul_f32 v34, v34, |v34|
    v_mfma_f32_16x16x32_bf16 v[48:51], a[240:243], v[152:155], v[48:51]
    ds_read_b128 a[236:239], v3 offset:11264
    v_mul_f32 v35, v35, |v35|
    v_mul_f32 v36, v36, |v36|
    v_mfma_f32_16x16x32_bf16 v[56:59], a[240:243], v[156:159], v[56:59]
    v_mul_f32 v37, v37, |v37|
    v_mfma_f32_16x16x32_bf16 v[52:55], a[244:247], v[152:155], v[52:55]
    ds_read_b128 a[240:243], v3 offset:31744
    v_mul_f32 v38, v38, |v38|
    v_mul_f32 v39, v39, |v39|
    buffer_load_dwordx4 a[212:215], v1, s[8:11], s89 offen offset:3072
    v_mfma_f32_16x16x32_bf16 v[60:63], a[244:247], v[156:159], v[60:63]
    v_cvt_pk_bf16_f32 v32, v32, v33
    s_waitcnt lgkmcnt(4)
    v_mfma_f32_16x16x32_bf16 v[48:51], a[248:251], v[160:163], v[48:51]
    ds_read_b128 a[244:247], v3 offset:12288
    v_cvt_pk_bf16_f32 v33, v34, v35
    v_cvt_pk_bf16_f32 v34, v36, v37
    v_mfma_f32_16x16x32_bf16 v[56:59], a[248:251], v[164:167], v[56:59]
    v_cvt_pk_bf16_f32 v35, v38, v39
    v_mfma_f32_16x16x32_bf16 v[52:55], a[252:255], v[160:163], v[52:55]
    ds_read_b128 a[248:251], v3 offset:32768
    v_pk_max_i16 v32, v32, 0
    v_pk_max_i16 v33, v33, 0
    s_add_u32 s89, s89, 4096
    buffer_load_dwordx4 a[216:219], v1, s[8:11], s89 offen offset:0
    v_mfma_f32_16x16x32_bf16 v[60:63], a[252:255], v[164:167], v[60:63]
    v_pk_max_i16 v34, v34, 0
    v_mfma_f32_16x16x32_bf16 v[48:51], a[220:223], v[168:171], v[48:51]
    ds_read_b128 a[252:255], v3 offset:13312
    v_pk_max_i16 v35, v35, 0
    buffer_store_dwordx4 v[32:35], v1, s[8:11], s76 offen offset:0 sc1
    v_mfma_f32_16x16x32_bf16 v[56:59], a[220:223], v[172:175], v[56:59]
    v_mul_f32 v40, v40, |v40|
    v_mfma_f32_16x16x32_bf16 v[52:55], a[224:227], v[168:171], v[52:55]
    ds_read_b128 a[220:223], v3 offset:33792
    v_mul_f32 v41, v41, |v41|
    v_mul_f32 v42, v42, |v42|
    v_mfma_f32_16x16x32_bf16 v[60:63], a[224:227], v[172:175], v[60:63]
    v_mul_f32 v43, v43, |v43|
    s_waitcnt lgkmcnt(4)
    v_mfma_f32_16x16x32_bf16 v[48:51], a[228:231], v[176:179], v[48:51]
    ds_read_b128 a[224:227], v3 offset:14336
    v_mul_f32 v44, v44, |v44|
    v_mul_f32 v45, v45, |v45|
    v_mfma_f32_16x16x32_bf16 v[56:59], a[228:231], v[180:183], v[56:59]
    v_mul_f32 v46, v46, |v46|
    v_mfma_f32_16x16x32_bf16 v[52:55], a[232:235], v[176:179], v[52:55]
    ds_read_b128 a[228:231], v3 offset:34816
    v_mul_f32 v47, v47, |v47|
    v_cvt_pk_bf16_f32 v40, v40, v41
    v_mfma_f32_16x16x32_bf16 v[60:63], a[232:235], v[180:183], v[60:63]
    v_cvt_pk_bf16_f32 v41, v42, v43
    v_mfma_f32_16x16x32_bf16 v[48:51], a[236:239], v[184:187], v[48:51]
    ds_read_b128 a[232:235], v3 offset:15360
    v_cvt_pk_bf16_f32 v42, v44, v45
    v_cvt_pk_bf16_f32 v43, v46, v47
    v_mfma_f32_16x16x32_bf16 v[56:59], a[236:239], v[188:191], v[56:59]
    v_pk_max_i16 v40, v40, 0
    v_mfma_f32_16x16x32_bf16 v[52:55], a[240:243], v[184:187], v[52:55]
    ds_read_b128 a[236:239], v3 offset:35840
    v_pk_max_i16 v41, v41, 0
    v_pk_max_i16 v42, v42, 0
    v_mfma_f32_16x16x32_bf16 v[60:63], a[240:243], v[188:191], v[60:63]
    v_pk_max_i16 v43, v43, 0
    s_waitcnt lgkmcnt(4)
    v_mfma_f32_16x16x32_bf16 v[48:51], a[244:247], v[192:195], v[48:51]
    ds_read_b128 a[240:243], v3 offset:16384
    buffer_store_dwordx4 v[40:43], v1, s[8:11], s76 offen offset:1024 sc1
    v_mul_f32 v64, v64, |v64|
    v_mfma_f32_16x16x32_bf16 v[56:59], a[244:247], v[196:199], v[56:59]
    v_mul_f32 v65, v65, |v65|
    v_mfma_f32_16x16x32_bf16 v[52:55], a[248:251], v[192:195], v[52:55]
    ds_read_b128 a[244:247], v3 offset:36864
    v_mul_f32 v66, v66, |v66|
    v_mul_f32 v67, v67, |v67|
    v_mfma_f32_16x16x32_bf16 v[60:63], a[248:251], v[196:199], v[60:63]
    v_cvt_pk_bf16_f32 v64, v64, v65
    v_mfma_f32_16x16x32_bf16 v[48:51], a[252:255], v[200:203], v[48:51]
    ds_read_b128 a[248:251], v3 offset:17408
    v_cvt_pk_bf16_f32 v65, v66, v67
    v_pk_max_i16 v64, v64, 0
    v_mfma_f32_16x16x32_bf16 v[56:59], a[252:255], v[204:207], v[56:59]
    v_pk_max_i16 v65, v65, 0
    v_mfma_f32_16x16x32_bf16 v[52:55], a[220:223], v[200:203], v[52:55]
    ds_read_b128 a[252:255], v3 offset:37888
    buffer_store_dwordx2 v[64:65], v6, s[8:11], s77 offen offset:0 sc1
    v_mul_f32 v68, v68, |v68|
    v_mfma_f32_16x16x32_bf16 v[60:63], a[220:223], v[204:207], v[60:63]
    v_mul_f32 v69, v69, |v69|
    s_waitcnt lgkmcnt(4)
    v_mfma_f32_16x16x32_bf16 v[48:51], a[224:227], v[208:211], v[48:51]
    ds_read_b128 a[220:223], v3 offset:18432
    v_mul_f32 v70, v70, |v70|
    v_mul_f32 v71, v71, |v71|
    v_mfma_f32_16x16x32_bf16 v[56:59], a[224:227], v[212:215], v[56:59]
    v_cvt_pk_bf16_f32 v68, v68, v69
    v_mfma_f32_16x16x32_bf16 v[52:55], a[228:231], v[208:211], v[52:55]
    ds_read_b128 a[224:227], v3 offset:38912
    v_cvt_pk_bf16_f32 v69, v70, v71
    v_pk_max_i16 v68, v68, 0
    v_mfma_f32_16x16x32_bf16 v[60:63], a[228:231], v[212:215], v[60:63]
    v_pk_max_i16 v69, v69, 0
    v_mfma_f32_16x16x32_bf16 v[48:51], a[232:235], v[216:219], v[48:51]
    ds_read_b128 a[228:231], v3 offset:19456
    buffer_store_dwordx2 v[68:69], v6, s[8:11], s77 offen offset:1024 sc1
    v_mfma_f32_16x16x32_bf16 v[56:59], a[232:235], v[220:223], v[56:59]
    v_mfma_f32_16x16x32_bf16 v[52:55], a[236:239], v[216:219], v[52:55]
    ds_read_b128 a[232:235], v3 offset:39936
    v_mfma_f32_16x16x32_bf16 v[60:63], a[236:239], v[220:223], v[60:63]
    s_waitcnt lgkmcnt(4)
    v_mfma_f32_16x16x32_bf16 v[48:51], a[240:243], v[224:227], v[48:51]
    ds_read_b128 a[236:239], v1 offset:3072
    v_mfma_f32_16x16x32_bf16 v[56:59], a[240:243], v[228:231], v[56:59]
    v_mfma_f32_16x16x32_bf16 v[52:55], a[244:247], v[224:227], v[52:55]
    ds_read_b128 a[240:243], v1 offset:4096
    v_mfma_f32_16x16x32_bf16 v[60:63], a[244:247], v[228:231], v[60:63]
    v_mfma_f32_16x16x32_bf16 v[48:51], a[248:251], v[232:235], v[48:51]
    ds_read_b128 a[244:247], v4 offset:0
    v_mfma_f32_16x16x32_bf16 v[56:59], a[248:251], v[236:239], v[56:59]
    v_mfma_f32_16x16x32_bf16 v[52:55], a[252:255], v[232:235], v[52:55]
    ds_read_b128 a[248:251], v4 offset:20480
    v_mfma_f32_16x16x32_bf16 v[60:63], a[252:255], v[236:239], v[60:63]
    s_waitcnt lgkmcnt(4)
    v_mfma_f32_16x16x32_bf16 v[48:51], a[220:223], v[240:243], v[48:51]
    ds_read_b128 a[252:255], v4 offset:1024
    v_mfma_f32_16x16x32_bf16 v[56:59], a[220:223], v[244:247], v[56:59]
    v_mfma_f32_16x16x32_bf16 v[52:55], a[224:227], v[240:243], v[52:55]
    ds_read_b128 a[220:223], v4 offset:21504
    v_mfma_f32_16x16x32_bf16 v[60:63], a[224:227], v[244:247], v[60:63]
    v_mfma_f32_16x16x32_bf16 v[48:51], a[228:231], v[248:251], v[48:51]
    ds_read_b128 a[224:227], v4 offset:2048
    v_mfma_f32_16x16x32_bf16 v[56:59], a[228:231], v[252:255], v[56:59]
    v_mfma_f32_16x16x32_bf16 v[52:55], a[232:235], v[248:251], v[52:55]
    ds_read_b128 a[228:231], v4 offset:22528
    v_mfma_f32_16x16x32_bf16 v[60:63], a[232:235], v[252:255], v[60:63]
    s_waitcnt lgkmcnt(6)
    v_mfma_f32_16x16x32_bf16 v[48:51], a[236:239], v[16:19], v[48:51]
    ds_read_b128 a[232:235], v4 offset:3072
    v_mfma_f32_16x16x32_bf16 v[56:59], a[236:239], v[20:23], v[56:59]
    v_mfma_f32_16x16x32_bf16 v[52:55], a[240:243], v[16:19], v[52:55]
    ds_read_b128 a[236:239], v4 offset:23552
    v_mfma_f32_16x16x32_bf16 v[60:63], a[240:243], v[20:23], v[60:63]
    s_waitcnt lgkmcnt(4)
    s_barrier
    v_mfma_f32_16x16x32_bf16 v[80:83], a[244:247], v[96:99], 0
    ds_read_b128 a[240:243], v4 offset:4096
    v_mfma_f32_16x16x32_bf16 v[88:91], a[244:247], v[100:103], 0
    v_mfma_f32_16x16x32_bf16 v[84:87], a[248:251], v[96:99], 0
    ds_read_b128 a[244:247], v4 offset:24576
    s_mul_i32 s91, s3, 10240
    s_add_u32 s91, s91, 68608
    s_add_u32 m0, s91, 0
    s_add_u32 s89, s45, s87
    buffer_load_dwordx4 v1, s[8:11], s89 offen offset:0 lds
    v_mfma_f32_16x16x32_bf16 v[92:95], a[248:251], v[100:103], 0
    v_mfma_f32_16x16x32_bf16 v[80:83], a[252:255], v[104:107], v[80:83]
    ds_read_b128 a[248:251], v4 offset:5120
    v_mfma_f32_16x16x32_bf16 v[88:91], a[252:255], v[108:111], v[88:91]
    s_add_u32 s76, s76, 4096
    v_mul_f32 v48, v48, |v48|
    v_mfma_f32_16x16x32_bf16 v[84:87], a[220:223], v[104:107], v[84:87]
    ds_read_b128 a[252:255], v4 offset:25600
    v_mul_f32 v49, v49, |v49|
    buffer_load_dwordx4 v1, s[8:11], s89 offen offset:1024 lds
    v_mfma_f32_16x16x32_bf16 v[92:95], a[220:223], v[108:111], v[92:95]
    v_mul_f32 v50, v50, |v50|
    v_mul_f32 v51, v51, |v51|
    s_waitcnt lgkmcnt(4)
    v_mfma_f32_16x16x32_bf16 v[80:83], a[224:227], v[112:115], v[80:83]
    ds_read_b128 a[220:223], v4 offset:6144
    v_mul_f32 v52, v52, |v52|
    v_mfma_f32_16x16x32_bf16 v[88:91], a[224:227], v[116:119], v[88:91]
    v_mul_f32 v53, v53, |v53|
    v_mul_f32 v54, v54, |v54|
    v_mfma_f32_16x16x32_bf16 v[84:87], a[228:231], v[112:115], v[84:87]
    ds_read_b128 a[224:227], v4 offset:26624
    v_mul_f32 v55, v55, |v55|
    buffer_load_dwordx4 v1, s[8:11], s89 offen offset:2048 lds
    v_mfma_f32_16x16x32_bf16 v[92:95], a[228:231], v[116:119], v[92:95]
    v_cvt_pk_bf16_f32 v48, v48, v49
    v_cvt_pk_bf16_f32 v49, v50, v51
    v_mfma_f32_16x16x32_bf16 v[80:83], a[232:235], v[120:123], v[80:83]
    ds_read_b128 a[228:231], v4 offset:7168
    v_cvt_pk_bf16_f32 v50, v52, v53
    v_mfma_f32_16x16x32_bf16 v[88:91], a[232:235], v[124:127], v[88:91]
    v_cvt_pk_bf16_f32 v51, v54, v55
    v_pk_max_i16 v48, v48, 0
    v_mfma_f32_16x16x32_bf16 v[84:87], a[236:239], v[120:123], v[84:87]
    ds_read_b128 a[232:235], v4 offset:27648
    v_pk_max_i16 v49, v49, 0
    buffer_load_dwordx4 v1, s[8:11], s89 offen offset:3072 lds
    v_mfma_f32_16x16x32_bf16 v[92:95], a[236:239], v[124:127], v[92:95]
    v_pk_max_i16 v50, v50, 0
    v_pk_max_i16 v51, v51, 0
    s_waitcnt lgkmcnt(4)
    v_mfma_f32_16x16x32_bf16 v[80:83], a[240:243], v[128:131], v[80:83]
    ds_read_b128 a[236:239], v4 offset:8192
    buffer_store_dwordx4 v[48:51], v1, s[8:11], s76 offen offset:0 sc1
    v_mfma_f32_16x16x32_bf16 v[88:91], a[240:243], v[132:135], v[88:91]
    v_mul_f32 v56, v56, |v56|
    v_mul_f32 v57, v57, |v57|
    v_mfma_f32_16x16x32_bf16 v[84:87], a[244:247], v[128:131], v[84:87]
    ds_read_b128 a[240:243], v4 offset:28672
    v_mul_f32 v58, v58, |v58|
    s_add_u32 m0, s91, 4096
    s_add_u32 s89, s89, 4096
    buffer_load_dwordx4 v1, s[8:11], s89 offen offset:0 lds
    v_mfma_f32_16x16x32_bf16 v[92:95], a[244:247], v[132:135], v[92:95]
    v_mul_f32 v59, v59, |v59|
    v_mul_f32 v60, v60, |v60|
    v_mfma_f32_16x16x32_bf16 v[80:83], a[248:251], v[136:139], v[80:83]
    ds_read_b128 a[244:247], v4 offset:9216
    v_mul_f32 v61, v61, |v61|
    v_mfma_f32_16x16x32_bf16 v[88:91], a[248:251], v[140:143], v[88:91]
    v_mul_f32 v62, v62, |v62|
    v_mul_f32 v63, v63, |v63|
    v_mfma_f32_16x16x32_bf16 v[84:87], a[252:255], v[136:139], v[84:87]
    ds_read_b128 a[248:251], v4 offset:29696
    v_cvt_pk_bf16_f32 v56, v56, v57
    s_add_u32 m0, s91, 5120
    s_add_u32 s89, s46, s87
    buffer_load_dwordx4 v1, s[8:11], s89 offen offset:0 lds
    v_mfma_f32_16x16x32_bf16 v[92:95], a[252:255], v[140:143], v[92:95]
    v_cvt_pk_bf16_f32 v57, v58, v59
    v_cvt_pk_bf16_f32 v58, v60, v61
    s_waitcnt lgkmcnt(4)
    v_mfma_f32_16x16x32_bf16 v[80:83], a[220:223], v[144:147], v[80:83]
    ds_read_b128 a[252:255], v4 offset:10240
    v_cvt_pk_bf16_f32 v59, v62, v63
    v_mfma_f32_16x16x32_bf16 v[88:91], a[220:223], v[148:151], v[88:91]
    v_pk_max_i16 v56, v56, 0
    v_pk_max_i16 v57, v57, 0
    v_mfma_f32_16x16x32_bf16 v[84:87], a[224:227], v[144:147], v[84:87]
    ds_read_b128 a[220:223], v4 offset:30720
    v_pk_max_i16 v58, v58, 0
    buffer_load_dwordx4 v1, s[8:11], s89 offen offset:1024 lds
    v_mfma_f32_16x16x32_bf16 v[92:95], a[224:227], v[148:151], v[92:95]
    v_pk_max_i16 v59, v59, 0
    buffer_store_dwordx4 v[56:59], v1, s[8:11], s76 offen offset:1024 sc1
    v_mfma_f32_16x16x32_bf16 v[80:83], a[228:231], v[152:155], v[80:83]
    ds_read_b128 a[224:227], v4 offset:11264
    v_mfma_f32_16x16x32_bf16 v[88:91], a[228:231], v[156:159], v[88:91]
    v_mfma_f32_16x16x32_bf16 v[84:87], a[232:235], v[152:155], v[84:87]
    ds_read_b128 a[228:231], v4 offset:31744
    buffer_load_dwordx4 v1, s[8:11], s89 offen offset:2048 lds
    v_mfma_f32_16x16x32_bf16 v[92:95], a[232:235], v[156:159], v[92:95]
    s_waitcnt lgkmcnt(4)
    v_mfma_f32_16x16x32_bf16 v[80:83], a[236:239], v[160:163], v[80:83]
    ds_read_b128 a[232:235], v4 offset:12288
    v_mfma_f32_16x16x32_bf16 v[88:91], a[236:239], v[164:167], v[88:91]
    v_mfma_f32_16x16x32_bf16 v[84:87], a[240:243], v[160:163], v[84:87]
    ds_read_b128 a[236:239], v4 offset:32768
    buffer_load_dwordx4 v1, s[8:11], s89 offen offset:3072 lds
    v_mfma_f32_16x16x32_bf16 v[92:95], a[240:243], v[164:167], v[92:95]
    v_mfma_f32_16x16x32_bf16 v[80:83], a[244:247], v[168:171], v[80:83]
    ds_read_b128 a[240:243], v4 offset:13312
    v_mfma_f32_16x16x32_bf16 v[88:91], a[244:247], v[172:175], v[88:91]
    v_mfma_f32_16x16x32_bf16 v[84:87], a[248:251], v[168:171], v[84:87]
    ds_read_b128 a[244:247], v4 offset:33792
    s_add_u32 m0, s91, 9216
    s_add_u32 s89, s89, 4096
    buffer_load_dwordx4 v1, s[8:11], s89 offen offset:0 lds
    v_mfma_f32_16x16x32_bf16 v[92:95], a[248:251], v[172:175], v[92:95]
    s_waitcnt lgkmcnt(4)
    v_mfma_f32_16x16x32_bf16 v[80:83], a[252:255], v[176:179], v[80:83]
    ds_read_b128 a[248:251], v4 offset:14336
    v_mfma_f32_16x16x32_bf16 v[88:91], a[252:255], v[180:183], v[88:91]
    v_mfma_f32_16x16x32_bf16 v[84:87], a[220:223], v[176:179], v[84:87]
    ds_read_b128 a[252:255], v4 offset:34816
    s_lshl1_add_u32 s90, s39, s80
    buffer_load_dwordx4 v[96:99], v12, s[8:11], s90 offen sc1
    v_mfma_f32_16x16x32_bf16 v[92:95], a[220:223], v[180:183], v[92:95]
    v_mfma_f32_16x16x32_bf16 v[80:83], a[224:227], v[184:187], v[80:83]
    ds_read_b128 a[220:223], v4 offset:15360
    v_mfma_f32_16x16x32_bf16 v[88:91], a[224:227], v[188:191], v[88:91]
    v_mfma_f32_16x16x32_bf16 v[84:87], a[228:231], v[184:187], v[84:87]
    ds_read_b128 a[224:227], v4 offset:35840
    buffer_load_dwordx4 v[100:103], v13, s[8:11], s90 offen sc1
    v_mfma_f32_16x16x32_bf16 v[92:95], a[228:231], v[188:191], v[92:95]
    s_waitcnt lgkmcnt(4)
    v_mfma_f32_16x16x32_bf16 v[80:83], a[232:235], v[192:195], v[80:83]
    ds_read_b128 a[228:231], v4 offset:16384
    v_mfma_f32_16x16x32_bf16 v[88:91], a[232:235], v[196:199], v[88:91]
    v_mfma_f32_16x16x32_bf16 v[84:87], a[236:239], v[192:195], v[84:87]
    ds_read_b128 a[232:235], v4 offset:36864
    buffer_load_dwordx4 v[104:107], v14, s[8:11], s90 offen sc1
    v_mfma_f32_16x16x32_bf16 v[92:95], a[236:239], v[196:199], v[92:95]
    v_mfma_f32_16x16x32_bf16 v[80:83], a[240:243], v[200:203], v[80:83]
    ds_read_b128 a[236:239], v4 offset:17408
    v_mfma_f32_16x16x32_bf16 v[88:91], a[240:243], v[204:207], v[88:91]
    v_mfma_f32_16x16x32_bf16 v[84:87], a[244:247], v[200:203], v[84:87]
    ds_read_b128 a[240:243], v4 offset:37888
    buffer_load_dwordx4 v[108:111], v15, s[8:11], s90 offen sc1
    v_mfma_f32_16x16x32_bf16 v[92:95], a[244:247], v[204:207], v[92:95]
    s_waitcnt lgkmcnt(4)
    v_mfma_f32_16x16x32_bf16 v[80:83], a[248:251], v[208:211], v[80:83]
    ds_read_b128 a[244:247], v4 offset:18432
    v_mfma_f32_16x16x32_bf16 v[88:91], a[248:251], v[212:215], v[88:91]
    v_mfma_f32_16x16x32_bf16 v[84:87], a[252:255], v[208:211], v[84:87]
    ds_read_b128 a[248:251], v4 offset:38912
    s_lshl1_add_u32 s90, s40, s80
    buffer_load_dwordx4 v[112:115], v12, s[8:11], s90 offen sc1
    v_mfma_f32_16x16x32_bf16 v[92:95], a[252:255], v[212:215], v[92:95]
    v_mfma_f32_16x16x32_bf16 v[80:83], a[220:223], v[216:219], v[80:83]
    ds_read_b128 a[252:255], v4 offset:19456
    v_mfma_f32_16x16x32_bf16 v[88:91], a[220:223], v[220:223], v[88:91]
    v_mfma_f32_16x16x32_bf16 v[84:87], a[224:227], v[216:219], v[84:87]
    ds_read_b128 a[220:223], v4 offset:39936
    buffer_load_dwordx4 v[116:119], v13, s[8:11], s90 offen sc1
    v_mfma_f32_16x16x32_bf16 v[92:95], a[224:227], v[220:223], v[92:95]
    s_waitcnt lgkmcnt(4)
    v_mfma_f32_16x16x32_bf16 v[80:83], a[228:231], v[224:227], v[80:83]
    ds_read_b128 a[224:227], v1 offset:5120
    v_mfma_f32_16x16x32_bf16 v[88:91], a[228:231], v[228:231], v[88:91]
    v_mfma_f32_16x16x32_bf16 v[84:87], a[232:235], v[224:227], v[84:87]
    ds_read_b128 a[228:231], v1 offset:6144
    buffer_load_dwordx4 v[120:123], v14, s[8:11], s90 offen sc1
    v_mfma_f32_16x16x32_bf16 v[92:95], a[232:235], v[228:231], v[92:95]
    v_mfma_f32_16x16x32_bf16 v[80:83], a[236:239], v[232:235], v[80:83]
    v_mfma_f32_16x16x32_bf16 v[88:91], a[236:239], v[236:239], v[88:91]
    v_mfma_f32_16x16x32_bf16 v[84:87], a[240:243], v[232:235], v[84:87]
    buffer_load_dwordx4 v[124:127], v15, s[8:11], s90 offen sc1
    v_mfma_f32_16x16x32_bf16 v[92:95], a[240:243], v[236:239], v[92:95]
    s_waitcnt lgkmcnt(2)
    v_mfma_f32_16x16x32_bf16 v[80:83], a[244:247], v[240:243], v[80:83]
    v_mfma_f32_16x16x32_bf16 v[88:91], a[244:247], v[244:247], v[88:91]
    v_mfma_f32_16x16x32_bf16 v[84:87], a[248:251], v[240:243], v[84:87]
    s_lshl1_add_u32 s90, s41, s80
    buffer_load_dwordx4 v[128:131], v12, s[8:11], s90 offen sc1
    s_waitcnt vmcnt(5)
    v_mfma_f32_16x16x32_bf16 v[92:95], a[248:251], v[244:247], v[92:95]
    v_or3_b32 v10, v96, v97, v98
    v_or3_b32 v10, v10, v99, v100
    v_mfma_f32_16x16x32_bf16 v[80:83], a[252:255], v[248:251], v[80:83]
    v_or3_b32 v10, v10, v101, v102
    v_mfma_f32_16x16x32_bf16 v[88:91], a[252:255], v[252:255], v[88:91]
    v_or3_b32 v10, v10, v103, v104
    v_or3_b32 v10, v10, v105, v106
    v_mfma_f32_16x16x32_bf16 v[84:87], a[220:223], v[248:251], v[84:87]
    buffer_load_dwordx4 v[132:135], v13, s[8:11], s90 offen sc1
    v_or3_b32 v10, v10, v107, v108
    v_mfma_f32_16x16x32_bf16 v[92:95], a[220:223], v[252:255], v[92:95]
    v_or3_b32 v10, v10, v109, v110
    v_or_b32 v10, v10, v111
    s_waitcnt lgkmcnt(0)
    v_mfma_f32_16x16x32_bf16 v[80:83], a[224:227], v[16:19], v[80:83]
    v_cmp_gt_i32 vcc, 0, v10
    v_mfma_f32_16x16x32_bf16 v[88:91], a[224:227], v[20:23], v[88:91]
    v_mfma_f32_16x16x32_bf16 v[84:87], a[228:231], v[16:19], v[84:87]
    buffer_load_dwordx4 v[136:139], v14, s[8:11], s90 offen sc1
    v_mfma_f32_16x16x32_bf16 v[92:95], a[228:231], v[20:23], v[92:95]
    s_lshl_b32 s88, s71, 12
    s_add_u32 s76, s77, s88
    s_add_u32 s76, s76, 131072
L_g2_0:
    s_cbranch_vccnz L_inte_retry_60
L_inte_back_61:
    v_mfma_f32_16x16x32_bf16 v[16:19], a[0:3], v[96:99], 0
    v_mfma_f32_16x16x32_bf16 v[20:23], a[4:7], v[96:99], 0
    buffer_load_dwordx4 v[140:143], v15, s[8:11], s90 offen sc1
    v_mfma_f32_16x16x32_bf16 v[24:27], a[8:11], v[96:99], 0
    v_mul_f32 v80, v80, |v80|
    v_mul_f32 v81, v81, |v81|
    v_mul_f32 v82, v82, |v82|
    v_mfma_f32_16x16x32_bf16 v[28:31], a[12:15], v[96:99], 0
    v_mul_f32 v83, v83, |v83|
    v_mul_f32 v84, v84, |v84|
    v_mul_f32 v85, v85, |v85|
    v_mfma_f32_16x16x32_bf16 v[32:35], a[16:19], v[96:99], 0
    v_mul_f32 v86, v86, |v86|
    v_mul_f32 v87, v87, |v87|
    v_mfma_f32_16x16x32_bf16 v[36:39], a[0:3], v[100:103], 0
    v_cvt_pk_bf16_f32 v80, v80, v81
    v_cvt_pk_bf16_f32 v81, v82, v83
    v_cvt_pk_bf16_f32 v82, v84, v85
    s_lshl1_add_u32 s90, s42, s80
    buffer_load_dwordx4 v[144:147], v12, s[8:11], s90 offen sc1
    v_mfma_f32_16x16x32_bf16 v[40:43], a[4:7], v[100:103], 0
    v_cvt_pk_bf16_f32 v83, v86, v87
    v_pk_max_i16 v80, v80, 0
    v_pk_max_i16 v81, v81, 0
    v_mfma_f32_16x16x32_bf16 v[44:47], a[8:11], v[100:103], 0
    s_waitcnt vmcnt(5)
    v_pk_max_i16 v82, v82, 0
    v_pk_max_i16 v83, v83, 0
    v_mfma_f32_16x16x32_bf16 v[48:51], a[12:15], v[100:103], 0
    v_or3_b32 v10, v112, v113, v114
    buffer_store_dwordx4 v[80:83], v1, s[8:11], s76 offen offset:0 sc1
    v_mul_f32 v88, v88, |v88|
    v_mul_f32 v89, v89, |v89|
    v_mfma_f32_16x16x32_bf16 v[52:55], a[16:19], v[100:103], 0
    v_or3_b32 v10, v10, v115, v116
    v_mul_f32 v90, v90, |v90|
    v_mul_f32 v91, v91, |v91|
    buffer_load_dwordx4 v[148:151], v13, s[8:11], s90 offen sc1
    v_mfma_f32_16x16x32_bf16 v[56:59], a[0:3], v[104:107], 0
    v_or3_b32 v10, v10, v117, v118
    v_mul_f32 v92, v92, |v92|
    v_mul_f32 v93, v93, |v93|
    v_mul_f32 v94, v94, |v94|
    v_mfma_f32_16x16x32_bf16 v[60:63], a[4:7], v[104:107], 0
    v_or3_b32 v10, v10, v119, v120
    v_mul_f32 v95, v95, |v95|
    v_cvt_pk_bf16_f32 v88, v88, v89
    v_cvt_pk_bf16_f32 v89, v90, v91
    v_mfma_f32_16x16x32_bf16 v[64:67], a[8:11], v[104:107], 0
    v_or3_b32 v10, v10, v121, v122
    v_cvt_pk_bf16_f32 v90, v92, v93
    v_cvt_pk_bf16_f32 v91, v94, v95
    v_mfma_f32_16x16x32_bf16 v[68:71], a[12:15], v[104:107], 0
    v_or3_b32 v10, v10, v123, v124
    v_pk_max_i16 v88, v88, 0
    v_pk_max_i16 v89, v89, 0
    v_pk_max_i16 v90, v90, 0
    buffer_load_dwordx4 v[152:155], v14, s[8:11], s90 offen sc1
    v_mfma_f32_16x16x32_bf16 v[72:75], a[16:19], v[104:107], 0
    v_or3_b32 v10, v10, v125, v126
    v_pk_max_i16 v91, v91, 0
    buffer_store_dwordx4 v[88:91], v1, s[8:11], s76 offen offset:1024 sc1
    v_mfma_f32_16x16x32_bf16 v[76:79], a[0:3], v[108:111], 0
    v_or_b32 v10, v10, v127
    v_mfma_f32_16x16x32_bf16 v[80:83], a[4:7], v[108:111], 0
    v_cmp_gt_i32 vcc, 0, v10
    v_mfma_f32_16x16x32_bf16 v[84:87], a[8:11], v[108:111], 0
    buffer_load_dwordx4 v[156:159], v15, s[8:11], s90 offen sc1
    v_mfma_f32_16x16x32_bf16 v[88:91], a[12:15], v[108:111], 0
    v_mfma_f32_16x16x32_bf16 v[92:95], a[16:19], v[108:111], 0
    s_waitcnt lgkmcnt(0)
    s_barrier
    s_cbranch_vccnz L_inte_retry_62
L_inte_back_63:
    v_mfma_f32_16x16x32_bf16 v[16:19], a[20:23], v[112:115], v[16:19]
    v_lshrrev_b32 v248, 4, v0
    s_mul_i32 s74, s73, 320
    s_add_u32 s74, s74, 0x2348000
    s_add_u32 m0, s69, 146432
    s_mov_b64 exec, 0xfffff
    buffer_load_dwordx4 v1, s[8:11], s74 offen lds
    s_mov_b64 exec, -1
    s_add_u32 s74, s69, 146432
    s_mul_i32 s88, s3, 10240
    s_add_u32 s88, s88, 68608
    v_add_u32 v11, s88, v1
    v_mfma_f32_16x16x32_bf16 v[20:23], a[24:27], v[112:115], v[20:23]
    s_mov_b32 s90, s81
    buffer_load_dwordx4 v[160:163], v12, s[8:11], s90 offen sc1
    v_mfma_f32_16x16x32_bf16 v[24:27], a[28:31], v[112:115], v[24:27]
    v_mul_u32_u24 v249, 80, v248
    v_add_u32 v249, s74, v249
    v_mfma_f32_16x16x32_bf16 v[28:31], a[32:35], v[112:115], v[28:31]
    v_and_b32 v250, 15, v0
    s_lshl_b32 s92, s70, 3
    v_mfma_f32_16x16x32_bf16 v[32:35], a[36:39], v[112:115], v[32:35]
    s_lshl_b32 s74, s72, 2
    s_add_u32 s92, s92, s74
    v_mfma_f32_16x16x32_bf16 v[36:39], a[20:23], v[116:119], v[36:39]
    buffer_load_dwordx4 v[164:167], v13, s[8:11], s90 offen sc1
    v_mfma_f32_16x16x32_bf16 v[40:43], a[24:27], v[116:119], v[40:43]
    s_add_u32 s92, s92, s3
    v_lshlrev_b32 v251, 4, v250
    v_mfma_f32_16x16x32_bf16 v[44:47], a[28:31], v[116:119], v[44:47]
    s_waitcnt vmcnt(9)
    v_mfma_f32_16x16x32_bf16 v[48:51], a[32:35], v[116:119], v[48:51]
    v_or3_b32 v10, v128, v129, v130
    v_mfma_f32_16x16x32_bf16 v[52:55], a[36:39], v[116:119], v[52:55]
    v_or3_b32 v10, v10, v131, v132
    buffer_load_dwordx4 v[168:171], v14, s[8:11], s90 offen sc1
    v_mfma_f32_16x16x32_bf16 v[56:59], a[20:23], v[120:123], v[56:59]
    v_or3_b32 v10, v10, v133, v134
    v_mfma_f32_16x16x32_bf16 v[60:63], a[24:27], v[120:123], v[60:63]
    v_or3_b32 v10, v10, v135, v136
    v_mfma_f32_16x16x32_bf16 v[64:67], a[28:31], v[120:123], v[64:67]
    v_or3_b32 v10, v10, v137, v138
    v_mfma_f32_16x16x32_bf16 v[68:71], a[32:35], v[120:123], v[68:71]
    v_or3_b32 v10, v10, v139, v140
    buffer_load_dwordx4 v[172:175], v15, s[8:11], s90 offen sc1
    v_mfma_f32_16x16x32_bf16 v[72:75], a[36:39], v[120:123], v[72:75]
    v_or3_b32 v10, v10, v141, v142
    v_mfma_f32_16x16x32_bf16 v[76:79], a[20:23], v[124:127], v[76:79]
    v_or_b32 v10, v10, v143
    v_mfma_f32_16x16x32_bf16 v[80:83], a[24:27], v[124:127], v[80:83]
    v_cmp_gt_i32 vcc, 0, v10
    v_mfma_f32_16x16x32_bf16 v[84:87], a[28:31], v[124:127], v[84:87]
    s_mov_b32 s90, s82
    buffer_load_dwordx4 v[176:179], v12, s[8:11], s90 offen sc1
    v_lshl_add_u32 v252, v248, 12, v251
    v_lshrrev_b32 v253, 5, v0
    v_mfma_f32_16x16x32_bf16 v[88:91], a[32:35], v[124:127], v[88:91]
    v_lshl_add_u32 v253, v253, 12, v251
    v_bfe_u32 v251, v0, 4, 1
    v_mfma_f32_16x16x32_bf16 v[92:95], a[36:39], v[124:127], v[92:95]
    v_lshl_add_u32 v253, v251, 3, v253
    s_lshr_b32 s74, s92, 1
    s_cbranch_vccnz L_inte_retry_64
L_inte_back_65:
    v_mfma_f32_16x16x32_bf16 v[16:19], a[40:43], v[128:131], v[16:19]
    s_mul_i32 s93, s74, 40960
    s_and_b32 s74, s92, 1
    v_mfma_f32_16x16x32_bf16 v[20:23], a[44:47], v[128:131], v[20:23]
    buffer_load_dwordx4 v[180:183], v13, s[8:11], s90 offen sc1
    v_mfma_f32_16x16x32_bf16 v[24:27], a[48:51], v[128:131], v[24:27]
    s_lshl_b32 s74, s74, 8
    s_add_u32 s93, s93, s74
    v_mfma_f32_16x16x32_bf16 v[28:31], a[52:55], v[128:131], v[28:31]
    s_lshl_b32 s74, s73, 9
    s_add_u32 s93, s93, s74
    s_add_u32 s74, s93, 0x280000
    v_mfma_f32_16x16x32_bf16 v[32:35], a[56:59], v[128:131], v[32:35]
    buffer_load_dwordx4 v[236:239], v252, s[8:11], s74 offen sc1
    s_add_u32 s74, s93, 0x284000
    v_mfma_f32_16x16x32_bf16 v[36:39], a[40:43], v[132:135], v[36:39]
    s_lshl1_add_u32 s90, s39, s24
    buffer_load_dwordx4 v[192:195], v12, s[8:11], s90 offen sc1
    v_mfma_f32_16x16x32_bf16 v[40:43], a[44:47], v[132:135], v[40:43]
    buffer_load_dwordx4 v[240:243], v252, s[8:11], s74 offen sc1
    s_add_u32 s74, s93, 0x288000
    v_mfma_f32_16x16x32_bf16 v[44:47], a[48:51], v[132:135], v[44:47]
    s_waitcnt vmcnt(10)
    v_mfma_f32_16x16x32_bf16 v[48:51], a[52:55], v[132:135], v[48:51]
    v_or3_b32 v10, v144, v145, v146
    v_mfma_f32_16x16x32_bf16 v[52:55], a[56:59], v[132:135], v[52:55]
    v_or3_b32 v10, v10, v147, v148
    buffer_load_dwordx4 v[196:199], v13, s[8:11], s90 offen sc1
    v_mfma_f32_16x16x32_bf16 v[56:59], a[40:43], v[136:139], v[56:59]
    v_or3_b32 v10, v10, v149, v150
    v_mfma_f32_16x16x32_bf16 v[60:63], a[44:47], v[136:139], v[60:63]
    v_or3_b32 v10, v10, v151, v152
    v_mfma_f32_16x16x32_bf16 v[64:67], a[48:51], v[136:139], v[64:67]
    v_or3_b32 v10, v10, v153, v154
    v_mfma_f32_16x16x32_bf16 v[68:71], a[52:55], v[136:139], v[68:71]
    v_or3_b32 v10, v10, v155, v156
    buffer_load_dwordx4 v[200:203], v14, s[8:11], s90 offen sc1
    v_mfma_f32_16x16x32_bf16 v[72:75], a[56:59], v[136:139], v[72:75]
    v_or3_b32 v10, v10, v157, v158
    v_mfma_f32_16x16x32_bf16 v[76:79], a[40:43], v[140:143], v[76:79]
    v_or_b32 v10, v10, v159
    v_mfma_f32_16x16x32_bf16 v[80:83], a[44:47], v[140:143], v[80:83]
    v_cmp_gt_i32 vcc, 0, v10
    v_mfma_f32_16x16x32_bf16 v[84:87], a[48:51], v[140:143], v[84:87]
    buffer_load_dwordx4 v[204:207], v15, s[8:11], s90 offen sc1
    buffer_load_dwordx2 v[244:245], v253, s[8:11], s74 offen sc1
    s_lshl_b32 s74, s72, 2
    v_mfma_f32_16x16x32_bf16 v[88:91], a[52:55], v[140:143], v[88:91]
    s_add_u32 s74, s74, s3
    s_lshl_b32 s74, s74, 6
    v_mfma_f32_16x16x32_bf16 v[92:95], a[56:59], v[140:143], v[92:95]
    s_add_u32 s74, s74, 151552
    v_lshl_add_u32 v251, v250, 2, s74
    s_cbranch_vccnz L_inte_retry_66
L_inte_back_67:
    v_mfma_f32_16x16x32_bf16 v[16:19], a[60:63], v[144:147], v[16:19]
    ds_read_b32 v254, v251
    s_add_u32 s74, s3, 1
    v_mfma_f32_16x16x32_bf16 v[20:23], a[64:67], v[144:147], v[20:23]
    s_lshl1_add_u32 s90, s40, s24
    buffer_load_dwordx4 v[96:99], v12, s[8:11], s90 offen sc1
    v_mfma_f32_16x16x32_bf16 v[24:27], a[68:71], v[144:147], v[24:27]
    s_and_b32 s74, s74, 3
    s_mul_i32 s74, s74, 15360
    ds_read_b128 a[0:3], v11 offset:0
    v_mfma_f32_16x16x32_bf16 v[28:31], a[72:75], v[144:147], v[28:31]
    s_add_u32 s74, s74, 68608
    v_add_u32 v2, s74, v1
    ds_read_b128 a[4:7], v11 offset:1024
    v_mfma_f32_16x16x32_bf16 v[32:35], a[76:79], v[144:147], v[32:35]
    s_add_u32 s74, s3, 2
    s_and_b32 s74, s74, 3
    ds_read_b128 a[8:11], v11 offset:2048
    v_mfma_f32_16x16x32_bf16 v[36:39], a[60:63], v[148:151], v[36:39]
    buffer_load_dwordx4 v[100:103], v13, s[8:11], s90 offen sc1
    ds_read_b128 a[12:15], v11 offset:3072
    v_mfma_f32_16x16x32_bf16 v[40:43], a[64:67], v[148:151], v[40:43]
    s_mul_i32 s74, s74, 15360
    s_add_u32 s74, s74, 73728
    ds_read_b128 a[16:19], v11 offset:4096
    v_mfma_f32_16x16x32_bf16 v[44:47], a[68:71], v[148:151], v[44:47]
    s_waitcnt vmcnt(11)
    v_mfma_f32_16x16x32_bf16 v[48:51], a[72:75], v[148:151], v[48:51]
    v_or3_b32 v10, v160, v161, v162
    v_mfma_f32_16x16x32_bf16 v[52:55], a[76:79], v[148:151], v[52:55]
    v_or3_b32 v10, v10, v163, v164
    buffer_load_dwordx4 v[104:107], v14, s[8:11], s90 offen sc1
    v_mfma_f32_16x16x32_bf16 v[56:59], a[60:63], v[152:155], v[56:59]
    v_or3_b32 v10, v10, v165, v166
    v_mfma_f32_16x16x32_bf16 v[60:63], a[64:67], v[152:155], v[60:63]
    v_or3_b32 v10, v10, v167, v168
    v_mfma_f32_16x16x32_bf16 v[64:67], a[68:71], v[152:155], v[64:67]
    v_or3_b32 v10, v10, v169, v170
    v_mfma_f32_16x16x32_bf16 v[68:71], a[72:75], v[152:155], v[68:71]
    v_or3_b32 v10, v10, v171, v172
    buffer_load_dwordx4 v[108:111], v15, s[8:11], s90 offen sc1
    v_mfma_f32_16x16x32_bf16 v[72:75], a[76:79], v[152:155], v[72:75]
    v_or3_b32 v10, v10, v173, v174
    v_mfma_f32_16x16x32_bf16 v[76:79], a[60:63], v[156:159], v[76:79]
    v_or_b32 v10, v10, v175
    v_mfma_f32_16x16x32_bf16 v[80:83], a[64:67], v[156:159], v[80:83]
    v_cmp_gt_i32 vcc, 0, v10
    v_mfma_f32_16x16x32_bf16 v[84:87], a[68:71], v[156:159], v[84:87]
    s_lshl1_add_u32 s90, s41, s24
    buffer_load_dwordx4 v[112:115], v12, s[8:11], s90 offen sc1
    v_add_u32 v3, s74, v1
    s_add_u32 s74, s3, 3
    s_and_b32 s74, s74, 3
    v_mfma_f32_16x16x32_bf16 v[88:91], a[72:75], v[156:159], v[88:91]
    s_mul_i32 s74, s74, 15360
    s_add_u32 s74, s74, 78848
    v_mfma_f32_16x16x32_bf16 v[92:95], a[76:79], v[156:159], v[92:95]
    v_add_u32 v4, s74, v1
    s_mul_i32 s74, s3, 15360
    s_cbranch_vccnz L_inte_retry_68
L_inte_back_69:
    v_mfma_f32_16x16x32_bf16 v[16:19], a[80:83], v[160:163], v[16:19]
    s_add_u32 s74, s74, 68608
    v_add_u32 v5, s74, v1
    v_mfma_f32_16x16x32_bf16 v[20:23], a[84:87], v[160:163], v[20:23]
    buffer_load_dwordx4 v[116:119], v13, s[8:11], s90 offen sc1
    v_mfma_f32_16x16x32_bf16 v[24:27], a[88:91], v[160:163], v[24:27]
    v_bfe_u32 v212, v0, 1, 3
    v_lshlrev_b32 v212, 16, v212
    ds_read_b128 a[20:23], v11 offset:5120
    v_mfma_f32_16x16x32_bf16 v[28:31], a[92:95], v[160:163], v[28:31]
    v_and_b32 v213, 1, v0
    v_lshl_add_u32 v212, v213, 5, v212
    ds_read_b128 a[24:27], v11 offset:6144
    v_mfma_f32_16x16x32_bf16 v[32:35], a[96:99], v[160:163], v[32:35]
    v_lshrrev_b32 v213, 4, v0
    v_lshl_add_u32 v212, v213, 3, v212
    ds_read_b128 a[28:31], v11 offset:7168
    v_mfma_f32_16x16x32_bf16 v[36:39], a[80:83], v[164:167], v[36:39]
    buffer_load_dwordx4 v[120:123], v14, s[8:11], s90 offen sc1
    ds_read_b128 a[32:35], v11 offset:8192
    v_mfma_f32_16x16x32_bf16 v[40:43], a[84:87], v[164:167], v[40:43]
    s_lshl_b32 s74, s73, 7
    s_add_u32 s74, s74, s92
    ds_read_b128 a[36:39], v11 offset:9216
    v_mfma_f32_16x16x32_bf16 v[44:47], a[88:91], v[164:167], v[44:47]
    s_waitcnt vmcnt(14)
    v_mfma_f32_16x16x32_bf16 v[48:51], a[92:95], v[164:167], v[48:51]
    v_or3_b32 v10, v176, v177, v178
    v_mfma_f32_16x16x32_bf16 v[52:55], a[96:99], v[164:167], v[52:55]
    v_or3_b32 v10, v10, v179, v180
    buffer_load_dwordx4 v[124:127], v15, s[8:11], s90 offen sc1
    v_mfma_f32_16x16x32_bf16 v[56:59], a[80:83], v[168:171], v[56:59]
    v_or3_b32 v10, v10, v181, v182
    v_mfma_f32_16x16x32_bf16 v[60:63], a[84:87], v[168:171], v[60:63]
    v_or_b32 v10, v10, v183
    v_mfma_f32_16x16x32_bf16 v[64:67], a[88:91], v[168:171], v[64:67]
    v_cmp_gt_i32 vcc, 0, v10
    v_mfma_f32_16x16x32_bf16 v[68:71], a[92:95], v[168:171], v[68:71]
    s_lshl1_add_u32 s90, s42, s24
    buffer_load_dwordx4 v[128:131], v12, s[8:11], s90 offen sc1
    v_mfma_f32_16x16x32_bf16 v[72:75], a[96:99], v[168:171], v[72:75]
    v_mfma_f32_16x16x32_bf16 v[76:79], a[80:83], v[172:175], v[76:79]
    v_mfma_f32_16x16x32_bf16 v[80:83], a[84:87], v[172:175], v[80:83]
    v_mfma_f32_16x16x32_bf16 v[84:87], a[88:91], v[172:175], v[84:87]
    buffer_load_dwordx4 v[132:135], v13, s[8:11], s90 offen sc1
    s_lshl_b32 s74, s74, 6
    s_add_u32 s94, s74, 0x2480000
    v_mfma_f32_16x16x32_bf16 v[88:91], a[92:95], v[172:175], v[88:91]
    v_lshlrev_b32 v214, 3, v250
    v_lshl_add_u32 v214, v248, 2, v214
    v_mfma_f32_16x16x32_bf16 v[92:95], a[96:99], v[172:175], v[92:95]
    s_lshl_b32 s95, s92, 7
    s_add_u32 s95, s95, 0x2344000
    s_cbranch_vccnz L_inte_retry_70
L_inte_back_71:
    v_mfma_f32_16x16x32_bf16 v[16:19], a[100:103], v[176:179], v[16:19]
    buffer_load_dwordx4 v[136:139], v14, s[8:11], s90 offen sc1
    v_mfma_f32_16x16x32_bf16 v[20:23], a[104:107], v[176:179], v[20:23]
    v_mfma_f32_16x16x32_bf16 v[24:27], a[108:111], v[176:179], v[24:27]
    v_mfma_f32_16x16x32_bf16 v[28:31], a[112:115], v[176:179], v[28:31]
    s_waitcnt vmcnt(12)
    v_mfma_f32_16x16x32_bf16 v[32:35], a[116:119], v[176:179], v[32:35]
    v_or3_b32 v10, v192, v193, v194
    v_or3_b32 v10, v10, v195, v196
    buffer_load_dwordx4 v[140:143], v15, s[8:11], s90 offen sc1
    v_mfma_f32_16x16x32_bf16 v[36:39], a[100:103], v[180:183], v[36:39]
    v_or3_b32 v10, v10, v197, v198
    v_or3_b32 v10, v10, v199, v200
    v_mfma_f32_16x16x32_bf16 v[40:43], a[104:107], v[180:183], v[40:43]
    v_or3_b32 v10, v10, v201, v202
    v_or3_b32 v10, v10, v203, v204
    v_mfma_f32_16x16x32_bf16 v[44:47], a[108:111], v[180:183], v[44:47]
    v_or3_b32 v10, v10, v205, v206
    v_or_b32 v10, v10, v207
    v_mfma_f32_16x16x32_bf16 v[48:51], a[112:115], v[180:183], v[48:51]
    v_cmp_gt_i32 vcc, 0, v10
    s_add_u32 s90, s39, s83
    buffer_load_dwordx4 v[144:147], v12, s[8:11], s90 offen sc1
    v_mfma_f32_16x16x32_bf16 v[52:55], a[116:119], v[180:183], v[52:55]
    s_cbranch_vccnz L_inte_retry_72
L_inte_back_73:
    v_mfma_f32_16x16x32_bf16 v[16:19], a[120:123], v[192:195], v[16:19]
    v_mfma_f32_16x16x32_bf16 v[20:23], a[124:127], v[192:195], v[20:23]
    buffer_load_dwordx4 v[148:151], v13, s[8:11], s90 offen sc1
    v_mfma_f32_16x16x32_bf16 v[24:27], a[128:131], v[192:195], v[24:27]
    v_mfma_f32_16x16x32_bf16 v[28:31], a[132:135], v[192:195], v[28:31]
    ds_read_b128 v[216:219], v249 offset:0
    v_mfma_f32_16x16x32_bf16 v[32:35], a[136:139], v[192:195], v[32:35]
    ds_read_b128 v[220:223], v249 offset:16
    v_mfma_f32_16x16x32_bf16 v[36:39], a[120:123], v[196:199], v[36:39]
    buffer_load_dwordx4 v[152:155], v14, s[8:11], s90 offen sc1
    ds_read_b128 v[224:227], v249 offset:32
    v_mfma_f32_16x16x32_bf16 v[40:43], a[124:127], v[196:199], v[40:43]
    ds_read_b128 v[228:231], v249 offset:48
    v_mfma_f32_16x16x32_bf16 v[44:47], a[128:131], v[196:199], v[44:47]
    s_waitcnt vmcnt(11)
    ds_read_b128 v[232:235], v249 offset:64
    v_mfma_f32_16x16x32_bf16 v[48:51], a[132:135], v[196:199], v[48:51]
    v_or3_b32 v10, v96, v97, v98
    v_mfma_f32_16x16x32_bf16 v[52:55], a[136:139], v[196:199], v[52:55]
    v_or3_b32 v10, v10, v99, v100
    buffer_load_dwordx4 v[156:159], v15, s[8:11], s90 offen sc1
    v_mfma_f32_16x16x32_bf16 v[56:59], a[120:123], v[200:203], v[56:59]
    v_or3_b32 v10, v10, v101, v102
    v_mfma_f32_16x16x32_bf16 v[60:63], a[124:127], v[200:203], v[60:63]
    v_or3_b32 v10, v10, v103, v104
    v_mfma_f32_16x16x32_bf16 v[64:67], a[128:131], v[200:203], v[64:67]
    v_or3_b32 v10, v10, v105, v106
    v_mfma_f32_16x16x32_bf16 v[68:71], a[132:135], v[200:203], v[68:71]
    v_or3_b32 v10, v10, v107, v108
    s_add_u32 s90, s40, s83
    buffer_load_dwordx4 v[160:163], v12, s[8:11], s90 offen sc1
    v_mfma_f32_16x16x32_bf16 v[72:75], a[136:139], v[200:203], v[72:75]
    v_or3_b32 v10, v10, v109, v110
    v_mfma_f32_16x16x32_bf16 v[76:79], a[120:123], v[204:207], v[76:79]
    v_or_b32 v10, v10, v111
    v_mfma_f32_16x16x32_bf16 v[80:83], a[124:127], v[204:207], v[80:83]
    v_cmp_gt_i32 vcc, 0, v10
    v_mfma_f32_16x16x32_bf16 v[84:87], a[128:131], v[204:207], v[84:87]
    buffer_load_dwordx4 v[164:167], v13, s[8:11], s90 offen sc1
    v_mfma_f32_16x16x32_bf16 v[88:91], a[132:135], v[204:207], v[88:91]
    v_mfma_f32_16x16x32_bf16 v[92:95], a[136:139], v[204:207], v[92:95]
    s_lshl_b32 s52, s5, 2
    s_add_u32 s52, s52, s3
    s_lshl_b32 s52, s52, 12
    s_min_u32 s52, s52, L_last-L_tail0-4096
    v_lshl_add_u32 v210, v0, 6, s52
    v_mov_b32 v211, 0
    s_sub_u32 s52, s6, dft_tables-L_tail0
    s_subb_u32 s53, s7, 0
    v_lshl_add_u64 v[210:211], v[210:211], 0, s[52:53]
    global_load_dword v209, v[210:211], off
    s_cbranch_vccnz L_inte_retry_74
L_inte_back_75:
    v_mfma_f32_16x16x32_bf16 v[16:19], a[140:143], v[96:99], v[16:19]
    v_lshlrev_b32 v255, 16, v236
    s_waitcnt lgkmcnt(4)
    v_add_f32 v216, v216, v255
    v_mfma_f32_16x16x32_bf16 v[20:23], a[144:147], v[96:99], v[20:23]
    buffer_load_dwordx4 v[168:171], v14, s[8:11], s90 offen sc1
    v_mfma_f32_16x16x32_bf16 v[24:27], a[148:151], v[96:99], v[24:27]
    v_and_b32 v255, 0xffff0000, v236
    v_mfma_f32_16x16x32_bf16 v[28:31], a[152:155], v[96:99], v[28:31]
    v_add_f32 v217, v217, v255
    v_mfma_f32_16x16x32_bf16 v[32:35], a[156:159], v[96:99], v[32:35]
    v_lshlrev_b32 v255, 16, v237
    v_mfma_f32_16x16x32_bf16 v[36:39], a[140:143], v[100:103], v[36:39]
    buffer_load_dwordx4 v[172:175], v15, s[8:11], s90 offen sc1
    v_add_f32 v218, v218, v255
    v_mfma_f32_16x16x32_bf16 v[40:43], a[144:147], v[100:103], v[40:43]
    v_and_b32 v255, 0xffff0000, v237
    v_mfma_f32_16x16x32_bf16 v[44:47], a[148:151], v[100:103], v[44:47]
    s_waitcnt vmcnt(13)
    v_mfma_f32_16x16x32_bf16 v[48:51], a[152:155], v[100:103], v[48:51]
    v_or3_b32 v10, v112, v113, v114
    v_mfma_f32_16x16x32_bf16 v[52:55], a[156:159], v[100:103], v[52:55]
    v_or3_b32 v10, v10, v115, v116
    s_add_u32 s90, s41, s83
    buffer_load_dwordx4 v[176:179], v12, s[8:11], s90 offen sc1
    v_mfma_f32_16x16x32_bf16 v[56:59], a[140:143], v[104:107], v[56:59]
    v_or3_b32 v10, v10, v117, v118
    v_mfma_f32_16x16x32_bf16 v[60:63], a[144:147], v[104:107], v[60:63]
    v_or3_b32 v10, v10, v119, v120
    v_mfma_f32_16x16x32_bf16 v[64:67], a[148:151], v[104:107], v[64:67]
    v_or3_b32 v10, v10, v121, v122
    v_mfma_f32_16x16x32_bf16 v[68:71], a[152:155], v[104:107], v[68:71]
    v_or3_b32 v10, v10, v123, v124
    buffer_load_dwordx4 v[180:183], v13, s[8:11], s90 offen sc1
    v_mfma_f32_16x16x32_bf16 v[72:75], a[156:159], v[104:107], v[72:75]
    v_or3_b32 v10, v10, v125, v126
    v_mfma_f32_16x16x32_bf16 v[76:79], a[140:143], v[108:111], v[76:79]
    v_or_b32 v10, v10, v127
    v_mfma_f32_16x16x32_bf16 v[80:83], a[144:147], v[108:111], v[80:83]
    v_cmp_gt_i32 vcc, 0, v10
    v_mfma_f32_16x16x32_bf16 v[84:87], a[148:151], v[108:111], v[84:87]
    buffer_load_dwordx4 v[184:187], v14, s[8:11], s90 offen sc1
    v_add_f32 v219, v219, v255
    v_mfma_f32_16x16x32_bf16 v[88:91], a[152:155], v[108:111], v[88:91]
    v_lshlrev_b32 v255, 16, v238
    v_mfma_f32_16x16x32_bf16 v[92:95], a[156:159], v[108:111], v[92:95]
    s_waitcnt lgkmcnt(3)
    v_add_f32 v220, v220, v255
    s_cbranch_vccnz L_inte_retry_76
L_inte_back_77:
    v_mfma_f32_16x16x32_bf16 v[16:19], a[160:163], v[112:115], v[16:19]
    v_and_b32 v255, 0xffff0000, v238
    v_add_f32 v221, v221, v255
    v_mfma_f32_16x16x32_bf16 v[20:23], a[164:167], v[112:115], v[20:23]
    buffer_load_dwordx4 v[188:191], v15, s[8:11], s90 offen sc1
    v_mfma_f32_16x16x32_bf16 v[24:27], a[168:171], v[112:115], v[24:27]
    v_lshlrev_b32 v255, 16, v239
    v_mfma_f32_16x16x32_bf16 v[28:31], a[172:175], v[112:115], v[28:31]
    v_add_f32 v222, v222, v255
    v_mfma_f32_16x16x32_bf16 v[32:35], a[176:179], v[112:115], v[32:35]
    v_and_b32 v255, 0xffff0000, v239
    v_mfma_f32_16x16x32_bf16 v[36:39], a[160:163], v[116:119], v[36:39]
    s_add_u32 s90, s42, s83
    buffer_load_dwordx4 v[192:195], v12, s[8:11], s90 offen sc1
    v_add_f32 v223, v223, v255
    v_mfma_f32_16x16x32_bf16 v[40:43], a[164:167], v[116:119], v[40:43]
    v_lshlrev_b32 v255, 16, v240
    v_mfma_f32_16x16x32_bf16 v[44:47], a[168:171], v[116:119], v[44:47]
    s_waitcnt vmcnt(14)
    v_mfma_f32_16x16x32_bf16 v[48:51], a[172:175], v[116:119], v[48:51]
    v_or3_b32 v10, v128, v129, v130
    v_mfma_f32_16x16x32_bf16 v[52:55], a[176:179], v[116:119], v[52:55]
    v_or3_b32 v10, v10, v131, v132
    buffer_load_dwordx4 v[196:199], v13, s[8:11], s90 offen sc1
    v_mfma_f32_16x16x32_bf16 v[56:59], a[160:163], v[120:123], v[56:59]
    v_or3_b32 v10, v10, v133, v134
    v_mfma_f32_16x16x32_bf16 v[60:63], a[164:167], v[120:123], v[60:63]
    v_or3_b32 v10, v10, v135, v136
    v_mfma_f32_16x16x32_bf16 v[64:67], a[168:171], v[120:123], v[64:67]
    v_or3_b32 v10, v10, v137, v138
    v_mfma_f32_16x16x32_bf16 v[68:71], a[172:175], v[120:123], v[68:71]
    v_or3_b32 v10, v10, v139, v140
    buffer_load_dwordx4 v[200:203], v14, s[8:11], s90 offen sc1
    v_mfma_f32_16x16x32_bf16 v[72:75], a[176:179], v[120:123], v[72:75]
    v_or3_b32 v10, v10, v141, v142
    v_mfma_f32_16x16x32_bf16 v[76:79], a[160:163], v[124:127], v[76:79]
    v_or_b32 v10, v10, v143
    v_mfma_f32_16x16x32_bf16 v[80:83], a[164:167], v[124:127], v[80:83]
    v_cmp_gt_i32 vcc, 0, v10
    v_mfma_f32_16x16x32_bf16 v[84:87], a[168:171], v[124:127], v[84:87]
    buffer_load_dwordx4 v[204:207], v15, s[8:11], s90 offen sc1
    s_waitcnt lgkmcnt(2)
    v_add_f32 v224, v224, v255
    v_mfma_f32_16x16x32_bf16 v[88:91], a[172:175], v[124:127], v[88:91]
    v_and_b32 v255, 0xffff0000, v240
    v_mfma_f32_16x16x32_bf16 v[92:95], a[176:179], v[124:127], v[92:95]
    v_add_f32 v225, v225, v255
    s_cbranch_vccnz L_inte_retry_78
L_inte_back_79:
    v_mfma_f32_16x16x32_bf16 v[16:19], a[180:183], v[128:131], v[16:19]
    v_lshlrev_b32 v255, 16, v241
    v_add_f32 v226, v226, v255
    v_mfma_f32_16x16x32_bf16 v[20:23], a[184:187], v[128:131], v[20:23]
    v_add_u32 v6, s69, v1
    v_add_u32 v6, 0x0, v6
    v_mov_b32 v7, 0
    v_lshl_add_u64 v[6:7], v[6:7], 0, s[6:7]
    s_mov_b32 s96, 4096
    s_mov_b32 s97, 0
    s_add_u32 m0, s69, 130048
    s_nop 0
    global_load_lds_dwordx4 v[6:7], off
    v_mfma_f32_16x16x32_bf16 v[24:27], a[188:191], v[128:131], v[24:27]
    v_and_b32 v255, 0xffff0000, v241
    v_mfma_f32_16x16x32_bf16 v[28:31], a[192:195], v[128:131], v[28:31]
    v_add_f32 v227, v227, v255
    v_mfma_f32_16x16x32_bf16 v[32:35], a[196:199], v[128:131], v[32:35]
    v_lshlrev_b32 v255, 16, v242
    v_mfma_f32_16x16x32_bf16 v[36:39], a[180:183], v[132:135], v[36:39]
    s_add_u32 m0, s69, 134144
    v_lshl_add_u64 v[6:7], v[6:7], 0, s[96:97]
    global_load_lds_dwordx4 v[6:7], off
    s_waitcnt lgkmcnt(1)
    v_add_f32 v228, v228, v255
    v_mfma_f32_16x16x32_bf16 v[40:43], a[184:187], v[132:135], v[40:43]
    v_and_b32 v255, 0xffff0000, v242
    v_mfma_f32_16x16x32_bf16 v[44:47], a[188:191], v[132:135], v[44:47]
    s_waitcnt vmcnt(15)
    v_mfma_f32_16x16x32_bf16 v[48:51], a[192:195], v[132:135], v[48:51]
    v_or3_b32 v10, v144, v145, v146
    v_mfma_f32_16x16x32_bf16 v[52:55], a[196:199], v[132:135], v[52:55]
    v_or3_b32 v10, v10, v147, v148
    s_add_u32 m0, s69, 138240
    v_lshl_add_u64 v[6:7], v[6:7], 0, s[96:97]
    global_load_lds_dwordx4 v[6:7], off
    v_mfma_f32_16x16x32_bf16 v[56:59], a[180:183], v[136:139], v[56:59]
    v_or3_b32 v10, v10, v149, v150
    v_mfma_f32_16x16x32_bf16 v[60:63], a[184:187], v[136:139], v[60:63]
    v_or3_b32 v10, v10, v151, v152
    v_mfma_f32_16x16x32_bf16 v[64:67], a[188:191], v[136:139], v[64:67]
    v_or3_b32 v10, v10, v153, v154
    v_mfma_f32_16x16x32_bf16 v[68:71], a[192:195], v[136:139], v[68:71]
    v_or3_b32 v10, v10, v155, v156
    s_add_u32 m0, s69, 142336
    v_lshl_add_u64 v[6:7], v[6:7], 0, s[96:97]
    global_load_lds_dwordx4 v[6:7], off
    v_mfma_f32_16x16x32_bf16 v[72:75], a[196:199], v[136:139], v[72:75]
    v_or3_b32 v10, v10, v157, v158
    v_mfma_f32_16x16x32_bf16 v[76:79], a[180:183], v[140:143], v[76:79]
    v_or_b32 v10, v10, v159
    v_mfma_f32_16x16x32_bf16 v[80:83], a[184:187], v[140:143], v[80:83]
    v_cmp_gt_i32 vcc, 0, v10
    v_mfma_f32_16x16x32_bf16 v[84:87], a[188:191], v[140:143], v[84:87]
    s_add_u32 s89, s44, s87
    buffer_load_dwordx4 a[220:223], v1, s[8:11], s89 offen offset:0
    v_add_f32 v229, v229, v255
    v_mfma_f32_16x16x32_bf16 v[88:91], a[192:195], v[140:143], v[88:91]
    v_lshlrev_b32 v255, 16, v243
    v_mfma_f32_16x16x32_bf16 v[92:95], a[196:199], v[140:143], v[92:95]
    v_add_f32 v230, v230, v255
    s_cbranch_vccnz L_inte_retry_80
L_inte_back_81:
    v_mfma_f32_16x16x32_bf16 v[16:19], a[200:203], v[144:147], v[16:19]
    v_and_b32 v255, 0xffff0000, v243
    v_add_f32 v231, v231, v255
    v_mfma_f32_16x16x32_bf16 v[20:23], a[204:207], v[144:147], v[20:23]
    buffer_load_dwordx4 a[224:227], v1, s[8:11], s89 offen offset:1024
    v_mfma_f32_16x16x32_bf16 v[24:27], a[208:211], v[144:147], v[24:27]
    v_lshlrev_b32 v255, 16, v244
    v_mfma_f32_16x16x32_bf16 v[28:31], a[212:215], v[144:147], v[28:31]
    s_waitcnt lgkmcnt(0)
    v_add_f32 v232, v232, v255
    v_mfma_f32_16x16x32_bf16 v[32:35], a[216:219], v[144:147], v[32:35]
    v_and_b32 v255, 0xffff0000, v244
    v_mfma_f32_16x16x32_bf16 v[36:39], a[200:203], v[148:151], v[36:39]
    buffer_load_dwordx4 a[228:231], v1, s[8:11], s89 offen offset:2048
    v_add_f32 v233, v233, v255
    v_mfma_f32_16x16x32_bf16 v[40:43], a[204:207], v[148:151], v[40:43]
    v_lshlrev_b32 v255, 16, v245
    v_mfma_f32_16x16x32_bf16 v[44:47], a[208:211], v[148:151], v[44:47]
    s_waitcnt vmcnt(15)
    v_mfma_f32_16x16x32_bf16 v[48:51], a[212:215], v[148:151], v[48:51]
    v_or3_b32 v10, v160, v161, v162
    v_mfma_f32_16x16x32_bf16 v[52:55], a[216:219], v[148:151], v[52:55]
    v_or3_b32 v10, v10, v163, v164
    buffer_load_dwordx4 a[232:235], v1, s[8:11], s89 offen offset:3072
    v_mfma_f32_16x16x32_bf16 v[56:59], a[200:203], v[152:155], v[56:59]
    v_or3_b32 v10, v10, v165, v166
    v_mfma_f32_16x16x32_bf16 v[60:63], a[204:207], v[152:155], v[60:63]
    v_or3_b32 v10, v10, v167, v168
    v_mfma_f32_16x16x32_bf16 v[64:67], a[208:211], v[152:155], v[64:67]
    v_or3_b32 v10, v10, v169, v170
    v_mfma_f32_16x16x32_bf16 v[68:71], a[212:215], v[152:155], v[68:71]
    v_or3_b32 v10, v10, v171, v172
    s_add_u32 s89, s89, 4096
    buffer_load_dwordx4 a[236:239], v1, s[8:11], s89 offen offset:0
    v_mfma_f32_16x16x32_bf16 v[72:75], a[216:219], v[152:155], v[72:75]
    v_or3_b32 v10, v10, v173, v174
    v_mfma_f32_16x16x32_bf16 v[76:79], a[200:203], v[156:159], v[76:79]
    v_or_b32 v10, v10, v175
    v_mfma_f32_16x16x32_bf16 v[80:83], a[204:207], v[156:159], v[80:83]
    v_cmp_gt_i32 vcc, 0, v10
    v_mfma_f32_16x16x32_bf16 v[84:87], a[208:211], v[156:159], v[84:87]
    v_add_f32 v234, v234, v255
    v_mfma_f32_16x16x32_bf16 v[88:91], a[212:215], v[156:159], v[88:91]
    v_and_b32 v255, 0xffff0000, v245
    v_mfma_f32_16x16x32_bf16 v[92:95], a[216:219], v[156:159], v[92:95]
    v_add_f32 v235, v235, v255
    s_waitcnt vmcnt(5)
    s_barrier
    v_add_u32 v6, 130048, v1
    s_cbranch_vccnz L_inte_retry_82
L_inte_back_83:
    s_waitcnt vmcnt(4)
    v_mfma_f32_16x16x32_bf16 v[16:19], a[220:223], v[160:163], v[16:19]
    v_or3_b32 v10, v176, v177, v178
    v_or3_b32 v10, v10, v179, v180
    s_waitcnt vmcnt(3)
    v_mfma_f32_16x16x32_bf16 v[20:23], a[224:227], v[160:163], v[20:23]
    v_or3_b32 v10, v10, v181, v182
    v_or3_b32 v10, v10, v183, v184
    v_or3_b32 v10, v10, v185, v186
    s_waitcnt vmcnt(2)
    v_mfma_f32_16x16x32_bf16 v[24:27], a[228:231], v[160:163], v[24:27]
    v_or3_b32 v10, v10, v187, v188
    v_or3_b32 v10, v10, v189, v190
    v_or_b32 v10, v10, v191
    s_waitcnt vmcnt(1)
    v_mfma_f32_16x16x32_bf16 v[28:31], a[232:235], v[160:163], v[28:31]
    v_cmp_gt_i32 vcc, 0, v10
    s_waitcnt vmcnt(0)
    v_mfma_f32_16x16x32_bf16 v[32:35], a[236:239], v[160:163], v[32:35]
    s_cbranch_vccnz L_inte_retry_84
L_inte_back_85:
    v_mfma_f32_16x16x32_bf16 v[16:19], a[0:3], v[176:179], v[16:19]
    v_or3_b32 v10, v192, v193, v194
    v_or3_b32 v10, v10, v195, v196
    v_mfma_f32_16x16x32_bf16 v[20:23], a[4:7], v[176:179], v[20:23]
    v_or3_b32 v10, v10, v197, v198
    v_or3_b32 v10, v10, v199, v200
    v_or3_b32 v10, v10, v201, v202
    v_mfma_f32_16x16x32_bf16 v[24:27], a[8:11], v[176:179], v[24:27]
    v_or3_b32 v10, v10, v203, v204
    v_or3_b32 v10, v10, v205, v206
    v_or_b32 v10, v10, v207
    v_mfma_f32_16x16x32_bf16 v[28:31], a[12:15], v[176:179], v[28:31]
    v_cmp_gt_i32 vcc, 0, v10
    v_mfma_f32_16x16x32_bf16 v[32:35], a[16:19], v[176:179], v[32:35]
    s_cbranch_vccnz L_inte_retry_86
L_inte_back_87:
    v_mfma_f32_16x16x32_bf16 v[16:19], a[20:23], v[192:195], v[16:19]
    v_mfma_f32_16x16x32_bf16 v[20:23], a[24:27], v[192:195], v[20:23]
    v_mfma_f32_16x16x32_bf16 v[24:27], a[28:31], v[192:195], v[24:27]
    v_mfma_f32_16x16x32_bf16 v[28:31], a[32:35], v[192:195], v[28:31]
    v_mfma_f32_16x16x32_bf16 v[32:35], a[36:39], v[192:195], v[32:35]
    v_mfma_f32_16x16x32_bf16 v[36:39], a[220:223], v[164:167], v[36:39]
    ds_read_b128 a[40:43], v6 offset:0
    s_and_b32 s97, s70, 3
    s_lshl_b32 s97, s97, 1
    s_add_u32 s97, s97, s72
    s_lshl_b32 s97, s97, 2
    s_add_u32 s97, s97, s3
    s_mul_i32 s97, s97, 8640
    s_mul_i32 s96, s73, 276480
    s_add_u32 s96, s96, s97
    s_add_u32 s96, s96, 0x2120000
    v_lshlrev_b32 v11, 6, v0
    v_mfma_f32_16x16x32_bf16 v[40:43], a[224:227], v[164:167], v[40:43]
    ds_read_b128 a[44:47], v6 offset:1024
    buffer_load_dword v208, v11, s[8:11], s96 offen
    v_mfma_f32_16x16x32_bf16 v[44:47], a[228:231], v[164:167], v[44:47]
    ds_read_b128 a[48:51], v6 offset:2048
    v_mfma_f32_16x16x32_bf16 v[48:51], a[232:235], v[164:167], v[48:51]
    ds_write_b128 v2, v[16:19] offset:0
    v_mfma_f32_16x16x32_bf16 v[52:55], a[236:239], v[164:167], v[52:55]
    ds_write_b128 v2, v[20:23] offset:1024
    v_mfma_f32_16x16x32_bf16 v[36:39], a[0:3], v[180:183], v[36:39]
    ds_write_b128 v2, v[24:27] offset:2048
    s_add_u32 s96, s96, 4096
    buffer_load_dword v210, v11, s[8:11], s96 offen
    v_mfma_f32_16x16x32_bf16 v[40:43], a[4:7], v[180:183], v[40:43]
    ds_write_b128 v2, v[28:31] offset:3072
    v_mfma_f32_16x16x32_bf16 v[44:47], a[8:11], v[180:183], v[44:47]
    ds_write_b128 v2, v[32:35] offset:4096
    v_mfma_f32_16x16x32_bf16 v[48:51], a[12:15], v[180:183], v[48:51]
    ds_read_b128 a[52:55], v6 offset:3072
    v_mfma_f32_16x16x32_bf16 v[52:55], a[16:19], v[180:183], v[52:55]
    ds_read_b128 a[56:59], v6 offset:4096
    s_add_u32 s96, s96, 448
    buffer_load_dword v211, v11, s[8:11], s96 offen
    v_mfma_f32_16x16x32_bf16 v[36:39], a[20:23], v[196:199], v[36:39]
    ds_read_b128 a[60:63], v6 offset:5120
    v_mfma_f32_16x16x32_bf16 v[40:43], a[24:27], v[196:199], v[40:43]
    ds_read_b128 a[64:67], v6 offset:6144
    v_mfma_f32_16x16x32_bf16 v[44:47], a[28:31], v[196:199], v[44:47]
    ds_read_b128 a[68:71], v6 offset:7168
    v_mfma_f32_16x16x32_bf16 v[48:51], a[32:35], v[196:199], v[48:51]
    ds_read_b128 a[72:75], v6 offset:8192
    v_mfma_f32_16x16x32_bf16 v[52:55], a[36:39], v[196:199], v[52:55]
    ds_read_b128 a[76:79], v6 offset:9216
    v_mfma_f32_16x16x32_bf16 v[56:59], a[220:223], v[168:171], v[56:59]
    ds_read_b128 a[80:83], v6 offset:10240
    v_mfma_f32_16x16x32_bf16 v[60:63], a[224:227], v[168:171], v[60:63]
    ds_read_b128 a[84:87], v6 offset:11264
    v_mfma_f32_16x16x32_bf16 v[64:67], a[228:231], v[168:171], v[64:67]
    ds_read_b128 a[88:91], v6 offset:12288
    v_mfma_f32_16x16x32_bf16 v[68:71], a[232:235], v[168:171], v[68:71]
    ds_write_b128 v3, v[36:39] offset:0
    v_mfma_f32_16x16x32_bf16 v[72:75], a[236:239], v[168:171], v[72:75]
    ds_write_b128 v3, v[40:43] offset:1024
    v_mfma_f32_16x16x32_bf16 v[56:59], a[0:3], v[184:187], v[56:59]
    ds_write_b128 v3, v[44:47] offset:2048
    v_mfma_f32_16x16x32_bf16 v[60:63], a[4:7], v[184:187], v[60:63]
    ds_write_b128 v3, v[48:51] offset:3072
    v_mfma_f32_16x16x32_bf16 v[64:67], a[8:11], v[184:187], v[64:67]
    ds_write_b128 v3, v[52:55] offset:4096
    v_mfma_f32_16x16x32_bf16 v[68:71], a[12:15], v[184:187], v[68:71]
    v_mfma_f32_16x16x32_bf16 v[72:75], a[16:19], v[184:187], v[72:75]
    v_mfma_f32_16x16x32_bf16 v[56:59], a[20:23], v[200:203], v[56:59]
    v_mfma_f32_16x16x32_bf16 v[60:63], a[24:27], v[200:203], v[60:63]
    v_mfma_f32_16x16x32_bf16 v[64:67], a[28:31], v[200:203], v[64:67]
    v_mfma_f32_16x16x32_bf16 v[68:71], a[32:35], v[200:203], v[68:71]
    v_mfma_f32_16x16x32_bf16 v[72:75], a[36:39], v[200:203], v[72:75]
    v_mfma_f32_16x16x32_bf16 v[76:79], a[220:223], v[172:175], v[76:79]
    v_mfma_f32_16x16x32_bf16 v[80:83], a[224:227], v[172:175], v[80:83]
    v_mfma_f32_16x16x32_bf16 v[84:87], a[228:231], v[172:175], v[84:87]
    v_mfma_f32_16x16x32_bf16 v[88:91], a[232:235], v[172:175], v[88:91]
    ds_write_b128 v4, v[56:59] offset:0
    v_mfma_f32_16x16x32_bf16 v[92:95], a[236:239], v[172:175], v[92:95]
    ds_write_b128 v4, v[60:63] offset:1024
    v_mfma_f32_16x16x32_bf16 v[76:79], a[0:3], v[188:191], v[76:79]
    ds_write_b128 v4, v[64:67] offset:2048
    v_mfma_f32_16x16x32_bf16 v[80:83], a[4:7], v[188:191], v[80:83]
    ds_write_b128 v4, v[68:71] offset:3072
    v_mfma_f32_16x16x32_bf16 v[84:87], a[8:11], v[188:191], v[84:87]
    ds_write_b128 v4, v[72:75] offset:4096
    v_mfma_f32_16x16x32_bf16 v[88:91], a[12:15], v[188:191], v[88:91]
    v_mfma_f32_16x16x32_bf16 v[92:95], a[16:19], v[188:191], v[92:95]
    v_mfma_f32_16x16x32_bf16 v[76:79], a[20:23], v[204:207], v[76:79]
    v_mfma_f32_16x16x32_bf16 v[80:83], a[24:27], v[204:207], v[80:83]
    v_mfma_f32_16x16x32_bf16 v[84:87], a[28:31], v[204:207], v[84:87]
    v_mfma_f32_16x16x32_bf16 v[88:91], a[32:35], v[204:207], v[88:91]
    v_mfma_f32_16x16x32_bf16 v[92:95], a[36:39], v[204:207], v[92:95]
    s_waitcnt lgkmcnt(0)
L_tail0:
    s_barrier
    ds_read_b128 v[96:99], v5 offset:0
    ds_read_b128 v[100:103], v5 offset:1024
    ds_read_b128 v[104:107], v5 offset:2048
    ds_read_b128 v[108:111], v5 offset:3072
    ds_read_b128 v[112:115], v5 offset:4096
    ds_read_b128 v[116:119], v5 offset:5120
    ds_read_b128 v[120:123], v5 offset:6144
    ds_read_b128 v[124:127], v5 offset:7168
    ds_read_b128 v[128:131], v5 offset:8192
    ds_read_b128 v[132:135], v5 offset:9216
    ds_read_b128 v[136:139], v5 offset:10240
    ds_read_b128 v[140:143], v5 offset:11264
    ds_read_b128 v[144:147], v5 offset:12288
    ds_read_b128 v[148:151], v5 offset:13312
    ds_read_b128 v[152:155], v5 offset:14336
    s_waitcnt lgkmcnt(14)
    v_pk_add_f32 v[76:77], v[76:77], v[96:97]
    v_pk_add_f32 v[78:79], v[78:79], v[98:99]
    s_waitcnt lgkmcnt(13)
    v_pk_add_f32 v[80:81], v[80:81], v[100:101]
    v_pk_add_f32 v[82:83], v[82:83], v[102:103]
    s_waitcnt lgkmcnt(12)
    v_pk_add_f32 v[84:85], v[84:85], v[104:105]
    v_pk_add_f32 v[86:87], v[86:87], v[106:107]
    s_waitcnt lgkmcnt(11)
    v_pk_add_f32 v[88:89], v[88:89], v[108:109]
    v_pk_add_f32 v[90:91], v[90:91], v[110:111]
    s_waitcnt lgkmcnt(10)
    v_pk_add_f32 v[92:93], v[92:93], v[112:113]
    v_pk_add_f32 v[94:95], v[94:95], v[114:115]
    s_waitcnt lgkmcnt(9)
    v_pk_add_f32 v[76:77], v[76:77], v[116:117]
    v_pk_add_f32 v[78:79], v[78:79], v[118:119]
    s_waitcnt lgkmcnt(8)
    v_pk_add_f32 v[80:81], v[80:81], v[120:121]
    v_pk_add_f32 v[82:83], v[82:83], v[122:123]
    s_waitcnt lgkmcnt(7)
    v_pk_add_f32 v[84:85], v[84:85], v[124:125]
    v_pk_add_f32 v[86:87], v[86:87], v[126:127]
    s_waitcnt lgkmcnt(6)
    v_pk_add_f32 v[88:89], v[88:89], v[128:129]
    v_pk_add_f32 v[90:91], v[90:91], v[130:131]
    s_waitcnt lgkmcnt(5)
    v_pk_add_f32 v[92:93], v[92:93], v[132:133]
    v_pk_add_f32 v[94:95], v[94:95], v[134:135]
    s_waitcnt lgkmcnt(4)
    v_pk_add_f32 v[76:77], v[76:77], v[136:137]
    v_pk_add_f32 v[78:79], v[78:79], v[138:139]
    s_waitcnt lgkmcnt(3)
    v_pk_add_f32 v[80:81], v[80:81], v[140:141]
    v_pk_add_f32 v[82:83], v[82:83], v[142:143]
    s_waitcnt lgkmcnt(2)
    v_pk_add_f32 v[84:85], v[84:85], v[144:145]
    v_pk_add_f32 v[86:87], v[86:87], v[146:147]
    s_waitcnt lgkmcnt(1)
    v_pk_add_f32 v[88:89], v[88:89], v[148:149]
    v_pk_add_f32 v[90:91], v[90:91], v[150:151]
    s_waitcnt lgkmcnt(0)
    v_pk_add_f32 v[92:93], v[92:93], v[152:153]
    v_pk_add_f32 v[94:95], v[94:95], v[154:155]
    v_pk_fma_f32 v[76:77], v[76:77], v[254:255], v[216:217] op_sel_hi:[1,0,1]
    v_pk_fma_f32 v[78:79], v[78:79], v[254:255], v[218:219] op_sel_hi:[1,0,1]
    v_pk_fma_f32 v[80:81], v[80:81], v[254:255], v[220:221] op_sel_hi:[1,0,1]
    v_pk_fma_f32 v[82:83], v[82:83], v[254:255], v[222:223] op_sel_hi:[1,0,1]
    v_pk_fma_f32 v[84:85], v[84:85], v[254:255], v[224:225] op_sel_hi:[1,0,1]
    v_pk_fma_f32 v[86:87], v[86:87], v[254:255], v[226:227] op_sel_hi:[1,0,1]
    v_pk_fma_f32 v[88:89], v[88:89], v[254:255], v[228:229] op_sel_hi:[1,0,1]
    v_pk_fma_f32 v[90:91], v[90:91], v[254:255], v[230:231] op_sel_hi:[1,0,1]
    v_pk_fma_f32 v[92:93], v[92:93], v[254:255], v[232:233] op_sel_hi:[1,0,1]
    v_pk_fma_f32 v[94:95], v[94:95], v[254:255], v[234:235] op_sel_hi:[1,0,1]
    v_cvt_pk_bf16_f32 v36, v76, v77
    v_cvt_pk_bf16_f32 v37, v78, v79
    v_cvt_pk_bf16_f32 v38, v80, v81
    v_cvt_pk_bf16_f32 v39, v82, v83
    v_cvt_pk_bf16_f32 v40, v84, v85
    v_cvt_pk_bf16_f32 v41, v86, v87
    v_cvt_pk_bf16_f32 v42, v88, v89
    v_cvt_pk_bf16_f32 v43, v90, v91
    v_cvt_pk_bf16_f32 v44, v92, v93
    v_cvt_pk_bf16_f32 v45, v94, v95
    v_mfma_f32_16x16x32_bf16 v[16:19], v[36:39], a[40:43], 0
    s_add_u32 s88, s93, 0x500000
    buffer_store_dwordx4 v[36:39], v252, s[8:11], s88 offen sc1
    v_mfma_f32_16x16x32_bf16 v[20:23], v[36:39], a[48:51], 0
    s_add_u32 s88, s93, 0x504000
    buffer_store_dwordx4 v[40:43], v252, s[8:11], s88 offen sc1
    v_mfma_f32_16x16x32_bf16 v[24:27], v[36:39], a[56:59], 0
    s_add_u32 s88, s93, 0x508000
    buffer_store_dwordx2 v[44:45], v253, s[8:11], s88 offen sc1
    v_mfma_f32_16x16x32_bf16 v[28:31], v[36:39], a[64:67], 0
    v_pk_add_f32 v[46:47], v[76:77], v[78:79]
    v_pk_mul_f32 v[48:49], v[76:77], v[76:77]
    v_mfma_f32_16x16x32_bf16 v[32:35], v[36:39], a[72:75], 0
    v_pk_fma_f32 v[48:49], v[78:79], v[78:79], v[48:49]
    v_pk_add_f32 v[46:47], v[46:47], v[80:81]
    v_mfma_f32_16x16x32_bf16 v[16:19], v[40:43], a[44:47], v[16:19]
    v_pk_fma_f32 v[48:49], v[80:81], v[80:81], v[48:49]
    v_pk_add_f32 v[46:47], v[46:47], v[82:83]
    v_mfma_f32_16x16x32_bf16 v[20:23], v[40:43], a[52:55], v[20:23]
    v_pk_fma_f32 v[48:49], v[82:83], v[82:83], v[48:49]
    v_pk_add_f32 v[46:47], v[46:47], v[84:85]
    v_mfma_f32_16x16x32_bf16 v[24:27], v[40:43], a[60:63], v[24:27]
    v_pk_fma_f32 v[48:49], v[84:85], v[84:85], v[48:49]
    v_pk_add_f32 v[46:47], v[46:47], v[86:87]
    v_mfma_f32_16x16x32_bf16 v[28:31], v[40:43], a[68:71], v[28:31]
    v_pk_fma_f32 v[48:49], v[86:87], v[86:87], v[48:49]
    v_pk_add_f32 v[46:47], v[46:47], v[88:89]
    v_mfma_f32_16x16x32_bf16 v[32:35], v[40:43], a[76:79], v[32:35]
    v_pk_fma_f32 v[48:49], v[88:89], v[88:89], v[48:49]
    v_pk_add_f32 v[46:47], v[46:47], v[90:91]
    v_mfma_f32_16x16x16_bf16 v[16:19], v[44:45], a[80:81], v[16:19]
    v_pk_fma_f32 v[48:49], v[90:91], v[90:91], v[48:49]
    v_pk_add_f32 v[46:47], v[46:47], v[92:93]
    v_mfma_f32_16x16x16_bf16 v[20:23], v[44:45], a[82:83], v[20:23]
    v_pk_fma_f32 v[48:49], v[92:93], v[92:93], v[48:49]
    v_pk_add_f32 v[46:47], v[46:47], v[94:95]
    v_mfma_f32_16x16x16_bf16 v[24:27], v[44:45], a[84:85], v[24:27]
    v_pk_fma_f32 v[48:49], v[94:95], v[94:95], v[48:49]
    v_add_f32 v46, v46, v47
    v_mfma_f32_16x16x16_bf16 v[28:31], v[44:45], a[86:87], v[28:31]
    v_add_f32 v47, v48, v49
    v_mfma_f32_16x16x16_bf16 v[32:35], v[44:45], a[88:89], v[32:35]
    v_mov_b32 v48, v46
    v_mov_b32 v49, v47
    s_nop 0
    v_permlane16_swap_b32 v46, v48
    v_permlane16_swap_b32 v47, v49
    v_add_f32 v46, v46, v48
    v_add_f32 v47, v47, v49
    v_mov_b32 v48, v46
    v_mov_b32 v49, v47
    s_nop 0
    v_permlane32_swap_b32 v46, v48
    v_permlane32_swap_b32 v47, v49
    v_add_f32 v46, v46, v48
    v_add_f32 v47, v47, v49
    v_cmp_gt_u32 vcc, 16, v0
    s_nop 1
    v_cndmask_b32 v46, v47, v46, vcc
    s_mov_b32 exec_hi, 0
    buffer_atomic_add_f32 v46, v214, s[8:11], s95 offen
    s_mov_b64 exec, -1
    v_mov_b32_dpp v52, v16 quad_perm:[0,0,0,0] row_mask:0xf bank_mask:0xf
    v_mov_b32_dpp v53, v17 quad_perm:[0,0,0,0] row_mask:0xf bank_mask:0xf
    v_mov_b32_dpp v54, v18 quad_perm:[0,0,0,0] row_mask:0xf bank_mask:0xf
    v_mov_b32_dpp v55, v19 quad_perm:[0,0,0,0] row_mask:0xf bank_mask:0xf
    v_cvt_pk_bf16_f32 v16, v16, v17
    v_cvt_pk_bf16_f32 v17, v18, v19
    buffer_store_dwordx2 v[16:17], v212, s[8:11], s94 offen sc1
    v_cvt_pk_bf16_f32 v56, v52, v53
    v_cvt_pk_bf16_f32 v57, v54, v55
    v_cvt_pk_bf16_f32 v20, v20, v21
    v_cvt_pk_bf16_f32 v21, v22, v23
    s_add_u32 s88, s94, 0x80000
    buffer_store_dwordx2 v[20:21], v212, s[8:11], s88 offen sc1
    v_lshlrev_b32 v58, 16, v56
    v_and_b32 v59, 0xffff0000, v56
    v_pk_add_f32 v[52:53], v[52:53], v[58:59] neg_lo:[0,1] neg_hi:[0,1]
    v_cvt_pk_bf16_f32 v24, v24, v25
    v_cvt_pk_bf16_f32 v25, v26, v27
    s_add_u32 s88, s94, 0x100000
    buffer_store_dwordx2 v[24:25], v212, s[8:11], s88 offen sc1
    v_lshlrev_b32 v58, 16, v57
    v_and_b32 v59, 0xffff0000, v57
    v_pk_add_f32 v[54:55], v[54:55], v[58:59] neg_lo:[0,1] neg_hi:[0,1]
    v_cvt_pk_bf16_f32 v28, v28, v29
    v_cvt_pk_bf16_f32 v29, v30, v31
    s_add_u32 s88, s94, 0x180000
    buffer_store_dwordx2 v[28:29], v212, s[8:11], s88 offen sc1
    s_mov_b32 vcc_lo, 0x00020002
    s_mov_b32 vcc_hi, 0x00020002
    v_cvt_pk_bf16_f32 v52, v52, v53
    v_cvt_pk_bf16_f32 v53, v54, v55
    v_cndmask_b32 v52, v56, v52, vcc
    v_cndmask_b32 v53, v57, v53, vcc
    v_cvt_pk_bf16_f32 v32, v32, v33
    v_cvt_pk_bf16_f32 v33, v34, v35
    s_add_u32 s88, s94, 0x200000
    buffer_store_dwordx2 v[32:33], v212, s[8:11], s88 offen sc1
    s_add_u32 s88, s94, 0x280000
    s_mov_b32 exec_lo, 0x00030003
    s_mov_b32 exec_hi, 0x00030003
    buffer_store_dwordx2 v[52:53], v212, s[8:11], s88 offen sc1
    s_mov_b64 exec, -1
L_ffend0:
    s_lshl_b32 s88, s70, 2
    s_add_u32 s88, s88, s3
    s_mul_i32 s74, s88, 40960
    s_add_u32 s74, s74, 0x780000
    s_lshr_b32 s89, s88, 1
    s_mul_i32 s77, s89, 221184
    s_and_b32 s90, s3, 1
    s_lshl_b32 s90, s90, 11
    s_add_u32 s77, s77, s90
    s_add_u32 s77, s77, 0xf00000
    s_lshl_b32 s90, s71, 13
    s_add_u32 s76, s77, s90
    s_lshl_b32 s89, s70, 1
    s_add_u32 s89, s89, s72
    s_mul_i32 s89, s89, 221184
    s_add_u32 s89, s89, 0xf00000
    s_mul_i32 s88, s3, 32768
    s_add_u32 s80, s89, s88
    s_add_u32 s24, s80, 4096
    s_mul_i32 s88, s3, 4096
    s_add_u32 s88, s88, 196608
    s_add_u32 s81, s89, s88
    s_and_b32 s88, s3, 1
    s_mul_i32 s88, s88, 4096
    s_add_u32 s88, s88, 212992
    s_add_u32 s82, s89, s88
    s_mul_i32 s88, s3, 16384
    s_add_u32 s88, s88, 131072
    s_add_u32 s83, s89, s88
    s_mul_i32 s89, s73, 276480
    s_add_u32 s89, s89, 0x2120000
    s_mul_i32 s88, s3, 40960
    s_add_u32 s84, s89, s88
    s_add_u32 s25, s84, 5120
    s_mul_i32 s88, s3, 5120
    s_add_u32 s88, s88, 245760
    s_add_u32 s85, s89, s88
    s_and_b32 s88, s3, 1
    s_mul_i32 s88, s88, 5120
    s_add_u32 s88, s88, 266240
    s_add_u32 s86, s89, s88
    s_mul_i32 s88, s3, 20480
    s_add_u32 s88, s88, 163840
    s_add_u32 s87, s89, s88
    s_cmp_eq_u32 s68, 0
    s_cbranch_scc1 L_inte_idle_88
    v_lshlrev_b32 v15, 4, v0
    s_cmp_eq_u32 s50, 0
    s_cselect_b32 s52, 0, s50
    s_lshl_b32 s52, s52, 10
    s_add_u32 s52, s52, 41984
    s_lshl_b32 s53, s51, 11
    s_add_u32 s53, s53, 12288
    s_mov_b32 s54, 18432
    s_lshl_b32 s55, s3, 1
    s_add_u32 s55, s55, 0
    s_min_u32 s55, s55, 6
    s_cmp_lt_u32 s55, 3
    s_cselect_b32 s56, s53, s54
    s_cmp_eq_u32 s55, 0
    s_cselect_b32 s56, s52, s56
    s_lshl_b32 s55, s55, 10
    s_add_u32 s56, s56, s55
    v_add_u32 v16, s56, v15
    v_mov_b32 v17, 0
    v_lshl_add_u64 v[16:17], v[16:17], 0, s[6:7]
    s_add_u32 m0, s55, 152064
    s_nop 0
    global_load_lds_dwordx4 v[16:17], off
    s_lshl_b32 s55, s3, 1
    s_add_u32 s55, s55, 1
    s_min_u32 s55, s55, 6
    s_cmp_lt_u32 s55, 3
    s_cselect_b32 s56, s53, s54
    s_cmp_eq_u32 s55, 0
    s_cselect_b32 s56, s52, s56
    s_lshl_b32 s55, s55, 10
    s_add_u32 s56, s56, s55
    v_add_u32 v16, s56, v15
    v_mov_b32 v17, 0
    v_lshl_add_u64 v[16:17], v[16:17], 0, s[6:7]
    s_add_u32 m0, s55, 152064
    s_nop 0
    global_load_lds_dwordx4 v[16:17], off
    s_lshl_b32 s60, s3, 10
    s_add_u32 s60, s60, 0x2344000
    s_cmp_eq_u32 s50, 40
    s_cselect_b32 s61, 0, s50
    s_cmp_eq_u32 s50, 0
    s_cselect_b32 s62, 40, s61
    s_lshl_b32 s62, s62, 16
    s_lshl_b32 s63, s3, 9
    s_add_u32 s62, s62, s63
    s_add_u32 s62, s62, 0x2480000
    s_lshl_b32 s63, s50, 9
    s_add_u32 s64, s63, 0x500000
    s_add_u32 s66, s63, 0x780000
    s_sub_u32 s65, 0x50a000, s63
    s_sub_u32 s67, 0x78a000, s63
    s_cmp_eq_u32 s61, 0
    s_cselect_b32 s65, 0x7f000000, s65
    s_cselect_b32 s67, 0x7f000000, s67
    s_lshl_b32 s52, s51, 2
    s_add_u32 s52, s52, s3
    s_lshl_b32 s52, s52, 10
    v_lshrrev_b32 v34, 5, v0
    v_and_b32 v35, 15, v0
    v_lshl_add_u32 v34, v34, 4, v35
    v_lshl_add_u32 v34, v34, 3, s52
    v_add_u32 v38, 0x6400, v34
    v_mov_b32 v39, 0
    v_lshl_add_u64 v[38:39], v[38:39], 0, s[6:7]
    global_load_dwordx2 v[104:105], v[38:39], off offset:0
    global_load_dwordx2 v[106:107], v[38:39], off offset:256
    global_load_dwordx2 v[108:109], v[38:39], off offset:512
    global_load_dwordx2 v[110:111], v[38:39], off offset:768
    s_mul_i32 s58, s3, 18432
    s_add_u32 s58, s58, 68608
    s_lshl_b32 s59, s3, 11
    s_add_u32 s59, s59, 142336
    v_lshrrev_b32 v42, 4, v0
    v_lshrrev_b32 v43, 5, v0
    v_bfe_u32 v44, v0, 4, 1
    v_bfe_u32 v45, v0, 3, 1
    v_bfe_u32 v46, v0, 2, 1
    v_and_b32 v47, 3, v0
    v_lshl_add_u32 v1, v43, 1, v45
    v_mul_u32_u24 v1, 1152, v1
    v_lshl_add_u32 v1, v44, 6, v1
    v_lshl_add_u32 v1, v46, 5, v1
    v_lshl_add_u32 v1, v47, 3, v1
    v_add_u32 v10, s58, v1
    v_lshlrev_b32 v1, 6, v45
    v_lshl_add_u32 v1, v42, 4, v1
    v_add_u32 v11, s59, v1
    v_lshl_add_u32 v12, v0, 3, s59
    v_and_b32 v1, 31, v0
    v_lshlrev_b32 v1, 4, v1
    v_lshl_add_u32 v14, v43, 13, v1
    v_lshlrev_b32 v1, 11, v44
    v_bfe_u32 v34, v0, 2, 2
    v_lshl_add_u32 v1, v34, 9, v1
    v_lshl_add_u32 v1, v43, 8, v1
    v_lshl_add_u32 v1, v47, 6, v1
    v_add_u32 v1, s58, v1
    v_bfe_u32 v35, v0, 1, 2
    v_xor_b32 v36, 0, v35
    v_lshl_add_u32 v4, v36, 4, v1
    v_xor_b32 v36, 1, v35
    v_lshl_add_u32 v5, v36, 4, v1
    v_xor_b32 v36, 2, v35
    v_lshl_add_u32 v6, v36, 4, v1
    v_xor_b32 v36, 3, v35
    v_lshl_add_u32 v7, v36, 4, v1
    v_mul_u32_u24 v1, 18432, v43
    v_lshl_add_u32 v1, v44, 8, v1
    v_lshl_add_u32 v1, v34, 6, v1
    s_lshl_b32 s52, s3, 1
    v_add_u32 v36, s52, v45
    v_and_b32 v36, 3, v36
    v_xor_b32 v36, v36, v47
    v_lshl_add_u32 v1, v36, 4, v1
    s_lshl_b32 s52, s3, 9
    s_add_u32 s52, s52, 68608
    v_add_u32 v13, s52, v1
    s_lshl_b32 s52, s3, 4
    s_add_u32 s52, s52, s51
    v_and_b32 v34, 15, v0
    v_lshlrev_b32 v34, 6, v34
    v_lshl_add_u32 v34, v42, 2, v34
    v_add_u32 v34, s52, v34
    v_lshrrev_b32 v1, 9, v34
    v_bfe_u32 v2, v34, 1, 4
    v_lshl_add_u32 v2, v1, 4, v2
    v_mul_u32_u24 v2, 40960, v2
    v_and_b32 v1, 1, v34
    v_lshl_add_u32 v2, v1, 8, v2
    v_bfe_u32 v1, v34, 5, 1
    v_lshl_add_u32 v2, v1, 7, v2
    v_bfe_u32 v1, v34, 6, 3
    v_lshl_add_u32 v2, v1, 4, v2
    v_add_u32 v3, 1310720, v2
    v_sub_u32 v35, 2048, v34
    v_and_b32 v35, 2047, v35
    v_lshrrev_b32 v1, 9, v35
    v_bfe_u32 v8, v35, 1, 4
    v_lshl_add_u32 v8, v1, 4, v8
    v_mul_u32_u24 v8, 40960, v8
    v_and_b32 v1, 1, v35
    v_lshl_add_u32 v8, v1, 8, v8
    v_bfe_u32 v1, v35, 5, 1
    v_lshl_add_u32 v8, v1, 7, v8
    v_bfe_u32 v1, v35, 6, 3
    v_lshl_add_u32 v8, v1, 4, v8
    v_sub_u32 v35, 1024, v34
    v_and_b32 v35, 2047, v35
    v_lshrrev_b32 v1, 9, v35
    v_bfe_u32 v9, v35, 1, 4
    v_lshl_add_u32 v9, v1, 4, v9
    v_mul_u32_u24 v9, 40960, v9
    v_and_b32 v1, 1, v35
    v_lshl_add_u32 v9, v1, 8, v9
    v_bfe_u32 v1, v35, 5, 1
    v_lshl_add_u32 v9, v1, 7, v9
    v_bfe_u32 v1, v35, 6, 3
    v_lshl_add_u32 v9, v1, 4, v9
    v_lshlrev_b32 v1, 4, v0
    s_waitcnt vmcnt(4)
    s_barrier
    s_nop 2
    s_cmp_eq_u32 s3, 0
    s_cbranch_scc0 L_inte_others_90
    s_and_b32 s89, s2, 15
    s_cmp_lt_u32 s89, 0
    s_cselect_b32 s90, 17, 16
    s_add_u32 s89, s89, 64
    s_lshl_b32 s88, s89, 8
    s_add_u32 s88, s88, 0x2350000
    v_mov_b32 v16, 1
    v_mov_b32 v17, 1
    s_mov_b64 exec, 1
    buffer_atomic_add v16, off, s[8:11], s88 sc0 sc1
    s_waitcnt vmcnt(0)
    v_readfirstlane_b32 s91, v16
    s_add_u32 s88, s88, 4096
    s_nop 2
    s_add_u32 s91, s91, 1
    s_cmp_eq_u32 s91, s90
    s_cbranch_scc0 L_inte_notlast_92
    buffer_store_dword v17, off, s[8:11], s88 sc1
L_inte_notlast_92:
    s_mov_b64 exec, -1
    v_mov_b32 v20, -1
    v_mov_b32 v21, -1
    v_mov_b32 v22, -1
    v_mov_b32 v23, -1
    buffer_store_dwordx4 v[20:23], v2, s[8:11], s66 offen sc1
    buffer_store_dwordx4 v[20:23], v3, s[8:11], s66 offen sc1
    buffer_store_dwordx4 v[20:23], v8, s[8:11], s67 offen sc1
    buffer_store_dwordx4 v[20:23], v9, s[8:11], s67 offen sc1
    s_lshl1_add_u32 s89, s43, s84
    buffer_load_dwordx4 a[0:3], v1, s[8:11], s89 offen offset:0
    buffer_load_dwordx4 a[4:7], v1, s[8:11], s89 offen offset:1024
    buffer_load_dwordx4 a[8:11], v1, s[8:11], s89 offen offset:2048
    buffer_load_dwordx4 a[12:15], v1, s[8:11], s89 offen offset:3072
    s_add_u32 s89, s89, 4096
    buffer_load_dwordx4 a[16:19], v1, s[8:11], s89 offen offset:0
    s_lshl1_add_u32 s89, s44, s84
    buffer_load_dwordx4 a[20:23], v1, s[8:11], s89 offen offset:0
    buffer_load_dwordx4 a[24:27], v1, s[8:11], s89 offen offset:1024
    buffer_load_dwordx4 a[28:31], v1, s[8:11], s89 offen offset:2048
    buffer_load_dwordx4 a[32:35], v1, s[8:11], s89 offen offset:3072
    s_add_u32 s89, s89, 4096
    buffer_load_dwordx4 a[36:39], v1, s[8:11], s89 offen offset:0
    s_lshl1_add_u32 s89, s45, s84
    buffer_load_dwordx4 a[40:43], v1, s[8:11], s89 offen offset:0
    buffer_load_dwordx4 a[44:47], v1, s[8:11], s89 offen offset:1024
    buffer_load_dwordx4 a[48:51], v1, s[8:11], s89 offen offset:2048
    buffer_load_dwordx4 a[52:55], v1, s[8:11], s89 offen offset:3072
    s_add_u32 s89, s89, 4096
    buffer_load_dwordx4 a[56:59], v1, s[8:11], s89 offen offset:0
    s_lshl1_add_u32 s89, s46, s84
    buffer_load_dwordx4 a[60:63], v1, s[8:11], s89 offen offset:0
    buffer_load_dwordx4 a[64:67], v1, s[8:11], s89 offen offset:1024
    buffer_load_dwordx4 a[68:71], v1, s[8:11], s89 offen offset:2048
    buffer_load_dwordx4 a[72:75], v1, s[8:11], s89 offen offset:3072
    s_add_u32 s89, s89, 4096
    buffer_load_dwordx4 a[76:79], v1, s[8:11], s89 offen offset:0
    s_mov_b32 s89, s85
    buffer_load_dwordx4 a[80:83], v1, s[8:11], s89 offen offset:0
    buffer_load_dwordx4 a[84:87], v1, s[8:11], s89 offen offset:1024
    buffer_load_dwordx4 a[88:91], v1, s[8:11], s89 offen offset:2048
    buffer_load_dwordx4 a[92:95], v1, s[8:11], s89 offen offset:3072
    s_add_u32 s89, s89, 4096
    buffer_load_dwordx4 a[96:99], v1, s[8:11], s89 offen offset:0
    s_mov_b32 s89, s86
    buffer_load_dwordx4 a[100:103], v1, s[8:11], s89 offen offset:0
    buffer_load_dwordx4 a[104:107], v1, s[8:11], s89 offen offset:1024
    buffer_load_dwordx4 a[108:111], v1, s[8:11], s89 offen offset:2048
    buffer_load_dwordx4 a[112:115], v1, s[8:11], s89 offen offset:3072
    s_add_u32 s89, s89, 4096
    buffer_load_dwordx4 a[116:119], v1, s[8:11], s89 offen offset:0
    v_and_b32 v18, 15, v0
    v_lshlrev_b32 v18, 8, v18
    v_add_u32 v18, 0x2355000, v18
    buffer_load_dword v19, v18, s[8:11], 0 offen sc1
    v_mov_b32 v64, 0
    v_mov_b32 v65, 0
    v_mov_b32 v66, 0
    v_mov_b32 v67, 0
    v_mov_b32 v68, 0
    v_mov_b32 v69, 0
    v_mov_b32 v70, 0
    v_mov_b32 v71, 0
    v_mov_b32 v72, 0
    v_mov_b32 v73, 0
    v_mov_b32 v74, 0
    v_mov_b32 v75, 0
    v_mov_b32 v76, 0
    v_mov_b32 v77, 0
    v_mov_b32 v78, 0
    v_mov_b32 v79, 0
    v_mov_b32 v80, 0
    v_mov_b32 v81, 0
    v_mov_b32 v82, 0
    v_mov_b32 v83, 0
    v_mov_b32 v84, 0
    v_mov_b32 v85, 0
    v_mov_b32 v86, 0
    v_mov_b32 v87, 0
    v_mov_b32 v88, 0
    v_mov_b32 v89, 0
    v_mov_b32 v90, 0
    v_mov_b32 v91, 0
    v_mov_b32 v92, 0
    v_mov_b32 v93, 0
    v_mov_b32 v94, 0
    v_mov_b32 v95, 0
    v_lshrrev_b32 v26, 5, v0
    v_and_b32 v27, 7, v0
    v_lshlrev_b32 v26, 7, v26
    v_lshl_add_u32 v26, v27, 4, v26
    s_mul_i32 s53, s51, 0
    s_add_u32 s53, s53, 0
    s_and_b32 s53, s53, 3
    s_lshl_b32 s53, s53, 8
    s_add_u32 s53, s53, 152064
    v_add_u32 v28, s53, v26
    s_mul_i32 s53, s51, 0
    s_add_u32 s53, s53, 1
    s_and_b32 s53, s53, 3
    s_lshl_b32 s53, s53, 8
    s_add_u32 s53, s53, 152064
    v_add_u32 v29, s53, v26
    s_mul_i32 s53, s51, 1
    s_add_u32 s53, s53, 0
    s_and_b32 s53, s53, 3
    s_lshl_b32 s53, s53, 8
    s_add_u32 s53, s53, 152064
    v_add_u32 v30, s53, v26
    s_mul_i32 s53, s51, 1
    s_add_u32 s53, s53, 1
    s_and_b32 s53, s53, 3
    s_lshl_b32 s53, s53, 8
    s_add_u32 s53, s53, 152064
    v_add_u32 v31, s53, v26
    s_mul_i32 s53, s51, 2
    s_add_u32 s53, s53, 0
    s_and_b32 s53, s53, 3
    s_lshl_b32 s53, s53, 8
    s_add_u32 s53, s53, 152064
    v_add_u32 v32, s53, v26
    s_mul_i32 s53, s51, 2
    s_add_u32 s53, s53, 1
    s_and_b32 s53, s53, 3
    s_lshl_b32 s53, s53, 8
    s_add_u32 s53, s53, 152064
    v_add_u32 v33, s53, v26
    s_mul_i32 s53, s51, 3
    s_add_u32 s53, s53, 0
    s_and_b32 s53, s53, 3
    s_lshl_b32 s53, s53, 8
    s_add_u32 s53, s53, 152064
    v_add_u32 v34, s53, v26
    s_mul_i32 s53, s51, 3
    s_add_u32 s53, s53, 1
    s_and_b32 s53, s53, 3
    s_lshl_b32 s53, s53, 8
    s_add_u32 s53, s53, 152064
    v_add_u32 v35, s53, v26
    v_add_u32 v27, 153088, v15
    s_mov_b32 exec_lo, 0xff0000ff
    s_mov_b32 exec_hi, 0xff0000ff
    ds_read_b128 v[64:67], v28
    ds_read_b128 v[68:71], v29
    ds_read_b128 v[72:75], v30
    ds_read_b128 v[76:79], v31
    ds_read_b128 v[80:83], v32
    ds_read_b128 v[84:87], v33
    ds_read_b128 v[88:91], v34
    ds_read_b128 v[92:95], v35
    s_mov_b64 exec, -1
    ds_read_b128 v[96:99], v27 offset:0
    ds_read_b128 v[100:103], v27 offset:1024
    ds_read_b128 v[112:115], v27 offset:2048
    ds_read_b128 v[116:119], v27 offset:3072
    ds_read_b128 v[120:123], v27 offset:4096
    ds_read_b128 v[124:127], v27 offset:5120
    s_mov_b32 s91, 0
    s_waitcnt vmcnt(0)
    v_cmp_eq_u32 vcc, 0, v19
    s_nop 3
    s_cmp_eq_u64 vcc, 0
    s_cbranch_scc1 L_inte_ok_94
L_inte_again_93:
    buffer_load_dword v19, v18, s[8:11], 0 offen sc1
    s_add_u32 s91, s91, 1
    s_waitcnt vmcnt(0)
    v_cmp_eq_u32 vcc, 0, v19
    s_cmp_ge_u32 s91, 500000
    s_cbranch_scc1 L_inte_ok_94
    s_nop 1
    s_cmp_eq_u64 vcc, 0
    s_cbranch_scc0 L_inte_again_93
L_inte_ok_94:
    s_waitcnt lgkmcnt(0)
    s_branch L_inte_join_91
L_inte_others_90:
    v_mov_b32 v20, -1
    v_mov_b32 v21, -1
    v_mov_b32 v22, -1
    v_mov_b32 v23, -1
    buffer_store_dwordx4 v[20:23], v2, s[8:11], s66 offen sc1
    buffer_store_dwordx4 v[20:23], v3, s[8:11], s66 offen sc1
    buffer_store_dwordx4 v[20:23], v8, s[8:11], s67 offen sc1
    buffer_store_dwordx4 v[20:23], v9, s[8:11], s67 offen sc1
    s_lshl1_add_u32 s89, s43, s84
    buffer_load_dwordx4 a[0:3], v1, s[8:11], s89 offen offset:0
    buffer_load_dwordx4 a[4:7], v1, s[8:11], s89 offen offset:1024
    buffer_load_dwordx4 a[8:11], v1, s[8:11], s89 offen offset:2048
    buffer_load_dwordx4 a[12:15], v1, s[8:11], s89 offen offset:3072
    s_add_u32 s89, s89, 4096
    buffer_load_dwordx4 a[16:19], v1, s[8:11], s89 offen offset:0
    s_lshl1_add_u32 s89, s44, s84
    buffer_load_dwordx4 a[20:23], v1, s[8:11], s89 offen offset:0
    buffer_load_dwordx4 a[24:27], v1, s[8:11], s89 offen offset:1024
    buffer_load_dwordx4 a[28:31], v1, s[8:11], s89 offen offset:2048
    buffer_load_dwordx4 a[32:35], v1, s[8:11], s89 offen offset:3072
    s_add_u32 s89, s89, 4096
    buffer_load_dwordx4 a[36:39], v1, s[8:11], s89 offen offset:0
    s_lshl1_add_u32 s89, s45, s84
    buffer_load_dwordx4 a[40:43], v1, s[8:11], s89 offen offset:0
    buffer_load_dwordx4 a[44:47], v1, s[8:11], s89 offen offset:1024
    buffer_load_dwordx4 a[48:51], v1, s[8:11], s89 offen offset:2048
    buffer_load_dwordx4 a[52:55], v1, s[8:11], s89 offen offset:3072
    s_add_u32 s89, s89, 4096
    buffer_load_dwordx4 a[56:59], v1, s[8:11], s89 offen offset:0
    s_lshl1_add_u32 s89, s46, s84
    buffer_load_dwordx4 a[60:63], v1, s[8:11], s89 offen offset:0
    buffer_load_dwordx4 a[64:67], v1, s[8:11], s89 offen offset:1024
    buffer_load_dwordx4 a[68:71], v1, s[8:11], s89 offen offset:2048
    buffer_load_dwordx4 a[72:75], v1, s[8:11], s89 offen offset:3072
    s_add_u32 s89, s89, 4096
    buffer_load_dwordx4 a[76:79], v1, s[8:11], s89 offen offset:0
    s_mov_b32 s89, s85
    buffer_load_dwordx4 a[80:83], v1, s[8:11], s89 offen offset:0
    buffer_load_dwordx4 a[84:87], v1, s[8:11], s89 offen offset:1024
    buffer_load_dwordx4 a[88:91], v1, s[8:11], s89 offen offset:2048
    buffer_load_dwordx4 a[92:95], v1, s[8:11], s89 offen offset:3072
    s_add_u32 s89, s89, 4096
    buffer_load_dwordx4 a[96:99], v1, s[8:11], s89 offen offset:0
    s_mov_b32 s89, s86
    buffer_load_dwordx4 a[100:103], v1, s[8:11], s89 offen offset:0
    buffer_load_dwordx4 a[104:107], v1, s[8:11], s89 offen offset:1024
    buffer_load_dwordx4 a[108:111], v1, s[8:11], s89 offen offset:2048
    buffer_load_dwordx4 a[112:115], v1, s[8:11], s89 offen offset:3072
    s_add_u32 s89, s89, 4096
    buffer_load_dwordx4 a[116:119], v1, s[8:11], s89 offen offset:0
    v_mov_b32 v64, 0
    v_mov_b32 v65, 0
    v_mov_b32 v66, 0
    v_mov_b32 v67, 0
    v_mov_b32 v68, 0
    v_mov_b32 v69, 0
    v_mov_b32 v70, 0
    v_mov_b32 v71, 0
    v_mov_b32 v72, 0
    v_mov_b32 v73, 0
    v_mov_b32 v74, 0
    v_mov_b32 v75, 0
    v_mov_b32 v76, 0
    v_mov_b32 v77, 0
    v_mov_b32 v78, 0
    v_mov_b32 v79, 0
    v_mov_b32 v80, 0
    v_mov_b32 v81, 0
    v_mov_b32 v82, 0
    v_mov_b32 v83, 0
    v_mov_b32 v84, 0
    v_mov_b32 v85, 0
    v_mov_b32 v86, 0
    v_mov_b32 v87, 0
    v_mov_b32 v88, 0
    v_mov_b32 v89, 0
    v_mov_b32 v90, 0
    v_mov_b32 v91, 0
    v_mov_b32 v92, 0
    v_mov_b32 v93, 0
    v_mov_b32 v94, 0
    v_mov_b32 v95, 0
    v_lshrrev_b32 v26, 5, v0
    v_and_b32 v27, 7, v0
    v_lshlrev_b32 v26, 7, v26
    v_lshl_add_u32 v26, v27, 4, v26
    s_mul_i32 s53, s51, 0
    s_add_u32 s53, s53, 0
    s_and_b32 s53, s53, 3
    s_lshl_b32 s53, s53, 8
    s_add_u32 s53, s53, 152064
    v_add_u32 v28, s53, v26
    s_mul_i32 s53, s51, 0
    s_add_u32 s53, s53, 1
    s_and_b32 s53, s53, 3
    s_lshl_b32 s53, s53, 8
    s_add_u32 s53, s53, 152064
    v_add_u32 v29, s53, v26
    s_mul_i32 s53, s51, 1
    s_add_u32 s53, s53, 0
    s_and_b32 s53, s53, 3
    s_lshl_b32 s53, s53, 8
    s_add_u32 s53, s53, 152064
    v_add_u32 v30, s53, v26
    s_mul_i32 s53, s51, 1
    s_add_u32 s53, s53, 1
    s_and_b32 s53, s53, 3
    s_lshl_b32 s53, s53, 8
    s_add_u32 s53, s53, 152064
    v_add_u32 v31, s53, v26
    s_mul_i32 s53, s51, 2
    s_add_u32 s53, s53, 0
    s_and_b32 s53, s53, 3
    s_lshl_b32 s53, s53, 8
    s_add_u32 s53, s53, 152064
    v_add_u32 v32, s53, v26
    s_mul_i32 s53, s51, 2
    s_add_u32 s53, s53, 1
    s_and_b32 s53, s53, 3
    s_lshl_b32 s53, s53, 8
    s_add_u32 s53, s53, 152064
    v_add_u32 v33, s53, v26
    s_mul_i32 s53, s51, 3
    s_add_u32 s53, s53, 0
    s_and_b32 s53, s53, 3
    s_lshl_b32 s53, s53, 8
    s_add_u32 s53, s53, 152064
    v_add_u32 v34, s53, v26
    s_mul_i32 s53, s51, 3
    s_add_u32 s53, s53, 1
    s_and_b32 s53, s53, 3
    s_lshl_b32 s53, s53, 8
    s_add_u32 s53, s53, 152064
    v_add_u32 v35, s53, v26
    v_add_u32 v27, 153088, v15
    s_mov_b32 exec_lo, 0xff0000ff
    s_mov_b32 exec_hi, 0xff0000ff
    ds_read_b128 v[64:67], v28
    ds_read_b128 v[68:71], v29
    ds_read_b128 v[72:75], v30
    ds_read_b128 v[76:79], v31
    ds_read_b128 v[80:83], v32
    ds_read_b128 v[84:87], v33
    ds_read_b128 v[88:91], v34
    ds_read_b128 v[92:95], v35
    s_mov_b64 exec, -1
    ds_read_b128 v[96:99], v27 offset:0
    ds_read_b128 v[100:103], v27 offset:1024
    ds_read_b128 v[112:115], v27 offset:2048
    ds_read_b128 v[116:119], v27 offset:3072
    ds_read_b128 v[120:123], v27 offset:4096
    ds_read_b128 v[124:127], v27 offset:5120
    s_waitcnt vmcnt(30)
    s_waitcnt lgkmcnt(0)
L_inte_join_91:
    s_barrier
    buffer_load_dwordx4 v[128:131], v15, s[8:11], s60 offen sc1
    s_add_u32 s60, s60, 4096
    buffer_load_dwordx4 v[132:135], v15, s[8:11], s60 offen sc1
    s_add_u32 s60, s60, 4096
    buffer_load_dwordx4 v[136:139], v15, s[8:11], s60 offen sc1
    s_add_u32 s60, s60, 4096
    buffer_load_dwordx4 v[140:143], v15, s[8:11], s60 offen sc1
    s_add_u32 m0, s58, 0
    s_add_u32 s63, s62, 0
    buffer_load_dwordx4 v14, s[8:11], s63 offen sc1 lds
    s_add_u32 m0, s58, 1152
    s_add_u32 s63, s62, 16384
    buffer_load_dwordx4 v14, s[8:11], s63 offen sc1 lds
    s_add_u32 m0, s58, 2304
    s_add_u32 s63, s62, 32768
    buffer_load_dwordx4 v14, s[8:11], s63 offen sc1 lds
    s_add_u32 m0, s58, 3456
    s_add_u32 s63, s62, 49152
    buffer_load_dwordx4 v14, s[8:11], s63 offen sc1 lds
    s_add_u32 m0, s58, 4608
    s_add_u32 s63, s62, 2048
    buffer_load_dwordx4 v14, s[8:11], s63 offen sc1 lds
    s_add_u32 m0, s58, 5760
    s_add_u32 s63, s62, 18432
    buffer_load_dwordx4 v14, s[8:11], s63 offen sc1 lds
    s_add_u32 m0, s58, 6912
    s_add_u32 s63, s62, 34816
    buffer_load_dwordx4 v14, s[8:11], s63 offen sc1 lds
    s_add_u32 m0, s58, 8064
    s_add_u32 s63, s62, 51200
    buffer_load_dwordx4 v14, s[8:11], s63 offen sc1 lds
    s_add_u32 m0, s58, 9216
    s_add_u32 s63, s62, 4096
    buffer_load_dwordx4 v14, s[8:11], s63 offen sc1 lds
    s_add_u32 m0, s58, 10368
    s_add_u32 s63, s62, 20480
    buffer_load_dwordx4 v14, s[8:11], s63 offen sc1 lds
    s_add_u32 m0, s58, 11520
    s_add_u32 s63, s62, 36864
    buffer_load_dwordx4 v14, s[8:11], s63 offen sc1 lds
    s_add_u32 m0, s58, 12672
    s_add_u32 s63, s62, 53248
    buffer_load_dwordx4 v14, s[8:11], s63 offen sc1 lds
    s_add_u32 m0, s58, 13824
    s_add_u32 s63, s62, 6144
    buffer_load_dwordx4 v14, s[8:11], s63 offen sc1 lds
    s_add_u32 m0, s58, 14976
    s_add_u32 s63, s62, 22528
    buffer_load_dwordx4 v14, s[8:11], s63 offen sc1 lds
    s_add_u32 m0, s58, 16128
    s_add_u32 s63, s62, 38912
    buffer_load_dwordx4 v14, s[8:11], s63 offen sc1 lds
    s_add_u32 m0, s58, 17280
    s_add_u32 s63, s62, 55296
    buffer_load_dwordx4 v14, s[8:11], s63 offen sc1 lds
    s_waitcnt vmcnt(19)
    v_mul_f32 v128, 0x3acccccd, v128
    v_mul_f32 v129, 0x3acccccd, v129
    v_mul_f32 v130, 0x3acccccd, v130
    v_mul_f32 v131, 0x3acccccd, v131
    v_fma_f32 v129, -v128, v128, v129
    v_fma_f32 v131, -v130, v130, v131
    v_max_f32 v129, 0, v129
    v_max_f32 v131, 0, v131
    v_add_f32 v129, 0x3727c5ac, v129
    v_add_f32 v131, 0x3727c5ac, v131
    v_rsq_f32 v128, v129
    v_rsq_f32 v129, v131
    ds_write_b64 v12, v[128:129] offset:0
    s_waitcnt vmcnt(18)
    v_mul_f32 v132, 0x3acccccd, v132
    v_mul_f32 v133, 0x3acccccd, v133
    v_mul_f32 v134, 0x3acccccd, v134
    v_mul_f32 v135, 0x3acccccd, v135
    v_fma_f32 v133, -v132, v132, v133
    v_fma_f32 v135, -v134, v134, v135
    v_max_f32 v133, 0, v133
    v_max_f32 v135, 0, v135
    v_add_f32 v133, 0x3727c5ac, v133
    v_add_f32 v135, 0x3727c5ac, v135
    v_rsq_f32 v132, v133
    v_rsq_f32 v133, v135
    ds_write_b64 v12, v[132:133] offset:512
    s_waitcnt vmcnt(17)
    v_mul_f32 v136, 0x3acccccd, v136
    v_mul_f32 v137, 0x3acccccd, v137
    v_mul_f32 v138, 0x3acccccd, v138
    v_mul_f32 v139, 0x3acccccd, v139
    v_fma_f32 v137, -v136, v136, v137
    v_fma_f32 v139, -v138, v138, v139
    v_max_f32 v137, 0, v137
    v_max_f32 v139, 0, v139
    v_add_f32 v137, 0x3727c5ac, v137
    v_add_f32 v139, 0x3727c5ac, v139
    v_rsq_f32 v136, v137
    v_rsq_f32 v137, v139
    ds_write_b64 v12, v[136:137] offset:1024
    s_waitcnt vmcnt(16)
    v_mul_f32 v140, 0x3acccccd, v140
    v_mul_f32 v141, 0x3acccccd, v141
    v_mul_f32 v142, 0x3acccccd, v142
    v_mul_f32 v143, 0x3acccccd, v143
    v_fma_f32 v141, -v140, v140, v141
    v_fma_f32 v143, -v142, v142, v143
    v_max_f32 v141, 0, v141
    v_max_f32 v143, 0, v143
    v_add_f32 v141, 0x3727c5ac, v141
    v_add_f32 v143, 0x3727c5ac, v143
    v_rsq_f32 v140, v141
    v_rsq_f32 v141, v143
    ds_write_b64 v12, v[140:141] offset:1536
    s_waitcnt vmcnt(12)
    ds_read_b64_tr_b16 v[160:161], v10 offset:0
    ds_read_b64_tr_b16 v[162:163], v10 offset:512
    ds_read_b64_tr_b16 v[164:165], v10 offset:128
    ds_read_b64_tr_b16 v[166:167], v10 offset:640
    ds_read_b64_tr_b16 v[168:169], v10 offset:256
    ds_read_b64_tr_b16 v[170:171], v10 offset:768
    ds_read_b64_tr_b16 v[172:173], v10 offset:384
    ds_read_b64_tr_b16 v[174:175], v10 offset:896
    ds_read_b128 v[128:131], v11 offset:0
    ds_read_b128 v[132:135], v11 offset:128
    ds_read_b128 v[136:139], v11 offset:256
    ds_read_b128 v[140:143], v11 offset:384
    s_waitcnt lgkmcnt(10)
    v_mfma_f32_16x16x32_bf16 v[192:195], v[160:163], v[64:67], 0
    v_mfma_f32_16x16x32_bf16 v[196:199], v[160:163], v[68:71], 0
    s_waitcnt lgkmcnt(8)
    v_mfma_f32_16x16x32_bf16 v[200:203], v[164:167], v[64:67], 0
    v_mfma_f32_16x16x32_bf16 v[204:207], v[164:167], v[68:71], 0
    s_waitcnt lgkmcnt(6)
    v_mfma_f32_16x16x32_bf16 v[208:211], v[168:171], v[64:67], 0
    v_mfma_f32_16x16x32_bf16 v[212:215], v[168:171], v[68:71], 0
    s_waitcnt lgkmcnt(4)
    v_mfma_f32_16x16x32_bf16 v[216:219], v[172:175], v[64:67], 0
    v_mfma_f32_16x16x32_bf16 v[220:223], v[172:175], v[68:71], 0
    buffer_load_dwordx4 v[48:51], v2, s[8:11], s64 offen sc1
    buffer_load_dwordx4 v[52:55], v3, s[8:11], s64 offen sc1
    s_waitcnt vmcnt(10)
    ds_read_b64_tr_b16 v[176:177], v10 offset:4608
    ds_read_b64_tr_b16 v[178:179], v10 offset:5120
    ds_read_b64_tr_b16 v[180:181], v10 offset:4736
    ds_read_b64_tr_b16 v[182:183], v10 offset:5248
    ds_read_b64_tr_b16 v[184:185], v10 offset:4864
    ds_read_b64_tr_b16 v[186:187], v10 offset:5376
    ds_read_b64_tr_b16 v[188:189], v10 offset:4992
    ds_read_b64_tr_b16 v[190:191], v10 offset:5504
    ds_read_b128 v[144:147], v11 offset:512
    ds_read_b128 v[148:151], v11 offset:640
    ds_read_b128 v[152:155], v11 offset:768
    ds_read_b128 v[156:159], v11 offset:896
    s_waitcnt lgkmcnt(10)
    v_mfma_f32_16x16x32_bf16 v[224:227], v[176:179], v[72:75], 0
    v_pk_mul_f32 v[16:17], v[192:193], v[128:129]
    v_pk_mul_f32 v[18:19], v[194:195], v[130:131]
    v_mfma_f32_16x16x32_bf16 v[228:231], v[176:179], v[76:79], 0
    v_pk_mul_f32 v[20:21], v[196:197], v[128:129]
    v_pk_mul_f32 v[22:23], v[198:199], v[130:131]
    s_waitcnt lgkmcnt(8)
    v_mfma_f32_16x16x32_bf16 v[232:235], v[180:183], v[72:75], 0
    v_pk_mul_f32 v[24:25], v[200:201], v[132:133]
    v_pk_mul_f32 v[26:27], v[202:203], v[134:135]
    v_mfma_f32_16x16x32_bf16 v[236:239], v[180:183], v[76:79], 0
    v_pk_mul_f32 v[28:29], v[204:205], v[132:133]
    v_pk_mul_f32 v[30:31], v[206:207], v[134:135]
    s_waitcnt lgkmcnt(6)
    v_mfma_f32_16x16x32_bf16 v[240:243], v[184:187], v[72:75], 0
    v_pk_mul_f32 v[32:33], v[208:209], v[136:137]
    v_pk_mul_f32 v[34:35], v[210:211], v[138:139]
    v_mfma_f32_16x16x32_bf16 v[244:247], v[184:187], v[76:79], 0
    v_pk_mul_f32 v[36:37], v[212:213], v[136:137]
    v_pk_mul_f32 v[38:39], v[214:215], v[138:139]
    s_waitcnt lgkmcnt(4)
    v_mfma_f32_16x16x32_bf16 v[248:251], v[188:191], v[72:75], 0
    v_pk_mul_f32 v[40:41], v[216:217], v[140:141]
    v_pk_mul_f32 v[42:43], v[218:219], v[142:143]
    v_mfma_f32_16x16x32_bf16 v[252:255], v[188:191], v[76:79], 0
    v_pk_mul_f32 v[44:45], v[220:221], v[140:141]
    v_pk_mul_f32 v[46:47], v[222:223], v[142:143]
    buffer_load_dwordx4 v[56:59], v8, s[8:11], s65 offen sc1
    buffer_load_dwordx4 v[60:63], v9, s[8:11], s65 offen sc1
    s_waitcnt vmcnt(8)
    ds_read_b64_tr_b16 v[160:161], v10 offset:9216
    ds_read_b64_tr_b16 v[162:163], v10 offset:9728
    ds_read_b64_tr_b16 v[164:165], v10 offset:9344
    ds_read_b64_tr_b16 v[166:167], v10 offset:9856
    ds_read_b64_tr_b16 v[168:169], v10 offset:9472
    ds_read_b64_tr_b16 v[170:171], v10 offset:9984
    ds_read_b64_tr_b16 v[172:173], v10 offset:9600
    ds_read_b64_tr_b16 v[174:175], v10 offset:10112
    ds_read_b128 v[128:131], v11 offset:1024
    ds_read_b128 v[132:135], v11 offset:1152
    ds_read_b128 v[136:139], v11 offset:1280
    ds_read_b128 v[140:143], v11 offset:1408
    s_waitcnt lgkmcnt(10)
    v_mfma_f32_16x16x32_bf16 v[192:195], v[160:163], v[80:83], 0
    v_pk_fma_f32 v[16:17], v[224:225], v[144:145], v[16:17]
    v_pk_fma_f32 v[18:19], v[226:227], v[146:147], v[18:19]
    v_mfma_f32_16x16x32_bf16 v[196:199], v[160:163], v[84:87], 0
    s_lshl1_add_u32 s89, s43, s25
    buffer_load_dwordx4 a[120:123], v1, s[8:11], s89 offen offset:0
    v_pk_fma_f32 v[20:21], v[228:229], v[144:145], v[20:21]
    v_pk_fma_f32 v[22:23], v[230:231], v[146:147], v[22:23]
    s_waitcnt lgkmcnt(8)
    v_mfma_f32_16x16x32_bf16 v[200:203], v[164:167], v[80:83], 0
    v_pk_fma_f32 v[24:25], v[232:233], v[148:149], v[24:25]
    v_pk_fma_f32 v[26:27], v[234:235], v[150:151], v[26:27]
    v_mfma_f32_16x16x32_bf16 v[204:207], v[164:167], v[84:87], 0
    v_pk_fma_f32 v[28:29], v[236:237], v[148:149], v[28:29]
    v_pk_fma_f32 v[30:31], v[238:239], v[150:151], v[30:31]
    s_waitcnt lgkmcnt(6)
    v_mfma_f32_16x16x32_bf16 v[208:211], v[168:171], v[80:83], 0
    v_pk_fma_f32 v[32:33], v[240:241], v[152:153], v[32:33]
    v_pk_fma_f32 v[34:35], v[242:243], v[154:155], v[34:35]
    buffer_load_dwordx4 a[124:127], v1, s[8:11], s89 offen offset:1024
    v_mfma_f32_16x16x32_bf16 v[212:215], v[168:171], v[84:87], 0
    v_pk_fma_f32 v[36:37], v[244:245], v[152:153], v[36:37]
    v_pk_fma_f32 v[38:39], v[246:247], v[154:155], v[38:39]
    s_waitcnt lgkmcnt(4)
    v_mfma_f32_16x16x32_bf16 v[216:219], v[172:175], v[80:83], 0
    v_pk_fma_f32 v[40:41], v[248:249], v[156:157], v[40:41]
    v_pk_fma_f32 v[42:43], v[250:251], v[158:159], v[42:43]
    v_mfma_f32_16x16x32_bf16 v[220:223], v[172:175], v[84:87], 0
    v_pk_fma_f32 v[44:45], v[252:253], v[156:157], v[44:45]
    v_pk_fma_f32 v[46:47], v[254:255], v[158:159], v[46:47]
    s_waitcnt vmcnt(6)
    ds_read_b64_tr_b16 v[176:177], v10 offset:13824
    ds_read_b64_tr_b16 v[178:179], v10 offset:14336
    buffer_load_dwordx4 a[128:131], v1, s[8:11], s89 offen offset:2048
    ds_read_b64_tr_b16 v[180:181], v10 offset:13952
    ds_read_b64_tr_b16 v[182:183], v10 offset:14464
    ds_read_b64_tr_b16 v[184:185], v10 offset:14080
    ds_read_b64_tr_b16 v[186:187], v10 offset:14592
    ds_read_b64_tr_b16 v[188:189], v10 offset:14208
    ds_read_b64_tr_b16 v[190:191], v10 offset:14720
    ds_read_b128 v[144:147], v11 offset:1536
    ds_read_b128 v[148:151], v11 offset:1664
    ds_read_b128 v[152:155], v11 offset:1792
    ds_read_b128 v[156:159], v11 offset:1920
    s_waitcnt lgkmcnt(10)
    v_mfma_f32_16x16x32_bf16 v[224:227], v[176:179], v[88:91], 0
    v_pk_fma_f32 v[16:17], v[192:193], v[128:129], v[16:17]
    v_pk_fma_f32 v[18:19], v[194:195], v[130:131], v[18:19]
    v_mfma_f32_16x16x32_bf16 v[228:231], v[176:179], v[92:95], 0
    buffer_load_dwordx4 a[132:135], v1, s[8:11], s89 offen offset:3072
    v_pk_fma_f32 v[20:21], v[196:197], v[128:129], v[20:21]
    v_pk_fma_f32 v[22:23], v[198:199], v[130:131], v[22:23]
    s_waitcnt lgkmcnt(8)
    v_mfma_f32_16x16x32_bf16 v[232:235], v[180:183], v[88:91], 0
    v_pk_fma_f32 v[24:25], v[200:201], v[132:133], v[24:25]
    v_pk_fma_f32 v[26:27], v[202:203], v[134:135], v[26:27]
    v_mfma_f32_16x16x32_bf16 v[236:239], v[180:183], v[92:95], 0
    v_pk_fma_f32 v[28:29], v[204:205], v[132:133], v[28:29]
    v_pk_fma_f32 v[30:31], v[206:207], v[134:135], v[30:31]
    s_waitcnt lgkmcnt(6)
    v_mfma_f32_16x16x32_bf16 v[240:243], v[184:187], v[88:91], 0
    v_pk_fma_f32 v[32:33], v[208:209], v[136:137], v[32:33]
    v_pk_fma_f32 v[34:35], v[210:211], v[138:139], v[34:35]
    s_add_u32 s89, s89, 4096
    buffer_load_dwordx4 a[136:139], v1, s[8:11], s89 offen offset:0
    v_mfma_f32_16x16x32_bf16 v[244:247], v[184:187], v[92:95], 0
    v_pk_fma_f32 v[36:37], v[212:213], v[136:137], v[36:37]
    v_pk_fma_f32 v[38:39], v[214:215], v[138:139], v[38:39]
    s_waitcnt lgkmcnt(4)
    v_mfma_f32_16x16x32_bf16 v[248:251], v[188:191], v[88:91], 0
    v_pk_fma_f32 v[40:41], v[216:217], v[140:141], v[40:41]
    v_pk_fma_f32 v[42:43], v[218:219], v[142:143], v[42:43]
    v_mfma_f32_16x16x32_bf16 v[252:255], v[188:191], v[92:95], 0
    v_pk_fma_f32 v[44:45], v[220:221], v[140:141], v[44:45]
    v_pk_fma_f32 v[46:47], v[222:223], v[142:143], v[46:47]
    s_waitcnt lgkmcnt(3)
    v_pk_fma_f32 v[16:17], v[224:225], v[144:145], v[16:17]
    v_pk_fma_f32 v[18:19], v[226:227], v[146:147], v[18:19]
    s_lshl1_add_u32 s89, s44, s25
    buffer_load_dwordx4 a[140:143], v1, s[8:11], s89 offen offset:0
    v_pk_fma_f32 v[20:21], v[228:229], v[144:145], v[20:21]
    v_pk_fma_f32 v[22:23], v[230:231], v[146:147], v[22:23]
    v_cvt_pk_bf16_f32 v160, v16, v20
    v_cvt_pk_bf16_f32 v161, v17, v21
    v_cvt_pk_bf16_f32 v162, v18, v22
    v_cvt_pk_bf16_f32 v163, v19, v23
    s_nop 1
    v_mfma_f32_16x16x32_bf16 v[192:195], v[160:163], v[96:99], 0
    v_mfma_f32_16x16x32_bf16 v[196:199], v[160:163], v[100:103], 0
    s_waitcnt lgkmcnt(2)
    v_pk_fma_f32 v[24:25], v[232:233], v[148:149], v[24:25]
    v_pk_fma_f32 v[26:27], v[234:235], v[150:151], v[26:27]
    v_pk_fma_f32 v[28:29], v[236:237], v[148:149], v[28:29]
    v_pk_fma_f32 v[30:31], v[238:239], v[150:151], v[30:31]
    v_cvt_pk_bf16_f32 v164, v24, v28
    v_cvt_pk_bf16_f32 v165, v25, v29
    buffer_load_dwordx4 a[144:147], v1, s[8:11], s89 offen offset:1024
    v_cvt_pk_bf16_f32 v166, v26, v30
    v_cvt_pk_bf16_f32 v167, v27, v31
    s_nop 1
    v_mfma_f32_16x16x32_bf16 v[200:203], v[164:167], v[96:99], 0
    v_mfma_f32_16x16x32_bf16 v[204:207], v[164:167], v[100:103], 0
    s_waitcnt lgkmcnt(1)
    v_pk_fma_f32 v[32:33], v[240:241], v[152:153], v[32:33]
    v_pk_fma_f32 v[34:35], v[242:243], v[154:155], v[34:35]
    v_pk_fma_f32 v[36:37], v[244:245], v[152:153], v[36:37]
    v_pk_fma_f32 v[38:39], v[246:247], v[154:155], v[38:39]
    v_cvt_pk_bf16_f32 v168, v32, v36
    v_cvt_pk_bf16_f32 v169, v33, v37
    v_cvt_pk_bf16_f32 v170, v34, v38
    v_cvt_pk_bf16_f32 v171, v35, v39
    s_nop 1
    v_mfma_f32_16x16x32_bf16 v[208:211], v[168:171], v[96:99], 0
    buffer_load_dwordx4 a[148:151], v1, s[8:11], s89 offen offset:2048
    v_mfma_f32_16x16x32_bf16 v[212:215], v[168:171], v[100:103], 0
    s_waitcnt lgkmcnt(0)
    v_pk_fma_f32 v[40:41], v[248:249], v[156:157], v[40:41]
    v_pk_fma_f32 v[42:43], v[250:251], v[158:159], v[42:43]
    v_pk_fma_f32 v[44:45], v[252:253], v[156:157], v[44:45]
    v_pk_fma_f32 v[46:47], v[254:255], v[158:159], v[46:47]
    v_cvt_pk_bf16_f32 v172, v40, v44
    v_cvt_pk_bf16_f32 v173, v41, v45
    v_cvt_pk_bf16_f32 v174, v42, v46
    v_cvt_pk_bf16_f32 v175, v43, v47
    s_nop 1
    v_mfma_f32_16x16x32_bf16 v[216:219], v[172:175], v[96:99], 0
    v_mfma_f32_16x16x32_bf16 v[220:223], v[172:175], v[100:103], 0
    buffer_load_dwordx4 a[152:155], v1, s[8:11], s89 offen offset:3072
    s_and_b32 s55, s2, 15
    s_add_u32 s55, s55, 96
    s_lshl_b32 s55, s55, 8
    s_add_u32 s55, s55, 0x2350000
    s_cmp_eq_u32 s3, 0
    s_cselect_b32 s55, s55, 0x7f000000
    s_cselect_b32 s56, 15, -1
    v_mov_b32 v14, 1
    v_mov_b32 v15, 1
    s_mov_b64 exec, 1
    buffer_atomic_add v14, off, s[8:11], s55 sc0 sc1
    s_mov_b64 exec, -1
    v_pk_mul_f32 v[128:129], v[192:193], v[104:105] op_sel:[0,0] op_sel_hi:[0,1]
    v_pk_mul_f32 v[130:131], v[192:193], v[104:105] op_sel:[1,0] op_sel_hi:[1,1]
    v_pk_mul_f32 v[132:133], v[194:195], v[104:105] op_sel:[0,0] op_sel_hi:[0,1]
    v_pk_mul_f32 v[134:135], v[194:195], v[104:105] op_sel:[1,0] op_sel_hi:[1,1]
    v_pk_fma_f32 v[128:129], v[196:197], v[104:105], v[128:129] op_sel:[0,1,0] op_sel_hi:[0,0,1] neg_lo:[1,0,0]
    v_pk_fma_f32 v[130:131], v[196:197], v[104:105], v[130:131] op_sel:[1,1,0] op_sel_hi:[1,0,1] neg_lo:[1,0,0]
    v_pk_fma_f32 v[132:133], v[198:199], v[104:105], v[132:133] op_sel:[0,1,0] op_sel_hi:[0,0,1] neg_lo:[1,0,0]
    v_pk_fma_f32 v[134:135], v[198:199], v[104:105], v[134:135] op_sel:[1,1,0] op_sel_hi:[1,0,1] neg_lo:[1,0,0]
    v_cvt_pk_bf16_f32 v16, v128, v129
    v_cvt_pk_bf16_f32 v20, v130, v131
    v_cvt_pk_bf16_f32 v24, v132, v133
    v_cvt_pk_bf16_f32 v28, v134, v135
    v_pk_mul_f32 v[136:137], v[200:201], v[106:107] op_sel:[0,0] op_sel_hi:[0,1]
    v_pk_mul_f32 v[138:139], v[200:201], v[106:107] op_sel:[1,0] op_sel_hi:[1,1]
    v_pk_mul_f32 v[140:141], v[202:203], v[106:107] op_sel:[0,0] op_sel_hi:[0,1]
    v_pk_mul_f32 v[142:143], v[202:203], v[106:107] op_sel:[1,0] op_sel_hi:[1,1]
    v_pk_fma_f32 v[136:137], v[204:205], v[106:107], v[136:137] op_sel:[0,1,0] op_sel_hi:[0,0,1] neg_lo:[1,0,0]
    v_pk_fma_f32 v[138:139], v[204:205], v[106:107], v[138:139] op_sel:[1,1,0] op_sel_hi:[1,0,1] neg_lo:[1,0,0]
    v_pk_fma_f32 v[140:141], v[206:207], v[106:107], v[140:141] op_sel:[0,1,0] op_sel_hi:[0,0,1] neg_lo:[1,0,0]
    s_add_u32 s89, s89, 4096
    buffer_load_dwordx4 a[156:159], v1, s[8:11], s89 offen offset:0
    v_pk_fma_f32 v[142:143], v[206:207], v[106:107], v[142:143] op_sel:[1,1,0] op_sel_hi:[1,0,1] neg_lo:[1,0,0]
    v_cvt_pk_bf16_f32 v17, v136, v137
    v_cvt_pk_bf16_f32 v21, v138, v139
    v_cvt_pk_bf16_f32 v25, v140, v141
    v_cvt_pk_bf16_f32 v29, v142, v143
    v_pk_mul_f32 v[144:145], v[208:209], v[108:109] op_sel:[0,0] op_sel_hi:[0,1]
    v_pk_mul_f32 v[146:147], v[208:209], v[108:109] op_sel:[1,0] op_sel_hi:[1,1]
    v_pk_mul_f32 v[148:149], v[210:211], v[108:109] op_sel:[0,0] op_sel_hi:[0,1]
    v_pk_mul_f32 v[150:151], v[210:211], v[108:109] op_sel:[1,0] op_sel_hi:[1,1]
    v_pk_fma_f32 v[144:145], v[212:213], v[108:109], v[144:145] op_sel:[0,1,0] op_sel_hi:[0,0,1] neg_lo:[1,0,0]
    v_pk_fma_f32 v[146:147], v[212:213], v[108:109], v[146:147] op_sel:[1,1,0] op_sel_hi:[1,0,1] neg_lo:[1,0,0]
    v_pk_fma_f32 v[148:149], v[214:215], v[108:109], v[148:149] op_sel:[0,1,0] op_sel_hi:[0,0,1] neg_lo:[1,0,0]
    v_pk_fma_f32 v[150:151], v[214:215], v[108:109], v[150:151] op_sel:[1,1,0] op_sel_hi:[1,0,1] neg_lo:[1,0,0]
    v_cvt_pk_bf16_f32 v18, v144, v145
    v_cvt_pk_bf16_f32 v22, v146, v147
    v_cvt_pk_bf16_f32 v26, v148, v149
    v_cvt_pk_bf16_f32 v30, v150, v151
    v_pk_mul_f32 v[152:153], v[216:217], v[110:111] op_sel:[0,0] op_sel_hi:[0,1]
    v_pk_mul_f32 v[154:155], v[216:217], v[110:111] op_sel:[1,0] op_sel_hi:[1,1]
    v_pk_mul_f32 v[156:157], v[218:219], v[110:111] op_sel:[0,0] op_sel_hi:[0,1]
    s_lshl1_add_u32 s89, s45, s25
    buffer_load_dwordx4 a[160:163], v1, s[8:11], s89 offen offset:0
    v_pk_mul_f32 v[158:159], v[218:219], v[110:111] op_sel:[1,0] op_sel_hi:[1,1]
    v_pk_fma_f32 v[152:153], v[220:221], v[110:111], v[152:153] op_sel:[0,1,0] op_sel_hi:[0,0,1] neg_lo:[1,0,0]
    v_pk_fma_f32 v[154:155], v[220:221], v[110:111], v[154:155] op_sel:[1,1,0] op_sel_hi:[1,0,1] neg_lo:[1,0,0]
    v_pk_fma_f32 v[156:157], v[222:223], v[110:111], v[156:157] op_sel:[0,1,0] op_sel_hi:[0,0,1] neg_lo:[1,0,0]
    v_pk_fma_f32 v[158:159], v[222:223], v[110:111], v[158:159] op_sel:[1,1,0] op_sel_hi:[1,0,1] neg_lo:[1,0,0]
    v_cvt_pk_bf16_f32 v19, v152, v153
    v_cvt_pk_bf16_f32 v23, v154, v155
    v_cvt_pk_bf16_f32 v27, v156, v157
    v_cvt_pk_bf16_f32 v31, v158, v159
    ds_write_b128 v4, v[16:19]
    ds_write_b128 v5, v[20:23]
    ds_write_b128 v6, v[24:27]
    ds_write_b128 v7, v[28:31]
    s_waitcnt vmcnt(15)
    v_lshlrev_b32 v64, 16, v48
    v_and_b32 v65, 0xffff0000, v48
    v_lshlrev_b32 v66, 16, v49
    v_and_b32 v67, 0xffff0000, v49
    v_lshlrev_b32 v68, 16, v50
    v_and_b32 v69, 0xffff0000, v50
    v_lshlrev_b32 v70, 16, v51
    buffer_load_dwordx4 a[164:167], v1, s[8:11], s89 offen offset:1024
    v_and_b32 v71, 0xffff0000, v51
    s_waitcnt vmcnt(15)
    v_lshlrev_b32 v72, 16, v52
    v_and_b32 v73, 0xffff0000, v52
    v_lshlrev_b32 v74, 16, v53
    v_and_b32 v75, 0xffff0000, v53
    v_lshlrev_b32 v76, 16, v54
    v_and_b32 v77, 0xffff0000, v54
    v_lshlrev_b32 v78, 16, v55
    v_and_b32 v79, 0xffff0000, v55
    s_waitcnt vmcnt(14)
    v_lshlrev_b32 v87, 16, v56
    v_and_b32 v86, 0xffff0000, v56
    v_lshlrev_b32 v85, 16, v57
    v_and_b32 v84, 0xffff0000, v57
    v_lshlrev_b32 v83, 16, v58
    v_and_b32 v82, 0xffff0000, v58
    v_lshlrev_b32 v81, 16, v59
    v_and_b32 v80, 0xffff0000, v59
    s_waitcnt vmcnt(13)
    v_lshlrev_b32 v95, 16, v60
    v_and_b32 v94, 0xffff0000, v60
    v_lshlrev_b32 v93, 16, v61
    buffer_load_dwordx4 a[168:171], v1, s[8:11], s89 offen offset:2048
    v_and_b32 v92, 0xffff0000, v61
    v_lshlrev_b32 v91, 16, v62
    v_and_b32 v90, 0xffff0000, v62
    v_lshlrev_b32 v89, 16, v63
    v_and_b32 v88, 0xffff0000, v63
    s_waitcnt lgkmcnt(0)
    s_barrier
    ds_read_b128 v[160:163], v13 offset:0
    ds_read_b128 v[164:167], v13 offset:36864
    ds_read_b128 v[168:171], v13 offset:2048
    ds_read_b128 v[172:175], v13 offset:38912
    s_waitcnt lgkmcnt(3)
    v_mfma_f32_16x16x32_bf16 v[192:195], v[160:163], v[112:115], v[64:67]
    s_waitcnt lgkmcnt(1)
    v_mfma_f32_16x16x32_bf16 v[196:199], v[168:171], v[112:115], v[68:71]
    v_mfma_f32_16x16x32_bf16 v[200:203], v[160:163], v[116:119], v[72:75]
    buffer_load_dwordx4 a[172:175], v1, s[8:11], s89 offen offset:3072
    v_mfma_f32_16x16x32_bf16 v[204:207], v[168:171], v[116:119], v[76:79]
    v_mfma_f32_16x16x32_bf16 v[208:211], v[160:163], v[112:115], v[80:83]
    v_mfma_f32_16x16x32_bf16 v[212:215], v[168:171], v[112:115], v[84:87]
    v_mfma_f32_16x16x32_bf16 v[216:219], v[160:163], v[116:119], v[88:91]
    v_mfma_f32_16x16x32_bf16 v[220:223], v[168:171], v[116:119], v[92:95]
    s_add_u32 s89, s89, 4096
    buffer_load_dwordx4 a[176:179], v1, s[8:11], s89 offen offset:0
    v_mfma_f32_16x16x32_bf16 v[192:195], v[164:167], v[120:123], v[192:195]
    s_waitcnt lgkmcnt(0)
    v_mfma_f32_16x16x32_bf16 v[196:199], v[172:175], v[120:123], v[196:199]
    v_mfma_f32_16x16x32_bf16 v[200:203], v[164:167], v[124:127], v[200:203]
    v_mfma_f32_16x16x32_bf16 v[204:207], v[172:175], v[124:127], v[204:207]
    v_mfma_f32_16x16x32_bf16 v[208:211], v[164:167], v[120:123], v[208:211]
    s_lshl1_add_u32 s89, s46, s25
    buffer_load_dwordx4 a[180:183], v1, s[8:11], s89 offen offset:0
    v_mfma_f32_16x16x32_bf16 v[212:215], v[172:175], v[120:123], v[212:215]
    v_mfma_f32_16x16x32_bf16 v[216:219], v[164:167], v[124:127], v[216:219]
    v_mfma_f32_16x16x32_bf16 v[220:223], v[172:175], v[124:127], v[220:223]
    s_barrier
    s_waitcnt vmcnt(7)
    v_readfirstlane_b32 s57, v14
    s_add_u32 s55, s55, 4096
    s_nop 2
    s_cmp_eq_u32 s57, s56
    s_cbranch_scc0 L_inte_notlast_95
    s_mov_b64 exec, 1
    buffer_store_dword v15, off, s[8:11], s55 sc1
    s_mov_b64 exec, -1
L_inte_notlast_95:
    v_cvt_pk_bf16_f32 v224, v192, v193
    v_cvt_pk_bf16_f32 v225, v194, v195
    v_cvt_pk_bf16_f32 v226, v196, v197
    v_cvt_pk_bf16_f32 v227, v198, v199
    buffer_store_dwordx4 v[224:227], v2, s[8:11], s66 offen sc1
    v_cvt_pk_bf16_f32 v228, v200, v201
    v_cvt_pk_bf16_f32 v229, v202, v203
    v_cvt_pk_bf16_f32 v230, v204, v205
    v_cvt_pk_bf16_f32 v231, v206, v207
    buffer_store_dwordx4 v[228:231], v3, s[8:11], s66 offen sc1
    v_cvt_pk_bf16_f32 v232, v215, v214
    v_cvt_pk_bf16_f32 v233, v213, v212
    v_cvt_pk_bf16_f32 v234, v211, v210
    v_cvt_pk_bf16_f32 v235, v209, v208
    buffer_store_dwordx4 v[232:235], v8, s[8:11], s67 offen sc1
    v_cvt_pk_bf16_f32 v236, v223, v222
    v_cvt_pk_bf16_f32 v237, v221, v220
    v_cvt_pk_bf16_f32 v238, v219, v218
    v_cvt_pk_bf16_f32 v239, v217, v216
    buffer_store_dwordx4 v[236:239], v9, s[8:11], s67 offen sc1
    buffer_load_dwordx4 a[184:187], v1, s[8:11], s89 offen offset:1024
    buffer_load_dwordx4 a[188:191], v1, s[8:11], s89 offen offset:2048
    buffer_load_dwordx4 a[192:195], v1, s[8:11], s89 offen offset:3072
    s_add_u32 s89, s89, 4096
    buffer_load_dwordx4 a[196:199], v1, s[8:11], s89 offen offset:0
    v_lshlrev_b32 v1, 4, v0
    v_add_u32 v2, 27648, v1
    v_add_u32 v3, 68608, v1
    v_add_u32 v4, 109568, v1
    v_and_b32 v16, 15, v0
    v_lshrrev_b32 v17, 4, v0
    v_lshlrev_b32 v18, 4, v16
    v_lshl_add_u32 v5, v17, 9, v18
    s_mul_i32 s88, s71, 3
    v_add_u32 v19, s88, v17
    v_and_b32 v20, 1, v19
    v_lshl_add_u32 v18, v20, 3, v18
    v_bfe_u32 v20, v19, 1, 2
    v_lshl_add_u32 v18, v20, 8, v18
    v_lshrrev_b32 v20, 3, v19
    v_add_u32 v20, 48, v20
    v_lshl_add_u32 v18, v20, 12, v18
    v_add_u32 v19, 1, v17
    v_lshrrev_b32 v19, 2, v19
    v_lshl_add_u32 v6, v19, 30, v18
    v_lshrrev_b32 v19, 2, v16
    v_lshl_add_u32 v19, v19, 4, v16
    v_lshlrev_b32 v7, 2, v19
    v_add_lshl_u32 v10, v16, 48, 2
    s_lshl_b32 s88, s3, 7
    s_add_u32 s88, s88, 151552
    v_lshl_add_u32 v11, v16, 2, s88
    v_min_u32 v16, 1, v0
    v_lshlrev_b32 v8, 30, v16
    v_mov_b32 v9, 1
    s_mov_b32 s92, 0x22222222
    s_mov_b32 s93, 0x22222222
    s_mov_b32 s94, 0x44444444
    s_mov_b32 s95, 0x44444444
    s_mov_b32 s96, 0x88888888
    s_mov_b32 s97, 0x88888888
    s_add_u32 s88, s3, 1
    s_and_b32 s88, s88, 3
    s_lshl_b32 s88, s88, 10
    v_add_u32 v12, s88, v1
    s_add_u32 s88, s3, 2
    s_and_b32 s88, s88, 3
    s_lshl_b32 s88, s88, 10
    v_add_u32 v13, s88, v1
    s_add_u32 s88, s3, 3
    s_and_b32 s88, s88, 3
    s_lshl_b32 s88, s88, 10
    v_add_u32 v14, s88, v1
    s_add_u32 s88, s3, 4
    s_and_b32 s88, s88, 3
    s_lshl_b32 s88, s88, 10
    v_add_u32 v15, s88, v1
    s_nop 4
    s_cmp_eq_u32 s3, 0
    s_cbranch_scc0 L_inte_others_96
    v_and_b32 v18, 15, v0
    v_lshlrev_b32 v18, 8, v18
    v_add_u32 v18, 0x2357000, v18
    buffer_load_dword v19, v18, s[8:11], 0 offen sc1
    s_mov_b32 s91, 0
    s_waitcnt vmcnt(0)
    v_cmp_eq_u32 vcc, 0, v19
    s_nop 3
    s_cmp_eq_u64 vcc, 0
    s_cbranch_scc1 L_inte_ok_99
L_inte_again_98:
    buffer_load_dword v19, v18, s[8:11], 0 offen sc1
    s_add_u32 s91, s91, 1
    s_waitcnt vmcnt(0)
    v_cmp_eq_u32 vcc, 0, v19
    s_cmp_ge_u32 s91, 500000
    s_cbranch_scc1 L_inte_ok_99
    s_nop 1
    s_cmp_eq_u64 vcc, 0
    s_cbranch_scc0 L_inte_again_98
L_inte_ok_99:
    s_branch L_inte_join_97
L_inte_others_96:
    s_add_u32 s89, s75, 67584
    s_add_u32 s88, s69, 67584
    s_add_u32 m0, s88, 0
    s_nop 0
    buffer_load_dwordx4 v1, s[8:11], s89 offen lds
    s_add_u32 m0, s88, 3072
    s_add_u32 s89, s89, 3072
    buffer_load_dwordx4 v1, s[8:11], s89 offen lds
    s_add_u32 m0, s88, 6144
    s_add_u32 s89, s89, 3072
    buffer_load_dwordx4 v1, s[8:11], s89 offen lds
    s_add_u32 m0, s88, 9216
    s_add_u32 s89, s89, 3072
    buffer_load_dwordx4 v1, s[8:11], s89 offen lds
    s_add_u32 m0, s88, 12288
    s_add_u32 s89, s89, 3072
    buffer_load_dwordx4 v1, s[8:11], s89 offen lds
    s_add_u32 m0, s88, 15360
    s_add_u32 s89, s89, 3072
    buffer_load_dwordx4 v1, s[8:11], s89 offen lds
    s_add_u32 m0, s88, 18432
    s_add_u32 s89, s89, 3072
    buffer_load_dwordx4 v1, s[8:11], s89 offen lds
    s_add_u32 m0, s88, 21504
    s_add_u32 s89, s89, 3072
    buffer_load_dwordx4 v1, s[8:11], s89 offen lds
    s_add_u32 m0, s88, 24576
    s_add_u32 s89, s89, 3072
    buffer_load_dwordx4 v1, s[8:11], s89 offen lds
    s_add_u32 m0, s88, 27648
    s_add_u32 s89, s89, 3072
    buffer_load_dwordx4 v1, s[8:11], s89 offen lds
    s_add_u32 m0, s88, 30720
    s_add_u32 s89, s89, 3072
    buffer_load_dwordx4 v1, s[8:11], s89 offen lds
    s_add_u32 m0, s88, 33792
    s_add_u32 s89, s89, 3072
    buffer_load_dwordx4 v1, s[8:11], s89 offen lds
    s_add_u32 m0, s88, 36864
    s_add_u32 s89, s89, 3072
    buffer_load_dwordx4 v1, s[8:11], s89 offen lds
    s_add_u32 m0, s88, 39936
    s_add_u32 s89, s89, 3072
    buffer_load_dwordx4 v1, s[8:11], s89 offen lds
    s_add_u32 m0, s88, 43008
    s_add_u32 s89, s89, 3072
    buffer_load_dwordx4 v1, s[8:11], s89 offen lds
    s_add_u32 m0, s88, 46080
    s_add_u32 s89, s89, 3072
    buffer_load_dwordx4 v1, s[8:11], s89 offen lds
    s_add_u32 m0, s88, 49152
    s_add_u32 s89, s89, 3072
    buffer_load_dwordx4 v1, s[8:11], s89 offen lds
    s_add_u32 m0, s88, 52224
    s_add_u32 s89, s89, 3072
    buffer_load_dwordx4 v1, s[8:11], s89 offen lds
    s_add_u32 m0, s88, 55296
    s_add_u32 s89, s89, 3072
    buffer_load_dwordx4 v1, s[8:11], s89 offen lds
    s_add_u32 m0, s88, 58368
    s_add_u32 s89, s89, 3072
    buffer_load_dwordx4 v1, s[8:11], s89 offen lds
    s_add_u32 m0, s88, 61440
    s_add_u32 s89, s89, 3072
    buffer_load_dwordx4 v1, s[8:11], s89 offen lds
    s_add_u32 m0, s88, 64512
    s_add_u32 s89, s89, 3072
    buffer_load_dwordx4 v1, s[8:11], s89 offen lds
    s_add_u32 m0, s88, 67584
    s_add_u32 s89, s89, 3072
    buffer_load_dwordx4 v1, s[8:11], s89 offen lds
    s_add_u32 m0, s88, 70656
    s_add_u32 s89, s89, 3072
    buffer_load_dwordx4 v1, s[8:11], s89 offen lds
    s_add_u32 m0, s88, 73728
    s_add_u32 s89, s89, 3072
    buffer_load_dwordx4 v1, s[8:11], s89 offen lds
    s_add_u32 m0, s88, 76800
    s_add_u32 s89, s89, 3072
    buffer_load_dwordx4 v1, s[8:11], s89 offen lds
    s_add_u32 m0, s88, 79872
    s_add_u32 s89, s89, 3072
    buffer_load_dwordx4 v1, s[8:11], s89 offen lds
L_inte_join_97:
    s_barrier
    s_branch L_inte_go_89
L_inte_idle_88:
    s_waitcnt vmcnt(0)
    s_barrier
    s_cmp_eq_u32 s3, 0
    s_cbranch_scc0 L_inte_others_100
    s_and_b32 s89, s2, 15
    s_cmp_lt_u32 s89, 0
    s_cselect_b32 s90, 17, 16
    s_add_u32 s89, s89, 64
    s_lshl_b32 s88, s89, 8
    s_add_u32 s88, s88, 0x2350000
    v_mov_b32 v16, 1
    v_mov_b32 v17, 1
    s_mov_b64 exec, 1
    buffer_atomic_add v16, off, s[8:11], s88 sc0 sc1
    s_waitcnt vmcnt(0)
    v_readfirstlane_b32 s91, v16
    s_add_u32 s88, s88, 4096
    s_nop 2
    s_add_u32 s91, s91, 1
    s_cmp_eq_u32 s91, s90
    s_cbranch_scc0 L_inte_notlast_102
    buffer_store_dword v17, off, s[8:11], s88 sc1
L_inte_notlast_102:
    s_mov_b64 exec, -1
    s_branch L_inte_join_101
L_inte_others_100:
L_inte_join_101:
    s_barrier
    v_lshlrev_b32 v1, 4, v0
    v_add_u32 v2, 27648, v1
    v_add_u32 v3, 68608, v1
    v_add_u32 v4, 109568, v1
    v_and_b32 v16, 15, v0
    v_lshrrev_b32 v17, 4, v0
    v_lshlrev_b32 v18, 4, v16
    v_lshl_add_u32 v5, v17, 9, v18
    s_mul_i32 s88, s71, 3
    v_add_u32 v19, s88, v17
    v_and_b32 v20, 1, v19
    v_lshl_add_u32 v18, v20, 3, v18
    v_bfe_u32 v20, v19, 1, 2
    v_lshl_add_u32 v18, v20, 8, v18
    v_lshrrev_b32 v20, 3, v19
    v_add_u32 v20, 48, v20
    v_lshl_add_u32 v18, v20, 12, v18
    v_add_u32 v19, 1, v17
    v_lshrrev_b32 v19, 2, v19
    v_lshl_add_u32 v6, v19, 30, v18
    v_lshrrev_b32 v19, 2, v16
    v_lshl_add_u32 v19, v19, 4, v16
    v_lshlrev_b32 v7, 2, v19
    v_add_lshl_u32 v10, v16, 48, 2
    s_lshl_b32 s88, s3, 7
    s_add_u32 s88, s88, 151552
    v_lshl_add_u32 v11, v16, 2, s88
    v_min_u32 v16, 1, v0
    v_lshlrev_b32 v8, 30, v16
    v_mov_b32 v9, 1
    s_mov_b32 s92, 0x22222222
    s_mov_b32 s93, 0x22222222
    s_mov_b32 s94, 0x44444444
    s_mov_b32 s95, 0x44444444
    s_mov_b32 s96, 0x88888888
    s_mov_b32 s97, 0x88888888
    s_add_u32 s88, s3, 1
    s_and_b32 s88, s88, 3
    s_lshl_b32 s88, s88, 10
    v_add_u32 v12, s88, v1
    s_add_u32 s88, s3, 2
    s_and_b32 s88, s88, 3
    s_lshl_b32 s88, s88, 10
    v_add_u32 v13, s88, v1
    s_add_u32 s88, s3, 3
    s_and_b32 s88, s88, 3
    s_lshl_b32 s88, s88, 10
    v_add_u32 v14, s88, v1
    s_add_u32 s88, s3, 4
    s_and_b32 s88, s88, 3
    s_lshl_b32 s88, s88, 10
    v_add_u32 v15, s88, v1
    s_nop 4
    s_cmp_eq_u32 s3, 0
    s_cbranch_scc0 L_inte_others_103
    s_and_b32 s89, s2, 15
    s_cmp_lt_u32 s89, 0
    s_cselect_b32 s90, 17, 16
    s_add_u32 s89, s89, 96
    s_lshl_b32 s88, s89, 8
    s_add_u32 s88, s88, 0x2350000
    v_mov_b32 v16, 1
    v_mov_b32 v17, 1
    s_mov_b64 exec, 1
    buffer_atomic_add v16, off, s[8:11], s88 sc0 sc1
    s_waitcnt vmcnt(0)
    v_readfirstlane_b32 s91, v16
    s_add_u32 s88, s88, 4096
    s_nop 2
    s_add_u32 s91, s91, 1
    s_cmp_eq_u32 s91, s90
    s_cbranch_scc0 L_inte_notlast_105
    buffer_store_dword v17, off, s[8:11], s88 sc1
L_inte_notlast_105:
    s_mov_b64 exec, -1
    v_and_b32 v18, 15, v0
    v_lshlrev_b32 v18, 8, v18
    v_add_u32 v18, 0x2355000, v18
    buffer_load_dword v19, v18, s[8:11], 0 offen sc1
    s_mov_b32 s91, 0
    s_waitcnt vmcnt(0)
    v_cmp_eq_u32 vcc, 0, v19
    s_nop 3
    s_cmp_eq_u64 vcc, 0
    s_cbranch_scc1 L_inte_ok_107
L_inte_again_106:
    buffer_load_dword v19, v18, s[8:11], 0 offen sc1
    s_add_u32 s91, s91, 1
    s_waitcnt vmcnt(0)
    v_cmp_eq_u32 vcc, 0, v19
    s_cmp_ge_u32 s91, 500000
    s_cbranch_scc1 L_inte_ok_107
    s_nop 1
    s_cmp_eq_u64 vcc, 0
    s_cbranch_scc0 L_inte_again_106
L_inte_ok_107:
    s_branch L_inte_join_104
L_inte_others_103:
    s_add_u32 s89, s75, 66560
    s_add_u32 s88, s69, 66560
    s_add_u32 m0, s88, 0
    s_nop 0
    buffer_load_dwordx4 v1, s[8:11], s89 offen lds
    s_add_u32 m0, s88, 3072
    s_add_u32 s89, s89, 3072
    buffer_load_dwordx4 v1, s[8:11], s89 offen lds
    s_add_u32 m0, s88, 6144
    s_add_u32 s89, s89, 3072
    buffer_load_dwordx4 v1, s[8:11], s89 offen lds
    s_add_u32 m0, s88, 9216
    s_add_u32 s89, s89, 3072
    buffer_load_dwordx4 v1, s[8:11], s89 offen lds
    s_add_u32 m0, s88, 12288
    s_add_u32 s89, s89, 3072
    buffer_load_dwordx4 v1, s[8:11], s89 offen lds
    s_add_u32 m0, s88, 15360
    s_add_u32 s89, s89, 3072
    buffer_load_dwordx4 v1, s[8:11], s89 offen lds
    s_add_u32 m0, s88, 18432
    s_add_u32 s89, s89, 3072
    buffer_load_dwordx4 v1, s[8:11], s89 offen lds
    s_add_u32 m0, s88, 21504
    s_add_u32 s89, s89, 3072
    buffer_load_dwordx4 v1, s[8:11], s89 offen lds
    s_add_u32 m0, s88, 24576
    s_add_u32 s89, s89, 3072
    buffer_load_dwordx4 v1, s[8:11], s89 offen lds
    s_add_u32 m0, s88, 27648
    s_add_u32 s89, s89, 3072
    buffer_load_dwordx4 v1, s[8:11], s89 offen lds
    s_add_u32 m0, s88, 30720
    s_add_u32 s89, s89, 3072
    buffer_load_dwordx4 v1, s[8:11], s89 offen lds
    s_add_u32 m0, s88, 33792
    s_add_u32 s89, s89, 3072
    buffer_load_dwordx4 v1, s[8:11], s89 offen lds
    s_add_u32 m0, s88, 36864
    s_add_u32 s89, s89, 3072
    buffer_load_dwordx4 v1, s[8:11], s89 offen lds
    s_add_u32 m0, s88, 39936
    s_add_u32 s89, s89, 3072
    buffer_load_dwordx4 v1, s[8:11], s89 offen lds
    s_add_u32 m0, s88, 43008
    s_add_u32 s89, s89, 3072
    buffer_load_dwordx4 v1, s[8:11], s89 offen lds
    s_add_u32 m0, s88, 46080
    s_add_u32 s89, s89, 3072
    buffer_load_dwordx4 v1, s[8:11], s89 offen lds
    s_add_u32 m0, s88, 49152
    s_add_u32 s89, s89, 3072
    buffer_load_dwordx4 v1, s[8:11], s89 offen lds
    s_add_u32 m0, s88, 52224
    s_add_u32 s89, s89, 3072
    buffer_load_dwordx4 v1, s[8:11], s89 offen lds
    s_add_u32 m0, s88, 55296
    s_add_u32 s89, s89, 3072
    buffer_load_dwordx4 v1, s[8:11], s89 offen lds
    s_add_u32 m0, s88, 58368
    s_add_u32 s89, s89, 3072
    buffer_load_dwordx4 v1, s[8:11], s89 offen lds
    s_add_u32 m0, s88, 61440
    s_add_u32 s89, s89, 3072
    buffer_load_dwordx4 v1, s[8:11], s89 offen lds
    s_add_u32 m0, s88, 64512
    s_add_u32 s89, s89, 3072
    buffer_load_dwordx4 v1, s[8:11], s89 offen lds
    s_add_u32 m0, s88, 67584
    s_add_u32 s89, s89, 3072
    buffer_load_dwordx4 v1, s[8:11], s89 offen lds
    s_add_u32 m0, s88, 70656
    s_add_u32 s89, s89, 3072
    buffer_load_dwordx4 v1, s[8:11], s89 offen lds
    s_add_u32 m0, s88, 73728
    s_add_u32 s89, s89, 3072
    buffer_load_dwordx4 v1, s[8:11], s89 offen lds
    s_add_u32 m0, s88, 76800
    s_add_u32 s89, s89, 3072
    buffer_load_dwordx4 v1, s[8:11], s89 offen lds
    s_add_u32 m0, s88, 79872
    s_add_u32 s89, s89, 3072
    buffer_load_dwordx4 v1, s[8:11], s89 offen lds
L_inte_join_104:
    s_barrier
    s_lshl1_add_u32 s89, s43, s84
    buffer_load_dwordx4 a[0:3], v1, s[8:11], s89 offen offset:0
    buffer_load_dwordx4 a[4:7], v1, s[8:11], s89 offen offset:1024
    buffer_load_dwordx4 a[8:11], v1, s[8:11], s89 offen offset:2048
    buffer_load_dwordx4 a[12:15], v1, s[8:11], s89 offen offset:3072
    s_add_u32 s89, s89, 4096
    buffer_load_dwordx4 a[16:19], v1, s[8:11], s89 offen offset:0
    s_lshl1_add_u32 s89, s44, s84
    buffer_load_dwordx4 a[20:23], v1, s[8:11], s89 offen offset:0
    buffer_load_dwordx4 a[24:27], v1, s[8:11], s89 offen offset:1024
    buffer_load_dwordx4 a[28:31], v1, s[8:11], s89 offen offset:2048
    buffer_load_dwordx4 a[32:35], v1, s[8:11], s89 offen offset:3072
    s_add_u32 s89, s89, 4096
    buffer_load_dwordx4 a[36:39], v1, s[8:11], s89 offen offset:0
    s_lshl1_add_u32 s89, s45, s84
    buffer_load_dwordx4 a[40:43], v1, s[8:11], s89 offen offset:0
    buffer_load_dwordx4 a[44:47], v1, s[8:11], s89 offen offset:1024
    buffer_load_dwordx4 a[48:51], v1, s[8:11], s89 offen offset:2048
    buffer_load_dwordx4 a[52:55], v1, s[8:11], s89 offen offset:3072
    s_add_u32 s89, s89, 4096
    buffer_load_dwordx4 a[56:59], v1, s[8:11], s89 offen offset:0
    s_lshl1_add_u32 s89, s46, s84
    buffer_load_dwordx4 a[60:63], v1, s[8:11], s89 offen offset:0
    buffer_load_dwordx4 a[64:67], v1, s[8:11], s89 offen offset:1024
    buffer_load_dwordx4 a[68:71], v1, s[8:11], s89 offen offset:2048
    buffer_load_dwordx4 a[72:75], v1, s[8:11], s89 offen offset:3072
    s_add_u32 s89, s89, 4096
    buffer_load_dwordx4 a[76:79], v1, s[8:11], s89 offen offset:0
    s_mov_b32 s89, s85
    buffer_load_dwordx4 a[80:83], v1, s[8:11], s89 offen offset:0
    buffer_load_dwordx4 a[84:87], v1, s[8:11], s89 offen offset:1024
    buffer_load_dwordx4 a[88:91], v1, s[8:11], s89 offen offset:2048
    buffer_load_dwordx4 a[92:95], v1, s[8:11], s89 offen offset:3072
    s_add_u32 s89, s89, 4096
    buffer_load_dwordx4 a[96:99], v1, s[8:11], s89 offen offset:0
    s_mov_b32 s89, s86
    buffer_load_dwordx4 a[100:103], v1, s[8:11], s89 offen offset:0
    buffer_load_dwordx4 a[104:107], v1, s[8:11], s89 offen offset:1024
    buffer_load_dwordx4 a[108:111], v1, s[8:11], s89 offen offset:2048
    buffer_load_dwordx4 a[112:115], v1, s[8:11], s89 offen offset:3072
    s_add_u32 s89, s89, 4096
    buffer_load_dwordx4 a[116:119], v1, s[8:11], s89 offen offset:0
    s_lshl1_add_u32 s89, s43, s25
    buffer_load_dwordx4 a[120:123], v1, s[8:11], s89 offen offset:0
    buffer_load_dwordx4 a[124:127], v1, s[8:11], s89 offen offset:1024
    buffer_load_dwordx4 a[128:131], v1, s[8:11], s89 offen offset:2048
    buffer_load_dwordx4 a[132:135], v1, s[8:11], s89 offen offset:3072
    s_add_u32 s89, s89, 4096
    buffer_load_dwordx4 a[136:139], v1, s[8:11], s89 offen offset:0
    s_lshl1_add_u32 s89, s44, s25
    buffer_load_dwordx4 a[140:143], v1, s[8:11], s89 offen offset:0
    buffer_load_dwordx4 a[144:147], v1, s[8:11], s89 offen offset:1024
    buffer_load_dwordx4 a[148:151], v1, s[8:11], s89 offen offset:2048
    buffer_load_dwordx4 a[152:155], v1, s[8:11], s89 offen offset:3072
    s_add_u32 s89, s89, 4096
    buffer_load_dwordx4 a[156:159], v1, s[8:11], s89 offen offset:0
    s_lshl1_add_u32 s89, s45, s25
    buffer_load_dwordx4 a[160:163], v1, s[8:11], s89 offen offset:0
    buffer_load_dwordx4 a[164:167], v1, s[8:11], s89 offen offset:1024
    buffer_load_dwordx4 a[168:171], v1, s[8:11], s89 offen offset:2048
    buffer_load_dwordx4 a[172:175], v1, s[8:11], s89 offen offset:3072
    s_add_u32 s89, s89, 4096
    buffer_load_dwordx4 a[176:179], v1, s[8:11], s89 offen offset:0
    s_lshl1_add_u32 s89, s46, s25
    buffer_load_dwordx4 a[180:183], v1, s[8:11], s89 offen offset:0
    buffer_load_dwordx4 a[184:187], v1, s[8:11], s89 offen offset:1024
    buffer_load_dwordx4 a[188:191], v1, s[8:11], s89 offen offset:2048
    buffer_load_dwordx4 a[192:195], v1, s[8:11], s89 offen offset:3072
    s_add_u32 s89, s89, 4096
    buffer_load_dwordx4 a[196:199], v1, s[8:11], s89 offen offset:0
    s_cmp_eq_u32 s3, 0
    s_cbranch_scc0 L_inte_others_108
    v_and_b32 v18, 15, v0
    v_lshlrev_b32 v18, 8, v18
    v_add_u32 v18, 0x2357000, v18
    buffer_load_dword v19, v18, s[8:11], 0 offen sc1
    s_mov_b32 s91, 0
    s_waitcnt vmcnt(0)
    v_cmp_eq_u32 vcc, 0, v19
    s_nop 3
    s_cmp_eq_u64 vcc, 0
    s_cbranch_scc1 L_inte_ok_111
L_inte_again_110:
    buffer_load_dword v19, v18, s[8:11], 0 offen sc1
    s_add_u32 s91, s91, 1
    s_waitcnt vmcnt(0)
    v_cmp_eq_u32 vcc, 0, v19
    s_cmp_ge_u32 s91, 500000
    s_cbranch_scc1 L_inte_ok_111
    s_nop 1
    s_cmp_eq_u64 vcc, 0
    s_cbranch_scc0 L_inte_again_110
L_inte_ok_111:
    s_branch L_inte_join_109
L_inte_others_108:
L_inte_join_109:
    s_barrier
L_inte_go_89:
L_go1:
    s_mov_b32 s52, s74
    buffer_load_dwordx4 v[96:99], v5, s[8:11], s74 offen offset:0 sc1
    buffer_load_dwordx4 v[100:103], v5, s[8:11], s74 offen offset:256 sc1
    buffer_load_dwordx4 v[104:107], v5, s[8:11], s74 offen offset:2048 sc1
    buffer_load_dwordx4 v[108:111], v5, s[8:11], s74 offen offset:2304 sc1
    s_add_u32 s74, s74, 4096
    buffer_load_dwordx4 v[112:115], v5, s[8:11], s74 offen offset:0 sc1
    buffer_load_dwordx4 v[116:119], v5, s[8:11], s74 offen offset:256 sc1
    buffer_load_dwordx4 v[120:123], v5, s[8:11], s74 offen offset:2048 sc1
    buffer_load_dwordx4 v[124:127], v5, s[8:11], s74 offen offset:2304 sc1
    s_add_u32 s74, s74, 4096
    buffer_load_dwordx4 v[128:131], v5, s[8:11], s74 offen offset:0 sc1
    buffer_load_dwordx4 v[132:135], v5, s[8:11], s74 offen offset:256 sc1
    buffer_load_dwordx4 v[136:139], v5, s[8:11], s74 offen offset:2048 sc1
    buffer_load_dwordx4 v[140:143], v5, s[8:11], s74 offen offset:2304 sc1
    s_add_u32 s74, s74, 4096
    buffer_load_dwordx4 v[144:147], v5, s[8:11], s74 offen offset:0 sc1
    buffer_load_dwordx4 v[148:151], v5, s[8:11], s74 offen offset:256 sc1
    ds_read_b128 a[220:223], v1 offset:7168
    ds_read_b128 a[224:227], v2 offset:0
    ds_read_b128 a[228:231], v2 offset:20480
    ds_read_b128 a[232:235], v1 offset:8192
    ds_read_b128 a[236:239], v2 offset:1024
    ds_read_b128 a[240:243], v2 offset:21504
    s_waitcnt vmcnt(12)
    v_max3_u32 v31, v96, v97, v98
    v_max3_u32 v31, v31, v99, v100
    v_max3_u32 v31, v31, v101, v102
    v_max_u32 v31, v31, v103
    v_cmp_eq_u32 vcc, -1, v31
    s_nop 1
    s_cbranch_vccnz L_inte_xretry_112
L_inte_xback_113:
    s_waitcnt lgkmcnt(3)
    v_mfma_f32_16x16x32_bf16 v[64:67], a[220:223], v[96:99], 0
    ds_read_b128 a[244:247], v1 offset:9216
    s_waitcnt vmcnt(10)
    v_mfma_f32_16x16x32_bf16 v[68:71], a[220:223], v[100:103], 0
    buffer_load_dwordx4 v[152:155], v5, s[8:11], s74 offen offset:2048 sc1
    v_max3_u32 v31, v104, v105, v106
    v_mfma_f32_16x16x32_bf16 v[32:35], a[224:227], v[96:99], 0
    ds_read_b128 a[248:251], v2 offset:2048
    s_lshr_b32 s78, s73, 1
    v_max3_u32 v31, v31, v107, v108
    v_mfma_f32_16x16x32_bf16 v[40:43], a[224:227], v[100:103], 0
    s_mov_b32 s79, 0x05040100
    v_max3_u32 v31, v31, v109, v110
    v_mfma_f32_16x16x32_bf16 v[36:39], a[228:231], v[96:99], 0
    ds_read_b128 a[252:255], v2 offset:22528
    s_bitcmp0_b32 s73, 0
    v_max_u32 v31, v31, v111
    v_mfma_f32_16x16x32_bf16 v[44:47], a[228:231], v[100:103], 0
    buffer_load_dwordx4 v[156:159], v5, s[8:11], s74 offen offset:2304 sc1
    s_cselect_b32 s79, s79, 0x07060302
    v_cmp_eq_u32 vcc, -1, v31
    v_mfma_f32_16x16x32_bf16 v[72:75], v[96:99], v[96:99], 0
    ds_read_b128 a[220:223], v1 offset:10240
    v_and_b32 v24, 15, v0
    v_mfma_f32_16x16x32_bf16 v[76:79], v[100:103], v[100:103], 0
    v_mul_u32_u24 v24, 160, v24
    s_cbranch_vccnz L_inte_xretry_114
L_inte_xback_115:
    s_waitcnt lgkmcnt(4)
    v_mfma_f32_16x16x32_bf16 v[64:67], a[232:235], v[104:107], v[64:67]
    ds_read_b128 a[224:227], v2 offset:3072
    v_lshrrev_b32 v25, 4, v0
    s_waitcnt vmcnt(10)
    v_mfma_f32_16x16x32_bf16 v[68:71], a[232:235], v[108:111], v[68:71]
    s_add_u32 s74, s74, 4096
    buffer_load_dwordx4 v[160:163], v5, s[8:11], s74 offen offset:0 sc1
    v_lshl_add_u32 v24, v25, 2, v24
    v_max3_u32 v31, v112, v113, v114
    v_mfma_f32_16x16x32_bf16 v[32:35], a[236:239], v[104:107], v[32:35]
    ds_read_b128 a[228:231], v2 offset:23552
    s_and_b32 s88, s3, 1
    v_max3_u32 v31, v31, v115, v116
    v_mfma_f32_16x16x32_bf16 v[40:43], a[236:239], v[108:111], v[40:43]
    s_mul_i32 s88, s88, 5120
    v_max3_u32 v31, v31, v117, v118
    v_mfma_f32_16x16x32_bf16 v[36:39], a[240:243], v[104:107], v[36:39]
    ds_read_b128 a[232:235], v1 offset:11264
    s_add_u32 s88, s88, 152064
    v_max_u32 v31, v31, v119
    v_mfma_f32_16x16x32_bf16 v[44:47], a[240:243], v[108:111], v[44:47]
    buffer_load_dwordx4 v[164:167], v5, s[8:11], s74 offen offset:256 sc1
    s_lshr_b32 s91, s3, 1
    v_cmp_eq_u32 vcc, -1, v31
    v_mfma_f32_16x16x32_bf16 v[72:75], v[104:107], v[104:107], v[72:75]
    ds_read_b128 a[236:239], v2 offset:4096
    s_cmp_eq_u32 s91, s72
    v_mfma_f32_16x16x32_bf16 v[76:79], v[108:111], v[108:111], v[76:79]
    s_cselect_b32 s88, s88, 0x30000
    s_cbranch_vccnz L_inte_xretry_116
L_inte_xback_117:
    s_waitcnt lgkmcnt(5)
    v_mfma_f32_16x16x32_bf16 v[64:67], a[244:247], v[112:115], v[64:67]
    ds_read_b128 a[240:243], v2 offset:24576
    v_add_u32 v24, s88, v24
    s_waitcnt vmcnt(10)
    v_mfma_f32_16x16x32_bf16 v[68:71], a[244:247], v[116:119], v[68:71]
    buffer_load_dwordx4 v[168:171], v5, s[8:11], s74 offen offset:2048 sc1
    v_add_u32 v25, 2560, v24
    v_max3_u32 v31, v120, v121, v122
    v_mfma_f32_16x16x32_bf16 v[32:35], a[248:251], v[112:115], v[32:35]
    ds_read_b128 a[244:247], v1 offset:12288
    v_max3_u32 v31, v31, v123, v124
    v_mfma_f32_16x16x32_bf16 v[40:43], a[248:251], v[116:119], v[40:43]
    v_max3_u32 v31, v31, v125, v126
    v_mfma_f32_16x16x32_bf16 v[36:39], a[252:255], v[112:115], v[36:39]
    ds_read_b128 a[248:251], v2 offset:5120
    v_max_u32 v31, v31, v127
    v_mfma_f32_16x16x32_bf16 v[44:47], a[252:255], v[116:119], v[44:47]
    buffer_load_dwordx4 v[172:175], v5, s[8:11], s74 offen offset:2304 sc1
    v_cmp_eq_u32 vcc, -1, v31
    v_mfma_f32_16x16x32_bf16 v[72:75], v[112:115], v[112:115], v[72:75]
    ds_read_b128 a[252:255], v2 offset:25600
    v_mfma_f32_16x16x32_bf16 v[76:79], v[116:119], v[116:119], v[76:79]
    s_cbranch_vccnz L_inte_xretry_118
L_inte_xback_119:
    s_waitcnt lgkmcnt(6)
    v_mfma_f32_16x16x32_bf16 v[64:67], a[220:223], v[120:123], v[64:67]
    s_waitcnt vmcnt(10)
    v_mfma_f32_16x16x32_bf16 v[68:71], a[220:223], v[124:127], v[68:71]
    s_add_u32 s74, s74, 4096
    buffer_load_dwordx4 v[176:179], v5, s[8:11], s74 offen offset:0 sc1
    v_max3_u32 v31, v128, v129, v130
    v_mfma_f32_16x16x32_bf16 v[32:35], a[224:227], v[120:123], v[32:35]
    ds_read_b128 a[220:223], v1 offset:13312
    v_max3_u32 v31, v31, v131, v132
    v_mfma_f32_16x16x32_bf16 v[40:43], a[224:227], v[124:127], v[40:43]
    v_max3_u32 v31, v31, v133, v134
    v_mfma_f32_16x16x32_bf16 v[36:39], a[228:231], v[120:123], v[36:39]
    ds_read_b128 a[224:227], v2 offset:6144
    v_max_u32 v31, v31, v135
    v_mfma_f32_16x16x32_bf16 v[44:47], a[228:231], v[124:127], v[44:47]
    buffer_load_dwordx4 v[180:183], v5, s[8:11], s74 offen offset:256 sc1
    v_cmp_eq_u32 vcc, -1, v31
    v_mfma_f32_16x16x32_bf16 v[72:75], v[120:123], v[120:123], v[72:75]
    ds_read_b128 a[228:231], v2 offset:26624
    v_mfma_f32_16x16x32_bf16 v[76:79], v[124:127], v[124:127], v[76:79]
    s_cbranch_vccnz L_inte_xretry_120
L_inte_xback_121:
    s_waitcnt lgkmcnt(6)
    v_mfma_f32_16x16x32_bf16 v[64:67], a[232:235], v[128:131], v[64:67]
    s_waitcnt vmcnt(10)
    v_mfma_f32_16x16x32_bf16 v[68:71], a[232:235], v[132:135], v[68:71]
    buffer_load_dwordx4 v[184:187], v5, s[8:11], s74 offen offset:2048 sc1
    v_max3_u32 v31, v136, v137, v138
    v_mfma_f32_16x16x32_bf16 v[32:35], a[236:239], v[128:131], v[32:35]
    ds_read_b128 a[232:235], v1 offset:14336
    s_set_gpr_idx_on s78, gpr_idx(SRC0,SRC1)
    v_perm_b32 v26, v104, v96, s79
    v_perm_b32 v27, v120, v112, s79
    s_set_gpr_idx_off
    ds_write2_b32 v24, v26, v27 offset0:0 offset1:4
    v_max3_u32 v31, v31, v139, v140
    v_mfma_f32_16x16x32_bf16 v[40:43], a[236:239], v[132:135], v[40:43]
    v_max3_u32 v31, v31, v141, v142
    v_mfma_f32_16x16x32_bf16 v[36:39], a[240:243], v[128:131], v[36:39]
    ds_read_b128 a[236:239], v2 offset:7168
    v_max_u32 v31, v31, v143
    v_mfma_f32_16x16x32_bf16 v[44:47], a[240:243], v[132:135], v[44:47]
    buffer_load_dwordx4 v[188:191], v5, s[8:11], s74 offen offset:2304 sc1
    s_set_gpr_idx_on s78, gpr_idx(SRC0,SRC1)
    v_perm_b32 v28, v108, v100, s79
    v_perm_b32 v29, v124, v116, s79
    s_set_gpr_idx_off
    ds_write2_b32 v25, v28, v29 offset0:0 offset1:4
    v_cmp_eq_u32 vcc, -1, v31
    v_mfma_f32_16x16x32_bf16 v[72:75], v[128:131], v[128:131], v[72:75]
    ds_read_b128 a[240:243], v2 offset:27648
    v_mfma_f32_16x16x32_bf16 v[76:79], v[132:135], v[132:135], v[76:79]
    s_cbranch_vccnz L_inte_xretry_122
L_inte_xback_123:
    s_waitcnt lgkmcnt(8)
    v_mfma_f32_16x16x32_bf16 v[64:67], a[244:247], v[136:139], v[64:67]
    s_waitcnt vmcnt(10)
    v_mfma_f32_16x16x32_bf16 v[68:71], a[244:247], v[140:143], v[68:71]
    s_add_u32 s74, s74, 4096
    buffer_load_dwordx4 v[192:195], v5, s[8:11], s74 offen offset:0 sc1
    v_max3_u32 v31, v144, v145, v146
    v_mfma_f32_16x16x32_bf16 v[32:35], a[248:251], v[136:139], v[32:35]
    ds_read_b128 a[244:247], v1 offset:15360
    v_max3_u32 v31, v31, v147, v148
    v_mfma_f32_16x16x32_bf16 v[40:43], a[248:251], v[140:143], v[40:43]
    v_max3_u32 v31, v31, v149, v150
    v_mfma_f32_16x16x32_bf16 v[36:39], a[252:255], v[136:139], v[36:39]
    ds_read_b128 a[248:251], v2 offset:8192
    v_max_u32 v31, v31, v151
    v_mfma_f32_16x16x32_bf16 v[44:47], a[252:255], v[140:143], v[44:47]
    buffer_load_dwordx4 v[196:199], v5, s[8:11], s74 offen offset:256 sc1
    v_cmp_eq_u32 vcc, -1, v31
    v_mfma_f32_16x16x32_bf16 v[72:75], v[136:139], v[136:139], v[72:75]
    ds_read_b128 a[252:255], v2 offset:28672
    v_mfma_f32_16x16x32_bf16 v[76:79], v[140:143], v[140:143], v[76:79]
    s_cbranch_vccnz L_inte_xretry_124
L_inte_xback_125:
    s_waitcnt lgkmcnt(8)
    v_mfma_f32_16x16x32_bf16 v[64:67], a[220:223], v[144:147], v[64:67]
    s_waitcnt vmcnt(10)
    v_mfma_f32_16x16x32_bf16 v[68:71], a[220:223], v[148:151], v[68:71]
    buffer_load_dwordx4 v[200:203], v5, s[8:11], s74 offen offset:2048 sc1
    v_max3_u32 v31, v152, v153, v154
    v_mfma_f32_16x16x32_bf16 v[32:35], a[224:227], v[144:147], v[32:35]
    ds_read_b128 a[220:223], v1 offset:16384
    v_max3_u32 v31, v31, v155, v156
    v_mfma_f32_16x16x32_bf16 v[40:43], a[224:227], v[148:151], v[40:43]
    v_max3_u32 v31, v31, v157, v158
    v_mfma_f32_16x16x32_bf16 v[36:39], a[228:231], v[144:147], v[36:39]
    ds_read_b128 a[224:227], v2 offset:9216
    v_max_u32 v31, v31, v159
    v_mfma_f32_16x16x32_bf16 v[44:47], a[228:231], v[148:151], v[44:47]
    buffer_load_dwordx4 v[204:207], v5, s[8:11], s74 offen offset:2304 sc1
    v_cmp_eq_u32 vcc, -1, v31
    v_mfma_f32_16x16x32_bf16 v[72:75], v[144:147], v[144:147], v[72:75]
    ds_read_b128 a[228:231], v2 offset:29696
    v_mfma_f32_16x16x32_bf16 v[76:79], v[148:151], v[148:151], v[76:79]
    s_cbranch_vccnz L_inte_xretry_126
L_inte_xback_127:
    s_waitcnt lgkmcnt(6)
    v_mfma_f32_16x16x32_bf16 v[64:67], a[232:235], v[152:155], v[64:67]
    s_waitcnt vmcnt(10)
    v_mfma_f32_16x16x32_bf16 v[68:71], a[232:235], v[156:159], v[68:71]
    s_add_u32 s74, s74, 4096
    buffer_load_dwordx4 v[208:211], v5, s[8:11], s74 offen offset:0 sc1
    v_max3_u32 v31, v160, v161, v162
    v_mfma_f32_16x16x32_bf16 v[32:35], a[236:239], v[152:155], v[32:35]
    ds_read_b128 a[232:235], v1 offset:17408
    v_max3_u32 v31, v31, v163, v164
    v_mfma_f32_16x16x32_bf16 v[40:43], a[236:239], v[156:159], v[40:43]
    v_max3_u32 v31, v31, v165, v166
    v_mfma_f32_16x16x32_bf16 v[36:39], a[240:243], v[152:155], v[36:39]
    ds_read_b128 a[236:239], v2 offset:10240
    v_max_u32 v31, v31, v167
    v_mfma_f32_16x16x32_bf16 v[44:47], a[240:243], v[156:159], v[44:47]
    buffer_load_dwordx4 v[212:215], v5, s[8:11], s74 offen offset:256 sc1
    v_cmp_eq_u32 vcc, -1, v31
    v_mfma_f32_16x16x32_bf16 v[72:75], v[152:155], v[152:155], v[72:75]
    ds_read_b128 a[240:243], v2 offset:30720
    v_mfma_f32_16x16x32_bf16 v[76:79], v[156:159], v[156:159], v[76:79]
    s_cbranch_vccnz L_inte_xretry_128
L_inte_xback_129:
    s_waitcnt lgkmcnt(6)
    v_mfma_f32_16x16x32_bf16 v[64:67], a[244:247], v[160:163], v[64:67]
    s_waitcnt vmcnt(10)
    v_mfma_f32_16x16x32_bf16 v[68:71], a[244:247], v[164:167], v[68:71]
    buffer_load_dwordx4 v[216:219], v5, s[8:11], s74 offen offset:2048 sc1
    v_max3_u32 v31, v168, v169, v170
    v_mfma_f32_16x16x32_bf16 v[32:35], a[248:251], v[160:163], v[32:35]
    ds_read_b128 a[244:247], v1 offset:18432
    s_set_gpr_idx_on s78, gpr_idx(SRC0,SRC1)
    v_perm_b32 v26, v136, v128, s79
    v_perm_b32 v27, v152, v144, s79
    s_set_gpr_idx_off
    ds_write2_b32 v24, v26, v27 offset0:8 offset1:12
    v_max3_u32 v31, v31, v171, v172
    v_mfma_f32_16x16x32_bf16 v[40:43], a[248:251], v[164:167], v[40:43]
    v_max3_u32 v31, v31, v173, v174
    v_mfma_f32_16x16x32_bf16 v[36:39], a[252:255], v[160:163], v[36:39]
    ds_read_b128 a[248:251], v2 offset:11264
    v_max_u32 v31, v31, v175
    v_mfma_f32_16x16x32_bf16 v[44:47], a[252:255], v[164:167], v[44:47]
    buffer_load_dwordx4 v[220:223], v5, s[8:11], s74 offen offset:2304 sc1
    s_set_gpr_idx_on s78, gpr_idx(SRC0,SRC1)
    v_perm_b32 v28, v140, v132, s79
    v_perm_b32 v29, v156, v148, s79
    s_set_gpr_idx_off
    ds_write2_b32 v25, v28, v29 offset0:8 offset1:12
    v_cmp_eq_u32 vcc, -1, v31
    v_mfma_f32_16x16x32_bf16 v[72:75], v[160:163], v[160:163], v[72:75]
    ds_read_b128 a[252:255], v2 offset:31744
    v_mfma_f32_16x16x32_bf16 v[76:79], v[164:167], v[164:167], v[76:79]
    s_cbranch_vccnz L_inte_xretry_130
L_inte_xback_131:
    s_waitcnt lgkmcnt(8)
    v_mfma_f32_16x16x32_bf16 v[64:67], a[220:223], v[168:171], v[64:67]
    s_waitcnt vmcnt(10)
    v_mfma_f32_16x16x32_bf16 v[68:71], a[220:223], v[172:175], v[68:71]
    s_add_u32 s74, s74, 4096
    buffer_load_dwordx4 v[224:227], v5, s[8:11], s74 offen offset:0 sc1
    v_max3_u32 v31, v176, v177, v178
    v_mfma_f32_16x16x32_bf16 v[32:35], a[224:227], v[168:171], v[32:35]
    ds_read_b128 a[220:223], v1 offset:19456
    v_max3_u32 v31, v31, v179, v180
    v_mfma_f32_16x16x32_bf16 v[40:43], a[224:227], v[172:175], v[40:43]
    v_max3_u32 v31, v31, v181, v182
    v_mfma_f32_16x16x32_bf16 v[36:39], a[228:231], v[168:171], v[36:39]
    ds_read_b128 a[224:227], v2 offset:12288
    v_max_u32 v31, v31, v183
    v_mfma_f32_16x16x32_bf16 v[44:47], a[228:231], v[172:175], v[44:47]
    buffer_load_dwordx4 v[228:231], v5, s[8:11], s74 offen offset:256 sc1
    v_cmp_eq_u32 vcc, -1, v31
    v_mfma_f32_16x16x32_bf16 v[72:75], v[168:171], v[168:171], v[72:75]
    ds_read_b128 a[228:231], v2 offset:32768
    v_mfma_f32_16x16x32_bf16 v[76:79], v[172:175], v[172:175], v[76:79]
    s_cbranch_vccnz L_inte_xretry_132
L_inte_xback_133:
    s_waitcnt lgkmcnt(8)
    v_mfma_f32_16x16x32_bf16 v[64:67], a[232:235], v[176:179], v[64:67]
    s_waitcnt vmcnt(10)
    v_mfma_f32_16x16x32_bf16 v[68:71], a[232:235], v[180:183], v[68:71]
    buffer_load_dwordx4 v[232:235], v5, s[8:11], s74 offen offset:2048 sc1
    v_max3_u32 v31, v184, v185, v186
    v_mfma_f32_16x16x32_bf16 v[32:35], a[236:239], v[176:179], v[32:35]
    ds_read_b128 a[232:235], v1 offset:20480
    v_max3_u32 v31, v31, v187, v188
    v_mfma_f32_16x16x32_bf16 v[40:43], a[236:239], v[180:183], v[40:43]
    v_max3_u32 v31, v31, v189, v190
    v_mfma_f32_16x16x32_bf16 v[36:39], a[240:243], v[176:179], v[36:39]
    ds_read_b128 a[236:239], v2 offset:13312
    v_max_u32 v31, v31, v191
    v_mfma_f32_16x16x32_bf16 v[44:47], a[240:243], v[180:183], v[44:47]
    buffer_load_dwordx4 v[236:239], v5, s[8:11], s74 offen offset:2304 sc1
    v_cmp_eq_u32 vcc, -1, v31
    v_mfma_f32_16x16x32_bf16 v[72:75], v[176:179], v[176:179], v[72:75]
    ds_read_b128 a[240:243], v2 offset:33792
    v_mfma_f32_16x16x32_bf16 v[76:79], v[180:183], v[180:183], v[76:79]
    s_cbranch_vccnz L_inte_xretry_134
L_inte_xback_135:
    s_waitcnt lgkmcnt(6)
    v_mfma_f32_16x16x32_bf16 v[64:67], a[244:247], v[184:187], v[64:67]
    s_waitcnt vmcnt(10)
    v_mfma_f32_16x16x32_bf16 v[68:71], a[244:247], v[188:191], v[68:71]
    s_add_u32 s74, s74, 4096
    buffer_load_dwordx4 v[240:243], v5, s[8:11], s74 offen offset:0 sc1
    v_max3_u32 v31, v192, v193, v194
    v_mfma_f32_16x16x32_bf16 v[32:35], a[248:251], v[184:187], v[32:35]
    ds_read_b128 a[244:247], v1 offset:21504
    v_max3_u32 v31, v31, v195, v196
    v_mfma_f32_16x16x32_bf16 v[40:43], a[248:251], v[188:191], v[40:43]
    v_max3_u32 v31, v31, v197, v198
    v_mfma_f32_16x16x32_bf16 v[36:39], a[252:255], v[184:187], v[36:39]
    ds_read_b128 a[248:251], v2 offset:14336
    v_max_u32 v31, v31, v199
    v_mfma_f32_16x16x32_bf16 v[44:47], a[252:255], v[188:191], v[44:47]
    buffer_load_dwordx4 v[244:247], v5, s[8:11], s74 offen offset:256 sc1
    v_cmp_eq_u32 vcc, -1, v31
    v_mfma_f32_16x16x32_bf16 v[72:75], v[184:187], v[184:187], v[72:75]
    ds_read_b128 a[252:255], v2 offset:34816
    v_mfma_f32_16x16x32_bf16 v[76:79], v[188:191], v[188:191], v[76:79]
    s_cbranch_vccnz L_inte_xretry_136
L_inte_xback_137:
    s_waitcnt lgkmcnt(6)
    v_mfma_f32_16x16x32_bf16 v[64:67], a[220:223], v[192:195], v[64:67]
    s_waitcnt vmcnt(10)
    v_mfma_f32_16x16x32_bf16 v[68:71], a[220:223], v[196:199], v[68:71]
    buffer_load_dwordx4 v[248:251], v5, s[8:11], s74 offen offset:2048 sc1
    v_max3_u32 v31, v200, v201, v202
    v_mfma_f32_16x16x32_bf16 v[32:35], a[224:227], v[192:195], v[32:35]
    ds_read_b128 a[220:223], v1 offset:22528
    s_set_gpr_idx_on s78, gpr_idx(SRC0,SRC1)
    v_perm_b32 v26, v168, v160, s79
    v_perm_b32 v27, v184, v176, s79
    s_set_gpr_idx_off
    ds_write2_b32 v24, v26, v27 offset0:16 offset1:20
    v_max3_u32 v31, v31, v203, v204
    v_mfma_f32_16x16x32_bf16 v[40:43], a[224:227], v[196:199], v[40:43]
    v_max3_u32 v31, v31, v205, v206
    v_mfma_f32_16x16x32_bf16 v[36:39], a[228:231], v[192:195], v[36:39]
    ds_read_b128 a[224:227], v2 offset:15360
    v_max_u32 v31, v31, v207
    v_mfma_f32_16x16x32_bf16 v[44:47], a[228:231], v[196:199], v[44:47]
    buffer_load_dwordx4 v[252:255], v5, s[8:11], s74 offen offset:2304 sc1
    s_set_gpr_idx_on s78, gpr_idx(SRC0,SRC1)
    v_perm_b32 v28, v172, v164, s79
    v_perm_b32 v29, v188, v180, s79
    s_set_gpr_idx_off
    ds_write2_b32 v25, v28, v29 offset0:16 offset1:20
    v_cmp_eq_u32 vcc, -1, v31
    v_mfma_f32_16x16x32_bf16 v[72:75], v[192:195], v[192:195], v[72:75]
    ds_read_b128 a[228:231], v2 offset:35840
    v_mfma_f32_16x16x32_bf16 v[76:79], v[196:199], v[196:199], v[76:79]
    s_cbranch_vccnz L_inte_xretry_138
L_inte_xback_139:
    s_waitcnt lgkmcnt(8)
    v_mfma_f32_16x16x32_bf16 v[64:67], a[232:235], v[200:203], v[64:67]
    s_add_u32 s89, s43, s87
    buffer_load_dwordx4 a[200:203], v1, s[8:11], s89 offen offset:0
    s_waitcnt vmcnt(11)
    v_mfma_f32_16x16x32_bf16 v[68:71], a[232:235], v[204:207], v[68:71]
    v_max3_u32 v31, v208, v209, v210
    v_mfma_f32_16x16x32_bf16 v[32:35], a[236:239], v[200:203], v[32:35]
    ds_read_b128 a[232:235], v1 offset:23552
    v_max3_u32 v31, v31, v211, v212
    v_mfma_f32_16x16x32_bf16 v[40:43], a[236:239], v[204:207], v[40:43]
    v_max3_u32 v31, v31, v213, v214
    v_mfma_f32_16x16x32_bf16 v[36:39], a[240:243], v[200:203], v[36:39]
    ds_read_b128 a[236:239], v2 offset:16384
    buffer_load_dwordx4 a[204:207], v1, s[8:11], s89 offen offset:1024
    v_max_u32 v31, v31, v215
    v_mfma_f32_16x16x32_bf16 v[44:47], a[240:243], v[204:207], v[44:47]
    v_cmp_eq_u32 vcc, -1, v31
    v_mfma_f32_16x16x32_bf16 v[72:75], v[200:203], v[200:203], v[72:75]
    ds_read_b128 a[240:243], v2 offset:36864
    v_mfma_f32_16x16x32_bf16 v[76:79], v[204:207], v[204:207], v[76:79]
    s_cbranch_vccnz L_inte_xretry_140
L_inte_xback_141:
    s_waitcnt lgkmcnt(8)
    v_mfma_f32_16x16x32_bf16 v[64:67], a[244:247], v[208:211], v[64:67]
    buffer_load_dwordx4 a[208:211], v1, s[8:11], s89 offen offset:2048
    s_waitcnt vmcnt(11)
    v_mfma_f32_16x16x32_bf16 v[68:71], a[244:247], v[212:215], v[68:71]
    v_max3_u32 v31, v216, v217, v218
    v_mfma_f32_16x16x32_bf16 v[32:35], a[248:251], v[208:211], v[32:35]
    ds_read_b128 a[244:247], v1 offset:24576
    v_max3_u32 v31, v31, v219, v220
    v_mfma_f32_16x16x32_bf16 v[40:43], a[248:251], v[212:215], v[40:43]
    v_max3_u32 v31, v31, v221, v222
    v_mfma_f32_16x16x32_bf16 v[36:39], a[252:255], v[208:211], v[36:39]
    ds_read_b128 a[248:251], v2 offset:17408
    buffer_load_dwordx4 a[212:215], v1, s[8:11], s89 offen offset:3072
    v_max_u32 v31, v31, v223
    v_mfma_f32_16x16x32_bf16 v[44:47], a[252:255], v[212:215], v[44:47]
    v_cmp_eq_u32 vcc, -1, v31
    v_mfma_f32_16x16x32_bf16 v[72:75], v[208:211], v[208:211], v[72:75]
    ds_read_b128 a[252:255], v2 offset:37888
    v_mfma_f32_16x16x32_bf16 v[76:79], v[212:215], v[212:215], v[76:79]
    s_cbranch_vccnz L_inte_xretry_142
L_inte_xback_143:
    s_waitcnt lgkmcnt(6)
    v_mfma_f32_16x16x32_bf16 v[64:67], a[220:223], v[216:219], v[64:67]
    s_add_u32 s89, s89, 4096
    buffer_load_dwordx4 a[216:219], v1, s[8:11], s89 offen offset:0
    s_waitcnt vmcnt(11)
    v_mfma_f32_16x16x32_bf16 v[68:71], a[220:223], v[220:223], v[68:71]
    v_max3_u32 v31, v224, v225, v226
    v_mfma_f32_16x16x32_bf16 v[32:35], a[224:227], v[216:219], v[32:35]
    ds_read_b128 a[220:223], v1 offset:25600
    v_max3_u32 v31, v31, v227, v228
    v_mfma_f32_16x16x32_bf16 v[40:43], a[224:227], v[220:223], v[40:43]
    v_max3_u32 v31, v31, v229, v230
    v_mfma_f32_16x16x32_bf16 v[36:39], a[228:231], v[216:219], v[36:39]
    ds_read_b128 a[224:227], v2 offset:18432
    v_max_u32 v31, v31, v231
    v_mfma_f32_16x16x32_bf16 v[44:47], a[228:231], v[220:223], v[44:47]
    v_cmp_eq_u32 vcc, -1, v31
    v_mfma_f32_16x16x32_bf16 v[72:75], v[216:219], v[216:219], v[72:75]
    ds_read_b128 a[228:231], v2 offset:38912
    v_mfma_f32_16x16x32_bf16 v[76:79], v[220:223], v[220:223], v[76:79]
    s_cbranch_vccnz L_inte_xretry_144
L_inte_xback_145:
    s_waitcnt lgkmcnt(6)
    v_mfma_f32_16x16x32_bf16 v[64:67], a[232:235], v[224:227], v[64:67]
    s_waitcnt vmcnt(9)
    v_mfma_f32_16x16x32_bf16 v[68:71], a[232:235], v[228:231], v[68:71]
    v_max3_u32 v31, v232, v233, v234
    v_mfma_f32_16x16x32_bf16 v[32:35], a[236:239], v[224:227], v[32:35]
    ds_read_b128 a[232:235], v1 offset:26624
    s_set_gpr_idx_on s78, gpr_idx(SRC0,SRC1)
    v_perm_b32 v26, v200, v192, s79
    v_perm_b32 v27, v216, v208, s79
    s_set_gpr_idx_off
    ds_write2_b32 v24, v26, v27 offset0:24 offset1:28
    v_max3_u32 v31, v31, v235, v236
    v_mfma_f32_16x16x32_bf16 v[40:43], a[236:239], v[228:231], v[40:43]
    v_max3_u32 v31, v31, v237, v238
    v_mfma_f32_16x16x32_bf16 v[36:39], a[240:243], v[224:227], v[36:39]
    ds_read_b128 a[236:239], v2 offset:19456
    v_max_u32 v31, v31, v239
    v_mfma_f32_16x16x32_bf16 v[44:47], a[240:243], v[228:231], v[44:47]
    s_set_gpr_idx_on s78, gpr_idx(SRC0,SRC1)
    v_perm_b32 v28, v204, v196, s79
    v_perm_b32 v29, v220, v212, s79
    s_set_gpr_idx_off
    ds_write2_b32 v25, v28, v29 offset0:24 offset1:28
    v_cmp_eq_u32 vcc, -1, v31
    v_mfma_f32_16x16x32_bf16 v[72:75], v[224:227], v[224:227], v[72:75]
    ds_read_b128 a[240:243], v2 offset:39936
    v_mfma_f32_16x16x32_bf16 v[76:79], v[228:231], v[228:231], v[76:79]
    s_cbranch_vccnz L_inte_xretry_146
L_inte_xback_147:
    s_waitcnt lgkmcnt(8)
    v_mfma_f32_16x16x32_bf16 v[64:67], a[244:247], v[232:235], v[64:67]
    s_waitcnt vmcnt(7)
    v_mfma_f32_16x16x32_bf16 v[68:71], a[244:247], v[236:239], v[68:71]
    v_max3_u32 v31, v240, v241, v242
    v_mfma_f32_16x16x32_bf16 v[32:35], a[248:251], v[232:235], v[32:35]
    s_barrier
    ds_read_b128 a[244:247], v3 offset:0
    v_max3_u32 v31, v31, v243, v244
    v_mfma_f32_16x16x32_bf16 v[40:43], a[248:251], v[236:239], v[40:43]
    v_max3_u32 v31, v31, v245, v246
    v_mfma_f32_16x16x32_bf16 v[36:39], a[252:255], v[232:235], v[36:39]
    ds_read_b128 a[248:251], v3 offset:20480
    v_max_u32 v31, v31, v247
    v_mfma_f32_16x16x32_bf16 v[44:47], a[252:255], v[236:239], v[44:47]
    v_cmp_eq_u32 vcc, -1, v31
    v_mfma_f32_16x16x32_bf16 v[72:75], v[232:235], v[232:235], v[72:75]
    ds_read_b128 a[252:255], v3 offset:1024
    v_mfma_f32_16x16x32_bf16 v[76:79], v[236:239], v[236:239], v[76:79]
    s_cbranch_vccnz L_inte_xretry_148
L_inte_xback_149:
    s_waitcnt lgkmcnt(8)
    v_mfma_f32_16x16x32_bf16 v[64:67], a[220:223], v[240:243], v[64:67]
    s_waitcnt vmcnt(5)
    v_mfma_f32_16x16x32_bf16 v[68:71], a[220:223], v[244:247], v[68:71]
    v_max3_u32 v31, v248, v249, v250
    v_mfma_f32_16x16x32_bf16 v[32:35], a[224:227], v[240:243], v[32:35]
    ds_read_b128 a[220:223], v3 offset:21504
    v_max3_u32 v31, v31, v251, v252
    v_mfma_f32_16x16x32_bf16 v[40:43], a[224:227], v[244:247], v[40:43]
    v_max3_u32 v31, v31, v253, v254
    v_mfma_f32_16x16x32_bf16 v[36:39], a[228:231], v[240:243], v[36:39]
    ds_read_b128 a[224:227], v3 offset:2048
    v_max_u32 v31, v31, v255
    v_mfma_f32_16x16x32_bf16 v[44:47], a[228:231], v[244:247], v[44:47]
    v_cmp_eq_u32 vcc, -1, v31
    v_mfma_f32_16x16x32_bf16 v[72:75], v[240:243], v[240:243], v[72:75]
    ds_read_b128 a[228:231], v3 offset:22528
    v_mfma_f32_16x16x32_bf16 v[76:79], v[244:247], v[244:247], v[76:79]
    s_cbranch_vccnz L_inte_xretry_150
L_inte_xback_151:
    s_waitcnt lgkmcnt(6)
    v_mfma_f32_16x16x32_bf16 v[64:67], a[232:235], v[248:251], v[64:67]
    v_mfma_f32_16x16x32_bf16 v[68:71], a[232:235], v[252:255], v[68:71]
    v_mfma_f32_16x16x32_bf16 v[32:35], a[236:239], v[248:251], v[32:35]
    ds_read_b128 a[232:235], v3 offset:3072
    v_mfma_f32_16x16x32_bf16 v[40:43], a[236:239], v[252:255], v[40:43]
    v_mfma_f32_16x16x32_bf16 v[36:39], a[240:243], v[248:251], v[36:39]
    ds_read_b128 a[236:239], v3 offset:23552
    v_mfma_f32_16x16x32_bf16 v[44:47], a[240:243], v[252:255], v[44:47]
    v_mfma_f32_16x16x32_bf16 v[72:75], v[248:251], v[248:251], v[72:75]
    ds_read_b128 a[240:243], v3 offset:4096
    v_mfma_f32_16x16x32_bf16 v[76:79], v[252:255], v[252:255], v[76:79]
    s_waitcnt lgkmcnt(5)
    s_barrier
    v_mfma_f32_16x16x32_bf16 v[48:51], a[244:247], v[96:99], 0
    s_set_gpr_idx_on s78, gpr_idx(SRC0,SRC1)
    v_perm_b32 v26, v232, v224, s79
    v_perm_b32 v27, v248, v240, s79
    s_set_gpr_idx_off
    ds_write2_b32 v24, v26, v27 offset0:32 offset1:36
    v_mfma_f32_16x16x32_bf16 v[56:59], a[244:247], v[100:103], 0
    s_set_gpr_idx_on s78, gpr_idx(SRC0,SRC1)
    v_perm_b32 v28, v236, v228, s79
    v_perm_b32 v29, v252, v244, s79
    s_set_gpr_idx_off
    ds_write2_b32 v25, v28, v29 offset0:32 offset1:36
    v_mfma_f32_16x16x32_bf16 v[52:55], a[248:251], v[96:99], 0
    ds_read_b128 a[244:247], v3 offset:24576
    s_mul_i32 s91, s3, 15360
    s_add_u32 s91, s91, 7168
    s_add_u32 m0, s91, 0
    s_add_u32 s89, s44, s87
    buffer_load_dwordx4 v1, s[8:11], s89 offen offset:0 lds
    v_mfma_f32_16x16x32_bf16 v[60:63], a[248:251], v[100:103], 0
    ds_bpermute_b32 v24, v10, v64
    ds_bpermute_b32 v28, v10, v68
    v_cndmask_b32 v72, v72, v73, s[92:93]
    v_mfma_f32_16x16x32_bf16 v[48:51], a[252:255], v[104:107], v[48:51]
    ds_read_b128 a[248:251], v3 offset:5120
    v_cndmask_b32 v76, v76, v77, s[92:93]
    v_cndmask_b32 v72, v72, v74, s[94:95]
    v_mfma_f32_16x16x32_bf16 v[56:59], a[252:255], v[108:111], v[56:59]
    v_cndmask_b32 v76, v76, v78, s[94:95]
    v_cndmask_b32 v72, v72, v75, s[96:97]
    v_mfma_f32_16x16x32_bf16 v[52:55], a[220:223], v[104:107], v[52:55]
    ds_read_b128 a[252:255], v3 offset:25600
    v_cndmask_b32 v76, v76, v79, s[96:97]
    ds_bpermute_b32 v73, v7, v72
    buffer_load_dwordx4 v1, s[8:11], s89 offen offset:1024 lds
    v_mfma_f32_16x16x32_bf16 v[60:63], a[220:223], v[108:111], v[60:63]
    ds_bpermute_b32 v77, v7, v76
    v_mov_b32 v19, 0
    v_mov_b32 v23, 0
    s_waitcnt lgkmcnt(10)
    v_mfma_f32_16x16x32_bf16 v[48:51], a[224:227], v[112:115], v[48:51]
    ds_read_b128 a[220:223], v1 offset:1024
    s_waitcnt lgkmcnt(6)
    v_mul_f32 v24, 0xbacccccd, v24
    s_waitcnt lgkmcnt(5)
    v_mul_f32 v28, 0xbacccccd, v28
    v_mfma_f32_16x16x32_bf16 v[56:59], a[224:227], v[116:119], v[56:59]
    v_cvt_pk_bf16_f32 v16, v24, v24
    v_cvt_pk_bf16_f32 v20, v28, v28
    v_mfma_f32_16x16x32_bf16 v[52:55], a[228:231], v[112:115], v[52:55]
    ds_read_b128 a[224:227], v1 offset:2048
    v_lshlrev_b32 v25, 16, v16
    v_lshlrev_b32 v29, 16, v20
    buffer_load_dwordx4 v1, s[8:11], s89 offen offset:2048 lds
    v_mfma_f32_16x16x32_bf16 v[60:63], a[228:231], v[116:119], v[60:63]
    v_sub_f32 v25, v24, v25
    v_sub_f32 v29, v28, v29
    v_mfma_f32_16x16x32_bf16 v[48:51], a[232:235], v[120:123], v[48:51]
    ds_read_b128 a[228:231], v1 offset:0
    s_waitcnt lgkmcnt(4)
    v_mul_f32 v72, 0x3acccccd, v73
    s_waitcnt lgkmcnt(3)
    v_mul_f32 v76, 0x3acccccd, v77
    v_fma_f32 v72, -v24, v24, v72
    v_mfma_f32_16x16x32_bf16 v[56:59], a[232:235], v[124:127], v[56:59]
    v_fma_f32 v76, -v28, v28, v76
    v_max_f32 v72, 0, v72
    v_mfma_f32_16x16x32_bf16 v[52:55], a[236:239], v[120:123], v[52:55]
    ds_read_b128 a[232:235], v3 offset:6144
    v_max_f32 v76, 0, v76
    v_add_f32 v72, 0x3727c5ac, v72
    buffer_load_dwordx4 v1, s[8:11], s89 offen offset:3072 lds
    v_mfma_f32_16x16x32_bf16 v[60:63], a[236:239], v[124:127], v[60:63]
    v_add_f32 v76, 0x3727c5ac, v76
    v_sqrt_f32 v26, v72
    v_mfma_f32_16x16x32_bf16 v[48:51], a[240:243], v[128:131], v[48:51]
    ds_read_b128 a[236:239], v3 offset:26624
    v_sqrt_f32 v30, v76
    v_rcp_f32 v72, v72
    v_mfma_f32_16x16x32_bf16 v[56:59], a[240:243], v[132:135], v[56:59]
    v_rcp_f32 v76, v76
    v_cvt_pk_bf16_f32 v17, v25, v26
    v_cvt_pk_bf16_f32 v21, v29, v30
    v_mfma_f32_16x16x32_bf16 v[52:55], a[244:247], v[128:131], v[52:55]
    ds_read_b128 a[240:243], v3 offset:7168
    v_and_b32 v27, 0xffff0000, v17
    v_and_b32 v31, 0xffff0000, v21
    s_add_u32 m0, s91, 4096
    s_add_u32 s89, s89, 4096
    buffer_load_dwordx4 v1, s[8:11], s89 offen offset:0 lds
    v_mfma_f32_16x16x32_bf16 v[60:63], a[244:247], v[132:135], v[60:63]
    v_sub_f32 v27, v26, v27
    v_sub_f32 v31, v30, v31
    v_mfma_f32_16x16x32_bf16 v[48:51], a[248:251], v[136:139], v[48:51]
    ds_read_b128 a[244:247], v3 offset:27648
    v_cvt_pk_bf16_f32 v18, v27, 0
    v_cvt_pk_bf16_f32 v22, v31, 0
    v_mfma_f32_16x16x32_bf16 v[56:59], a[248:251], v[140:143], v[56:59]
    ds_write_b32 v11, v72 offset:0
    ds_write_b32 v11, v76 offset:64
    v_mfma_f32_16x16x32_bf16 v[52:55], a[252:255], v[136:139], v[52:55]
    ds_read_b128 a[248:251], v3 offset:8192
    s_add_u32 m0, s91, 5120
    s_add_u32 s89, s45, s87
    buffer_load_dwordx4 v1, s[8:11], s89 offen offset:0 lds
    v_mfma_f32_16x16x32_bf16 v[60:63], a[252:255], v[140:143], v[60:63]
    s_waitcnt lgkmcnt(7)
    v_mfma_f32_16x16x32_bf16 v[32:35], a[220:223], v[16:19], v[32:35]
    ds_read_b128 a[252:255], v3 offset:28672
    v_mfma_f32_16x16x32_bf16 v[40:43], a[220:223], v[20:23], v[40:43]
    v_mfma_f32_16x16x32_bf16 v[36:39], a[224:227], v[16:19], v[36:39]
    ds_read_b128 a[220:223], v3 offset:9216
    buffer_load_dwordx4 v1, s[8:11], s89 offen offset:1024 lds
    v_mfma_f32_16x16x32_bf16 v[44:47], a[224:227], v[20:23], v[44:47]
    v_mfma_f32_16x16x32_bf16 v[64:67], a[228:231], v[16:19], v[64:67]
    ds_read_b128 a[224:227], v3 offset:29696
    v_mfma_f32_16x16x32_bf16 v[68:71], a[228:231], v[20:23], v[68:71]
    s_waitcnt lgkmcnt(6)
    v_mfma_f32_16x16x32_bf16 v[48:51], a[232:235], v[144:147], v[48:51]
    ds_read_b128 a[228:231], v3 offset:10240
    buffer_load_dwordx4 v1, s[8:11], s89 offen offset:2048 lds
    v_mfma_f32_16x16x32_bf16 v[56:59], a[232:235], v[148:151], v[56:59]
    v_mfma_f32_16x16x32_bf16 v[52:55], a[236:239], v[144:147], v[52:55]
    ds_read_b128 a[232:235], v3 offset:30720
    s_mov_b32 s79, 0x80008000
    v_mul_f32 v32, -v32, |v32|
    v_mfma_f32_16x16x32_bf16 v[60:63], a[236:239], v[148:151], v[60:63]
    v_mul_f32 v33, -v33, |v33|
    v_mfma_f32_16x16x32_bf16 v[48:51], a[240:243], v[152:155], v[48:51]
    ds_read_b128 a[236:239], v3 offset:11264
    v_mul_f32 v34, -v34, |v34|
    v_mul_f32 v35, -v35, |v35|
    buffer_load_dwordx4 v1, s[8:11], s89 offen offset:3072 lds
    v_mfma_f32_16x16x32_bf16 v[56:59], a[240:243], v[156:159], v[56:59]
    v_mul_f32 v36, -v36, |v36|
    v_mfma_f32_16x16x32_bf16 v[52:55], a[244:247], v[152:155], v[52:55]
    ds_read_b128 a[240:243], v3 offset:31744
    v_mul_f32 v37, -v37, |v37|
    v_mul_f32 v38, -v38, |v38|
    v_mfma_f32_16x16x32_bf16 v[60:63], a[244:247], v[156:159], v[60:63]
    v_mul_f32 v39, -v39, |v39|
    s_waitcnt lgkmcnt(4)
    v_mfma_f32_16x16x32_bf16 v[48:51], a[248:251], v[160:163], v[48:51]
    ds_read_b128 a[244:247], v3 offset:12288
    v_cvt_pk_bf16_f32 v32, v32, v33
    v_cvt_pk_bf16_f32 v33, v34, v35
    s_add_u32 m0, s91, 9216
    s_add_u32 s89, s89, 4096
    buffer_load_dwordx4 v1, s[8:11], s89 offen offset:0 lds
    v_mfma_f32_16x16x32_bf16 v[56:59], a[248:251], v[164:167], v[56:59]
    v_cvt_pk_bf16_f32 v34, v36, v37
    v_mfma_f32_16x16x32_bf16 v[52:55], a[252:255], v[160:163], v[52:55]
    ds_read_b128 a[248:251], v3 offset:32768
    v_cvt_pk_bf16_f32 v35, v38, v39
    v_pk_max_u16 v32, v32, s79
    v_mfma_f32_16x16x32_bf16 v[60:63], a[252:255], v[164:167], v[60:63]
    v_pk_max_u16 v33, v33, s79
    v_mfma_f32_16x16x32_bf16 v[48:51], a[220:223], v[168:171], v[48:51]
    ds_read_b128 a[252:255], v3 offset:13312
    v_pk_max_u16 v34, v34, s79
    v_pk_max_u16 v35, v35, s79
    s_add_u32 m0, s91, 10240
    s_add_u32 s89, s46, s87
    buffer_load_dwordx4 v1, s[8:11], s89 offen offset:0 lds
    v_mfma_f32_16x16x32_bf16 v[56:59], a[220:223], v[172:175], v[56:59]
    buffer_store_dwordx4 v[32:35], v1, s[8:11], s76 offen offset:0 sc1
    v_mfma_f32_16x16x32_bf16 v[52:55], a[224:227], v[168:171], v[52:55]
    ds_read_b128 a[220:223], v3 offset:33792
    v_mul_f32 v40, -v40, |v40|
    v_mul_f32 v41, -v41, |v41|
    v_mfma_f32_16x16x32_bf16 v[60:63], a[224:227], v[172:175], v[60:63]
    v_mul_f32 v42, -v42, |v42|
    s_waitcnt lgkmcnt(4)
    v_mfma_f32_16x16x32_bf16 v[48:51], a[228:231], v[176:179], v[48:51]
    ds_read_b128 a[224:227], v3 offset:14336
    v_mul_f32 v43, -v43, |v43|
    v_mul_f32 v44, -v44, |v44|
    buffer_load_dwordx4 v1, s[8:11], s89 offen offset:1024 lds
    v_mfma_f32_16x16x32_bf16 v[56:59], a[228:231], v[180:183], v[56:59]
    v_mul_f32 v45, -v45, |v45|
    v_mfma_f32_16x16x32_bf16 v[52:55], a[232:235], v[176:179], v[52:55]
    ds_read_b128 a[228:231], v3 offset:34816
    v_mul_f32 v46, -v46, |v46|
    v_mul_f32 v47, -v47, |v47|
    v_mfma_f32_16x16x32_bf16 v[60:63], a[232:235], v[180:183], v[60:63]
    v_cvt_pk_bf16_f32 v40, v40, v41
    v_mfma_f32_16x16x32_bf16 v[48:51], a[236:239], v[184:187], v[48:51]
    ds_read_b128 a[232:235], v3 offset:15360
    v_cvt_pk_bf16_f32 v41, v42, v43
    v_cvt_pk_bf16_f32 v42, v44, v45
    buffer_load_dwordx4 v1, s[8:11], s89 offen offset:2048 lds
    v_mfma_f32_16x16x32_bf16 v[56:59], a[236:239], v[188:191], v[56:59]
    v_cvt_pk_bf16_f32 v43, v46, v47
    v_mfma_f32_16x16x32_bf16 v[52:55], a[240:243], v[184:187], v[52:55]
    ds_read_b128 a[236:239], v3 offset:35840
    v_pk_max_u16 v40, v40, s79
    v_pk_max_u16 v41, v41, s79
    v_mfma_f32_16x16x32_bf16 v[60:63], a[240:243], v[188:191], v[60:63]
    v_pk_max_u16 v42, v42, s79
    s_waitcnt lgkmcnt(4)
    v_mfma_f32_16x16x32_bf16 v[48:51], a[244:247], v[192:195], v[48:51]
    ds_read_b128 a[240:243], v3 offset:16384
    v_pk_max_u16 v43, v43, s79
    buffer_store_dwordx4 v[40:43], v1, s[8:11], s76 offen offset:1024 sc1
    buffer_load_dwordx4 v1, s[8:11], s89 offen offset:3072 lds
    v_mfma_f32_16x16x32_bf16 v[56:59], a[244:247], v[196:199], v[56:59]
    v_mul_f32 v64, -v64, |v64|
    v_mfma_f32_16x16x32_bf16 v[52:55], a[248:251], v[192:195], v[52:55]
    ds_read_b128 a[244:247], v3 offset:36864
    v_mul_f32 v65, -v65, |v65|
    v_mul_f32 v66, -v66, |v66|
    v_mfma_f32_16x16x32_bf16 v[60:63], a[248:251], v[196:199], v[60:63]
    v_mul_f32 v67, -v67, |v67|
    v_mfma_f32_16x16x32_bf16 v[48:51], a[252:255], v[200:203], v[48:51]
    ds_read_b128 a[248:251], v3 offset:17408
    v_cvt_pk_bf16_f32 v64, v64, v65
    v_cvt_pk_bf16_f32 v65, v66, v67
    s_add_u32 m0, s91, 14336
    s_add_u32 s89, s89, 4096
    buffer_load_dwordx4 v1, s[8:11], s89 offen offset:0 lds
    v_mfma_f32_16x16x32_bf16 v[56:59], a[252:255], v[204:207], v[56:59]
    v_pk_max_u16 v64, v64, s79
    v_mfma_f32_16x16x32_bf16 v[52:55], a[220:223], v[200:203], v[52:55]
    ds_read_b128 a[252:255], v3 offset:37888
    v_pk_max_u16 v65, v65, s79
    buffer_store_dwordx2 v[64:65], v6, s[8:11], s77 offen offset:0 sc1
    v_mfma_f32_16x16x32_bf16 v[60:63], a[220:223], v[204:207], v[60:63]
    v_mul_f32 v68, -v68, |v68|
    s_waitcnt lgkmcnt(4)
    v_mfma_f32_16x16x32_bf16 v[48:51], a[224:227], v[208:211], v[48:51]
    ds_read_b128 a[220:223], v3 offset:18432
    v_mul_f32 v69, -v69, |v69|
    v_mul_f32 v70, -v70, |v70|
    v_mfma_f32_16x16x32_bf16 v[56:59], a[224:227], v[212:215], v[56:59]
    v_mul_f32 v71, -v71, |v71|
    v_mfma_f32_16x16x32_bf16 v[52:55], a[228:231], v[208:211], v[52:55]
    ds_read_b128 a[224:227], v3 offset:38912
    v_cvt_pk_bf16_f32 v68, v68, v69
    v_cvt_pk_bf16_f32 v69, v70, v71
    v_mfma_f32_16x16x32_bf16 v[60:63], a[228:231], v[212:215], v[60:63]
    v_pk_max_u16 v68, v68, s79
    v_mfma_f32_16x16x32_bf16 v[48:51], a[232:235], v[216:219], v[48:51]
    ds_read_b128 a[228:231], v3 offset:19456
    v_pk_max_u16 v69, v69, s79
    buffer_store_dwordx2 v[68:69], v6, s[8:11], s77 offen offset:1024 sc1
    v_mfma_f32_16x16x32_bf16 v[56:59], a[232:235], v[220:223], v[56:59]
    v_mfma_f32_16x16x32_bf16 v[52:55], a[236:239], v[216:219], v[52:55]
    ds_read_b128 a[232:235], v3 offset:39936
    v_mfma_f32_16x16x32_bf16 v[60:63], a[236:239], v[220:223], v[60:63]
    s_waitcnt lgkmcnt(4)
    v_mfma_f32_16x16x32_bf16 v[48:51], a[240:243], v[224:227], v[48:51]
    ds_read_b128 a[236:239], v1 offset:3072
    v_mfma_f32_16x16x32_bf16 v[56:59], a[240:243], v[228:231], v[56:59]
    v_mfma_f32_16x16x32_bf16 v[52:55], a[244:247], v[224:227], v[52:55]
    ds_read_b128 a[240:243], v1 offset:4096
    v_mfma_f32_16x16x32_bf16 v[60:63], a[244:247], v[228:231], v[60:63]
    v_mfma_f32_16x16x32_bf16 v[48:51], a[248:251], v[232:235], v[48:51]
    ds_read_b128 a[244:247], v4 offset:0
    v_mfma_f32_16x16x32_bf16 v[56:59], a[248:251], v[236:239], v[56:59]
    v_mfma_f32_16x16x32_bf16 v[52:55], a[252:255], v[232:235], v[52:55]
    ds_read_b128 a[248:251], v4 offset:20480
    v_mfma_f32_16x16x32_bf16 v[60:63], a[252:255], v[236:239], v[60:63]
    s_waitcnt lgkmcnt(4)
    v_mfma_f32_16x16x32_bf16 v[48:51], a[220:223], v[240:243], v[48:51]
    ds_read_b128 a[252:255], v4 offset:1024
    v_mfma_f32_16x16x32_bf16 v[56:59], a[220:223], v[244:247], v[56:59]
    v_mfma_f32_16x16x32_bf16 v[52:55], a[224:227], v[240:243], v[52:55]
    ds_read_b128 a[220:223], v4 offset:21504
    v_mfma_f32_16x16x32_bf16 v[60:63], a[224:227], v[244:247], v[60:63]
    v_mfma_f32_16x16x32_bf16 v[48:51], a[228:231], v[248:251], v[48:51]
    ds_read_b128 a[224:227], v4 offset:2048
    v_mfma_f32_16x16x32_bf16 v[56:59], a[228:231], v[252:255], v[56:59]
    v_mfma_f32_16x16x32_bf16 v[52:55], a[232:235], v[248:251], v[52:55]
    ds_read_b128 a[228:231], v4 offset:22528
    v_mfma_f32_16x16x32_bf16 v[60:63], a[232:235], v[252:255], v[60:63]
    s_waitcnt lgkmcnt(6)
    v_mfma_f32_16x16x32_bf16 v[48:51], a[236:239], v[16:19], v[48:51]
    ds_read_b128 a[232:235], v4 offset:3072
    v_mfma_f32_16x16x32_bf16 v[56:59], a[236:239], v[20:23], v[56:59]
    v_mfma_f32_16x16x32_bf16 v[52:55], a[240:243], v[16:19], v[52:55]
    ds_read_b128 a[236:239], v4 offset:23552
    v_mfma_f32_16x16x32_bf16 v[60:63], a[240:243], v[20:23], v[60:63]
    s_waitcnt lgkmcnt(4)
    v_mfma_f32_16x16x32_bf16 v[80:83], a[244:247], v[96:99], 0
    ds_read_b128 a[240:243], v4 offset:4096
    v_mfma_f32_16x16x32_bf16 v[88:91], a[244:247], v[100:103], 0
    v_mfma_f32_16x16x32_bf16 v[84:87], a[248:251], v[96:99], 0
    ds_read_b128 a[244:247], v4 offset:24576
    v_mfma_f32_16x16x32_bf16 v[92:95], a[248:251], v[100:103], 0
    v_mfma_f32_16x16x32_bf16 v[80:83], a[252:255], v[104:107], v[80:83]
    ds_read_b128 a[248:251], v4 offset:5120
    v_mfma_f32_16x16x32_bf16 v[88:91], a[252:255], v[108:111], v[88:91]
    s_add_u32 s76, s76, 4096
    v_mul_f32 v48, -v48, |v48|
    v_mfma_f32_16x16x32_bf16 v[84:87], a[220:223], v[104:107], v[84:87]
    ds_read_b128 a[252:255], v4 offset:25600
    v_mul_f32 v49, -v49, |v49|
    v_mfma_f32_16x16x32_bf16 v[92:95], a[220:223], v[108:111], v[92:95]
    v_mul_f32 v50, -v50, |v50|
    v_mul_f32 v51, -v51, |v51|
    s_waitcnt lgkmcnt(4)
    v_mfma_f32_16x16x32_bf16 v[80:83], a[224:227], v[112:115], v[80:83]
    ds_read_b128 a[220:223], v4 offset:6144
    v_mul_f32 v52, -v52, |v52|
    v_mfma_f32_16x16x32_bf16 v[88:91], a[224:227], v[116:119], v[88:91]
    v_mul_f32 v53, -v53, |v53|
    v_mul_f32 v54, -v54, |v54|
    v_mfma_f32_16x16x32_bf16 v[84:87], a[228:231], v[112:115], v[84:87]
    ds_read_b128 a[224:227], v4 offset:26624
    v_mul_f32 v55, -v55, |v55|
    v_mfma_f32_16x16x32_bf16 v[92:95], a[228:231], v[116:119], v[92:95]
    v_cvt_pk_bf16_f32 v48, v48, v49
    v_cvt_pk_bf16_f32 v49, v50, v51
    v_mfma_f32_16x16x32_bf16 v[80:83], a[232:235], v[120:123], v[80:83]
    ds_read_b128 a[228:231], v4 offset:7168
    v_cvt_pk_bf16_f32 v50, v52, v53
    v_mfma_f32_16x16x32_bf16 v[88:91], a[232:235], v[124:127], v[88:91]
    v_cvt_pk_bf16_f32 v51, v54, v55
    v_pk_max_u16 v48, v48, s79
    v_mfma_f32_16x16x32_bf16 v[84:87], a[236:239], v[120:123], v[84:87]
    ds_read_b128 a[232:235], v4 offset:27648
    v_pk_max_u16 v49, v49, s79
    v_mfma_f32_16x16x32_bf16 v[92:95], a[236:239], v[124:127], v[92:95]
    v_pk_max_u16 v50, v50, s79
    v_pk_max_u16 v51, v51, s79
    s_waitcnt lgkmcnt(4)
    v_mfma_f32_16x16x32_bf16 v[80:83], a[240:243], v[128:131], v[80:83]
    ds_read_b128 a[236:239], v4 offset:8192
    buffer_store_dwordx4 v[48:51], v1, s[8:11], s76 offen offset:0 sc1
    v_mfma_f32_16x16x32_bf16 v[88:91], a[240:243], v[132:135], v[88:91]
    v_mul_f32 v56, -v56, |v56|
    v_mul_f32 v57, -v57, |v57|
    v_mfma_f32_16x16x32_bf16 v[84:87], a[244:247], v[128:131], v[84:87]
    ds_read_b128 a[240:243], v4 offset:28672
    v_mul_f32 v58, -v58, |v58|
    v_mfma_f32_16x16x32_bf16 v[92:95], a[244:247], v[132:135], v[92:95]
    v_mul_f32 v59, -v59, |v59|
    v_mul_f32 v60, -v60, |v60|
    v_mfma_f32_16x16x32_bf16 v[80:83], a[248:251], v[136:139], v[80:83]
    ds_read_b128 a[244:247], v4 offset:9216
    v_mul_f32 v61, -v61, |v61|
    v_mfma_f32_16x16x32_bf16 v[88:91], a[248:251], v[140:143], v[88:91]
    v_mul_f32 v62, -v62, |v62|
    v_mul_f32 v63, -v63, |v63|
    v_mfma_f32_16x16x32_bf16 v[84:87], a[252:255], v[136:139], v[84:87]
    ds_read_b128 a[248:251], v4 offset:29696
    v_cvt_pk_bf16_f32 v56, v56, v57
    v_mfma_f32_16x16x32_bf16 v[92:95], a[252:255], v[140:143], v[92:95]
    v_cvt_pk_bf16_f32 v57, v58, v59
    v_cvt_pk_bf16_f32 v58, v60, v61
    s_waitcnt lgkmcnt(4)
    v_mfma_f32_16x16x32_bf16 v[80:83], a[220:223], v[144:147], v[80:83]
    ds_read_b128 a[252:255], v4 offset:10240
    v_cvt_pk_bf16_f32 v59, v62, v63
    v_mfma_f32_16x16x32_bf16 v[88:91], a[220:223], v[148:151], v[88:91]
    v_pk_max_u16 v56, v56, s79
    v_pk_max_u16 v57, v57, s79
    v_mfma_f32_16x16x32_bf16 v[84:87], a[224:227], v[144:147], v[84:87]
    ds_read_b128 a[220:223], v4 offset:30720
    v_pk_max_u16 v58, v58, s79
    v_mfma_f32_16x16x32_bf16 v[92:95], a[224:227], v[148:151], v[92:95]
    v_pk_max_u16 v59, v59, s79
    buffer_store_dwordx4 v[56:59], v1, s[8:11], s76 offen offset:1024 sc1
    v_mfma_f32_16x16x32_bf16 v[80:83], a[228:231], v[152:155], v[80:83]
    ds_read_b128 a[224:227], v4 offset:11264
    s_lshl1_add_u32 s90, s39, s80
    buffer_load_dwordx4 v[96:99], v12, s[8:11], s90 offen sc1
    v_mfma_f32_16x16x32_bf16 v[88:91], a[228:231], v[156:159], v[88:91]
    v_mfma_f32_16x16x32_bf16 v[84:87], a[232:235], v[152:155], v[84:87]
    ds_read_b128 a[228:231], v4 offset:31744
    v_mfma_f32_16x16x32_bf16 v[92:95], a[232:235], v[156:159], v[92:95]
    s_waitcnt lgkmcnt(4)
    v_mfma_f32_16x16x32_bf16 v[80:83], a[236:239], v[160:163], v[80:83]
    ds_read_b128 a[232:235], v4 offset:12288
    buffer_load_dwordx4 v[100:103], v13, s[8:11], s90 offen sc1
    v_mfma_f32_16x16x32_bf16 v[88:91], a[236:239], v[164:167], v[88:91]
    v_mfma_f32_16x16x32_bf16 v[84:87], a[240:243], v[160:163], v[84:87]
    ds_read_b128 a[236:239], v4 offset:32768
    v_mfma_f32_16x16x32_bf16 v[92:95], a[240:243], v[164:167], v[92:95]
    v_mfma_f32_16x16x32_bf16 v[80:83], a[244:247], v[168:171], v[80:83]
    ds_read_b128 a[240:243], v4 offset:13312
    buffer_load_dwordx4 v[104:107], v14, s[8:11], s90 offen sc1
    v_mfma_f32_16x16x32_bf16 v[88:91], a[244:247], v[172:175], v[88:91]
    v_mfma_f32_16x16x32_bf16 v[84:87], a[248:251], v[168:171], v[84:87]
    ds_read_b128 a[244:247], v4 offset:33792
    v_mfma_f32_16x16x32_bf16 v[92:95], a[248:251], v[172:175], v[92:95]
    s_waitcnt lgkmcnt(4)
    v_mfma_f32_16x16x32_bf16 v[80:83], a[252:255], v[176:179], v[80:83]
    ds_read_b128 a[248:251], v4 offset:14336
    buffer_load_dwordx4 v[108:111], v15, s[8:11], s90 offen sc1
    v_mfma_f32_16x16x32_bf16 v[88:91], a[252:255], v[180:183], v[88:91]
    v_mfma_f32_16x16x32_bf16 v[84:87], a[220:223], v[176:179], v[84:87]
    ds_read_b128 a[252:255], v4 offset:34816
    v_mfma_f32_16x16x32_bf16 v[92:95], a[220:223], v[180:183], v[92:95]
    v_mfma_f32_16x16x32_bf16 v[80:83], a[224:227], v[184:187], v[80:83]
    ds_read_b128 a[220:223], v4 offset:15360
    s_lshl1_add_u32 s90, s40, s80
    buffer_load_dwordx4 v[112:115], v12, s[8:11], s90 offen sc1
    v_mfma_f32_16x16x32_bf16 v[88:91], a[224:227], v[188:191], v[88:91]
    v_mfma_f32_16x16x32_bf16 v[84:87], a[228:231], v[184:187], v[84:87]
    ds_read_b128 a[224:227], v4 offset:35840
    v_mfma_f32_16x16x32_bf16 v[92:95], a[228:231], v[188:191], v[92:95]
    s_waitcnt lgkmcnt(4)
    v_mfma_f32_16x16x32_bf16 v[80:83], a[232:235], v[192:195], v[80:83]
    ds_read_b128 a[228:231], v4 offset:16384
    buffer_load_dwordx4 v[116:119], v13, s[8:11], s90 offen sc1
    v_mfma_f32_16x16x32_bf16 v[88:91], a[232:235], v[196:199], v[88:91]
    v_mfma_f32_16x16x32_bf16 v[84:87], a[236:239], v[192:195], v[84:87]
    ds_read_b128 a[232:235], v4 offset:36864
    v_mfma_f32_16x16x32_bf16 v[92:95], a[236:239], v[196:199], v[92:95]
    v_mfma_f32_16x16x32_bf16 v[80:83], a[240:243], v[200:203], v[80:83]
    ds_read_b128 a[236:239], v4 offset:17408
    buffer_load_dwordx4 v[120:123], v14, s[8:11], s90 offen sc1
    v_mfma_f32_16x16x32_bf16 v[88:91], a[240:243], v[204:207], v[88:91]
    v_mfma_f32_16x16x32_bf16 v[84:87], a[244:247], v[200:203], v[84:87]
    ds_read_b128 a[240:243], v4 offset:37888
    v_mfma_f32_16x16x32_bf16 v[92:95], a[244:247], v[204:207], v[92:95]
    s_waitcnt lgkmcnt(4)
    v_mfma_f32_16x16x32_bf16 v[80:83], a[248:251], v[208:211], v[80:83]
    ds_read_b128 a[244:247], v4 offset:18432
    buffer_load_dwordx4 v[124:127], v15, s[8:11], s90 offen sc1
    v_mfma_f32_16x16x32_bf16 v[88:91], a[248:251], v[212:215], v[88:91]
    v_mfma_f32_16x16x32_bf16 v[84:87], a[252:255], v[208:211], v[84:87]
    ds_read_b128 a[248:251], v4 offset:38912
    v_mfma_f32_16x16x32_bf16 v[92:95], a[252:255], v[212:215], v[92:95]
    v_mfma_f32_16x16x32_bf16 v[80:83], a[220:223], v[216:219], v[80:83]
    ds_read_b128 a[252:255], v4 offset:19456
    s_lshl1_add_u32 s90, s41, s80
    buffer_load_dwordx4 v[128:131], v12, s[8:11], s90 offen sc1
    v_mfma_f32_16x16x32_bf16 v[88:91], a[220:223], v[220:223], v[88:91]
    v_mfma_f32_16x16x32_bf16 v[84:87], a[224:227], v[216:219], v[84:87]
    ds_read_b128 a[220:223], v4 offset:39936
    v_mfma_f32_16x16x32_bf16 v[92:95], a[224:227], v[220:223], v[92:95]
    s_waitcnt lgkmcnt(4)
    v_mfma_f32_16x16x32_bf16 v[80:83], a[228:231], v[224:227], v[80:83]
    ds_read_b128 a[224:227], v1 offset:5120
    buffer_load_dwordx4 v[132:135], v13, s[8:11], s90 offen sc1
    v_mfma_f32_16x16x32_bf16 v[88:91], a[228:231], v[228:231], v[88:91]
    v_mfma_f32_16x16x32_bf16 v[84:87], a[232:235], v[224:227], v[84:87]
    ds_read_b128 a[228:231], v1 offset:6144
    v_mfma_f32_16x16x32_bf16 v[92:95], a[232:235], v[228:231], v[92:95]
    v_mfma_f32_16x16x32_bf16 v[80:83], a[236:239], v[232:235], v[80:83]
    buffer_load_dwordx4 v[136:139], v14, s[8:11], s90 offen sc1
    v_mfma_f32_16x16x32_bf16 v[88:91], a[236:239], v[236:239], v[88:91]
    v_mfma_f32_16x16x32_bf16 v[84:87], a[240:243], v[232:235], v[84:87]
    v_mfma_f32_16x16x32_bf16 v[92:95], a[240:243], v[236:239], v[92:95]
    s_waitcnt lgkmcnt(2)
    v_mfma_f32_16x16x32_bf16 v[80:83], a[244:247], v[240:243], v[80:83]
    buffer_load_dwordx4 v[140:143], v15, s[8:11], s90 offen sc1
    v_mfma_f32_16x16x32_bf16 v[88:91], a[244:247], v[244:247], v[88:91]
    v_mfma_f32_16x16x32_bf16 v[84:87], a[248:251], v[240:243], v[84:87]
    s_waitcnt vmcnt(8)
    v_mfma_f32_16x16x32_bf16 v[92:95], a[248:251], v[244:247], v[92:95]
    v_min3_u32 v10, v96, v97, v98
    v_min3_u32 v10, v10, v99, v100
    v_mfma_f32_16x16x32_bf16 v[80:83], a[252:255], v[248:251], v[80:83]
    s_lshl1_add_u32 s90, s42, s80
    buffer_load_dwordx4 v[144:147], v12, s[8:11], s90 offen sc1
    v_min3_u32 v10, v10, v101, v102
    v_mfma_f32_16x16x32_bf16 v[88:91], a[252:255], v[252:255], v[88:91]
    v_min3_u32 v10, v10, v103, v104
    v_min3_u32 v10, v10, v105, v106
    v_mfma_f32_16x16x32_bf16 v[84:87], a[220:223], v[248:251], v[84:87]
    v_min3_u32 v10, v10, v107, v108
    v_mfma_f32_16x16x32_bf16 v[92:95], a[220:223], v[252:255], v[92:95]
    v_min3_u32 v10, v10, v109, v110
    v_min_u32 v10, v10, v111
    s_waitcnt lgkmcnt(0)
    v_mfma_f32_16x16x32_bf16 v[80:83], a[224:227], v[16:19], v[80:83]
    buffer_load_dwordx4 v[148:151], v13, s[8:11], s90 offen sc1
    v_cmp_le_i32 vcc, 0, v10
    v_mfma_f32_16x16x32_bf16 v[88:91], a[224:227], v[20:23], v[88:91]
    v_mfma_f32_16x16x32_bf16 v[84:87], a[228:231], v[16:19], v[84:87]
    v_mfma_f32_16x16x32_bf16 v[92:95], a[228:231], v[20:23], v[92:95]
    s_lshl_b32 s88, s71, 12
    s_add_u32 s76, s77, s88
    s_add_u32 s76, s76, 131072
L_g2_1:
    s_cbranch_vccnz L_inte_retry_152
L_inte_back_153:
    v_mfma_f32_16x16x32_bf16 v[16:19], a[0:3], v[96:99], 0
    v_mfma_f32_16x16x32_bf16 v[20:23], a[4:7], v[96:99], 0
    buffer_load_dwordx4 v[152:155], v14, s[8:11], s90 offen sc1
    v_mfma_f32_16x16x32_bf16 v[24:27], a[8:11], v[96:99], 0
    v_mul_f32 v80, -v80, |v80|
    v_mul_f32 v81, -v81, |v81|
    v_mul_f32 v82, -v82, |v82|
    v_mfma_f32_16x16x32_bf16 v[28:31], a[12:15], v[96:99], 0
    v_mul_f32 v83, -v83, |v83|
    v_mul_f32 v84, -v84, |v84|
    v_mul_f32 v85, -v85, |v85|
    v_mfma_f32_16x16x32_bf16 v[32:35], a[16:19], v[96:99], 0
    v_mul_f32 v86, -v86, |v86|
    v_mul_f32 v87, -v87, |v87|
    v_mfma_f32_16x16x32_bf16 v[36:39], a[0:3], v[100:103], 0
    v_cvt_pk_bf16_f32 v80, v80, v81
    v_cvt_pk_bf16_f32 v81, v82, v83
    v_cvt_pk_bf16_f32 v82, v84, v85
    buffer_load_dwordx4 v[156:159], v15, s[8:11], s90 offen sc1
    v_mfma_f32_16x16x32_bf16 v[40:43], a[4:7], v[100:103], 0
    v_cvt_pk_bf16_f32 v83, v86, v87
    v_pk_max_u16 v80, v80, s79
    v_pk_max_u16 v81, v81, s79
    v_mfma_f32_16x16x32_bf16 v[44:47], a[8:11], v[100:103], 0
    s_waitcnt vmcnt(8)
    v_pk_max_u16 v82, v82, s79
    v_pk_max_u16 v83, v83, s79
    v_mfma_f32_16x16x32_bf16 v[48:51], a[12:15], v[100:103], 0
    v_min3_u32 v10, v112, v113, v114
    buffer_store_dwordx4 v[80:83], v1, s[8:11], s76 offen offset:0 sc1
    v_mul_f32 v88, -v88, |v88|
    v_mul_f32 v89, -v89, |v89|
    v_mfma_f32_16x16x32_bf16 v[52:55], a[16:19], v[100:103], 0
    v_min3_u32 v10, v10, v115, v116
    v_mul_f32 v90, -v90, |v90|
    v_mul_f32 v91, -v91, |v91|
    s_mov_b32 s90, s81
    buffer_load_dwordx4 v[160:163], v12, s[8:11], s90 offen sc1
    v_mfma_f32_16x16x32_bf16 v[56:59], a[0:3], v[104:107], 0
    v_min3_u32 v10, v10, v117, v118
    v_mul_f32 v92, -v92, |v92|
    v_mul_f32 v93, -v93, |v93|
    v_mul_f32 v94, -v94, |v94|
    v_mfma_f32_16x16x32_bf16 v[60:63], a[4:7], v[104:107], 0
    v_min3_u32 v10, v10, v119, v120
    v_mul_f32 v95, -v95, |v95|
    v_cvt_pk_bf16_f32 v88, v88, v89
    v_cvt_pk_bf16_f32 v89, v90, v91
    v_mfma_f32_16x16x32_bf16 v[64:67], a[8:11], v[104:107], 0
    v_min3_u32 v10, v10, v121, v122
    v_cvt_pk_bf16_f32 v90, v92, v93
    v_cvt_pk_bf16_f32 v91, v94, v95
    v_mfma_f32_16x16x32_bf16 v[68:71], a[12:15], v[104:107], 0
    v_min3_u32 v10, v10, v123, v124
    v_pk_max_u16 v88, v88, s79
    v_pk_max_u16 v89, v89, s79
    v_pk_max_u16 v90, v90, s79
    buffer_load_dwordx4 v[164:167], v13, s[8:11], s90 offen sc1
    v_mfma_f32_16x16x32_bf16 v[72:75], a[16:19], v[104:107], 0
    v_min3_u32 v10, v10, v125, v126
    v_pk_max_u16 v91, v91, s79
    buffer_store_dwordx4 v[88:91], v1, s[8:11], s76 offen offset:1024 sc1
    v_mfma_f32_16x16x32_bf16 v[76:79], a[0:3], v[108:111], 0
    v_min_u32 v10, v10, v127
    v_mfma_f32_16x16x32_bf16 v[80:83], a[4:7], v[108:111], 0
    v_cmp_le_i32 vcc, 0, v10
    v_mfma_f32_16x16x32_bf16 v[84:87], a[8:11], v[108:111], 0
    buffer_load_dwordx4 v[168:171], v14, s[8:11], s90 offen sc1
    v_mfma_f32_16x16x32_bf16 v[88:91], a[12:15], v[108:111], 0
    v_mfma_f32_16x16x32_bf16 v[92:95], a[16:19], v[108:111], 0
    s_waitcnt lgkmcnt(0)
    s_barrier
    s_cbranch_vccnz L_inte_retry_154
L_inte_back_155:
    v_mfma_f32_16x16x32_bf16 v[16:19], a[20:23], v[112:115], v[16:19]
    v_lshrrev_b32 v248, 4, v0
    s_mul_i32 s74, s73, 320
    s_add_u32 s74, s74, 0x2348a00
    s_add_u32 m0, s69, 146432
    s_mov_b64 exec, 0xfffff
    buffer_load_dwordx4 v1, s[8:11], s74 offen lds
    s_mov_b64 exec, -1
    s_mul_i32 s88, s3, 15360
    s_add_u32 s88, s88, 7168
    v_add_u32 v11, s88, v1
    v_mfma_f32_16x16x32_bf16 v[20:23], a[24:27], v[112:115], v[20:23]
    buffer_load_dwordx4 v[172:175], v15, s[8:11], s90 offen sc1
    v_mfma_f32_16x16x32_bf16 v[24:27], a[28:31], v[112:115], v[24:27]
    s_add_u32 s74, s69, 146432
    v_mul_u32_u24 v249, 80, v248
    v_mfma_f32_16x16x32_bf16 v[28:31], a[32:35], v[112:115], v[28:31]
    v_add_u32 v249, s74, v249
    v_and_b32 v250, 15, v0
    v_mfma_f32_16x16x32_bf16 v[32:35], a[36:39], v[112:115], v[32:35]
    s_lshl_b32 s92, s70, 3
    s_lshl_b32 s74, s72, 2
    v_mfma_f32_16x16x32_bf16 v[36:39], a[20:23], v[116:119], v[36:39]
    s_mov_b32 s90, s82
    buffer_load_dwordx4 v[176:179], v12, s[8:11], s90 offen sc1
    v_mfma_f32_16x16x32_bf16 v[40:43], a[24:27], v[116:119], v[40:43]
    s_add_u32 s92, s92, s74
    s_add_u32 s92, s92, s3
    v_mfma_f32_16x16x32_bf16 v[44:47], a[28:31], v[116:119], v[44:47]
    s_waitcnt vmcnt(12)
    v_mfma_f32_16x16x32_bf16 v[48:51], a[32:35], v[116:119], v[48:51]
    v_min3_u32 v10, v128, v129, v130
    v_mfma_f32_16x16x32_bf16 v[52:55], a[36:39], v[116:119], v[52:55]
    v_min3_u32 v10, v10, v131, v132
    buffer_load_dwordx4 v[180:183], v13, s[8:11], s90 offen sc1
    v_mfma_f32_16x16x32_bf16 v[56:59], a[20:23], v[120:123], v[56:59]
    v_min3_u32 v10, v10, v133, v134
    v_mfma_f32_16x16x32_bf16 v[60:63], a[24:27], v[120:123], v[60:63]
    v_min3_u32 v10, v10, v135, v136
    v_mfma_f32_16x16x32_bf16 v[64:67], a[28:31], v[120:123], v[64:67]
    v_min3_u32 v10, v10, v137, v138
    v_mfma_f32_16x16x32_bf16 v[68:71], a[32:35], v[120:123], v[68:71]
    v_min3_u32 v10, v10, v139, v140
    s_lshl1_add_u32 s90, s39, s24
    buffer_load_dwordx4 v[192:195], v12, s[8:11], s90 offen sc1
    v_mfma_f32_16x16x32_bf16 v[72:75], a[36:39], v[120:123], v[72:75]
    v_min3_u32 v10, v10, v141, v142
    v_mfma_f32_16x16x32_bf16 v[76:79], a[20:23], v[124:127], v[76:79]
    v_min_u32 v10, v10, v143
    v_mfma_f32_16x16x32_bf16 v[80:83], a[24:27], v[124:127], v[80:83]
    v_cmp_le_i32 vcc, 0, v10
    v_mfma_f32_16x16x32_bf16 v[84:87], a[28:31], v[124:127], v[84:87]
    buffer_load_dwordx4 v[196:199], v13, s[8:11], s90 offen sc1
    v_mul_u32_u24 v251, 160, v250
    s_mul_i32 s74, s3, 2560
    v_mfma_f32_16x16x32_bf16 v[88:91], a[32:35], v[124:127], v[88:91]
    s_add_u32 s74, s74, 152064
    v_add_u32 v251, s74, v251
    v_mfma_f32_16x16x32_bf16 v[92:95], a[36:39], v[124:127], v[92:95]
    v_lshl_add_u32 v252, v248, 4, v251
    v_lshrrev_b32 v253, 5, v0
    s_cbranch_vccnz L_inte_retry_156
L_inte_back_157:
    v_mfma_f32_16x16x32_bf16 v[16:19], a[40:43], v[128:131], v[16:19]
    v_lshl_add_u32 v253, v253, 4, v251
    ds_read_b128 v[236:239], v252
    v_mfma_f32_16x16x32_bf16 v[20:23], a[44:47], v[128:131], v[20:23]
    buffer_load_dwordx4 v[200:203], v14, s[8:11], s90 offen sc1
    v_mfma_f32_16x16x32_bf16 v[24:27], a[48:51], v[128:131], v[24:27]
    ds_read_b128 v[240:243], v252 offset:64
    ds_read_b128 v[244:247], v253 offset:128
    ds_read_b128 a[220:223], v11 offset:0
    v_mfma_f32_16x16x32_bf16 v[28:31], a[52:55], v[128:131], v[28:31]
    v_and_b32 v252, 16, v0
    v_xor_b32 v252, 16, v252
    ds_read_b128 a[224:227], v11 offset:1024
    v_mfma_f32_16x16x32_bf16 v[32:35], a[56:59], v[128:131], v[32:35]
    s_lshl_b32 s74, s72, 2
    s_add_u32 s74, s74, s3
    ds_read_b128 a[228:231], v11 offset:2048
    v_mfma_f32_16x16x32_bf16 v[36:39], a[40:43], v[132:135], v[36:39]
    buffer_load_dwordx4 v[204:207], v15, s[8:11], s90 offen sc1
    ds_read_b128 a[232:235], v11 offset:3072
    v_mfma_f32_16x16x32_bf16 v[40:43], a[44:47], v[132:135], v[40:43]
    s_lshl_b32 s74, s74, 6
    s_add_u32 s74, s74, 151552
    ds_read_b128 a[236:239], v11 offset:4096
    v_mfma_f32_16x16x32_bf16 v[44:47], a[48:51], v[132:135], v[44:47]
    s_waitcnt vmcnt(13)
    v_mfma_f32_16x16x32_bf16 v[48:51], a[52:55], v[132:135], v[48:51]
    v_min3_u32 v10, v144, v145, v146
    v_mfma_f32_16x16x32_bf16 v[52:55], a[56:59], v[132:135], v[52:55]
    v_min3_u32 v10, v10, v147, v148
    s_lshl1_add_u32 s90, s40, s24
    buffer_load_dwordx4 v[96:99], v12, s[8:11], s90 offen sc1
    v_mfma_f32_16x16x32_bf16 v[56:59], a[40:43], v[136:139], v[56:59]
    v_min3_u32 v10, v10, v149, v150
    v_mfma_f32_16x16x32_bf16 v[60:63], a[44:47], v[136:139], v[60:63]
    v_min3_u32 v10, v10, v151, v152
    v_mfma_f32_16x16x32_bf16 v[64:67], a[48:51], v[136:139], v[64:67]
    v_min3_u32 v10, v10, v153, v154
    v_mfma_f32_16x16x32_bf16 v[68:71], a[52:55], v[136:139], v[68:71]
    v_min3_u32 v10, v10, v155, v156
    buffer_load_dwordx4 v[100:103], v13, s[8:11], s90 offen sc1
    v_mfma_f32_16x16x32_bf16 v[72:75], a[56:59], v[136:139], v[72:75]
    v_min3_u32 v10, v10, v157, v158
    v_mfma_f32_16x16x32_bf16 v[76:79], a[40:43], v[140:143], v[76:79]
    v_min_u32 v10, v10, v159
    v_mfma_f32_16x16x32_bf16 v[80:83], a[44:47], v[140:143], v[80:83]
    v_cmp_le_i32 vcc, 0, v10
    v_mfma_f32_16x16x32_bf16 v[84:87], a[48:51], v[140:143], v[84:87]
    buffer_load_dwordx4 v[104:107], v14, s[8:11], s90 offen sc1
    v_lshl_add_u32 v251, v250, 2, s74
    ds_read_b32 v254, v251
    v_mfma_f32_16x16x32_bf16 v[88:91], a[52:55], v[140:143], v[88:91]
    s_add_u32 s74, s3, 1
    s_and_b32 s74, s74, 3
    v_mfma_f32_16x16x32_bf16 v[92:95], a[56:59], v[140:143], v[92:95]
    s_mul_i32 s74, s74, 15360
    s_add_u32 s74, s74, 68608
    s_cbranch_vccnz L_inte_retry_158
L_inte_back_159:
    v_mfma_f32_16x16x32_bf16 v[16:19], a[60:63], v[144:147], v[16:19]
    v_add_u32 v2, s74, v1
    s_add_u32 s74, s3, 2
    v_mfma_f32_16x16x32_bf16 v[20:23], a[64:67], v[144:147], v[20:23]
    buffer_load_dwordx4 v[108:111], v15, s[8:11], s90 offen sc1
    v_mfma_f32_16x16x32_bf16 v[24:27], a[68:71], v[144:147], v[24:27]
    s_and_b32 s74, s74, 3
    s_mul_i32 s74, s74, 15360
    ds_read_b128 a[0:3], v11 offset:5120
    v_mfma_f32_16x16x32_bf16 v[28:31], a[72:75], v[144:147], v[28:31]
    s_add_u32 s74, s74, 73728
    v_add_u32 v3, s74, v1
    ds_read_b128 a[4:7], v11 offset:6144
    v_mfma_f32_16x16x32_bf16 v[32:35], a[76:79], v[144:147], v[32:35]
    s_add_u32 s74, s3, 3
    s_and_b32 s74, s74, 3
    ds_read_b128 a[8:11], v11 offset:7168
    v_mfma_f32_16x16x32_bf16 v[36:39], a[60:63], v[148:151], v[36:39]
    s_lshl1_add_u32 s90, s41, s24
    buffer_load_dwordx4 v[112:115], v12, s[8:11], s90 offen sc1
    ds_read_b128 a[12:15], v11 offset:8192
    v_mfma_f32_16x16x32_bf16 v[40:43], a[64:67], v[148:151], v[40:43]
    s_mul_i32 s74, s74, 15360
    s_add_u32 s74, s74, 78848
    ds_read_b128 a[16:19], v11 offset:9216
    v_mfma_f32_16x16x32_bf16 v[44:47], a[68:71], v[148:151], v[44:47]
    s_waitcnt vmcnt(11)
    v_mfma_f32_16x16x32_bf16 v[48:51], a[72:75], v[148:151], v[48:51]
    v_min3_u32 v10, v160, v161, v162
    v_mfma_f32_16x16x32_bf16 v[52:55], a[76:79], v[148:151], v[52:55]
    v_min3_u32 v10, v10, v163, v164
    buffer_load_dwordx4 v[116:119], v13, s[8:11], s90 offen sc1
    v_mfma_f32_16x16x32_bf16 v[56:59], a[60:63], v[152:155], v[56:59]
    v_min3_u32 v10, v10, v165, v166
    v_mfma_f32_16x16x32_bf16 v[60:63], a[64:67], v[152:155], v[60:63]
    v_min3_u32 v10, v10, v167, v168
    v_mfma_f32_16x16x32_bf16 v[64:67], a[68:71], v[152:155], v[64:67]
    v_min3_u32 v10, v10, v169, v170
    v_mfma_f32_16x16x32_bf16 v[68:71], a[72:75], v[152:155], v[68:71]
    v_min3_u32 v10, v10, v171, v172
    buffer_load_dwordx4 v[120:123], v14, s[8:11], s90 offen sc1
    v_mfma_f32_16x16x32_bf16 v[72:75], a[76:79], v[152:155], v[72:75]
    v_min3_u32 v10, v10, v173, v174
    v_mfma_f32_16x16x32_bf16 v[76:79], a[60:63], v[156:159], v[76:79]
    v_min_u32 v10, v10, v175
    v_mfma_f32_16x16x32_bf16 v[80:83], a[64:67], v[156:159], v[80:83]
    v_cmp_le_i32 vcc, 0, v10
    v_mfma_f32_16x16x32_bf16 v[84:87], a[68:71], v[156:159], v[84:87]
    buffer_load_dwordx4 v[124:127], v15, s[8:11], s90 offen sc1
    v_add_u32 v4, s74, v1
    s_mul_i32 s74, s3, 15360
    v_mfma_f32_16x16x32_bf16 v[88:91], a[72:75], v[156:159], v[88:91]
    s_add_u32 s74, s74, 68608
    v_add_u32 v5, s74, v1
    v_mfma_f32_16x16x32_bf16 v[92:95], a[76:79], v[156:159], v[92:95]
    s_mov_b32 s12, s32
    s_mov_b32 s13, s33
    s_cbranch_vccnz L_inte_retry_160
L_inte_back_161:
    v_mfma_f32_16x16x32_bf16 v[16:19], a[80:83], v[160:163], v[16:19]
    s_mov_b32 s14, 0x280000
    s_mov_b32 s15, 0x00020000
    v_mfma_f32_16x16x32_bf16 v[20:23], a[84:87], v[160:163], v[20:23]
    s_lshl1_add_u32 s90, s42, s24
    buffer_load_dwordx4 v[128:131], v12, s[8:11], s90 offen sc1
    v_mfma_f32_16x16x32_bf16 v[24:27], a[88:91], v[160:163], v[24:27]
    v_and_b32 v212, 7, v0
    v_bfe_u32 v213, v0, 3, 1
    ds_read_b128 a[20:23], v11 offset:10240
    v_mfma_f32_16x16x32_bf16 v[28:31], a[92:95], v[160:163], v[28:31]
    v_lshl_add_u32 v212, v212, 1, v213
    v_mul_u32_u24 v212, 40960, v212
    ds_read_b128 a[24:27], v11 offset:11264
    v_mfma_f32_16x16x32_bf16 v[32:35], a[96:99], v[160:163], v[32:35]
    v_lshl_add_u32 v213, v248, 4, v212
    v_lshl_add_u32 v212, v248, 3, v212
    ds_read_b128 a[28:31], v11 offset:12288
    v_mfma_f32_16x16x32_bf16 v[36:39], a[80:83], v[164:167], v[36:39]
    buffer_load_dwordx4 v[132:135], v13, s[8:11], s90 offen sc1
    ds_read_b128 a[32:35], v11 offset:13312
    v_mfma_f32_16x16x32_bf16 v[40:43], a[84:87], v[164:167], v[40:43]
    s_lshr_b32 s74, s92, 5
    s_lshl_b32 s74, s74, 9
    ds_read_b128 a[36:39], v11 offset:14336
    v_mfma_f32_16x16x32_bf16 v[44:47], a[88:91], v[164:167], v[44:47]
    s_waitcnt vmcnt(14)
    v_mfma_f32_16x16x32_bf16 v[48:51], a[92:95], v[164:167], v[48:51]
    v_min3_u32 v10, v176, v177, v178
    v_mfma_f32_16x16x32_bf16 v[52:55], a[96:99], v[164:167], v[52:55]
    v_min3_u32 v10, v10, v179, v180
    buffer_load_dwordx4 v[136:139], v14, s[8:11], s90 offen sc1
    v_mfma_f32_16x16x32_bf16 v[56:59], a[80:83], v[168:171], v[56:59]
    v_min3_u32 v10, v10, v181, v182
    v_mfma_f32_16x16x32_bf16 v[60:63], a[84:87], v[168:171], v[60:63]
    v_min_u32 v10, v10, v183
    v_mfma_f32_16x16x32_bf16 v[64:67], a[88:91], v[168:171], v[64:67]
    v_cmp_le_i32 vcc, 0, v10
    v_mfma_f32_16x16x32_bf16 v[68:71], a[92:95], v[168:171], v[68:71]
    buffer_load_dwordx4 v[140:143], v15, s[8:11], s90 offen sc1
    v_mfma_f32_16x16x32_bf16 v[72:75], a[96:99], v[168:171], v[72:75]
    v_mfma_f32_16x16x32_bf16 v[76:79], a[80:83], v[172:175], v[76:79]
    v_mfma_f32_16x16x32_bf16 v[80:83], a[84:87], v[172:175], v[80:83]
    v_mfma_f32_16x16x32_bf16 v[84:87], a[88:91], v[172:175], v[84:87]
    s_add_u32 s90, s39, s83
    buffer_load_dwordx4 v[144:147], v12, s[8:11], s90 offen sc1
    s_and_b32 s94, s92, 31
    s_add_u32 s74, s74, s94
    v_mfma_f32_16x16x32_bf16 v[88:91], a[92:95], v[172:175], v[88:91]
    s_mul_i32 s74, s74, 1280
    s_mul_i32 s94, s73, 160
    v_mfma_f32_16x16x32_bf16 v[92:95], a[96:99], v[172:175], v[92:95]
    s_add_u32 s94, s94, s74
    s_cbranch_vccnz L_inte_retry_162
L_inte_back_163:
    v_mfma_f32_16x16x32_bf16 v[16:19], a[100:103], v[176:179], v[16:19]
    buffer_load_dwordx4 v[148:151], v13, s[8:11], s90 offen sc1
    v_mfma_f32_16x16x32_bf16 v[20:23], a[104:107], v[176:179], v[20:23]
    v_mfma_f32_16x16x32_bf16 v[24:27], a[108:111], v[176:179], v[24:27]
    v_mfma_f32_16x16x32_bf16 v[28:31], a[112:115], v[176:179], v[28:31]
    s_waitcnt vmcnt(14)
    v_mfma_f32_16x16x32_bf16 v[32:35], a[116:119], v[176:179], v[32:35]
    v_min3_u32 v10, v192, v193, v194
    v_min3_u32 v10, v10, v195, v196
    buffer_load_dwordx4 v[152:155], v14, s[8:11], s90 offen sc1
    v_mfma_f32_16x16x32_bf16 v[36:39], a[100:103], v[180:183], v[36:39]
    v_min3_u32 v10, v10, v197, v198
    v_min3_u32 v10, v10, v199, v200
    v_mfma_f32_16x16x32_bf16 v[40:43], a[104:107], v[180:183], v[40:43]
    v_min3_u32 v10, v10, v201, v202
    v_min3_u32 v10, v10, v203, v204
    v_mfma_f32_16x16x32_bf16 v[44:47], a[108:111], v[180:183], v[44:47]
    v_min3_u32 v10, v10, v205, v206
    v_min_u32 v10, v10, v207
    v_mfma_f32_16x16x32_bf16 v[48:51], a[112:115], v[180:183], v[48:51]
    v_cmp_le_i32 vcc, 0, v10
    buffer_load_dwordx4 v[156:159], v15, s[8:11], s90 offen sc1
    v_mfma_f32_16x16x32_bf16 v[52:55], a[116:119], v[180:183], v[52:55]
    s_cbranch_vccnz L_inte_retry_164
L_inte_back_165:
    v_mfma_f32_16x16x32_bf16 v[16:19], a[120:123], v[192:195], v[16:19]
    v_mfma_f32_16x16x32_bf16 v[20:23], a[124:127], v[192:195], v[20:23]
    s_add_u32 s90, s40, s83
    buffer_load_dwordx4 v[160:163], v12, s[8:11], s90 offen sc1
    v_mfma_f32_16x16x32_bf16 v[24:27], a[128:131], v[192:195], v[24:27]
    v_mfma_f32_16x16x32_bf16 v[28:31], a[132:135], v[192:195], v[28:31]
    ds_read_b128 v[216:219], v249 offset:0
    v_mfma_f32_16x16x32_bf16 v[32:35], a[136:139], v[192:195], v[32:35]
    ds_read_b128 v[220:223], v249 offset:16
    v_mfma_f32_16x16x32_bf16 v[36:39], a[120:123], v[196:199], v[36:39]
    buffer_load_dwordx4 v[164:167], v13, s[8:11], s90 offen sc1
    ds_read_b128 v[224:227], v249 offset:32
    v_mfma_f32_16x16x32_bf16 v[40:43], a[124:127], v[196:199], v[40:43]
    ds_read_b128 v[228:231], v249 offset:48
    v_mfma_f32_16x16x32_bf16 v[44:47], a[128:131], v[196:199], v[44:47]
    s_waitcnt vmcnt(14)
    ds_read_b128 v[232:235], v249 offset:64
    v_mfma_f32_16x16x32_bf16 v[48:51], a[132:135], v[196:199], v[48:51]
    v_min3_u32 v10, v96, v97, v98
    v_mfma_f32_16x16x32_bf16 v[52:55], a[136:139], v[196:199], v[52:55]
    v_min3_u32 v10, v10, v99, v100
    buffer_load_dwordx4 v[168:171], v14, s[8:11], s90 offen sc1
    v_mfma_f32_16x16x32_bf16 v[56:59], a[120:123], v[200:203], v[56:59]
    v_min3_u32 v10, v10, v101, v102
    v_mfma_f32_16x16x32_bf16 v[60:63], a[124:127], v[200:203], v[60:63]
    v_min3_u32 v10, v10, v103, v104
    v_mfma_f32_16x16x32_bf16 v[64:67], a[128:131], v[200:203], v[64:67]
    v_min3_u32 v10, v10, v105, v106
    v_mfma_f32_16x16x32_bf16 v[68:71], a[132:135], v[200:203], v[68:71]
    v_min3_u32 v10, v10, v107, v108
    buffer_load_dwordx4 v[172:175], v15, s[8:11], s90 offen sc1
    v_mfma_f32_16x16x32_bf16 v[72:75], a[136:139], v[200:203], v[72:75]
    v_min3_u32 v10, v10, v109, v110
    v_mfma_f32_16x16x32_bf16 v[76:79], a[120:123], v[204:207], v[76:79]
    v_min_u32 v10, v10, v111
    v_mfma_f32_16x16x32_bf16 v[80:83], a[124:127], v[204:207], v[80:83]
    v_cmp_le_i32 vcc, 0, v10
    v_mfma_f32_16x16x32_bf16 v[84:87], a[128:131], v[204:207], v[84:87]
    s_add_u32 s90, s41, s83
    buffer_load_dwordx4 v[176:179], v12, s[8:11], s90 offen sc1
    v_mfma_f32_16x16x32_bf16 v[88:91], a[132:135], v[204:207], v[88:91]
    v_mfma_f32_16x16x32_bf16 v[92:95], a[136:139], v[204:207], v[92:95]
    s_cbranch_vccnz L_inte_retry_166
L_inte_back_167:
    v_mfma_f32_16x16x32_bf16 v[16:19], a[140:143], v[96:99], v[16:19]
    s_waitcnt lgkmcnt(15)
    v_lshlrev_b32 v244, v252, v244
    v_lshlrev_b32 v245, v252, v245
    v_mfma_f32_16x16x32_bf16 v[20:23], a[144:147], v[96:99], v[20:23]
    buffer_load_dwordx4 v[180:183], v13, s[8:11], s90 offen sc1
    v_mfma_f32_16x16x32_bf16 v[24:27], a[148:151], v[96:99], v[24:27]
    v_lshlrev_b32 v246, v252, v246
    v_mfma_f32_16x16x32_bf16 v[28:31], a[152:155], v[96:99], v[28:31]
    v_lshlrev_b32 v247, v252, v247
    v_mfma_f32_16x16x32_bf16 v[32:35], a[156:159], v[96:99], v[32:35]
    v_lshlrev_b32 v255, 16, v236
    v_mfma_f32_16x16x32_bf16 v[36:39], a[140:143], v[100:103], v[36:39]
    buffer_load_dwordx4 v[184:187], v14, s[8:11], s90 offen sc1
    s_waitcnt lgkmcnt(4)
    v_add_f32 v216, v216, v255
    v_lshlrev_b32 v255, 16, v237
    v_mfma_f32_16x16x32_bf16 v[40:43], a[144:147], v[100:103], v[40:43]
    v_add_f32 v217, v217, v255
    v_mfma_f32_16x16x32_bf16 v[44:47], a[148:151], v[100:103], v[44:47]
    s_waitcnt vmcnt(15)
    v_mfma_f32_16x16x32_bf16 v[48:51], a[152:155], v[100:103], v[48:51]
    v_min3_u32 v10, v112, v113, v114
    v_mfma_f32_16x16x32_bf16 v[52:55], a[156:159], v[100:103], v[52:55]
    v_min3_u32 v10, v10, v115, v116
    buffer_load_dwordx4 v[188:191], v15, s[8:11], s90 offen sc1
    v_mfma_f32_16x16x32_bf16 v[56:59], a[140:143], v[104:107], v[56:59]
    v_min3_u32 v10, v10, v117, v118
    v_mfma_f32_16x16x32_bf16 v[60:63], a[144:147], v[104:107], v[60:63]
    v_min3_u32 v10, v10, v119, v120
    v_mfma_f32_16x16x32_bf16 v[64:67], a[148:151], v[104:107], v[64:67]
    v_min3_u32 v10, v10, v121, v122
    v_mfma_f32_16x16x32_bf16 v[68:71], a[152:155], v[104:107], v[68:71]
    v_min3_u32 v10, v10, v123, v124
    s_add_u32 s90, s42, s83
    buffer_load_dwordx4 v[192:195], v12, s[8:11], s90 offen sc1
    v_mfma_f32_16x16x32_bf16 v[72:75], a[156:159], v[104:107], v[72:75]
    v_min3_u32 v10, v10, v125, v126
    v_mfma_f32_16x16x32_bf16 v[76:79], a[140:143], v[108:111], v[76:79]
    v_min_u32 v10, v10, v127
    v_mfma_f32_16x16x32_bf16 v[80:83], a[144:147], v[108:111], v[80:83]
    v_cmp_le_i32 vcc, 0, v10
    v_mfma_f32_16x16x32_bf16 v[84:87], a[148:151], v[108:111], v[84:87]
    buffer_load_dwordx4 v[196:199], v13, s[8:11], s90 offen sc1
    v_lshlrev_b32 v255, 16, v238
    v_mfma_f32_16x16x32_bf16 v[88:91], a[152:155], v[108:111], v[88:91]
    v_add_f32 v218, v218, v255
    v_mfma_f32_16x16x32_bf16 v[92:95], a[156:159], v[108:111], v[92:95]
    v_lshlrev_b32 v255, 16, v239
    s_cbranch_vccnz L_inte_retry_168
L_inte_back_169:
    v_mfma_f32_16x16x32_bf16 v[16:19], a[160:163], v[112:115], v[16:19]
    v_add_f32 v219, v219, v255
    v_and_b32 v255, 0xffff0000, v236
    v_mfma_f32_16x16x32_bf16 v[20:23], a[164:167], v[112:115], v[20:23]
    buffer_load_dwordx4 v[200:203], v14, s[8:11], s90 offen sc1
    v_mfma_f32_16x16x32_bf16 v[24:27], a[168:171], v[112:115], v[24:27]
    s_waitcnt lgkmcnt(3)
    v_add_f32 v220, v220, v255
    v_mfma_f32_16x16x32_bf16 v[28:31], a[172:175], v[112:115], v[28:31]
    v_and_b32 v255, 0xffff0000, v237
    v_mfma_f32_16x16x32_bf16 v[32:35], a[176:179], v[112:115], v[32:35]
    v_add_f32 v221, v221, v255
    v_mfma_f32_16x16x32_bf16 v[36:39], a[160:163], v[116:119], v[36:39]
    buffer_load_dwordx4 v[204:207], v15, s[8:11], s90 offen sc1
    v_and_b32 v255, 0xffff0000, v238
    v_add_f32 v222, v222, v255
    v_mfma_f32_16x16x32_bf16 v[40:43], a[164:167], v[116:119], v[40:43]
    v_and_b32 v255, 0xffff0000, v239
    v_mfma_f32_16x16x32_bf16 v[44:47], a[168:171], v[116:119], v[44:47]
    s_waitcnt vmcnt(16)
    v_mfma_f32_16x16x32_bf16 v[48:51], a[172:175], v[116:119], v[48:51]
    v_min3_u32 v10, v128, v129, v130
    v_mfma_f32_16x16x32_bf16 v[52:55], a[176:179], v[116:119], v[52:55]
    v_min3_u32 v10, v10, v131, v132
    v_mfma_f32_16x16x32_bf16 v[56:59], a[160:163], v[120:123], v[56:59]
    v_min3_u32 v10, v10, v133, v134
    v_mfma_f32_16x16x32_bf16 v[60:63], a[164:167], v[120:123], v[60:63]
    v_min3_u32 v10, v10, v135, v136
    v_mfma_f32_16x16x32_bf16 v[64:67], a[168:171], v[120:123], v[64:67]
    v_min3_u32 v10, v10, v137, v138
    v_mfma_f32_16x16x32_bf16 v[68:71], a[172:175], v[120:123], v[68:71]
    v_min3_u32 v10, v10, v139, v140
    v_mfma_f32_16x16x32_bf16 v[72:75], a[176:179], v[120:123], v[72:75]
    v_min3_u32 v10, v10, v141, v142
    v_mfma_f32_16x16x32_bf16 v[76:79], a[160:163], v[124:127], v[76:79]
    v_min_u32 v10, v10, v143
    v_mfma_f32_16x16x32_bf16 v[80:83], a[164:167], v[124:127], v[80:83]
    v_cmp_le_i32 vcc, 0, v10
    v_mfma_f32_16x16x32_bf16 v[84:87], a[168:171], v[124:127], v[84:87]
    v_add_f32 v223, v223, v255
    v_mfma_f32_16x16x32_bf16 v[88:91], a[172:175], v[124:127], v[88:91]
    v_lshlrev_b32 v255, 16, v240
    v_mfma_f32_16x16x32_bf16 v[92:95], a[176:179], v[124:127], v[92:95]
    s_waitcnt lgkmcnt(2)
    v_add_f32 v224, v224, v255
    s_cbranch_vccnz L_inte_retry_170
L_inte_back_171:
    v_mfma_f32_16x16x32_bf16 v[16:19], a[180:183], v[128:131], v[16:19]
    v_lshlrev_b32 v255, 16, v241
    v_add_f32 v225, v225, v255
    v_mfma_f32_16x16x32_bf16 v[20:23], a[184:187], v[128:131], v[20:23]
    v_mfma_f32_16x16x32_bf16 v[24:27], a[188:191], v[128:131], v[24:27]
    v_lshlrev_b32 v255, 16, v242
    v_mfma_f32_16x16x32_bf16 v[28:31], a[192:195], v[128:131], v[28:31]
    v_add_f32 v226, v226, v255
    v_mfma_f32_16x16x32_bf16 v[32:35], a[196:199], v[128:131], v[32:35]
    v_lshlrev_b32 v255, 16, v243
    v_mfma_f32_16x16x32_bf16 v[36:39], a[180:183], v[132:135], v[36:39]
    v_add_f32 v227, v227, v255
    v_and_b32 v255, 0xffff0000, v240
    v_mfma_f32_16x16x32_bf16 v[40:43], a[184:187], v[132:135], v[40:43]
    s_waitcnt lgkmcnt(1)
    v_add_f32 v228, v228, v255
    v_mfma_f32_16x16x32_bf16 v[44:47], a[188:191], v[132:135], v[44:47]
    s_waitcnt vmcnt(12)
    v_mfma_f32_16x16x32_bf16 v[48:51], a[192:195], v[132:135], v[48:51]
    v_min3_u32 v10, v144, v145, v146
    v_mfma_f32_16x16x32_bf16 v[52:55], a[196:199], v[132:135], v[52:55]
    v_min3_u32 v10, v10, v147, v148
    v_mfma_f32_16x16x32_bf16 v[56:59], a[180:183], v[136:139], v[56:59]
    v_min3_u32 v10, v10, v149, v150
    v_mfma_f32_16x16x32_bf16 v[60:63], a[184:187], v[136:139], v[60:63]
    v_min3_u32 v10, v10, v151, v152
    v_mfma_f32_16x16x32_bf16 v[64:67], a[188:191], v[136:139], v[64:67]
    v_min3_u32 v10, v10, v153, v154
    v_mfma_f32_16x16x32_bf16 v[68:71], a[192:195], v[136:139], v[68:71]
    v_min3_u32 v10, v10, v155, v156
    v_mfma_f32_16x16x32_bf16 v[72:75], a[196:199], v[136:139], v[72:75]
    v_min3_u32 v10, v10, v157, v158
    v_mfma_f32_16x16x32_bf16 v[76:79], a[180:183], v[140:143], v[76:79]
    v_min_u32 v10, v10, v159
    v_mfma_f32_16x16x32_bf16 v[80:83], a[184:187], v[140:143], v[80:83]
    v_cmp_le_i32 vcc, 0, v10
    v_mfma_f32_16x16x32_bf16 v[84:87], a[188:191], v[140:143], v[84:87]
    v_and_b32 v255, 0xffff0000, v241
    v_mfma_f32_16x16x32_bf16 v[88:91], a[192:195], v[140:143], v[88:91]
    v_add_f32 v229, v229, v255
    v_mfma_f32_16x16x32_bf16 v[92:95], a[196:199], v[140:143], v[92:95]
    v_and_b32 v255, 0xffff0000, v242
    s_cbranch_vccnz L_inte_retry_172
L_inte_back_173:
    v_mfma_f32_16x16x32_bf16 v[16:19], a[200:203], v[144:147], v[16:19]
    v_add_f32 v230, v230, v255
    v_and_b32 v255, 0xffff0000, v243
    v_mfma_f32_16x16x32_bf16 v[20:23], a[204:207], v[144:147], v[20:23]
    v_mfma_f32_16x16x32_bf16 v[24:27], a[208:211], v[144:147], v[24:27]
    v_add_f32 v231, v231, v255
    v_mfma_f32_16x16x32_bf16 v[28:31], a[212:215], v[144:147], v[28:31]
    v_and_b32 v255, 0xffff0000, v244
    v_mfma_f32_16x16x32_bf16 v[32:35], a[216:219], v[144:147], v[32:35]
    s_waitcnt lgkmcnt(0)
    v_add_f32 v232, v232, v255
    v_mfma_f32_16x16x32_bf16 v[36:39], a[200:203], v[148:151], v[36:39]
    v_and_b32 v255, 0xffff0000, v245
    v_add_f32 v233, v233, v255
    v_mfma_f32_16x16x32_bf16 v[40:43], a[204:207], v[148:151], v[40:43]
    v_and_b32 v255, 0xffff0000, v246
    v_mfma_f32_16x16x32_bf16 v[44:47], a[208:211], v[148:151], v[44:47]
    s_waitcnt vmcnt(8)
    v_mfma_f32_16x16x32_bf16 v[48:51], a[212:215], v[148:151], v[48:51]
    v_min3_u32 v10, v160, v161, v162
    v_mfma_f32_16x16x32_bf16 v[52:55], a[216:219], v[148:151], v[52:55]
    v_min3_u32 v10, v10, v163, v164
    v_mfma_f32_16x16x32_bf16 v[56:59], a[200:203], v[152:155], v[56:59]
    v_min3_u32 v10, v10, v165, v166
    v_mfma_f32_16x16x32_bf16 v[60:63], a[204:207], v[152:155], v[60:63]
    v_min3_u32 v10, v10, v167, v168
    v_mfma_f32_16x16x32_bf16 v[64:67], a[208:211], v[152:155], v[64:67]
    v_min3_u32 v10, v10, v169, v170
    v_mfma_f32_16x16x32_bf16 v[68:71], a[212:215], v[152:155], v[68:71]
    v_min3_u32 v10, v10, v171, v172
    v_mfma_f32_16x16x32_bf16 v[72:75], a[216:219], v[152:155], v[72:75]
    v_min3_u32 v10, v10, v173, v174
    v_mfma_f32_16x16x32_bf16 v[76:79], a[200:203], v[156:159], v[76:79]
    v_min_u32 v10, v10, v175
    v_mfma_f32_16x16x32_bf16 v[80:83], a[204:207], v[156:159], v[80:83]
    v_cmp_le_i32 vcc, 0, v10
    v_mfma_f32_16x16x32_bf16 v[84:87], a[208:211], v[156:159], v[84:87]
    v_add_f32 v234, v234, v255
    v_mfma_f32_16x16x32_bf16 v[88:91], a[212:215], v[156:159], v[88:91]
    v_and_b32 v255, 0xffff0000, v247
    v_mfma_f32_16x16x32_bf16 v[92:95], a[216:219], v[156:159], v[92:95]
    v_add_f32 v235, v235, v255
    s_barrier
    s_cbranch_vccnz L_inte_retry_174
L_inte_back_175:
    v_mfma_f32_16x16x32_bf16 v[16:19], a[220:223], v[160:163], v[16:19]
    s_waitcnt vmcnt(4)
    v_min3_u32 v10, v176, v177, v178
    v_min3_u32 v10, v10, v179, v180
    v_mfma_f32_16x16x32_bf16 v[20:23], a[224:227], v[160:163], v[20:23]
    v_min3_u32 v10, v10, v181, v182
    v_min3_u32 v10, v10, v183, v184
    v_min3_u32 v10, v10, v185, v186
    v_mfma_f32_16x16x32_bf16 v[24:27], a[228:231], v[160:163], v[24:27]
    v_min3_u32 v10, v10, v187, v188
    v_min3_u32 v10, v10, v189, v190
    v_min_u32 v10, v10, v191
    v_mfma_f32_16x16x32_bf16 v[28:31], a[232:235], v[160:163], v[28:31]
    v_cmp_le_i32 vcc, 0, v10
    v_mfma_f32_16x16x32_bf16 v[32:35], a[236:239], v[160:163], v[32:35]
    s_cbranch_vccnz L_inte_retry_176
L_inte_back_177:
    v_mfma_f32_16x16x32_bf16 v[16:19], a[0:3], v[176:179], v[16:19]
    s_waitcnt vmcnt(0)
    v_min3_u32 v10, v192, v193, v194
    v_min3_u32 v10, v10, v195, v196
    v_mfma_f32_16x16x32_bf16 v[20:23], a[4:7], v[176:179], v[20:23]
    v_min3_u32 v10, v10, v197, v198
    v_min3_u32 v10, v10, v199, v200
    v_min3_u32 v10, v10, v201, v202
    v_mfma_f32_16x16x32_bf16 v[24:27], a[8:11], v[176:179], v[24:27]
    v_min3_u32 v10, v10, v203, v204
    v_min3_u32 v10, v10, v205, v206
    v_min_u32 v10, v10, v207
    v_mfma_f32_16x16x32_bf16 v[28:31], a[12:15], v[176:179], v[28:31]
    v_cmp_le_i32 vcc, 0, v10
    v_mfma_f32_16x16x32_bf16 v[32:35], a[16:19], v[176:179], v[32:35]
    s_cbranch_vccnz L_inte_retry_178
L_inte_back_179:
    v_mfma_f32_16x16x32_bf16 v[16:19], a[20:23], v[192:195], v[16:19]
    v_mfma_f32_16x16x32_bf16 v[20:23], a[24:27], v[192:195], v[20:23]
    v_mfma_f32_16x16x32_bf16 v[24:27], a[28:31], v[192:195], v[24:27]
    v_mfma_f32_16x16x32_bf16 v[28:31], a[32:35], v[192:195], v[28:31]
    v_mfma_f32_16x16x32_bf16 v[32:35], a[36:39], v[192:195], v[32:35]
    v_mfma_f32_16x16x32_bf16 v[36:39], a[220:223], v[164:167], v[36:39]
    v_mfma_f32_16x16x32_bf16 v[40:43], a[224:227], v[164:167], v[40:43]
    v_mfma_f32_16x16x32_bf16 v[44:47], a[228:231], v[164:167], v[44:47]
    v_mfma_f32_16x16x32_bf16 v[48:51], a[232:235], v[164:167], v[48:51]
    ds_write_b128 v2, v[16:19] offset:0
    v_mfma_f32_16x16x32_bf16 v[52:55], a[236:239], v[164:167], v[52:55]
    ds_write_b128 v2, v[20:23] offset:1024
    v_mfma_f32_16x16x32_bf16 v[36:39], a[0:3], v[180:183], v[36:39]
    ds_write_b128 v2, v[24:27] offset:2048
    v_mfma_f32_16x16x32_bf16 v[40:43], a[4:7], v[180:183], v[40:43]
    ds_write_b128 v2, v[28:31] offset:3072
    v_mfma_f32_16x16x32_bf16 v[44:47], a[8:11], v[180:183], v[44:47]
    ds_write_b128 v2, v[32:35] offset:4096
    v_mfma_f32_16x16x32_bf16 v[48:51], a[12:15], v[180:183], v[48:51]
    v_mfma_f32_16x16x32_bf16 v[52:55], a[16:19], v[180:183], v[52:55]
    v_mfma_f32_16x16x32_bf16 v[36:39], a[20:23], v[196:199], v[36:39]
    v_mfma_f32_16x16x32_bf16 v[40:43], a[24:27], v[196:199], v[40:43]
    v_mfma_f32_16x16x32_bf16 v[44:47], a[28:31], v[196:199], v[44:47]
    v_mfma_f32_16x16x32_bf16 v[48:51], a[32:35], v[196:199], v[48:51]
    v_mfma_f32_16x16x32_bf16 v[52:55], a[36:39], v[196:199], v[52:55]
    v_mfma_f32_16x16x32_bf16 v[56:59], a[220:223], v[168:171], v[56:59]
    v_mfma_f32_16x16x32_bf16 v[60:63], a[224:227], v[168:171], v[60:63]
    v_mfma_f32_16x16x32_bf16 v[64:67], a[228:231], v[168:171], v[64:67]
    v_mfma_f32_16x16x32_bf16 v[68:71], a[232:235], v[168:171], v[68:71]
    ds_write_b128 v3, v[36:39] offset:0
    v_mfma_f32_16x16x32_bf16 v[72:75], a[236:239], v[168:171], v[72:75]
    ds_write_b128 v3, v[40:43] offset:1024
    v_mfma_f32_16x16x32_bf16 v[56:59], a[0:3], v[184:187], v[56:59]
    ds_write_b128 v3, v[44:47] offset:2048
    v_mfma_f32_16x16x32_bf16 v[60:63], a[4:7], v[184:187], v[60:63]
    ds_write_b128 v3, v[48:51] offset:3072
    v_mfma_f32_16x16x32_bf16 v[64:67], a[8:11], v[184:187], v[64:67]
    ds_write_b128 v3, v[52:55] offset:4096
    v_mfma_f32_16x16x32_bf16 v[68:71], a[12:15], v[184:187], v[68:71]
    v_mfma_f32_16x16x32_bf16 v[72:75], a[16:19], v[184:187], v[72:75]
    v_mfma_f32_16x16x32_bf16 v[56:59], a[20:23], v[200:203], v[56:59]
    v_mfma_f32_16x16x32_bf16 v[60:63], a[24:27], v[200:203], v[60:63]
    v_mfma_f32_16x16x32_bf16 v[64:67], a[28:31], v[200:203], v[64:67]
    v_mfma_f32_16x16x32_bf16 v[68:71], a[32:35], v[200:203], v[68:71]
    v_mfma_f32_16x16x32_bf16 v[72:75], a[36:39], v[200:203], v[72:75]
    v_mfma_f32_16x16x32_bf16 v[76:79], a[220:223], v[172:175], v[76:79]
    v_mfma_f32_16x16x32_bf16 v[80:83], a[224:227], v[172:175], v[80:83]
    v_mfma_f32_16x16x32_bf16 v[84:87], a[228:231], v[172:175], v[84:87]
    v_mfma_f32_16x16x32_bf16 v[88:91], a[232:235], v[172:175], v[88:91]
    ds_write_b128 v4, v[56:59] offset:0
    v_mfma_f32_16x16x32_bf16 v[92:95], a[236:239], v[172:175], v[92:95]
    ds_write_b128 v4, v[60:63] offset:1024
    v_mfma_f32_16x16x32_bf16 v[76:79], a[0:3], v[188:191], v[76:79]
    ds_write_b128 v4, v[64:67] offset:2048
    v_mfma_f32_16x16x32_bf16 v[80:83], a[4:7], v[188:191], v[80:83]
    ds_write_b128 v4, v[68:71] offset:3072
    v_mfma_f32_16x16x32_bf16 v[84:87], a[8:11], v[188:191], v[84:87]
    ds_write_b128 v4, v[72:75] offset:4096
    v_mfma_f32_16x16x32_bf16 v[88:91], a[12:15], v[188:191], v[88:91]
    v_mfma_f32_16x16x32_bf16 v[92:95], a[16:19], v[188:191], v[92:95]
    v_mfma_f32_16x16x32_bf16 v[76:79], a[20:23], v[204:207], v[76:79]
    v_mfma_f32_16x16x32_bf16 v[80:83], a[24:27], v[204:207], v[80:83]
    v_mfma_f32_16x16x32_bf16 v[84:87], a[28:31], v[204:207], v[84:87]
    v_mfma_f32_16x16x32_bf16 v[88:91], a[32:35], v[204:207], v[88:91]
    v_mfma_f32_16x16x32_bf16 v[92:95], a[36:39], v[204:207], v[92:95]
    s_waitcnt lgkmcnt(0)
    s_barrier
    ds_read_b128 v[96:99], v5 offset:0
    ds_read_b128 v[100:103], v5 offset:1024
    ds_read_b128 v[104:107], v5 offset:2048
    ds_read_b128 v[108:111], v5 offset:3072
    ds_read_b128 v[112:115], v5 offset:4096
    ds_read_b128 v[116:119], v5 offset:5120
    ds_read_b128 v[120:123], v5 offset:6144
    ds_read_b128 v[124:127], v5 offset:7168
    ds_read_b128 v[128:131], v5 offset:8192
    ds_read_b128 v[132:135], v5 offset:9216
    ds_read_b128 v[136:139], v5 offset:10240
    ds_read_b128 v[140:143], v5 offset:11264
    ds_read_b128 v[144:147], v5 offset:12288
    ds_read_b128 v[148:151], v5 offset:13312
    ds_read_b128 v[152:155], v5 offset:14336
    s_waitcnt lgkmcnt(14)
    v_pk_add_f32 v[76:77], v[76:77], v[96:97]
    v_pk_add_f32 v[78:79], v[78:79], v[98:99]
    s_waitcnt lgkmcnt(13)
    v_pk_add_f32 v[80:81], v[80:81], v[100:101]
    v_pk_add_f32 v[82:83], v[82:83], v[102:103]
    s_waitcnt lgkmcnt(12)
    v_pk_add_f32 v[84:85], v[84:85], v[104:105]
    v_pk_add_f32 v[86:87], v[86:87], v[106:107]
    s_waitcnt lgkmcnt(11)
    v_pk_add_f32 v[88:89], v[88:89], v[108:109]
    v_pk_add_f32 v[90:91], v[90:91], v[110:111]
    s_waitcnt lgkmcnt(10)
    v_pk_add_f32 v[92:93], v[92:93], v[112:113]
    v_pk_add_f32 v[94:95], v[94:95], v[114:115]
    s_waitcnt lgkmcnt(9)
    v_pk_add_f32 v[76:77], v[76:77], v[116:117]
    v_pk_add_f32 v[78:79], v[78:79], v[118:119]
    s_waitcnt lgkmcnt(8)
    v_pk_add_f32 v[80:81], v[80:81], v[120:121]
    v_pk_add_f32 v[82:83], v[82:83], v[122:123]
    s_waitcnt lgkmcnt(7)
    v_pk_add_f32 v[84:85], v[84:85], v[124:125]
    v_pk_add_f32 v[86:87], v[86:87], v[126:127]
    s_waitcnt lgkmcnt(6)
    v_pk_add_f32 v[88:89], v[88:89], v[128:129]
    v_pk_add_f32 v[90:91], v[90:91], v[130:131]
    s_waitcnt lgkmcnt(5)
    v_pk_add_f32 v[92:93], v[92:93], v[132:133]
    v_pk_add_f32 v[94:95], v[94:95], v[134:135]
    s_waitcnt lgkmcnt(4)
    v_pk_add_f32 v[76:77], v[76:77], v[136:137]
    v_pk_add_f32 v[78:79], v[78:79], v[138:139]
    s_waitcnt lgkmcnt(3)
    v_pk_add_f32 v[80:81], v[80:81], v[140:141]
    v_pk_add_f32 v[82:83], v[82:83], v[142:143]
    s_waitcnt lgkmcnt(2)
    v_pk_add_f32 v[84:85], v[84:85], v[144:145]
    v_pk_add_f32 v[86:87], v[86:87], v[146:147]
    s_waitcnt lgkmcnt(1)
    v_pk_add_f32 v[88:89], v[88:89], v[148:149]
    v_pk_add_f32 v[90:91], v[90:91], v[150:151]
    s_waitcnt lgkmcnt(0)
    v_pk_add_f32 v[92:93], v[92:93], v[152:153]
    v_pk_add_f32 v[94:95], v[94:95], v[154:155]
    v_pk_fma_f32 v[76:77], v[76:77], v[254:255], v[216:217] op_sel_hi:[1,0,1] neg_lo:[1,0,0] neg_hi:[1,0,0]
    v_pk_fma_f32 v[78:79], v[78:79], v[254:255], v[218:219] op_sel_hi:[1,0,1] neg_lo:[1,0,0] neg_hi:[1,0,0]
    v_pk_fma_f32 v[80:81], v[80:81], v[254:255], v[220:221] op_sel_hi:[1,0,1] neg_lo:[1,0,0] neg_hi:[1,0,0]
    v_pk_fma_f32 v[82:83], v[82:83], v[254:255], v[222:223] op_sel_hi:[1,0,1] neg_lo:[1,0,0] neg_hi:[1,0,0]
    v_pk_fma_f32 v[84:85], v[84:85], v[254:255], v[224:225] op_sel_hi:[1,0,1] neg_lo:[1,0,0] neg_hi:[1,0,0]
    v_pk_fma_f32 v[86:87], v[86:87], v[254:255], v[226:227] op_sel_hi:[1,0,1] neg_lo:[1,0,0] neg_hi:[1,0,0]
    v_pk_fma_f32 v[88:89], v[88:89], v[254:255], v[228:229] op_sel_hi:[1,0,1] neg_lo:[1,0,0] neg_hi:[1,0,0]
    v_pk_fma_f32 v[90:91], v[90:91], v[254:255], v[230:231] op_sel_hi:[1,0,1] neg_lo:[1,0,0] neg_hi:[1,0,0]
    v_pk_fma_f32 v[92:93], v[92:93], v[254:255], v[232:233] op_sel_hi:[1,0,1] neg_lo:[1,0,0] neg_hi:[1,0,0]
    v_pk_fma_f32 v[94:95], v[94:95], v[254:255], v[234:235] op_sel_hi:[1,0,1] neg_lo:[1,0,0] neg_hi:[1,0,0]
    v_cvt_pk_bf16_f32 v36, v76, v77
    v_cvt_pk_bf16_f32 v37, v78, v79
    v_cvt_pk_bf16_f32 v38, v80, v81
    v_cvt_pk_bf16_f32 v39, v82, v83
    v_cvt_pk_bf16_f32 v40, v84, v85
    v_cvt_pk_bf16_f32 v41, v86, v87
    v_cvt_pk_bf16_f32 v42, v88, v89
    v_cvt_pk_bf16_f32 v43, v90, v91
    v_cvt_pk_bf16_f32 v44, v92, v93
    v_cvt_pk_bf16_f32 v45, v94, v95
    buffer_store_dwordx4 v[36:39], v213, s[12:15], s94 offen
    buffer_store_dwordx4 v[40:43], v213, s[12:15], s94 offen offset:64
    buffer_store_dwordx2 v[44:45], v212, s[12:15], s94 offen offset:128
L_ffend1:
L_last:
L_interleave_layers__spectral_fnet__dense_activation_squared_relu__prompt_kernel_end:
    s_endpgm
L_inte_retry_60:
    s_mov_b32 s91, 0
    s_lshl1_add_u32 s88, s39, s80
L_inte_loop_180:
    buffer_load_dwordx4 v[96:99], v12, s[8:11], s88 offen sc1
    buffer_load_dwordx4 v[100:103], v13, s[8:11], s88 offen sc1
    buffer_load_dwordx4 v[104:107], v14, s[8:11], s88 offen sc1
    buffer_load_dwordx4 v[108:111], v15, s[8:11], s88 offen sc1
    s_add_u32 s91, s91, 1
    s_waitcnt vmcnt(0)
    v_or3_b32 v10, v96, v97, v98
    v_or3_b32 v10, v10, v99, v100
    v_or3_b32 v10, v10, v101, v102
    v_or3_b32 v10, v10, v103, v104
    v_or3_b32 v10, v10, v105, v106
    v_or3_b32 v10, v10, v107, v108
    v_or3_b32 v10, v10, v109, v110
    v_or_b32 v10, v10, v111
    v_cmp_gt_i32 vcc, 0, v10
    s_cmp_ge_u32 s91, 400000
    s_cbranch_scc1 L_inte_back_61
    s_nop 2
    s_cbranch_vccnz L_inte_loop_180
    s_branch L_inte_back_61
L_inte_retry_62:
    s_mov_b32 s91, 0
    s_lshl1_add_u32 s88, s40, s80
L_inte_loop_181:
    buffer_load_dwordx4 v[112:115], v12, s[8:11], s88 offen sc1
    buffer_load_dwordx4 v[116:119], v13, s[8:11], s88 offen sc1
    buffer_load_dwordx4 v[120:123], v14, s[8:11], s88 offen sc1
    buffer_load_dwordx4 v[124:127], v15, s[8:11], s88 offen sc1
    s_add_u32 s91, s91, 1
    s_waitcnt vmcnt(0)
    v_or3_b32 v10, v112, v113, v114
    v_or3_b32 v10, v10, v115, v116
    v_or3_b32 v10, v10, v117, v118
    v_or3_b32 v10, v10, v119, v120
    v_or3_b32 v10, v10, v121, v122
    v_or3_b32 v10, v10, v123, v124
    v_or3_b32 v10, v10, v125, v126
    v_or_b32 v10, v10, v127
    v_cmp_gt_i32 vcc, 0, v10
    s_cmp_ge_u32 s91, 400000
    s_cbranch_scc1 L_inte_back_63
    s_nop 2
    s_cbranch_vccnz L_inte_loop_181
    s_branch L_inte_back_63
L_inte_retry_64:
    s_mov_b32 s91, 0
    s_lshl1_add_u32 s88, s41, s80
L_inte_loop_182:
    buffer_load_dwordx4 v[128:131], v12, s[8:11], s88 offen sc1
    buffer_load_dwordx4 v[132:135], v13, s[8:11], s88 offen sc1
    buffer_load_dwordx4 v[136:139], v14, s[8:11], s88 offen sc1
    buffer_load_dwordx4 v[140:143], v15, s[8:11], s88 offen sc1
    s_add_u32 s91, s91, 1
    s_waitcnt vmcnt(0)
    v_or3_b32 v10, v128, v129, v130
    v_or3_b32 v10, v10, v131, v132
    v_or3_b32 v10, v10, v133, v134
    v_or3_b32 v10, v10, v135, v136
    v_or3_b32 v10, v10, v137, v138
    v_or3_b32 v10, v10, v139, v140
    v_or3_b32 v10, v10, v141, v142
    v_or_b32 v10, v10, v143
    v_cmp_gt_i32 vcc, 0, v10
    s_cmp_ge_u32 s91, 400000
    s_cbranch_scc1 L_inte_back_65
    s_nop 2
    s_cbranch_vccnz L_inte_loop_182
    s_branch L_inte_back_65
L_inte_retry_66:
    s_mov_b32 s91, 0
    s_lshl1_add_u32 s88, s42, s80
L_inte_loop_183:
    buffer_load_dwordx4 v[144:147], v12, s[8:11], s88 offen sc1
    buffer_load_dwordx4 v[148:151], v13, s[8:11], s88 offen sc1
    buffer_load_dwordx4 v[152:155], v14, s[8:11], s88 offen sc1
    buffer_load_dwordx4 v[156:159], v15, s[8:11], s88 offen sc1
    s_add_u32 s91, s91, 1
    s_waitcnt vmcnt(0)
    v_or3_b32 v10, v144, v145, v146
    v_or3_b32 v10, v10, v147, v148
    v_or3_b32 v10, v10, v149, v150
    v_or3_b32 v10, v10, v151, v152
    v_or3_b32 v10, v10, v153, v154
    v_or3_b32 v10, v10, v155, v156
    v_or3_b32 v10, v10, v157, v158
    v_or_b32 v10, v10, v159
    v_cmp_gt_i32 vcc, 0, v10
    s_cmp_ge_u32 s91, 400000
    s_cbranch_scc1 L_inte_back_67
    s_nop 2
    s_cbranch_vccnz L_inte_loop_183
    s_branch L_inte_back_67
L_inte_retry_68:
    s_mov_b32 s91, 0
    s_mov_b32 s88, s81
L_inte_loop_184:
    buffer_load_dwordx4 v[160:163], v12, s[8:11], s88 offen sc1
    buffer_load_dwordx4 v[164:167], v13, s[8:11], s88 offen sc1
    buffer_load_dwordx4 v[168:171], v14, s[8:11], s88 offen sc1
    buffer_load_dwordx4 v[172:175], v15, s[8:11], s88 offen sc1
    s_add_u32 s91, s91, 1
    s_waitcnt vmcnt(0)
    v_or3_b32 v10, v160, v161, v162
    v_or3_b32 v10, v10, v163, v164
    v_or3_b32 v10, v10, v165, v166
    v_or3_b32 v10, v10, v167, v168
    v_or3_b32 v10, v10, v169, v170
    v_or3_b32 v10, v10, v171, v172
    v_or3_b32 v10, v10, v173, v174
    v_or_b32 v10, v10, v175
    v_cmp_gt_i32 vcc, 0, v10
    s_cmp_ge_u32 s91, 400000
    s_cbranch_scc1 L_inte_back_69
    s_nop 2
    s_cbranch_vccnz L_inte_loop_184
    s_branch L_inte_back_69
L_inte_retry_70:
    s_mov_b32 s91, 0
    s_mov_b32 s88, s82
L_inte_loop_185:
    buffer_load_dwordx4 v[176:179], v12, s[8:11], s88 offen sc1
    buffer_load_dwordx4 v[180:183], v13, s[8:11], s88 offen sc1
    s_add_u32 s91, s91, 1
    s_waitcnt vmcnt(0)
    v_or3_b32 v10, v176, v177, v178
    v_or3_b32 v10, v10, v179, v180
    v_or3_b32 v10, v10, v181, v182
    v_or_b32 v10, v10, v183
    v_cmp_gt_i32 vcc, 0, v10
    s_cmp_ge_u32 s91, 400000
    s_cbranch_scc1 L_inte_back_71
    s_nop 2
    s_cbranch_vccnz L_inte_loop_185
    s_branch L_inte_back_71
L_inte_retry_72:
    s_mov_b32 s91, 0
    s_lshl1_add_u32 s88, s39, s24
L_inte_loop_186:
    buffer_load_dwordx4 v[192:195], v12, s[8:11], s88 offen sc1
    buffer_load_dwordx4 v[196:199], v13, s[8:11], s88 offen sc1
    buffer_load_dwordx4 v[200:203], v14, s[8:11], s88 offen sc1
    buffer_load_dwordx4 v[204:207], v15, s[8:11], s88 offen sc1
    s_add_u32 s91, s91, 1
    s_waitcnt vmcnt(0)
    v_or3_b32 v10, v192, v193, v194
    v_or3_b32 v10, v10, v195, v196
    v_or3_b32 v10, v10, v197, v198
    v_or3_b32 v10, v10, v199, v200
    v_or3_b32 v10, v10, v201, v202
    v_or3_b32 v10, v10, v203, v204
    v_or3_b32 v10, v10, v205, v206
    v_or_b32 v10, v10, v207
    v_cmp_gt_i32 vcc, 0, v10
    s_cmp_ge_u32 s91, 400000
    s_cbranch_scc1 L_inte_back_73
    s_nop 2
    s_cbranch_vccnz L_inte_loop_186
    s_branch L_inte_back_73
L_inte_retry_74:
    s_mov_b32 s91, 0
    s_lshl1_add_u32 s88, s40, s24
L_inte_loop_187:
    buffer_load_dwordx4 v[96:99], v12, s[8:11], s88 offen sc1
    buffer_load_dwordx4 v[100:103], v13, s[8:11], s88 offen sc1
    buffer_load_dwordx4 v[104:107], v14, s[8:11], s88 offen sc1
    buffer_load_dwordx4 v[108:111], v15, s[8:11], s88 offen sc1
    s_add_u32 s91, s91, 1
    s_waitcnt vmcnt(0)
    v_or3_b32 v10, v96, v97, v98
    v_or3_b32 v10, v10, v99, v100
    v_or3_b32 v10, v10, v101, v102
    v_or3_b32 v10, v10, v103, v104
    v_or3_b32 v10, v10, v105, v106
    v_or3_b32 v10, v10, v107, v108
    v_or3_b32 v10, v10, v109, v110
    v_or_b32 v10, v10, v111
    v_cmp_gt_i32 vcc, 0, v10
    s_cmp_ge_u32 s91, 400000
    s_cbranch_scc1 L_inte_back_75
    s_nop 2
    s_cbranch_vccnz L_inte_loop_187
    s_branch L_inte_back_75
L_inte_retry_76:
    s_mov_b32 s91, 0
    s_lshl1_add_u32 s88, s41, s24
L_inte_loop_188:
    buffer_load_dwordx4 v[112:115], v12, s[8:11], s88 offen sc1
    buffer_load_dwordx4 v[116:119], v13, s[8:11], s88 offen sc1
    buffer_load_dwordx4 v[120:123], v14, s[8:11], s88 offen sc1
    buffer_load_dwordx4 v[124:127], v15, s[8:11], s88 offen sc1
    s_add_u32 s91, s91, 1
    s_waitcnt vmcnt(0)
    v_or3_b32 v10, v112, v113, v114
    v_or3_b32 v10, v10, v115, v116
    v_or3_b32 v10, v10, v117, v118
    v_or3_b32 v10, v10, v119, v120
    v_or3_b32 v10, v10, v121, v122
    v_or3_b32 v10, v10, v123, v124
    v_or3_b32 v10, v10, v125, v126
    v_or_b32 v10, v10, v127
    v_cmp_gt_i32 vcc, 0, v10
    s_cmp_ge_u32 s91, 400000
    s_cbranch_scc1 L_inte_back_77
    s_nop 2
    s_cbranch_vccnz L_inte_loop_188
    s_branch L_inte_back_77
L_inte_retry_78:
    s_mov_b32 s91, 0
    s_lshl1_add_u32 s88, s42, s24
L_inte_loop_189:
    buffer_load_dwordx4 v[128:131], v12, s[8:11], s88 offen sc1
    buffer_load_dwordx4 v[132:135], v13, s[8:11], s88 offen sc1
    buffer_load_dwordx4 v[136:139], v14, s[8:11], s88 offen sc1
    buffer_load_dwordx4 v[140:143], v15, s[8:11], s88 offen sc1
    s_add_u32 s91, s91, 1
    s_waitcnt vmcnt(0)
    v_or3_b32 v10, v128, v129, v130
    v_or3_b32 v10, v10, v131, v132
    v_or3_b32 v10, v10, v133, v134
    v_or3_b32 v10, v10, v135, v136
    v_or3_b32 v10, v10, v137, v138
    v_or3_b32 v10, v10, v139, v140
    v_or3_b32 v10, v10, v141, v142
    v_or_b32 v10, v10, v143
    v_cmp_gt_i32 vcc, 0, v10
    s_cmp_ge_u32 s91, 400000
    s_cbranch_scc1 L_inte_back_79
    s_nop 2
    s_cbranch_vccnz L_inte_loop_189
    s_branch L_inte_back_79
L_inte_retry_80:
    s_mov_b32 s91, 0
    s_add_u32 s88, s39, s83
L_inte_loop_190:
    buffer_load_dwordx4 v[144:147], v12, s[8:11], s88 offen sc1
    buffer_load_dwordx4 v[148:151], v13, s[8:11], s88 offen sc1
    buffer_load_dwordx4 v[152:155], v14, s[8:11], s88 offen sc1
    buffer_load_dwordx4 v[156:159], v15, s[8:11], s88 offen sc1
    s_add_u32 s91, s91, 1
    s_waitcnt vmcnt(0)
    v_or3_b32 v10, v144, v145, v146
    v_or3_b32 v10, v10, v147, v148
    v_or3_b32 v10, v10, v149, v150
    v_or3_b32 v10, v10, v151, v152
    v_or3_b32 v10, v10, v153, v154
    v_or3_b32 v10, v10, v155, v156
    v_or3_b32 v10, v10, v157, v158
    v_or_b32 v10, v10, v159
    v_cmp_gt_i32 vcc, 0, v10
    s_cmp_ge_u32 s91, 400000
    s_cbranch_scc1 L_inte_back_81
    s_nop 2
    s_cbranch_vccnz L_inte_loop_190
    s_branch L_inte_back_81
L_inte_retry_82:
    s_mov_b32 s91, 0
    s_add_u32 s88, s40, s83
L_inte_loop_191:
    buffer_load_dwordx4 v[160:163], v12, s[8:11], s88 offen sc1
    buffer_load_dwordx4 v[164:167], v13, s[8:11], s88 offen sc1
    buffer_load_dwordx4 v[168:171], v14, s[8:11], s88 offen sc1
    buffer_load_dwordx4 v[172:175], v15, s[8:11], s88 offen sc1
    s_add_u32 s91, s91, 1
    s_waitcnt vmcnt(0)
    v_or3_b32 v10, v160, v161, v162
    v_or3_b32 v10, v10, v163, v164
    v_or3_b32 v10, v10, v165, v166
    v_or3_b32 v10, v10, v167, v168
    v_or3_b32 v10, v10, v169, v170
    v_or3_b32 v10, v10, v171, v172
    v_or3_b32 v10, v10, v173, v174
    v_or_b32 v10, v10, v175
    v_cmp_gt_i32 vcc, 0, v10
    s_cmp_ge_u32 s91, 400000
    s_cbranch_scc1 L_inte_back_83
    s_nop 2
    s_cbranch_vccnz L_inte_loop_191
    s_branch L_inte_back_83
L_inte_retry_84:
    s_mov_b32 s91, 0
    s_add_u32 s88, s41, s83
L_inte_loop_192:
    buffer_load_dwordx4 v[176:179], v12, s[8:11], s88 offen sc1
    buffer_load_dwordx4 v[180:183], v13, s[8:11], s88 offen sc1
    buffer_load_dwordx4 v[184:187], v14, s[8:11], s88 offen sc1
    buffer_load_dwordx4 v[188:191], v15, s[8:11], s88 offen sc1
    s_add_u32 s91, s91, 1
    s_waitcnt vmcnt(0)
    v_or3_b32 v10, v176, v177, v178
    v_or3_b32 v10, v10, v179, v180
    v_or3_b32 v10, v10, v181, v182
    v_or3_b32 v10, v10, v183, v184
    v_or3_b32 v10, v10, v185, v186
    v_or3_b32 v10, v10, v187, v188
    v_or3_b32 v10, v10, v189, v190
    v_or_b32 v10, v10, v191
    v_cmp_gt_i32 vcc, 0, v10
    s_cmp_ge_u32 s91, 400000
    s_cbranch_scc1 L_inte_back_85
    s_nop 2
    s_cbranch_vccnz L_inte_loop_192
    s_branch L_inte_back_85
L_inte_retry_86:
    s_mov_b32 s91, 0
    s_add_u32 s88, s42, s83
L_inte_loop_193:
    buffer_load_dwordx4 v[192:195], v12, s[8:11], s88 offen sc1
    buffer_load_dwordx4 v[196:199], v13, s[8:11], s88 offen sc1
    buffer_load_dwordx4 v[200:203], v14, s[8:11], s88 offen sc1
    buffer_load_dwordx4 v[204:207], v15, s[8:11], s88 offen sc1
    s_add_u32 s91, s91, 1
    s_waitcnt vmcnt(0)
    v_or3_b32 v10, v192, v193, v194
    v_or3_b32 v10, v10, v195, v196
    v_or3_b32 v10, v10, v197, v198
    v_or3_b32 v10, v10, v199, v200
    v_or3_b32 v10, v10, v201, v202
    v_or3_b32 v10, v10, v203, v204
    v_or3_b32 v10, v10, v205, v206
    v_or_b32 v10, v10, v207
    v_cmp_gt_i32 vcc, 0, v10
    s_cmp_ge_u32 s91, 400000
    s_cbranch_scc1 L_inte_back_87
    s_nop 2
    s_cbranch_vccnz L_inte_loop_193
    s_branch L_inte_back_87
L_inte_xretry_112:
    s_mov_b32 s54, 0
L_inte_xloop_194:
    s_add_u32 s53, s52, 0
    buffer_load_dwordx4 v[96:99], v5, s[8:11], s53 offen offset:0 sc1
    buffer_load_dwordx4 v[100:103], v5, s[8:11], s53 offen offset:256 sc1
    buffer_load_dwordx4 v[104:107], v5, s[8:11], s53 offen offset:2048 sc1
    buffer_load_dwordx4 v[108:111], v5, s[8:11], s53 offen offset:2304 sc1
    s_add_u32 s53, s52, 4096
    buffer_load_dwordx4 v[112:115], v5, s[8:11], s53 offen offset:0 sc1
    buffer_load_dwordx4 v[116:119], v5, s[8:11], s53 offen offset:256 sc1
    buffer_load_dwordx4 v[120:123], v5, s[8:11], s53 offen offset:2048 sc1
    buffer_load_dwordx4 v[124:127], v5, s[8:11], s53 offen offset:2304 sc1
    s_add_u32 s53, s52, 8192
    buffer_load_dwordx4 v[128:131], v5, s[8:11], s53 offen offset:0 sc1
    buffer_load_dwordx4 v[132:135], v5, s[8:11], s53 offen offset:256 sc1
    buffer_load_dwordx4 v[136:139], v5, s[8:11], s53 offen offset:2048 sc1
    buffer_load_dwordx4 v[140:143], v5, s[8:11], s53 offen offset:2304 sc1
    s_add_u32 s53, s52, 12288
    buffer_load_dwordx4 v[144:147], v5, s[8:11], s53 offen offset:0 sc1
    buffer_load_dwordx4 v[148:151], v5, s[8:11], s53 offen offset:256 sc1
    s_add_u32 s54, s54, 1
    s_waitcnt vmcnt(0)
    v_max3_u32 v31, v96, v97, v98
    v_max3_u32 v31, v31, v99, v100
    v_max3_u32 v31, v31, v101, v102
    v_max_u32 v31, v31, v103
    v_cmp_eq_u32 vcc, -1, v31
    s_cmp_ge_u32 s54, 400000
    s_cbranch_scc1 L_inte_xback_113
    s_nop 2
    s_cbranch_vccnz L_inte_xloop_194
    s_branch L_inte_xback_113
L_inte_xretry_114:
    s_mov_b32 s54, 0
L_inte_xloop_195:
    s_add_u32 s53, s52, 0
    buffer_load_dwordx4 v[104:107], v5, s[8:11], s53 offen offset:2048 sc1
    buffer_load_dwordx4 v[108:111], v5, s[8:11], s53 offen offset:2304 sc1
    s_add_u32 s53, s52, 4096
    buffer_load_dwordx4 v[112:115], v5, s[8:11], s53 offen offset:0 sc1
    buffer_load_dwordx4 v[116:119], v5, s[8:11], s53 offen offset:256 sc1
    buffer_load_dwordx4 v[120:123], v5, s[8:11], s53 offen offset:2048 sc1
    buffer_load_dwordx4 v[124:127], v5, s[8:11], s53 offen offset:2304 sc1
    s_add_u32 s53, s52, 8192
    buffer_load_dwordx4 v[128:131], v5, s[8:11], s53 offen offset:0 sc1
    buffer_load_dwordx4 v[132:135], v5, s[8:11], s53 offen offset:256 sc1
    buffer_load_dwordx4 v[136:139], v5, s[8:11], s53 offen offset:2048 sc1
    buffer_load_dwordx4 v[140:143], v5, s[8:11], s53 offen offset:2304 sc1
    s_add_u32 s53, s52, 12288
    buffer_load_dwordx4 v[144:147], v5, s[8:11], s53 offen offset:0 sc1
    buffer_load_dwordx4 v[148:151], v5, s[8:11], s53 offen offset:256 sc1
    buffer_load_dwordx4 v[152:155], v5, s[8:11], s53 offen offset:2048 sc1
    buffer_load_dwordx4 v[156:159], v5, s[8:11], s53 offen offset:2304 sc1
    s_add_u32 s54, s54, 1
    s_waitcnt vmcnt(0)
    v_max3_u32 v31, v104, v105, v106
    v_max3_u32 v31, v31, v107, v108
    v_max3_u32 v31, v31, v109, v110
    v_max_u32 v31, v31, v111
    v_cmp_eq_u32 vcc, -1, v31
    s_cmp_ge_u32 s54, 400000
    s_cbranch_scc1 L_inte_xback_115
    s_nop 2
    s_cbranch_vccnz L_inte_xloop_195
    s_branch L_inte_xback_115
L_inte_xretry_116:
    s_mov_b32 s54, 0
L_inte_xloop_196:
    s_add_u32 s53, s52, 4096
    buffer_load_dwordx4 v[112:115], v5, s[8:11], s53 offen offset:0 sc1
    buffer_load_dwordx4 v[116:119], v5, s[8:11], s53 offen offset:256 sc1
    buffer_load_dwordx4 v[120:123], v5, s[8:11], s53 offen offset:2048 sc1
    buffer_load_dwordx4 v[124:127], v5, s[8:11], s53 offen offset:2304 sc1
    s_add_u32 s53, s52, 8192
    buffer_load_dwordx4 v[128:131], v5, s[8:11], s53 offen offset:0 sc1
    buffer_load_dwordx4 v[132:135], v5, s[8:11], s53 offen offset:256 sc1
    buffer_load_dwordx4 v[136:139], v5, s[8:11], s53 offen offset:2048 sc1
    buffer_load_dwordx4 v[140:143], v5, s[8:11], s53 offen offset:2304 sc1
    s_add_u32 s53, s52, 12288
    buffer_load_dwordx4 v[144:147], v5, s[8:11], s53 offen offset:0 sc1
    buffer_load_dwordx4 v[148:151], v5, s[8:11], s53 offen offset:256 sc1
    buffer_load_dwordx4 v[152:155], v5, s[8:11], s53 offen offset:2048 sc1
    buffer_load_dwordx4 v[156:159], v5, s[8:11], s53 offen offset:2304 sc1
    s_add_u32 s53, s52, 16384
    buffer_load_dwordx4 v[160:163], v5, s[8:11], s53 offen offset:0 sc1
    buffer_load_dwordx4 v[164:167], v5, s[8:11], s53 offen offset:256 sc1
    s_add_u32 s54, s54, 1
    s_waitcnt vmcnt(0)
    v_max3_u32 v31, v112, v113, v114
    v_max3_u32 v31, v31, v115, v116
    v_max3_u32 v31, v31, v117, v118
    v_max_u32 v31, v31, v119
    v_cmp_eq_u32 vcc, -1, v31
    s_cmp_ge_u32 s54, 400000
    s_cbranch_scc1 L_inte_xback_117
    s_nop 2
    s_cbranch_vccnz L_inte_xloop_196
    s_branch L_inte_xback_117
L_inte_xretry_118:
    s_mov_b32 s54, 0
L_inte_xloop_197:
    s_add_u32 s53, s52, 4096
    buffer_load_dwordx4 v[120:123], v5, s[8:11], s53 offen offset:2048 sc1
    buffer_load_dwordx4 v[124:127], v5, s[8:11], s53 offen offset:2304 sc1
    s_add_u32 s53, s52, 8192
    buffer_load_dwordx4 v[128:131], v5, s[8:11], s53 offen offset:0 sc1
    buffer_load_dwordx4 v[132:135], v5, s[8:11], s53 offen offset:256 sc1
    buffer_load_dwordx4 v[136:139], v5, s[8:11], s53 offen offset:2048 sc1
    buffer_load_dwordx4 v[140:143], v5, s[8:11], s53 offen offset:2304 sc1
    s_add_u32 s53, s52, 12288
    buffer_load_dwordx4 v[144:147], v5, s[8:11], s53 offen offset:0 sc1
    buffer_load_dwordx4 v[148:151], v5, s[8:11], s53 offen offset:256 sc1
    buffer_load_dwordx4 v[152:155], v5, s[8:11], s53 offen offset:2048 sc1
    buffer_load_dwordx4 v[156:159], v5, s[8:11], s53 offen offset:2304 sc1
    s_add_u32 s53, s52, 16384
    buffer_load_dwordx4 v[160:163], v5, s[8:11], s53 offen offset:0 sc1
    buffer_load_dwordx4 v[164:167], v5, s[8:11], s53 offen offset:256 sc1
    buffer_load_dwordx4 v[168:171], v5, s[8:11], s53 offen offset:2048 sc1
    buffer_load_dwordx4 v[172:175], v5, s[8:11], s53 offen offset:2304 sc1
    s_add_u32 s54, s54, 1
    s_waitcnt vmcnt(0)
    v_max3_u32 v31, v120, v121, v122
    v_max3_u32 v31, v31, v123, v124
    v_max3_u32 v31, v31, v125, v126
    v_max_u32 v31, v31, v127
    v_cmp_eq_u32 vcc, -1, v31
    s_cmp_ge_u32 s54, 400000
    s_cbranch_scc1 L_inte_xback_119
    s_nop 2
    s_cbranch_vccnz L_inte_xloop_197
    s_branch L_inte_xback_119
L_inte_xretry_120:
    s_mov_b32 s54, 0
L_inte_xloop_198:
    s_add_u32 s53, s52, 8192
    buffer_load_dwordx4 v[128:131], v5, s[8:11], s53 offen offset:0 sc1
    buffer_load_dwordx4 v[132:135], v5, s[8:11], s53 offen offset:256 sc1
    buffer_load_dwordx4 v[136:139], v5, s[8:11], s53 offen offset:2048 sc1
    buffer_load_dwordx4 v[140:143], v5, s[8:11], s53 offen offset:2304 sc1
    s_add_u32 s53, s52, 12288
    buffer_load_dwordx4 v[144:147], v5, s[8:11], s53 offen offset:0 sc1
    buffer_load_dwordx4 v[148:151], v5, s[8:11], s53 offen offset:256 sc1
    buffer_load_dwordx4 v[152:155], v5, s[8:11], s53 offen offset:2048 sc1
    buffer_load_dwordx4 v[156:159], v5, s[8:11], s53 offen offset:2304 sc1
    s_add_u32 s53, s52, 16384
    buffer_load_dwordx4 v[160:163], v5, s[8:11], s53 offen offset:0 sc1
    buffer_load_dwordx4 v[164:167], v5, s[8:11], s53 offen offset:256 sc1
    buffer_load_dwordx4 v[168:171], v5, s[8:11], s53 offen offset:2048 sc1
    buffer_load_dwordx4 v[172:175], v5, s[8:11], s53 offen offset:2304 sc1
    s_add_u32 s53, s52, 20480
    buffer_load_dwordx4 v[176:179], v5, s[8:11], s53 offen offset:0 sc1
    buffer_load_dwordx4 v[180:183], v5, s[8:11], s53 offen offset:256 sc1
    s_add_u32 s54, s54, 1
    s_waitcnt vmcnt(0)
    v_max3_u32 v31, v128, v129, v130
    v_max3_u32 v31, v31, v131, v132
    v_max3_u32 v31, v31, v133, v134
    v_max_u32 v31, v31, v135
    v_cmp_eq_u32 vcc, -1, v31
    s_cmp_ge_u32 s54, 400000
    s_cbranch_scc1 L_inte_xback_121
    s_nop 2
    s_cbranch_vccnz L_inte_xloop_198
    s_branch L_inte_xback_121
L_inte_xretry_122:
    s_mov_b32 s54, 0
L_inte_xloop_199:
    s_add_u32 s53, s52, 8192
    buffer_load_dwordx4 v[136:139], v5, s[8:11], s53 offen offset:2048 sc1
    buffer_load_dwordx4 v[140:143], v5, s[8:11], s53 offen offset:2304 sc1
    s_add_u32 s53, s52, 12288
    buffer_load_dwordx4 v[144:147], v5, s[8:11], s53 offen offset:0 sc1
    buffer_load_dwordx4 v[148:151], v5, s[8:11], s53 offen offset:256 sc1
    buffer_load_dwordx4 v[152:155], v5, s[8:11], s53 offen offset:2048 sc1
    buffer_load_dwordx4 v[156:159], v5, s[8:11], s53 offen offset:2304 sc1
    s_add_u32 s53, s52, 16384
    buffer_load_dwordx4 v[160:163], v5, s[8:11], s53 offen offset:0 sc1
    buffer_load_dwordx4 v[164:167], v5, s[8:11], s53 offen offset:256 sc1
    buffer_load_dwordx4 v[168:171], v5, s[8:11], s53 offen offset:2048 sc1
    buffer_load_dwordx4 v[172:175], v5, s[8:11], s53 offen offset:2304 sc1
    s_add_u32 s53, s52, 20480
    buffer_load_dwordx4 v[176:179], v5, s[8:11], s53 offen offset:0 sc1
    buffer_load_dwordx4 v[180:183], v5, s[8:11], s53 offen offset:256 sc1
    buffer_load_dwordx4 v[184:187], v5, s[8:11], s53 offen offset:2048 sc1
    buffer_load_dwordx4 v[188:191], v5, s[8:11], s53 offen offset:2304 sc1
    s_add_u32 s54, s54, 1
    s_waitcnt vmcnt(0)
    v_max3_u32 v31, v136, v137, v138
    v_max3_u32 v31, v31, v139, v140
    v_max3_u32 v31, v31, v141, v142
    v_max_u32 v31, v31, v143
    v_cmp_eq_u32 vcc, -1, v31
    s_cmp_ge_u32 s54, 400000
    s_cbranch_scc1 L_inte_xback_123
    s_nop 2
    s_cbranch_vccnz L_inte_xloop_199
    s_branch L_inte_xback_123
L_inte_xretry_124:
    s_mov_b32 s54, 0
L_inte_xloop_200:
    s_add_u32 s53, s52, 12288
    buffer_load_dwordx4 v[144:147], v5, s[8:11], s53 offen offset:0 sc1
    buffer_load_dwordx4 v[148:151], v5, s[8:11], s53 offen offset:256 sc1
    buffer_load_dwordx4 v[152:155], v5, s[8:11], s53 offen offset:2048 sc1
    buffer_load_dwordx4 v[156:159], v5, s[8:11], s53 offen offset:2304 sc1
    s_add_u32 s53, s52, 16384
    buffer_load_dwordx4 v[160:163], v5, s[8:11], s53 offen offset:0 sc1
    buffer_load_dwordx4 v[164:167], v5, s[8:11], s53 offen offset:256 sc1
    buffer_load_dwordx4 v[168:171], v5, s[8:11], s53 offen offset:2048 sc1
    buffer_load_dwordx4 v[172:175], v5, s[8:11], s53 offen offset:2304 sc1
    s_add_u32 s53, s52, 20480
    buffer_load_dwordx4 v[176:179], v5, s[8:11], s53 offen offset:0 sc1
    buffer_load_dwordx4 v[180:183], v5, s[8:11], s53 offen offset:256 sc1
    buffer_load_dwordx4 v[184:187], v5, s[8:11], s53 offen offset:2048 sc1
    buffer_load_dwordx4 v[188:191], v5, s[8:11], s53 offen offset:2304 sc1
    s_add_u32 s53, s52, 24576
    buffer_load_dwordx4 v[192:195], v5, s[8:11], s53 offen offset:0 sc1
    buffer_load_dwordx4 v[196:199], v5, s[8:11], s53 offen offset:256 sc1
    s_add_u32 s54, s54, 1
    s_waitcnt vmcnt(0)
    v_max3_u32 v31, v144, v145, v146
    v_max3_u32 v31, v31, v147, v148
    v_max3_u32 v31, v31, v149, v150
    v_max_u32 v31, v31, v151
    v_cmp_eq_u32 vcc, -1, v31
    s_cmp_ge_u32 s54, 400000
    s_cbranch_scc1 L_inte_xback_125
    s_nop 2
    s_cbranch_vccnz L_inte_xloop_200
    s_branch L_inte_xback_125
L_inte_xretry_126:
    s_mov_b32 s54, 0
L_inte_xloop_201:
    s_add_u32 s53, s52, 12288
    buffer_load_dwordx4 v[152:155], v5, s[8:11], s53 offen offset:2048 sc1
    buffer_load_dwordx4 v[156:159], v5, s[8:11], s53 offen offset:2304 sc1
    s_add_u32 s53, s52, 16384
    buffer_load_dwordx4 v[160:163], v5, s[8:11], s53 offen offset:0 sc1
    buffer_load_dwordx4 v[164:167], v5, s[8:11], s53 offen offset:256 sc1
    buffer_load_dwordx4 v[168:171], v5, s[8:11], s53 offen offset:2048 sc1
    buffer_load_dwordx4 v[172:175], v5, s[8:11], s53 offen offset:2304 sc1
    s_add_u32 s53, s52, 20480
    buffer_load_dwordx4 v[176:179], v5, s[8:11], s53 offen offset:0 sc1
    buffer_load_dwordx4 v[180:183], v5, s[8:11], s53 offen offset:256 sc1
    buffer_load_dwordx4 v[184:187], v5, s[8:11], s53 offen offset:2048 sc1
    buffer_load_dwordx4 v[188:191], v5, s[8:11], s53 offen offset:2304 sc1
    s_add_u32 s53, s52, 24576
    buffer_load_dwordx4 v[192:195], v5, s[8:11], s53 offen offset:0 sc1
    buffer_load_dwordx4 v[196:199], v5, s[8:11], s53 offen offset:256 sc1
    buffer_load_dwordx4 v[200:203], v5, s[8:11], s53 offen offset:2048 sc1
    buffer_load_dwordx4 v[204:207], v5, s[8:11], s53 offen offset:2304 sc1
    s_add_u32 s54, s54, 1
    s_waitcnt vmcnt(0)
    v_max3_u32 v31, v152, v153, v154
    v_max3_u32 v31, v31, v155, v156
    v_max3_u32 v31, v31, v157, v158
    v_max_u32 v31, v31, v159
    v_cmp_eq_u32 vcc, -1, v31
    s_cmp_ge_u32 s54, 400000
    s_cbranch_scc1 L_inte_xback_127
    s_nop 2
    s_cbranch_vccnz L_inte_xloop_201
    s_branch L_inte_xback_127
L_inte_xretry_128:
    s_mov_b32 s54, 0
L_inte_xloop_202:
    s_add_u32 s53, s52, 16384
    buffer_load_dwordx4 v[160:163], v5, s[8:11], s53 offen offset:0 sc1
    buffer_load_dwordx4 v[164:167], v5, s[8:11], s53 offen offset:256 sc1
    buffer_load_dwordx4 v[168:171], v5, s[8:11], s53 offen offset:2048 sc1
    buffer_load_dwordx4 v[172:175], v5, s[8:11], s53 offen offset:2304 sc1
    s_add_u32 s53, s52, 20480
    buffer_load_dwordx4 v[176:179], v5, s[8:11], s53 offen offset:0 sc1
    buffer_load_dwordx4 v[180:183], v5, s[8:11], s53 offen offset:256 sc1
    buffer_load_dwordx4 v[184:187], v5, s[8:11], s53 offen offset:2048 sc1
    buffer_load_dwordx4 v[188:191], v5, s[8:11], s53 offen offset:2304 sc1
    s_add_u32 s53, s52, 24576
    buffer_load_dwordx4 v[192:195], v5, s[8:11], s53 offen offset:0 sc1
    buffer_load_dwordx4 v[196:199], v5, s[8:11], s53 offen offset:256 sc1
    buffer_load_dwordx4 v[200:203], v5, s[8:11], s53 offen offset:2048 sc1
    buffer_load_dwordx4 v[204:207], v5, s[8:11], s53 offen offset:2304 sc1
    s_add_u32 s53, s52, 28672
    buffer_load_dwordx4 v[208:211], v5, s[8:11], s53 offen offset:0 sc1
    buffer_load_dwordx4 v[212:215], v5, s[8:11], s53 offen offset:256 sc1
    s_add_u32 s54, s54, 1
    s_waitcnt vmcnt(0)
    v_max3_u32 v31, v160, v161, v162
    v_max3_u32 v31, v31, v163, v164
    v_max3_u32 v31, v31, v165, v166
    v_max_u32 v31, v31, v167
    v_cmp_eq_u32 vcc, -1, v31
    s_cmp_ge_u32 s54, 400000
    s_cbranch_scc1 L_inte_xback_129
    s_nop 2
    s_cbranch_vccnz L_inte_xloop_202
    s_branch L_inte_xback_129
L_inte_xretry_130:
    s_mov_b32 s54, 0
L_inte_xloop_203:
    s_add_u32 s53, s52, 16384
    buffer_load_dwordx4 v[168:171], v5, s[8:11], s53 offen offset:2048 sc1
    buffer_load_dwordx4 v[172:175], v5, s[8:11], s53 offen offset:2304 sc1
    s_add_u32 s53, s52, 20480
    buffer_load_dwordx4 v[176:179], v5, s[8:11], s53 offen offset:0 sc1
    buffer_load_dwordx4 v[180:183], v5, s[8:11], s53 offen offset:256 sc1
    buffer_load_dwordx4 v[184:187], v5, s[8:11], s53 offen offset:2048 sc1
    buffer_load_dwordx4 v[188:191], v5, s[8:11], s53 offen offset:2304 sc1
    s_add_u32 s53, s52, 24576
    buffer_load_dwordx4 v[192:195], v5, s[8:11], s53 offen offset:0 sc1
    buffer_load_dwordx4 v[196:199], v5, s[8:11], s53 offen offset:256 sc1
    buffer_load_dwordx4 v[200:203], v5, s[8:11], s53 offen offset:2048 sc1
    buffer_load_dwordx4 v[204:207], v5, s[8:11], s53 offen offset:2304 sc1
    s_add_u32 s53, s52, 28672
    buffer_load_dwordx4 v[208:211], v5, s[8:11], s53 offen offset:0 sc1
    buffer_load_dwordx4 v[212:215], v5, s[8:11], s53 offen offset:256 sc1
    buffer_load_dwordx4 v[216:219], v5, s[8:11], s53 offen offset:2048 sc1
    buffer_load_dwordx4 v[220:223], v5, s[8:11], s53 offen offset:2304 sc1
    s_add_u32 s54, s54, 1
    s_waitcnt vmcnt(0)
    v_max3_u32 v31, v168, v169, v170
    v_max3_u32 v31, v31, v171, v172
    v_max3_u32 v31, v31, v173, v174
    v_max_u32 v31, v31, v175
    v_cmp_eq_u32 vcc, -1, v31
    s_cmp_ge_u32 s54, 400000
    s_cbranch_scc1 L_inte_xback_131
    s_nop 2
    s_cbranch_vccnz L_inte_xloop_203
    s_branch L_inte_xback_131
L_inte_xretry_132:
    s_mov_b32 s54, 0
L_inte_xloop_204:
    s_add_u32 s53, s52, 20480
    buffer_load_dwordx4 v[176:179], v5, s[8:11], s53 offen offset:0 sc1
    buffer_load_dwordx4 v[180:183], v5, s[8:11], s53 offen offset:256 sc1
    buffer_load_dwordx4 v[184:187], v5, s[8:11], s53 offen offset:2048 sc1
    buffer_load_dwordx4 v[188:191], v5, s[8:11], s53 offen offset:2304 sc1
    s_add_u32 s53, s52, 24576
    buffer_load_dwordx4 v[192:195], v5, s[8:11], s53 offen offset:0 sc1
    buffer_load_dwordx4 v[196:199], v5, s[8:11], s53 offen offset:256 sc1
    buffer_load_dwordx4 v[200:203], v5, s[8:11], s53 offen offset:2048 sc1
    buffer_load_dwordx4 v[204:207], v5, s[8:11], s53 offen offset:2304 sc1
    s_add_u32 s53, s52, 28672
    buffer_load_dwordx4 v[208:211], v5, s[8:11], s53 offen offset:0 sc1
    buffer_load_dwordx4 v[212:215], v5, s[8:11], s53 offen offset:256 sc1
    buffer_load_dwordx4 v[216:219], v5, s[8:11], s53 offen offset:2048 sc1
    buffer_load_dwordx4 v[220:223], v5, s[8:11], s53 offen offset:2304 sc1
    s_add_u32 s53, s52, 32768
    buffer_load_dwordx4 v[224:227], v5, s[8:11], s53 offen offset:0 sc1
    buffer_load_dwordx4 v[228:231], v5, s[8:11], s53 offen offset:256 sc1
    s_add_u32 s54, s54, 1
    s_waitcnt vmcnt(0)
    v_max3_u32 v31, v176, v177, v178
    v_max3_u32 v31, v31, v179, v180
    v_max3_u32 v31, v31, v181, v182
    v_max_u32 v31, v31, v183
    v_cmp_eq_u32 vcc, -1, v31
    s_cmp_ge_u32 s54, 400000
    s_cbranch_scc1 L_inte_xback_133
    s_nop 2
    s_cbranch_vccnz L_inte_xloop_204
    s_branch L_inte_xback_133
L_inte_xretry_134:
    s_mov_b32 s54, 0
L_inte_xloop_205:
    s_add_u32 s53, s52, 20480
    buffer_load_dwordx4 v[184:187], v5, s[8:11], s53 offen offset:2048 sc1
    buffer_load_dwordx4 v[188:191], v5, s[8:11], s53 offen offset:2304 sc1
    s_add_u32 s53, s52, 24576
    buffer_load_dwordx4 v[192:195], v5, s[8:11], s53 offen offset:0 sc1
    buffer_load_dwordx4 v[196:199], v5, s[8:11], s53 offen offset:256 sc1
    buffer_load_dwordx4 v[200:203], v5, s[8:11], s53 offen offset:2048 sc1
    buffer_load_dwordx4 v[204:207], v5, s[8:11], s53 offen offset:2304 sc1
    s_add_u32 s53, s52, 28672
    buffer_load_dwordx4 v[208:211], v5, s[8:11], s53 offen offset:0 sc1
    buffer_load_dwordx4 v[212:215], v5, s[8:11], s53 offen offset:256 sc1
    buffer_load_dwordx4 v[216:219], v5, s[8:11], s53 offen offset:2048 sc1
    buffer_load_dwordx4 v[220:223], v5, s[8:11], s53 offen offset:2304 sc1
    s_add_u32 s53, s52, 32768
    buffer_load_dwordx4 v[224:227], v5, s[8:11], s53 offen offset:0 sc1
    buffer_load_dwordx4 v[228:231], v5, s[8:11], s53 offen offset:256 sc1
    buffer_load_dwordx4 v[232:235], v5, s[8:11], s53 offen offset:2048 sc1
    buffer_load_dwordx4 v[236:239], v5, s[8:11], s53 offen offset:2304 sc1
    s_add_u32 s54, s54, 1
    s_waitcnt vmcnt(0)
    v_max3_u32 v31, v184, v185, v186
    v_max3_u32 v31, v31, v187, v188
    v_max3_u32 v31, v31, v189, v190
    v_max_u32 v31, v31, v191
    v_cmp_eq_u32 vcc, -1, v31
    s_cmp_ge_u32 s54, 400000
    s_cbranch_scc1 L_inte_xback_135
    s_nop 2
    s_cbranch_vccnz L_inte_xloop_205
    s_branch L_inte_xback_135
L_inte_xretry_136:
    s_mov_b32 s54, 0
L_inte_xloop_206:
    s_add_u32 s53, s52, 24576
    buffer_load_dwordx4 v[192:195], v5, s[8:11], s53 offen offset:0 sc1
    buffer_load_dwordx4 v[196:199], v5, s[8:11], s53 offen offset:256 sc1
    buffer_load_dwordx4 v[200:203], v5, s[8:11], s53 offen offset:2048 sc1
    buffer_load_dwordx4 v[204:207], v5, s[8:11], s53 offen offset:2304 sc1
    s_add_u32 s53, s52, 28672
    buffer_load_dwordx4 v[208:211], v5, s[8:11], s53 offen offset:0 sc1
    buffer_load_dwordx4 v[212:215], v5, s[8:11], s53 offen offset:256 sc1
    buffer_load_dwordx4 v[216:219], v5, s[8:11], s53 offen offset:2048 sc1
    buffer_load_dwordx4 v[220:223], v5, s[8:11], s53 offen offset:2304 sc1
    s_add_u32 s53, s52, 32768
    buffer_load_dwordx4 v[224:227], v5, s[8:11], s53 offen offset:0 sc1
    buffer_load_dwordx4 v[228:231], v5, s[8:11], s53 offen offset:256 sc1
    buffer_load_dwordx4 v[232:235], v5, s[8:11], s53 offen offset:2048 sc1
    buffer_load_dwordx4 v[236:239], v5, s[8:11], s53 offen offset:2304 sc1
    s_add_u32 s53, s52, 36864
    buffer_load_dwordx4 v[240:243], v5, s[8:11], s53 offen offset:0 sc1
    buffer_load_dwordx4 v[244:247], v5, s[8:11], s53 offen offset:256 sc1
    s_add_u32 s54, s54, 1
    s_waitcnt vmcnt(0)
    v_max3_u32 v31, v192, v193, v194
    v_max3_u32 v31, v31, v195, v196
    v_max3_u32 v31, v31, v197, v198
    v_max_u32 v31, v31, v199
    v_cmp_eq_u32 vcc, -1, v31
    s_cmp_ge_u32 s54, 400000
    s_cbranch_scc1 L_inte_xback_137
    s_nop 2
    s_cbranch_vccnz L_inte_xloop_206
    s_branch L_inte_xback_137
L_inte_xretry_138:
    s_mov_b32 s54, 0
L_inte_xloop_207:
    s_add_u32 s53, s52, 24576
    buffer_load_dwordx4 v[200:203], v5, s[8:11], s53 offen offset:2048 sc1
    buffer_load_dwordx4 v[204:207], v5, s[8:11], s53 offen offset:2304 sc1
    s_add_u32 s53, s52, 28672
    buffer_load_dwordx4 v[208:211], v5, s[8:11], s53 offen offset:0 sc1
    buffer_load_dwordx4 v[212:215], v5, s[8:11], s53 offen offset:256 sc1
    buffer_load_dwordx4 v[216:219], v5, s[8:11], s53 offen offset:2048 sc1
    buffer_load_dwordx4 v[220:223], v5, s[8:11], s53 offen offset:2304 sc1
    s_add_u32 s53, s52, 32768
    buffer_load_dwordx4 v[224:227], v5, s[8:11], s53 offen offset:0 sc1
    buffer_load_dwordx4 v[228:231], v5, s[8:11], s53 offen offset:256 sc1
    buffer_load_dwordx4 v[232:235], v5, s[8:11], s53 offen offset:2048 sc1
    buffer_load_dwordx4 v[236:239], v5, s[8:11], s53 offen offset:2304 sc1
    s_add_u32 s53, s52, 36864
    buffer_load_dwordx4 v[240:243], v5, s[8:11], s53 offen offset:0 sc1
    buffer_load_dwordx4 v[244:247], v5, s[8:11], s53 offen offset:256 sc1
    buffer_load_dwordx4 v[248:251], v5, s[8:11], s53 offen offset:2048 sc1
    buffer_load_dwordx4 v[252:255], v5, s[8:11], s53 offen offset:2304 sc1
    s_add_u32 s54, s54, 1
    s_waitcnt vmcnt(0)
    v_max3_u32 v31, v200, v201, v202
    v_max3_u32 v31, v31, v203, v204
    v_max3_u32 v31, v31, v205, v206
    v_max_u32 v31, v31, v207
    v_cmp_eq_u32 vcc, -1, v31
    s_cmp_ge_u32 s54, 400000
    s_cbranch_scc1 L_inte_xback_139
    s_nop 2
    s_cbranch_vccnz L_inte_xloop_207
    s_branch L_inte_xback_139
L_inte_xretry_140:
    s_mov_b32 s54, 0
L_inte_xloop_208:
    s_add_u32 s53, s52, 28672
    buffer_load_dwordx4 v[208:211], v5, s[8:11], s53 offen offset:0 sc1
    buffer_load_dwordx4 v[212:215], v5, s[8:11], s53 offen offset:256 sc1
    buffer_load_dwordx4 v[216:219], v5, s[8:11], s53 offen offset:2048 sc1
    buffer_load_dwordx4 v[220:223], v5, s[8:11], s53 offen offset:2304 sc1
    s_add_u32 s53, s52, 32768
    buffer_load_dwordx4 v[224:227], v5, s[8:11], s53 offen offset:0 sc1
    buffer_load_dwordx4 v[228:231], v5, s[8:11], s53 offen offset:256 sc1
    buffer_load_dwordx4 v[232:235], v5, s[8:11], s53 offen offset:2048 sc1
    buffer_load_dwordx4 v[236:239], v5, s[8:11], s53 offen offset:2304 sc1
    s_add_u32 s53, s52, 36864
    buffer_load_dwordx4 v[240:243], v5, s[8:11], s53 offen offset:0 sc1
    buffer_load_dwordx4 v[244:247], v5, s[8:11], s53 offen offset:256 sc1
    buffer_load_dwordx4 v[248:251], v5, s[8:11], s53 offen offset:2048 sc1
    buffer_load_dwordx4 v[252:255], v5, s[8:11], s53 offen offset:2304 sc1
    s_add_u32 s54, s54, 1
    s_waitcnt vmcnt(0)
    v_max3_u32 v31, v208, v209, v210
    v_max3_u32 v31, v31, v211, v212
    v_max3_u32 v31, v31, v213, v214
    v_max_u32 v31, v31, v215
    v_cmp_eq_u32 vcc, -1, v31
    s_cmp_ge_u32 s54, 400000
    s_cbranch_scc1 L_inte_xback_141
    s_nop 2
    s_cbranch_vccnz L_inte_xloop_208
    s_branch L_inte_xback_141
L_inte_xretry_142:
    s_mov_b32 s54, 0
L_inte_xloop_209:
    s_add_u32 s53, s52, 28672
    buffer_load_dwordx4 v[216:219], v5, s[8:11], s53 offen offset:2048 sc1
    buffer_load_dwordx4 v[220:223], v5, s[8:11], s53 offen offset:2304 sc1
    s_add_u32 s53, s52, 32768
    buffer_load_dwordx4 v[224:227], v5, s[8:11], s53 offen offset:0 sc1
    buffer_load_dwordx4 v[228:231], v5, s[8:11], s53 offen offset:256 sc1
    buffer_load_dwordx4 v[232:235], v5, s[8:11], s53 offen offset:2048 sc1
    buffer_load_dwordx4 v[236:239], v5, s[8:11], s53 offen offset:2304 sc1
    s_add_u32 s53, s52, 36864
    buffer_load_dwordx4 v[240:243], v5, s[8:11], s53 offen offset:0 sc1
    buffer_load_dwordx4 v[244:247], v5, s[8:11], s53 offen offset:256 sc1
    buffer_load_dwordx4 v[248:251], v5, s[8:11], s53 offen offset:2048 sc1
    buffer_load_dwordx4 v[252:255], v5, s[8:11], s53 offen offset:2304 sc1
    s_add_u32 s54, s54, 1
    s_waitcnt vmcnt(0)
    v_max3_u32 v31, v216, v217, v218
    v_max3_u32 v31, v31, v219, v220
    v_max3_u32 v31, v31, v221, v222
    v_max_u32 v31, v31, v223
    v_cmp_eq_u32 vcc, -1, v31
    s_cmp_ge_u32 s54, 400000
    s_cbranch_scc1 L_inte_xback_143
    s_nop 2
    s_cbranch_vccnz L_inte_xloop_209
    s_branch L_inte_xback_143
L_inte_xretry_144:
    s_mov_b32 s54, 0
L_inte_xloop_210:
    s_add_u32 s53, s52, 32768
    buffer_load_dwordx4 v[224:227], v5, s[8:11], s53 offen offset:0 sc1
    buffer_load_dwordx4 v[228:231], v5, s[8:11], s53 offen offset:256 sc1
    buffer_load_dwordx4 v[232:235], v5, s[8:11], s53 offen offset:2048 sc1
    buffer_load_dwordx4 v[236:239], v5, s[8:11], s53 offen offset:2304 sc1
    s_add_u32 s53, s52, 36864
    buffer_load_dwordx4 v[240:243], v5, s[8:11], s53 offen offset:0 sc1
    buffer_load_dwordx4 v[244:247], v5, s[8:11], s53 offen offset:256 sc1
    buffer_load_dwordx4 v[248:251], v5, s[8:11], s53 offen offset:2048 sc1
    buffer_load_dwordx4 v[252:255], v5, s[8:11], s53 offen offset:2304 sc1
    s_add_u32 s54, s54, 1
    s_waitcnt vmcnt(0)
    v_max3_u32 v31, v224, v225, v226
    v_max3_u32 v31, v31, v227, v228
    v_max3_u32 v31, v31, v229, v230
    v_max_u32 v31, v31, v231
    v_cmp_eq_u32 vcc, -1, v31
    s_cmp_ge_u32 s54, 400000
    s_cbranch_scc1 L_inte_xback_145
    s_nop 2
    s_cbranch_vccnz L_inte_xloop_210
    s_branch L_inte_xback_145
L_inte_xretry_146:
    s_mov_b32 s54, 0
L_inte_xloop_211:
    s_add_u32 s53, s52, 32768
    buffer_load_dwordx4 v[232:235], v5, s[8:11], s53 offen offset:2048 sc1
    buffer_load_dwordx4 v[236:239], v5, s[8:11], s53 offen offset:2304 sc1
    s_add_u32 s53, s52, 36864
    buffer_load_dwordx4 v[240:243], v5, s[8:11], s53 offen offset:0 sc1
    buffer_load_dwordx4 v[244:247], v5, s[8:11], s53 offen offset:256 sc1
    buffer_load_dwordx4 v[248:251], v5, s[8:11], s53 offen offset:2048 sc1
    buffer_load_dwordx4 v[252:255], v5, s[8:11], s53 offen offset:2304 sc1
    s_add_u32 s54, s54, 1
    s_waitcnt vmcnt(0)
    v_max3_u32 v31, v232, v233, v234
    v_max3_u32 v31, v31, v235, v236
    v_max3_u32 v31, v31, v237, v238
    v_max_u32 v31, v31, v239
    v_cmp_eq_u32 vcc, -1, v31
    s_cmp_ge_u32 s54, 400000
    s_cbranch_scc1 L_inte_xback_147
    s_nop 2
    s_cbranch_vccnz L_inte_xloop_211
    s_branch L_inte_xback_147
L_inte_xretry_148:
    s_mov_b32 s54, 0
L_inte_xloop_212:
    s_add_u32 s53, s52, 36864
    buffer_load_dwordx4 v[240:243], v5, s[8:11], s53 offen offset:0 sc1
    buffer_load_dwordx4 v[244:247], v5, s[8:11], s53 offen offset:256 sc1
    buffer_load_dwordx4 v[248:251], v5, s[8:11], s53 offen offset:2048 sc1
    buffer_load_dwordx4 v[252:255], v5, s[8:11], s53 offen offset:2304 sc1
    s_add_u32 s54, s54, 1
    s_waitcnt vmcnt(0)
    v_max3_u32 v31, v240, v241, v242
    v_max3_u32 v31, v31, v243, v244
    v_max3_u32 v31, v31, v245, v246
    v_max_u32 v31, v31, v247
    v_cmp_eq_u32 vcc, -1, v31
    s_cmp_ge_u32 s54, 400000
    s_cbranch_scc1 L_inte_xback_149
    s_nop 2
    s_cbranch_vccnz L_inte_xloop_212
    s_branch L_inte_xback_149
L_inte_xretry_150:
    s_mov_b32 s54, 0
L_inte_xloop_213:
    s_add_u32 s53, s52, 36864
    buffer_load_dwordx4 v[248:251], v5, s[8:11], s53 offen offset:2048 sc1
    buffer_load_dwordx4 v[252:255], v5, s[8:11], s53 offen offset:2304 sc1
    s_add_u32 s54, s54, 1
    s_waitcnt vmcnt(0)
    v_max3_u32 v31, v248, v249, v250
    v_max3_u32 v31, v31, v251, v252
    v_max3_u32 v31, v31, v253, v254
    v_max_u32 v31, v31, v255
    v_cmp_eq_u32 vcc, -1, v31
    s_cmp_ge_u32 s54, 400000
    s_cbranch_scc1 L_inte_xback_151
    s_nop 2
    s_cbranch_vccnz L_inte_xloop_213
    s_branch L_inte_xback_151
L_inte_retry_152:
    s_mov_b32 s91, 0
    s_lshl1_add_u32 s88, s39, s80
L_inte_loop_214:
    buffer_load_dwordx4 v[96:99], v12, s[8:11], s88 offen sc1
    buffer_load_dwordx4 v[100:103], v13, s[8:11], s88 offen sc1
    buffer_load_dwordx4 v[104:107], v14, s[8:11], s88 offen sc1
    buffer_load_dwordx4 v[108:111], v15, s[8:11], s88 offen sc1
    s_add_u32 s91, s91, 1
    s_waitcnt vmcnt(0)
    v_min3_u32 v10, v96, v97, v98
    v_min3_u32 v10, v10, v99, v100
    v_min3_u32 v10, v10, v101, v102
    v_min3_u32 v10, v10, v103, v104
    v_min3_u32 v10, v10, v105, v106
    v_min3_u32 v10, v10, v107, v108
    v_min3_u32 v10, v10, v109, v110
    v_min_u32 v10, v10, v111
    v_cmp_le_i32 vcc, 0, v10
    s_cmp_ge_u32 s91, 400000
    s_cbranch_scc1 L_inte_back_153
    s_nop 2
    s_cbranch_vccnz L_inte_loop_214
    s_branch L_inte_back_153
L_inte_retry_154:
    s_mov_b32 s91, 0
    s_lshl1_add_u32 s88, s40, s80
L_inte_loop_215:
    buffer_load_dwordx4 v[112:115], v12, s[8:11], s88 offen sc1
    buffer_load_dwordx4 v[116:119], v13, s[8:11], s88 offen sc1
    buffer_load_dwordx4 v[120:123], v14, s[8:11], s88 offen sc1
    buffer_load_dwordx4 v[124:127], v15, s[8:11], s88 offen sc1
    s_add_u32 s91, s91, 1
    s_waitcnt vmcnt(0)
    v_min3_u32 v10, v112, v113, v114
    v_min3_u32 v10, v10, v115, v116
    v_min3_u32 v10, v10, v117, v118
    v_min3_u32 v10, v10, v119, v120
    v_min3_u32 v10, v10, v121, v122
    v_min3_u32 v10, v10, v123, v124
    v_min3_u32 v10, v10, v125, v126
    v_min_u32 v10, v10, v127
    v_cmp_le_i32 vcc, 0, v10
    s_cmp_ge_u32 s91, 400000
    s_cbranch_scc1 L_inte_back_155
    s_nop 2
    s_cbranch_vccnz L_inte_loop_215
    s_branch L_inte_back_155
L_inte_retry_156:
    s_mov_b32 s91, 0
    s_lshl1_add_u32 s88, s41, s80
L_inte_loop_216:
    buffer_load_dwordx4 v[128:131], v12, s[8:11], s88 offen sc1
    buffer_load_dwordx4 v[132:135], v13, s[8:11], s88 offen sc1
    buffer_load_dwordx4 v[136:139], v14, s[8:11], s88 offen sc1
    buffer_load_dwordx4 v[140:143], v15, s[8:11], s88 offen sc1
    s_add_u32 s91, s91, 1
    s_waitcnt vmcnt(0)
    v_min3_u32 v10, v128, v129, v130
    v_min3_u32 v10, v10, v131, v132
    v_min3_u32 v10, v10, v133, v134
    v_min3_u32 v10, v10, v135, v136
    v_min3_u32 v10, v10, v137, v138
    v_min3_u32 v10, v10, v139, v140
    v_min3_u32 v10, v10, v141, v142
    v_min_u32 v10, v10, v143
    v_cmp_le_i32 vcc, 0, v10
    s_cmp_ge_u32 s91, 400000
    s_cbranch_scc1 L_inte_back_157
    s_nop 2
    s_cbranch_vccnz L_inte_loop_216
    s_branch L_inte_back_157
L_inte_retry_158:
    s_mov_b32 s91, 0
    s_lshl1_add_u32 s88, s42, s80
L_inte_loop_217:
    buffer_load_dwordx4 v[144:147], v12, s[8:11], s88 offen sc1
    buffer_load_dwordx4 v[148:151], v13, s[8:11], s88 offen sc1
    buffer_load_dwordx4 v[152:155], v14, s[8:11], s88 offen sc1
    buffer_load_dwordx4 v[156:159], v15, s[8:11], s88 offen sc1
    s_add_u32 s91, s91, 1
    s_waitcnt vmcnt(0)
    v_min3_u32 v10, v144, v145, v146
    v_min3_u32 v10, v10, v147, v148
    v_min3_u32 v10, v10, v149, v150
    v_min3_u32 v10, v10, v151, v152
    v_min3_u32 v10, v10, v153, v154
    v_min3_u32 v10, v10, v155, v156
    v_min3_u32 v10, v10, v157, v158
    v_min_u32 v10, v10, v159
    v_cmp_le_i32 vcc, 0, v10
    s_cmp_ge_u32 s91, 400000
    s_cbranch_scc1 L_inte_back_159
    s_nop 2
    s_cbranch_vccnz L_inte_loop_217
    s_branch L_inte_back_159
L_inte_retry_160:
    s_mov_b32 s91, 0
    s_mov_b32 s88, s81
L_inte_loop_218:
    buffer_load_dwordx4 v[160:163], v12, s[8:11], s88 offen sc1
    buffer_load_dwordx4 v[164:167], v13, s[8:11], s88 offen sc1
    buffer_load_dwordx4 v[168:171], v14, s[8:11], s88 offen sc1
    buffer_load_dwordx4 v[172:175], v15, s[8:11], s88 offen sc1
    s_add_u32 s91, s91, 1
    s_waitcnt vmcnt(0)
    v_min3_u32 v10, v160, v161, v162
    v_min3_u32 v10, v10, v163, v164
    v_min3_u32 v10, v10, v165, v166
    v_min3_u32 v10, v10, v167, v168
    v_min3_u32 v10, v10, v169, v170
    v_min3_u32 v10, v10, v171, v172
    v_min3_u32 v10, v10, v173, v174
    v_min_u32 v10, v10, v175
    v_cmp_le_i32 vcc, 0, v10
    s_cmp_ge_u32 s91, 400000
    s_cbranch_scc1 L_inte_back_161
    s_nop 2
    s_cbranch_vccnz L_inte_loop_218
    s_branch L_inte_back_161
L_inte_retry_162:
    s_mov_b32 s91, 0
    s_mov_b32 s88, s82
L_inte_loop_219:
    buffer_load_dwordx4 v[176:179], v12, s[8:11], s88 offen sc1
    buffer_load_dwordx4 v[180:183], v13, s[8:11], s88 offen sc1
    s_add_u32 s91, s91, 1
    s_waitcnt vmcnt(0)
    v_min3_u32 v10, v176, v177, v178
    v_min3_u32 v10, v10, v179, v180
    v_min3_u32 v10, v10, v181, v182
    v_min_u32 v10, v10, v183
    v_cmp_le_i32 vcc, 0, v10
    s_cmp_ge_u32 s91, 400000
    s_cbranch_scc1 L_inte_back_163
    s_nop 2
    s_cbranch_vccnz L_inte_loop_219
    s_branch L_inte_back_163
L_inte_retry_164:
    s_mov_b32 s91, 0
    s_lshl1_add_u32 s88, s39, s24
L_inte_loop_220:
    buffer_load_dwordx4 v[192:195], v12, s[8:11], s88 offen sc1
    buffer_load_dwordx4 v[196:199], v13, s[8:11], s88 offen sc1
    buffer_load_dwordx4 v[200:203], v14, s[8:11], s88 offen sc1
    buffer_load_dwordx4 v[204:207], v15, s[8:11], s88 offen sc1
    s_add_u32 s91, s91, 1
    s_waitcnt vmcnt(0)
    v_min3_u32 v10, v192, v193, v194
    v_min3_u32 v10, v10, v195, v196
    v_min3_u32 v10, v10, v197, v198
    v_min3_u32 v10, v10, v199, v200
    v_min3_u32 v10, v10, v201, v202
    v_min3_u32 v10, v10, v203, v204
    v_min3_u32 v10, v10, v205, v206
    v_min_u32 v10, v10, v207
    v_cmp_le_i32 vcc, 0, v10
    s_cmp_ge_u32 s91, 400000
    s_cbranch_scc1 L_inte_back_165
    s_nop 2
    s_cbranch_vccnz L_inte_loop_220
    s_branch L_inte_back_165
L_inte_retry_166:
    s_mov_b32 s91, 0
    s_lshl1_add_u32 s88, s40, s24
L_inte_loop_221:
    buffer_load_dwordx4 v[96:99], v12, s[8:11], s88 offen sc1
    buffer_load_dwordx4 v[100:103], v13, s[8:11], s88 offen sc1
    buffer_load_dwordx4 v[104:107], v14, s[8:11], s88 offen sc1
    buffer_load_dwordx4 v[108:111], v15, s[8:11], s88 offen sc1
    s_add_u32 s91, s91, 1
    s_waitcnt vmcnt(0)
    v_min3_u32 v10, v96, v97, v98
    v_min3_u32 v10, v10, v99, v100
    v_min3_u32 v10, v10, v101, v102
    v_min3_u32 v10, v10, v103, v104
    v_min3_u32 v10, v10, v105, v106
    v_min3_u32 v10, v10, v107, v108
    v_min3_u32 v10, v10, v109, v110
    v_min_u32 v10, v10, v111
    v_cmp_le_i32 vcc, 0, v10
    s_cmp_ge_u32 s91, 400000
    s_cbranch_scc1 L_inte_back_167
    s_nop 2
    s_cbranch_vccnz L_inte_loop_221
    s_branch L_inte_back_167
L_inte_retry_168:
    s_mov_b32 s91, 0
    s_lshl1_add_u32 s88, s41, s24
L_inte_loop_222:
    buffer_load_dwordx4 v[112:115], v12, s[8:11], s88 offen sc1
    buffer_load_dwordx4 v[116:119], v13, s[8:11], s88 offen sc1
    buffer_load_dwordx4 v[120:123], v14, s[8:11], s88 offen sc1
    buffer_load_dwordx4 v[124:127], v15, s[8:11], s88 offen sc1
    s_add_u32 s91, s91, 1
    s_waitcnt vmcnt(0)
    v_min3_u32 v10, v112, v113, v114
    v_min3_u32 v10, v10, v115, v116
    v_min3_u32 v10, v10, v117, v118
    v_min3_u32 v10, v10, v119, v120
    v_min3_u32 v10, v10, v121, v122
    v_min3_u32 v10, v10, v123, v124
    v_min3_u32 v10, v10, v125, v126
    v_min_u32 v10, v10, v127
    v_cmp_le_i32 vcc, 0, v10
    s_cmp_ge_u32 s91, 400000
    s_cbranch_scc1 L_inte_back_169
    s_nop 2
    s_cbranch_vccnz L_inte_loop_222
    s_branch L_inte_back_169
L_inte_retry_170:
    s_mov_b32 s91, 0
    s_lshl1_add_u32 s88, s42, s24
L_inte_loop_223:
    buffer_load_dwordx4 v[128:131], v12, s[8:11], s88 offen sc1
    buffer_load_dwordx4 v[132:135], v13, s[8:11], s88 offen sc1
    buffer_load_dwordx4 v[136:139], v14, s[8:11], s88 offen sc1
    buffer_load_dwordx4 v[140:143], v15, s[8:11], s88 offen sc1
    s_add_u32 s91, s91, 1
    s_waitcnt vmcnt(0)
    v_min3_u32 v10, v128, v129, v130
    v_min3_u32 v10, v10, v131, v132
    v_min3_u32 v10, v10, v133, v134
    v_min3_u32 v10, v10, v135, v136
    v_min3_u32 v10, v10, v137, v138
    v_min3_u32 v10, v10, v139, v140
    v_min3_u32 v10, v10, v141, v142
    v_min_u32 v10, v10, v143
    v_cmp_le_i32 vcc, 0, v10
    s_cmp_ge_u32 s91, 400000
    s_cbranch_scc1 L_inte_back_171
    s_nop 2
    s_cbranch_vccnz L_inte_loop_223
    s_branch L_inte_back_171
L_inte_retry_172:
    s_mov_b32 s91, 0
    s_add_u32 s88, s39, s83
L_inte_loop_224:
    buffer_load_dwordx4 v[144:147], v12, s[8:11], s88 offen sc1
    buffer_load_dwordx4 v[148:151], v13, s[8:11], s88 offen sc1
    buffer_load_dwordx4 v[152:155], v14, s[8:11], s88 offen sc1
    buffer_load_dwordx4 v[156:159], v15, s[8:11], s88 offen sc1
    s_add_u32 s91, s91, 1
    s_waitcnt vmcnt(0)
    v_min3_u32 v10, v144, v145, v146
    v_min3_u32 v10, v10, v147, v148
    v_min3_u32 v10, v10, v149, v150
    v_min3_u32 v10, v10, v151, v152
    v_min3_u32 v10, v10, v153, v154
    v_min3_u32 v10, v10, v155, v156
    v_min3_u32 v10, v10, v157, v158
    v_min_u32 v10, v10, v159
    v_cmp_le_i32 vcc, 0, v10
    s_cmp_ge_u32 s91, 400000
    s_cbranch_scc1 L_inte_back_173
    s_nop 2
    s_cbranch_vccnz L_inte_loop_224
    s_branch L_inte_back_173
L_inte_retry_174:
    s_mov_b32 s91, 0
    s_add_u32 s88, s40, s83
L_inte_loop_225:
    buffer_load_dwordx4 v[160:163], v12, s[8:11], s88 offen sc1
    buffer_load_dwordx4 v[164:167], v13, s[8:11], s88 offen sc1
    buffer_load_dwordx4 v[168:171], v14, s[8:11], s88 offen sc1
    buffer_load_dwordx4 v[172:175], v15, s[8:11], s88 offen sc1
    s_add_u32 s91, s91, 1
    s_waitcnt vmcnt(0)
    v_min3_u32 v10, v160, v161, v162
    v_min3_u32 v10, v10, v163, v164
    v_min3_u32 v10, v10, v165, v166
    v_min3_u32 v10, v10, v167, v168
    v_min3_u32 v10, v10, v169, v170
    v_min3_u32 v10, v10, v171, v172
    v_min3_u32 v10, v10, v173, v174
    v_min_u32 v10, v10, v175
    v_cmp_le_i32 vcc, 0, v10
    s_cmp_ge_u32 s91, 400000
    s_cbranch_scc1 L_inte_back_175
    s_nop 2
    s_cbranch_vccnz L_inte_loop_225
    s_branch L_inte_back_175
L_inte_retry_176:
    s_mov_b32 s91, 0
    s_add_u32 s88, s41, s83
L_inte_loop_226:
    buffer_load_dwordx4 v[176:179], v12, s[8:11], s88 offen sc1
    buffer_load_dwordx4 v[180:183], v13, s[8:11], s88 offen sc1
    buffer_load_dwordx4 v[184:187], v14, s[8:11], s88 offen sc1
    buffer_load_dwordx4 v[188:191], v15, s[8:11], s88 offen sc1
    s_add_u32 s91, s91, 1
    s_waitcnt vmcnt(0)
    v_min3_u32 v10, v176, v177, v178
    v_min3_u32 v10, v10, v179, v180
    v_min3_u32 v10, v10, v181, v182
    v_min3_u32 v10, v10, v183, v184
    v_min3_u32 v10, v10, v185, v186
    v_min3_u32 v10, v10, v187, v188
    v_min3_u32 v10, v10, v189, v190
    v_min_u32 v10, v10, v191
    v_cmp_le_i32 vcc, 0, v10
    s_cmp_ge_u32 s91, 400000
    s_cbranch_scc1 L_inte_back_177
    s_nop 2
    s_cbranch_vccnz L_inte_loop_226
    s_branch L_inte_back_177
L_inte_retry_178:
    s_mov_b32 s91, 0
    s_add_u32 s88, s42, s83
L_inte_loop_227:
    buffer_load_dwordx4 v[192:195], v12, s[8:11], s88 offen sc1
    buffer_load_dwordx4 v[196:199], v13, s[8:11], s88 offen sc1
    buffer_load_dwordx4 v[200:203], v14, s[8:11], s88 offen sc1
    buffer_load_dwordx4 v[204:207], v15, s[8:11], s88 offen sc1
    s_add_u32 s91, s91, 1
    s_waitcnt vmcnt(0)
    v_min3_u32 v10, v192, v193, v194
    v_min3_u32 v10, v10, v195, v196
    v_min3_u32 v10, v10, v197, v198
    v_min3_u32 v10, v10, v199, v200
    v_min3_u32 v10, v10, v201, v202
    v_min3_u32 v10, v10, v203, v204
    v_min3_u32 v10, v10, v205, v206
    v_min_u32 v10, v10, v207
    v_cmp_le_i32 vcc, 0, v10
    s_cmp_ge_u32 s91, 400000
    s_cbranch_scc1 L_inte_back_179
    s_nop 2
    s_cbranch_vccnz L_inte_loop_227
    s_branch L_inte_back_179
.p2align 8
.type dft_tables,@object
dft_tables:
.quad 0x3f803f803f803f80,0x3f803f803f803f80,0x3f803f803f803f80,0x3f803f803f803f80,0xbf3500003f353f80,0x3f350000bf35bf80,0xbf35bf80bf358000,0x3f353f803f358000
.quad 0xbf8000003f80,0xbf8000003f80,0x3f808000bf808000,0x3f808000bf808000,0x3f350000bf353f80,0xbf3500003f35bf80,0xbf353f80bf358000,0x3f35bf803f358000
.quad 0xbf803f80bf803f80,0xbf803f80bf803f80,0x8000800080008000,0x8000800080008000,0x3f350000bf353f80,0xbf3500003f35bf80,0x3f35bf803f358000,0xbf353f80bf358000
.quad 0xbf8000003f80,0xbf8000003f80,0xbf8080003f808000,0xbf8080003f808000,0xbf3500003f353f80,0x3f350000bf35bf80,0x3f353f803f358000,0xbf35bf80bf358000
.quad 0x3f803f803f803f80,0x3f803f803f803f80,0xbf80bf80bf80bf80,0xbf80bf80bf80bf80,0xbf43bda13f263f7f,0x3f433da1bf26bf7f,0xbf26bf7fbf43bda1,0x3f263f7f3f433da1
.quad 0x3e20bf7dbe203f7d,0x3e20bf7dbe203f7d,0x3f7d3e20bf7dbe20,0x3f7d3e20bf7dbe20,0x3f063e6fbf5a3f79,0xbf06be6f3f5abf79,0xbf5a3f79bf06be6f,0x3f5abf793f063e6f
.quad 0xbf733f73bf733f73,0xbf733f73bf733f73,0x3e9ebe9e3e9ebe9e,0x3e9ebe9e3e9ebe9e,0x3f6dbec4bec43f6d,0xbf6d3ec43ec4bf6d,0x3ec4bf6d3f6dbec4,0xbec43f6dbf6d3ec4
.quad 0xbee8bf643ee83f64,0xbee8bf643ee83f64,0xbf643ee83f64bee8,0xbf643ee83f64bee8,0xbe6f3f063f793f5a,0x3e6fbf06bf79bf5a,0x3f793f5a3e6fbf06,0xbf79bf5abe6f3f06
.quad 0x3f803f803f803f80,0x3f803f803f803f80,0x3f803f803f803f80,0x3f803f803f803f80,0xbf4fbe203f163f7d,0x3f4f3e20bf16bf7d,0xbf16bf7dbf4fbe20,0x3f163f7d3f4f3e20
.quad 0x3e9ebf73be9e3f73,0x3e9ebf73be9e3f73,0x3f733e9ebf73be9e,0x3f733e9ebf73be9e,0x3e9e3ee8bf733f64,0xbe9ebee83f73bf64,0xbf733f64be9ebee8,0x3f73bf643e9e3ee8
.quad 0xbf4f3f4fbf4f3f4f,0xbf4f3f4fbf4f3f4f,0x3f16bf163f16bf16,0x3f16bf163f16bf16,0x3f80bf3500003f35,0xbf803f350000bf35,0x8000bf353f80bf35,0x80003f35bf803f35
.quad 0xbf4fbf163f4f3f16,0xbf4fbf163f4f3f16,0xbf163f4f3f16bf4f,0xbf163f4f3f16bf4f,0x3e9e3f643f733ee8,0xbe9ebf64bf73bee8,0x3f733ee8be9ebf64,0xbf73bee83e9e3f64
.quad 0x3f803f803f803f80,0x3f803f803f803f80,0xbf80bf80bf80bf80,0xbf80bf80bf80bf80,0xbf5abe6f3f063f79,0x3f5a3e6fbf06bf79,0xbf06bf79bf5abe6f,0x3f063f793f5a3e6f
.quad 0x3ee8bf64bee83f64,0x3ee8bf64bee83f64,0x3f643ee8bf64bee8,0x3f643ee8bf64bee8,0x3da13f26bf7f3f43,0xbda1bf263f7fbf43,0xbf7f3f43bda1bf26,0x3f7fbf433da13f26
.quad 0xbf163f16bf163f16,0xbf163f16bf163f16,0x3f4fbf4f3f4fbf4f,0x3f4fbf4f3f4fbf4f,0x3f6dbf6d3ec43ec4,0xbf6d3f6dbec4bec4,0xbec4bec43f6dbf6d,0x3ec43ec4bf6d3f6d
.quad 0xbf7dbe203f7d3e20,0xbf7dbe203f7d3e20,0xbe203f7d3e20bf7d,0xbe203f7d3e20bf7d,0x3f433f7f3f26bda1,0xbf43bf7fbf263da1,0x3f26bda1bf43bf7f,0xbf263da13f433f7f
.quad 0x3f803f803f803f80,0x3f803f803f803f80,0x3f803f803f803f80,0x3f803f803f803f80,0xbf64be9e3ee83f73,0x3f643e9ebee8bf73,0xbee8bf73bf64be9e,0x3ee83f733f643e9e
.quad 0x3f16bf4fbf163f4f,0x3f16bf4fbf163f4f,0x3f4f3f16bf4fbf16,0x3f4f3f16bf4fbf16,0xbe203f4fbf7d3f16,0x3e20bf4f3f7dbf16,0xbf7d3f163e20bf4f,0x3f7dbf16be203f4f
.quad 0xbe9e3e9ebe9e3e9e,0xbe9e3e9ebe9e3e9e,0x3f73bf733f73bf73,0x3f73bf733f73bf73,0x3f35bf803f350000,0xbf353f80bf350000,0xbf3580003f35bf80,0x3f358000bf353f80
.quad 0xbf733e9e3f73be9e,0xbf733e9e3f73be9e,0x3e9e3f73be9ebf73,0x3e9e3f73be9ebf73,0x3f7d3f4f3e20bf16,0xbf7dbf4fbe203f16,0x3e20bf16bf7dbf4f,0xbe203f163f7d3f4f
.quad 0x3f803f803f803f80,0x3f803f803f803f80,0xbf80bf80bf80bf80,0xbf80bf80bf80bf80,0xbf6dbec43ec43f6d,0x3f6d3ec4bec4bf6d,0xbec4bf6dbf6dbec4,0x3ec43f6d3f6d3ec4
.quad 0x3f35bf35bf353f35,0x3f35bf35bf353f35,0x3f353f35bf35bf35,0x3f353f35bf35bf35,0xbec43f6dbf6d3ec4,0x3ec4bf6d3f6dbec4,0xbf6d3ec43ec4bf6d,0x3f6dbec4bec43f6d
.quad 0x0,0x0,0x3f80bf803f80bf80,0x3f80bf803f80bf80,0x3ec4bf6d3f6dbec4,0xbec43f6dbf6d3ec4,0xbf6d3ec43ec4bf6d,0x3f6dbec4bec43f6d
.quad 0xbf353f353f35bf35,0xbf353f353f35bf35,0x3f353f35bf35bf35,0x3f353f35bf35bf35,0x3f6d3ec4bec4bf6d,0xbf6dbec43ec43f6d,0xbec4bf6dbf6dbec4,0x3ec43f6d3f6d3ec4
.quad 0x3f803f803f803f80,0x3f803f803f803f80,0x3f803f803f803f80,0x3f803f803f803f80,0xbf73bee83e9e3f64,0x3f733ee8be9ebf64,0xbe9ebf64bf73bee8,0x3e9e3f643f733ee8
.quad 0x3f4fbf16bf4f3f16,0x3f4fbf16bf4f3f16,0x3f163f4fbf16bf4f,0x3f163f4fbf16bf4f,0xbf163f7dbf4f3e20,0x3f16bf7d3f4fbe20,0xbf4f3e203f16bf7d,0x3f4fbe20bf163f7d
.quad 0x3e9ebe9e3e9ebe9e,0x3e9ebe9e3e9ebe9e,0x3f73bf733f73bf73,0x3f73bf733f73bf73,0xbf353f80bf35,0x3f35bf803f35,0xbf803f358000bf35,0x3f80bf3580003f35
.quad 0xbe9e3f733e9ebf73,0xbe9e3f733e9ebf73,0x3f733e9ebf73be9e,0x3f733e9ebf73be9e,0x3f16be20bf4fbf7d,0xbf163e203f4f3f7d,0xbf4fbf7dbf163e20,0x3f4f3f7d3f16be20
.quad 0x3f803f803f803f80,0x3f803f803f803f80,0xbf80bf80bf80bf80,0xbf80bf80bf80bf80,0xbf79bf063e6f3f5a,0x3f793f06be6fbf5a,0xbe6fbf5abf79bf06,0x3e6f3f5a3f793f06
.quad 0x3f64bee8bf643ee8,0x3f64bee8bf643ee8,0x3ee83f64bee8bf64,0x3ee83f64bee8bf64,0xbf433f7fbf26bda1,0x3f43bf7f3f263da1,0xbf26bda13f43bf7f,0x3f263da1bf433f7f
.quad 0x3f16bf163f16bf16,0x3f16bf163f16bf16,0x3f4fbf4f3f4fbf4f,0x3f4fbf4f3f4fbf4f,0xbec4bec43f6dbf6d,0x3ec43ec4bf6d3f6d,0xbf6d3f6dbec4bec4,0x3f6dbf6d3ec43ec4
.quad 0x3e203f7dbe20bf7d,0x3e203f7dbe20bf7d,0x3f7dbe20bf7d3e20,0x3f7dbe20bf7d3e20,0x3da1bf26bf7fbf43,0xbda13f263f7f3f43,0xbf7fbf43bda13f26,0x3f7f3f433da1bf26
.quad 0x3f803f803f803f80,0x3f803f803f803f80,0x8000800080008000,0x8000800080008000,0xbf3500003f353f80,0x3f350000bf35bf80,0xbf35bf80bf358000,0x3f353f803f358000
.quad 0xbf8000003f80,0xbf8000003f80,0x3f808000bf808000,0x3f808000bf808000,0x3f350000bf353f80,0xbf3500003f35bf80,0xbf353f80bf358000,0x3f35bf803f358000
.quad 0xbf803f80bf803f80,0xbf803f80bf803f80,0x8000800080008000,0x8000800080008000,0x3f350000bf353f80,0xbf3500003f35bf80,0x3f35bf803f358000,0xbf353f80bf358000
.quad 0xbf8000003f80,0xbf8000003f80,0xbf8080003f808000,0xbf8080003f808000,0xbf3500003f353f80,0x3f350000bf35bf80,0x3f353f803f358000,0xbf35bf80bf358000
.quad 0x3f4f3f4f3f4f3f4f,0x3f4f3f4f3f4f3f4f,0xbf16bf16bf16bf16,0xbf16bf16bf16bf16,0xbf7fbf263da13f43,0x3f7f3f26bda1bf43,0xbda1bf43bf7fbf26,0x3da13f433f7f3f26
.quad 0x3f35bf35bf353f35,0x3f35bf35bf353f35,0x3f353f35bf35bf35,0x3f353f35bf35bf35,0xbda13f43bf7f3f26,0x3da1bf433f7fbf26,0xbf7f3f263da1bf43,0x3f7fbf26bda13f43
.quad 0xbf163f16bf163f16,0xbf163f16bf163f16,0x3f4fbf4f3f4fbf4f,0x3f4fbf4f3f4fbf4f,0x3f79bf5a3e6f3f06,0xbf793f5abe6fbf06,0xbe6fbf063f79bf5a,0x3e6f3f06bf793f5a
.quad 0xbf64bee83f643ee8,0xbf64bee83f643ee8,0xbee83f643ee8bf64,0xbee83f643ee8bf64,0x3ec43f6d3f6d3ec4,0xbec4bf6dbf6dbec4,0x3f6d3ec4bec4bf6d,0xbf6dbec43ec43f6d
.quad 0x3e9e3e9e3e9e3e9e,0x3e9e3e9e3e9e3e9e,0xbf73bf73bf73bf73,0xbf73bf73bf73bf73,0xbf4fbf7dbf163e20,0x3f4f3f7d3f16be20,0x3f16be20bf4fbf7d,0xbf163e203f4f3f7d
.quad 0x3f800000bf800000,0x3f800000bf800000,0x80003f808000bf80,0x80003f808000bf80,0xbf4f3f7dbf16be20,0x3f4fbf7d3f163e20,0xbf16be203f4fbf7d,0x3f163e20bf4f3f7d
.quad 0x3e9ebe9e3e9ebe9e,0x3e9ebe9e3e9ebe9e,0x3f73bf733f73bf73,0x3f73bf733f73bf73,0x3e9ebf643f73bee8,0xbe9e3f64bf733ee8,0xbf733ee83e9ebf64,0x3f73bee8be9e3f64
.quad 0xbf4f3f163f4fbf16,0xbf4f3f163f4fbf16,0x3f163f4fbf16bf4f,0x3f163f4fbf16bf4f,0x3f803f350000bf35,0xbf80bf3500003f35,0x8000bf35bf80bf35,0x80003f353f803f35
.quad 0xbe9ebe9ebe9ebe9e,0xbe9ebe9ebe9ebe9e,0xbf73bf73bf73bf73,0xbf73bf73bf73bf73,0xbe6fbf5abf79bf06,0x3e6f3f5a3f793f06,0x3f793f06be6fbf5a,0xbf79bf063e6f3f5a
.quad 0x3f353f35bf35bf35,0x3f353f35bf35bf35,0xbf353f353f35bf35,0xbf353f353f35bf35,0xbf793f063e6fbf5a,0x3f79bf06be6f3f5a,0x3e6fbf5a3f79bf06,0xbe6f3f5abf793f06
.quad 0x3f73bf733f73bf73,0x3f73bf733f73bf73,0x3e9ebe9e3e9ebe9e,0x3e9ebe9e3e9ebe9e,0xbf26bda13f43bf7f,0x3f263da1bf433f7f,0xbf433f7fbf26bda1,0x3f43bf7f3f263da1
.quad 0x3e203f7dbe20bf7d,0x3e203f7dbe20bf7d,0x3f7dbe20bf7d3e20,0x3f7dbe20bf7d3e20,0x3ec4bec4bf6dbf6d,0xbec43ec43f6d3f6d,0xbf6dbf6dbec43ec4,0x3f6d3f6d3ec4bec4
.quad 0xbf4fbf4fbf4fbf4f,0xbf4fbf4fbf4fbf4f,0xbf16bf16bf16bf16,0xbf16bf16bf16bf16,0x3ee8be9ebf64bf73,0xbee83e9e3f643f73,0x3f643f733ee8be9e,0xbf64bf73bee83e9e
.quad 0x3f800000bf80,0x3f800000bf80,0xbf8080003f808000,0xbf8080003f808000,0xbee8be9e3f64bf73,0x3ee83e9ebf643f73,0x3f64bf733ee83e9e,0xbf643f73bee8be9e
.quad 0x3f4fbf4f3f4fbf4f,0x3f4fbf4f3f4fbf4f,0xbf163f16bf163f16,0xbf163f16bf163f16,0xbf7d3f4fbe20bf16,0x3f7dbf4f3e203f16,0x3e203f16bf7d3f4f,0xbe20bf163f7dbf4f
.quad 0x3f733e9ebf73be9e,0x3f733e9ebf73be9e,0x3e9ebf73be9e3f73,0x3e9ebf73be9e3f73,0xbf35bf80bf350000,0x3f353f803f350000,0xbf3580003f353f80,0x3f358000bf35bf80
.quad 0xbf80bf80bf80bf80,0xbf80bf80bf80bf80,0x8000800080008000,0x8000800080008000,0x3f6d3ec4bec4bf6d,0xbf6dbec43ec43f6d,0x3ec43f6d3f6d3ec4,0xbec4bf6dbf6dbec4
.quad 0xbf353f353f35bf35,0xbf353f353f35bf35,0xbf35bf353f353f35,0xbf35bf353f353f35,0x3ec4bf6d3f6dbec4,0xbec43f6dbf6d3ec4,0x3f6dbec4bec43f6d,0xbf6d3ec43ec4bf6d
.quad 0x0,0x0,0xbf803f80bf803f80,0xbf803f80bf803f80,0xbec43f6dbf6d3ec4,0x3ec4bf6d3f6dbec4,0x3f6dbec4bec43f6d,0xbf6d3ec43ec4bf6d
.quad 0x3f35bf35bf353f35,0x3f35bf35bf353f35,0xbf35bf353f353f35,0xbf35bf353f353f35,0xbf6dbec43ec43f6d,0x3f6d3ec4bec4bf6d,0x3ec43f6d3f6d3ec4,0xbec4bf6dbf6dbec4
.quad 0xbf4fbf4fbf4fbf4f,0xbf4fbf4fbf4fbf4f,0x3f163f163f163f16,0x3f163f163f163f16,0x3f733f643e9ebee8,0xbf73bf64be9e3ee8,0xbe9e3ee83f733f64,0x3e9ebee8bf73bf64
.quad 0xbf8000003f800000,0xbf8000003f800000,0x8000bf8080003f80,0x8000bf8080003f80,0x3f73bf643e9e3ee8,0xbf733f64be9ebee8,0x3e9e3ee8bf733f64,0xbe9ebee83f73bf64
.quad 0xbf4f3f4fbf4f3f4f,0xbf4f3f4fbf4f3f4f,0xbf163f16bf163f16,0xbf163f16bf163f16,0x3f163e20bf4f3f7d,0xbf16be203f4fbf7d,0x3f4fbf7d3f163e20,0xbf4f3f7dbf16be20
.quad 0xbe9ebf733e9e3f73,0xbe9ebf733e9e3f73,0xbf733e9e3f73be9e,0xbf733e9e3f73be9e,0x3f353f803f35,0xbf35bf80bf35,0x3f803f358000bf35,0xbf80bf3580003f35
.quad 0xbe9ebe9ebe9ebe9e,0xbe9ebe9ebe9ebe9e,0x3f733f733f733f73,0x3f733f733f733f73,0x3f063f793f5a3e6f,0xbf06bf79bf5abe6f,0xbf5abe6f3f063f79,0x3f5a3e6fbf06bf79
.quad 0xbf35bf353f353f35,0xbf35bf353f353f35,0x3f35bf35bf353f35,0x3f35bf35bf353f35,0x3f5abe6fbf063f79,0xbf5a3e6f3f06bf79,0xbf063f79bf5a3e6f,0x3f06bf793f5abe6f
.quad 0xbf733f73bf733f73,0xbf733f73bf733f73,0x3e9ebe9e3e9ebe9e,0x3e9ebe9e3e9ebe9e,0x3f7fbf433da13f26,0xbf7f3f43bda1bf26,0xbda1bf263f7fbf43,0x3da13f26bf7f3f43
.quad 0xbf7dbe203f7d3e20,0xbf7dbe203f7d3e20,0xbe203f7d3e20bf7d,0xbe203f7d3e20bf7d,0x3f6d3f6d3ec4bec4,0xbf6dbf6dbec43ec4,0x3ec4bec4bf6dbf6d,0xbec43ec43f6d3f6d
.quad 0x3f803f803f803f80,0x3f803f803f803f80,0x8000800080008000,0x8000800080008000,0xbf3500003f353f80,0x3f350000bf35bf80,0xbf35bf80bf358000,0x3f353f803f358000
.quad 0xbf8000003f80,0xbf8000003f80,0x3f808000bf808000,0x3f808000bf808000,0x3f350000bf353f80,0xbf3500003f35bf80,0xbf353f80bf358000,0x3f35bf803f358000
.quad 0xbf803f80bf803f80,0xbf803f80bf803f80,0x8000800080008000,0x8000800080008000,0x3f350000bf353f80,0xbf3500003f35bf80,0x3f35bf803f358000,0xbf353f80bf358000
.quad 0xbf8000003f80,0xbf8000003f80,0xbf8080003f808000,0xbf8080003f808000,0xbf3500003f353f80,0x3f350000bf35bf80,0x3f353f803f358000,0xbf35bf80bf358000
.quad 0x3e9e3e9e3e9e3e9e,0x3e9e3e9e3e9e3e9e,0xbf73bf73bf73bf73,0xbf73bf73bf73bf73,0xbf5abf79bf063e6f,0x3f5a3f793f06be6f,0x3f06be6fbf5abf79,0xbf063e6f3f5a3f79
.quad 0x3f7dbe20bf7d3e20,0x3f7dbe20bf7d3e20,0x3e203f7dbe20bf7d,0x3e203f7dbe20bf7d,0xbf263f7fbf433da1,0x3f26bf7f3f43bda1,0xbf433da13f26bf7f,0x3f43bda1bf263f7f
.quad 0x0,0x0,0x3f80bf803f80bf80,0x3f80bf803f80bf80,0x3f26bf7f3f43bda1,0xbf263f7fbf433da1,0xbf433da13f26bf7f,0x3f43bda1bf263f7f
.quad 0xbf7d3e203f7dbe20,0xbf7d3e203f7dbe20,0x3e203f7dbe20bf7d,0x3e203f7dbe20bf7d,0x3f5a3f793f06be6f,0xbf5abf79bf063e6f,0x3f06be6fbf5abf79,0xbf063e6f3f5a3f79
.quad 0xbf4fbf4fbf4fbf4f,0xbf4fbf4fbf4fbf4f,0xbf16bf16bf16bf16,0xbf16bf16bf16bf16,0x3e9ebee8bf73bf64,0xbe9e3ee83f733f64,0x3f733f643e9ebee8,0xbf73bf64be9e3ee8
.quad 0x3e9e3f73be9ebf73,0x3e9e3f73be9ebf73,0xbf733e9e3f73be9e,0xbf733e9e3f73be9e,0xbf4f3e203f16bf7d,0x3f4fbe20bf163f7d,0x3f16bf7d3f4fbe20,0xbf163f7dbf4f3e20
.quad 0x3f80bf803f80bf80,0x3f80bf803f80bf80,0x8000800080008000,0x8000800080008000,0xbf4f3e203f16bf7d,0x3f4fbe20bf163f7d,0xbf163f7dbf4f3e20,0x3f16bf7d3f4fbe20
.quad 0x3e9e3f73be9ebf73,0x3e9e3f73be9ebf73,0x3f73be9ebf733e9e,0x3f73be9ebf733e9e,0x3e9ebee8bf73bf64,0xbe9e3ee83f733f64,0xbf73bf64be9e3ee8,0x3f733f643e9ebee8
.quad 0xbf4fbf4fbf4fbf4f,0xbf4fbf4fbf4fbf4f,0x3f163f163f163f16,0x3f163f163f163f16,0x3f7f3f433da1bf26,0xbf7fbf43bda13f26,0xbda13f263f7f3f43,0x3da1bf26bf7fbf43
.quad 0xbf643ee83f64bee8,0xbf643ee83f64bee8,0xbee8bf643ee83f64,0xbee8bf643ee83f64,0x3f06bf793f5abe6f,0xbf063f79bf5a3e6f,0x3f5abe6fbf063f79,0xbf5a3e6f3f06bf79
.quad 0x0,0x0,0xbf803f80bf803f80,0xbf803f80bf803f80,0xbf063f79bf5a3e6f,0x3f06bf793f5abe6f,0x3f5abe6fbf063f79,0xbf5a3e6f3f06bf79
.quad 0x3f64bee8bf643ee8,0x3f64bee8bf643ee8,0xbee8bf643ee83f64,0xbee8bf643ee83f64,0xbf7fbf43bda13f26,0x3f7f3f433da1bf26,0xbda13f263f7f3f43,0x3da1bf26bf7fbf43
.quad 0x3e9e3e9e3e9e3e9e,0x3e9e3e9e3e9e3e9e,0x3f733f733f733f73,0x3f733f733f733f73,0x3e203f4f3f7d3f16,0xbe20bf4fbf7dbf16,0xbf7dbf163e203f4f,0x3f7d3f16be20bf4f
.quad 0xbf16bf4f3f163f4f,0xbf16bf4f3f163f4f,0x3f4fbf16bf4f3f16,0x3f4fbf16bf4f3f16,0x3f64be9ebee83f73,0xbf643e9e3ee8bf73,0xbee83f73bf643e9e,0x3ee8bf733f64be9e
.quad 0xbf803f80bf803f80,0xbf803f80bf803f80,0x8000800080008000,0x8000800080008000,0x3f64be9ebee83f73,0xbf643e9e3ee8bf73,0x3ee8bf733f64be9e,0xbee83f73bf643e9e
.quad 0xbf16bf4f3f163f4f,0xbf16bf4f3f163f4f,0xbf4f3f163f4fbf16,0xbf4f3f163f4fbf16,0x3e203f4f3f7d3f16,0xbe20bf4fbf7dbf16,0x3f7d3f16be20bf4f,0xbf7dbf163e203f4f
.quad 0x3f803f803f803f80,0x3f803f803f803f80,0x8000800080008000,0x8000800080008000,0xbf6dbec43ec43f6d,0x3f6d3ec4bec4bf6d,0xbec4bf6dbf6dbec4,0x3ec43f6d3f6d3ec4
.quad 0x3f35bf35bf353f35,0x3f35bf35bf353f35,0x3f353f35bf35bf35,0x3f353f35bf35bf35,0xbec43f6dbf6d3ec4,0x3ec4bf6d3f6dbec4,0xbf6d3ec43ec4bf6d,0x3f6dbec4bec43f6d
.quad 0x0,0x0,0x3f80bf803f80bf80,0x3f80bf803f80bf80,0x3ec4bf6d3f6dbec4,0xbec43f6dbf6d3ec4,0xbf6d3ec43ec4bf6d,0x3f6dbec4bec43f6d
.quad 0xbf353f353f35bf35,0xbf353f353f35bf35,0x3f353f35bf35bf35,0x3f353f35bf35bf35,0x3f6d3ec4bec4bf6d,0xbf6dbec43ec43f6d,0xbec4bf6dbf6dbec4,0x3ec43f6d3f6d3ec4
.quad 0x3e9e3e9e3e9e3e9e,0x3e9e3e9e3e9e3e9e,0xbf73bf73bf73bf73,0xbf73bf73bf73bf73,0xbf16bf7dbf4fbe20,0x3f163f7d3f4f3e20,0x3f4f3e20bf16bf7d,0xbf4fbe203f163f7d
.quad 0x3f4f3f16bf4fbf16,0x3f4f3f16bf4fbf16,0xbf163f4f3f16bf4f,0xbf163f4f3f16bf4f,0xbf733ee83e9ebf64,0x3f73bee8be9e3f64,0x3e9ebf643f73bee8,0xbe9e3f64bf733ee8
.quad 0x3f80bf803f80bf80,0x3f80bf803f80bf80,0x8000800080008000,0x8000800080008000,0xbf733ee83e9ebf64,0x3f73bee8be9e3f64,0xbe9e3f64bf733ee8,0x3e9ebf643f73bee8
.quad 0x3f4f3f16bf4fbf16,0x3f4f3f16bf4fbf16,0x3f16bf4fbf163f4f,0x3f16bf4fbf163f4f,0xbf16bf7dbf4fbe20,0x3f163f7d3f4f3e20,0xbf4fbe203f163f7d,0x3f4f3e20bf16bf7d
.quad 0xbf4fbf4fbf4fbf4f,0xbf4fbf4fbf4fbf4f,0xbf16bf16bf16bf16,0xbf16bf16bf16bf16,0x3f26bda1bf43bf7f,0xbf263da13f433f7f,0x3f433f7f3f26bda1,0xbf43bf7fbf263da1
.quad 0xbee83f643ee8bf64,0xbee83f643ee8bf64,0xbf64bee83f643ee8,0xbf64bee83f643ee8,0x3e6fbf5a3f79bf06,0xbe6f3f5abf793f06,0x3f79bf06be6f3f5a,0xbf793f063e6fbf5a
.quad 0x0,0x0,0xbf803f80bf803f80,0xbf803f80bf803f80,0xbe6f3f5abf793f06,0x3e6fbf5a3f79bf06,0x3f79bf06be6f3f5a,0xbf793f063e6fbf5a
.quad 0x3ee8bf64bee83f64,0x3ee8bf64bee83f64,0xbf64bee83f643ee8,0xbf64bee83f643ee8,0xbf263da13f433f7f,0x3f26bda1bf43bf7f,0x3f433f7f3f26bda1,0xbf43bf7fbf263da1
.quad 0x3f803f803f803f80,0x3f803f803f803f80,0x8000800080008000,0x8000800080008000,0xbf3500003f353f80,0x3f350000bf35bf80,0xbf35bf80bf358000,0x3f353f803f358000
.quad 0xbf8000003f80,0xbf8000003f80,0x3f808000bf808000,0x3f808000bf808000,0x3f350000bf353f80,0xbf3500003f35bf80,0xbf353f80bf358000,0x3f35bf803f358000
.quad 0xbf803f80bf803f80,0xbf803f80bf803f80,0x8000800080008000,0x8000800080008000,0x3f350000bf353f80,0xbf3500003f35bf80,0x3f35bf803f358000,0xbf353f80bf358000
.quad 0xbf8000003f80,0xbf8000003f80,0xbf8080003f808000,0xbf8080003f808000,0xbf3500003f353f80,0x3f350000bf35bf80,0x3f353f803f358000,0xbf35bf80bf358000
.quad 0xbe9ebe9ebe9ebe9e,0xbe9ebe9ebe9ebe9e,0xbf73bf73bf73bf73,0xbf73bf73bf73bf73,0xbec4bf6dbf6dbec4,0x3ec43f6d3f6d3ec4,0x3f6d3ec4bec4bf6d,0xbf6dbec43ec43f6d
.quad 0x3f643ee8bf64bee8,0x3f643ee8bf64bee8,0xbee83f643ee8bf64,0xbee83f643ee8bf64,0xbf793f5abe6fbf06,0x3f79bf5a3e6f3f06,0xbe6fbf063f79bf5a,0x3e6f3f06bf793f5a
.quad 0x3f16bf163f16bf16,0x3f16bf163f16bf16,0x3f4fbf4f3f4fbf4f,0x3f4fbf4f3f4fbf4f,0x3da1bf433f7fbf26,0xbda13f43bf7f3f26,0xbf7f3f263da1bf43,0x3f7fbf26bda13f43
.quad 0xbf353f353f35bf35,0xbf353f353f35bf35,0x3f353f35bf35bf35,0x3f353f35bf35bf35,0x3f7f3f26bda1bf43,0xbf7fbf263da13f43,0xbda1bf43bf7fbf26,0x3da13f433f7f3f26
.quad 0xbf4fbf4fbf4fbf4f,0xbf4fbf4fbf4fbf4f,0x3f163f163f163f16,0x3f163f163f163f16,0x3f803f350000bf35,0xbf80bf3500003f35,0x80003f353f803f35,0x8000bf35bf80bf35
.quad 0xbf4f3f163f4fbf16,0xbf4f3f163f4fbf16,0xbf16bf4f3f163f4f,0xbf16bf4f3f163f4f,0x3e9ebf643f73bee8,0xbe9e3f64bf733ee8,0x3f73bee8be9e3f64,0xbf733ee83e9ebf64
.quad 0x3e9ebe9e3e9ebe9e,0x3e9ebe9e3e9ebe9e,0xbf733f73bf733f73,0xbf733f73bf733f73,0xbf4f3f7dbf16be20,0x3f4fbf7d3f163e20,0x3f163e20bf4f3f7d,0xbf16be203f4fbf7d
.quad 0x3f800000bf800000,0x3f800000bf800000,0x8000bf8080003f80,0x8000bf8080003f80,0xbf4fbf7dbf163e20,0x3f4f3f7d3f16be20,0xbf163e203f4f3f7d,0x3f16be20bf4fbf7d
.quad 0x3f4f3f4f3f4f3f4f,0x3f4f3f4f3f4f3f4f,0x3f163f163f163f16,0x3f163f163f163f16,0xbec43ec43f6d3f6d,0x3ec4bec4bf6dbf6d,0xbf6dbf6dbec43ec4,0x3f6d3f6d3ec4bec4
.quad 0xbe20bf7d3e203f7d,0xbe20bf7d3e203f7d,0x3f7dbe20bf7d3e20,0x3f7dbe20bf7d3e20,0x3f263da1bf433f7f,0xbf26bda13f43bf7f,0xbf433f7fbf26bda1,0x3f43bf7f3f263da1
.quad 0xbf733f73bf733f73,0xbf733f73bf733f73,0x3e9ebe9e3e9ebe9e,0x3e9ebe9e3e9ebe9e,0x3f79bf06be6f3f5a,0xbf793f063e6fbf5a,0x3e6fbf5a3f79bf06,0xbe6f3f5abf793f06
.quad 0xbf35bf353f353f35,0xbf35bf353f353f35,0xbf353f353f35bf35,0xbf353f353f35bf35,0x3e6f3f5a3f793f06,0xbe6fbf5abf79bf06,0x3f793f06be6fbf5a,0xbf79bf063e6f3f5a
.quad 0x3e9e3e9e3e9e3e9e,0x3e9e3e9e3e9e3e9e,0xbf73bf73bf73bf73,0xbf73bf73bf73bf73,0xbf35bf80bf350000,0x3f353f803f350000,0x3f358000bf35bf80,0xbf3580003f353f80
.quad 0x3f733e9ebf73be9e,0x3f733e9ebf73be9e,0xbe9e3f733e9ebf73,0xbe9e3f733e9ebf73,0xbf7d3f4fbe20bf16,0x3f7dbf4f3e203f16,0xbe20bf163f7dbf4f,0x3e203f16bf7d3f4f
.quad 0x3f4fbf4f3f4fbf4f,0x3f4fbf4f3f4fbf4f,0x3f16bf163f16bf16,0x3f16bf163f16bf16,0xbee8be9e3f64bf73,0x3ee83e9ebf643f73,0xbf643f73bee8be9e,0x3f64bf733ee83e9e
.quad 0x3f800000bf80,0x3f800000bf80,0x3f808000bf808000,0x3f808000bf808000,0x3ee8be9ebf64bf73,0xbee83e9e3f643f73,0xbf64bf73bee83e9e,0x3f643f733ee8be9e
.quad 0xbf80bf80bf80bf80,0xbf80bf80bf80bf80,0x8000800080008000,0x8000800080008000,0x3f6d3ec4bec4bf6d,0xbf6dbec43ec43f6d,0x3ec43f6d3f6d3ec4,0xbec4bf6dbf6dbec4
.quad 0xbf353f353f35bf35,0xbf353f353f35bf35,0xbf35bf353f353f35,0xbf35bf353f353f35,0x3ec4bf6d3f6dbec4,0xbec43f6dbf6d3ec4,0x3f6dbec4bec43f6d,0xbf6d3ec43ec4bf6d
.quad 0x0,0x0,0xbf803f80bf803f80,0xbf803f80bf803f80,0xbec43f6dbf6d3ec4,0x3ec4bf6d3f6dbec4,0x3f6dbec4bec43f6d,0xbf6d3ec43ec4bf6d
.quad 0x3f35bf35bf353f35,0x3f35bf35bf353f35,0xbf35bf353f353f35,0xbf35bf353f353f35,0xbf6dbec43ec43f6d,0x3f6d3ec4bec4bf6d,0x3ec43f6d3f6d3ec4,0xbec4bf6dbf6dbec4
.quad 0x3e9e3e9e3e9e3e9e,0x3e9e3e9e3e9e3e9e,0x3f733f733f733f73,0x3f733f733f733f73,0x3f353f803f35,0xbf35bf80bf35,0xbf80bf3580003f35,0x3f803f358000bf35
.quad 0xbe9ebf733e9e3f73,0xbe9ebf733e9e3f73,0x3f73be9ebf733e9e,0x3f73be9ebf733e9e,0x3f163e20bf4f3f7d,0xbf16be203f4fbf7d,0xbf4f3f7dbf16be20,0x3f4fbf7d3f163e20
.quad 0xbf4f3f4fbf4f3f4f,0xbf4f3f4fbf4f3f4f,0x3f16bf163f16bf16,0x3f16bf163f16bf16,0x3f73bf643e9e3ee8,0xbf733f64be9ebee8,0xbe9ebee83f73bf64,0x3e9e3ee8bf733f64
.quad 0xbf8000003f800000,0xbf8000003f800000,0x80003f808000bf80,0x80003f808000bf80,0x3f733f643e9ebee8,0xbf73bf64be9e3ee8,0x3e9ebee8bf73bf64,0xbe9e3ee83f733f64
.quad 0x3f4f3f4f3f4f3f4f,0x3f4f3f4f3f4f3f4f,0xbf16bf16bf16bf16,0xbf16bf16bf16bf16,0xbf6dbf6dbec43ec4,0x3f6d3f6d3ec4bec4,0x3ec4bec4bf6dbf6d,0xbec43ec43f6d3f6d
.quad 0x3f7d3e20bf7dbe20,0x3f7d3e20bf7dbe20,0xbe203f7d3e20bf7d,0xbe203f7d3e20bf7d,0xbf7f3f43bda1bf26,0x3f7fbf433da13f26,0xbda1bf263f7fbf43,0x3da13f26bf7f3f43
.quad 0x3f73bf733f73bf73,0x3f73bf733f73bf73,0x3e9ebe9e3e9ebe9e,0x3e9ebe9e3e9ebe9e,0xbf5a3e6f3f06bf79,0x3f5abe6fbf063f79,0xbf063f79bf5a3e6f,0x3f06bf793f5abe6f
.quad 0x3f353f35bf35bf35,0x3f353f35bf35bf35,0x3f35bf35bf353f35,0x3f35bf35bf353f35,0xbf06bf79bf5abe6f,0x3f063f793f5a3e6f,0xbf5abe6f3f063f79,0x3f5a3e6fbf06bf79
.quad 0x3f803f803f803f80,0x3f803f803f803f80,0x8000800080008000,0x8000800080008000,0xbf3500003f353f80,0x3f350000bf35bf80,0xbf35bf80bf358000,0x3f353f803f358000
.quad 0xbf8000003f80,0xbf8000003f80,0x3f808000bf808000,0x3f808000bf808000,0x3f350000bf353f80,0xbf3500003f35bf80,0xbf353f80bf358000,0x3f35bf803f358000
.quad 0xbf803f80bf803f80,0xbf803f80bf803f80,0x8000800080008000,0x8000800080008000,0x3f350000bf353f80,0xbf3500003f35bf80,0x3f35bf803f358000,0xbf353f80bf358000
.quad 0xbf8000003f80,0xbf8000003f80,0xbf8080003f808000,0xbf8080003f808000,0xbf3500003f353f80,0x3f350000bf35bf80,0x3f353f803f358000,0xbf35bf80bf358000
.quad 0xbf4fbf4fbf4fbf4f,0xbf4fbf4fbf4fbf4f,0xbf16bf16bf16bf16,0xbf16bf16bf16bf16,0x3e6fbf06bf79bf5a,0xbe6f3f063f793f5a,0x3f793f5a3e6fbf06,0xbf79bf5abe6f3f06
.quad 0x3ee83f64bee8bf64,0x3ee83f64bee8bf64,0xbf643ee83f64bee8,0xbf643ee83f64bee8,0xbf6d3ec43ec4bf6d,0x3f6dbec4bec43f6d,0x3ec4bf6d3f6dbec4,0xbec43f6dbf6d3ec4
.quad 0x3f73bf733f73bf73,0x3f73bf733f73bf73,0x3e9ebe9e3e9ebe9e,0x3e9ebe9e3e9ebe9e,0xbf06be6f3f5abf79,0x3f063e6fbf5a3f79,0xbf5a3f79bf06be6f,0x3f5abf793f063e6f
.quad 0xbe203f7d3e20bf7d,0xbe203f7d3e20bf7d,0x3f7d3e20bf7dbe20,0x3f7d3e20bf7dbe20,0x3f433da1bf26bf7f,0xbf43bda13f263f7f,0xbf26bf7fbf43bda1,0x3f263f7f3f433da1
.quad 0x3e9e3e9e3e9e3e9e,0x3e9e3e9e3e9e3e9e,0x3f733f733f733f73,0x3f733f733f733f73,0x3e9e3f643f733ee8,0xbe9ebf64bf73bee8,0xbf73bee83e9e3f64,0x3f733ee8be9ebf64
.quad 0xbf4fbf163f4f3f16,0xbf4fbf163f4f3f16,0x3f16bf4fbf163f4f,0x3f16bf4fbf163f4f,0x3f80bf3500003f35,0xbf803f350000bf35,0x80003f35bf803f35,0x8000bf353f80bf35
.quad 0xbf4f3f4fbf4f3f4f,0xbf4f3f4fbf4f3f4f,0xbf163f16bf163f16,0xbf163f16bf163f16,0x3e9e3ee8bf733f64,0xbe9ebee83f73bf64,0x3f73bf643e9e3ee8,0xbf733f64be9ebee8
.quad 0x3e9ebf73be9e3f73,0x3e9ebf73be9e3f73,0xbf73be9e3f733e9e,0xbf73be9e3f733e9e,0xbf4fbe203f163f7d,0x3f4f3e20bf16bf7d,0x3f163f7d3f4f3e20,0xbf16bf7dbf4fbe20
.quad 0x3e9e3e9e3e9e3e9e,0x3e9e3e9e3e9e3e9e,0xbf73bf73bf73bf73,0xbf73bf73bf73bf73,0xbf43bf7fbf263da1,0x3f433f7f3f26bda1,0x3f26bda1bf43bf7f,0xbf263da13f433f7f
.quad 0x3f7d3e20bf7dbe20,0x3f7d3e20bf7dbe20,0xbe203f7d3e20bf7d,0xbe203f7d3e20bf7d,0xbf6d3f6dbec4bec4,0x3f6dbf6d3ec43ec4,0xbec4bec43f6dbf6d,0x3ec43ec4bf6d3f6d
.quad 0x3f16bf163f16bf16,0x3f16bf163f16bf16,0x3f4fbf4f3f4fbf4f,0x3f4fbf4f3f4fbf4f,0xbda1bf263f7fbf43,0x3da13f26bf7f3f43,0xbf7f3f43bda1bf26,0x3f7fbf433da13f26
.quad 0xbee83f643ee8bf64,0xbee83f643ee8bf64,0x3f643ee8bf64bee8,0x3f643ee8bf64bee8,0x3f5a3e6fbf06bf79,0xbf5abe6f3f063f79,0xbf06bf79bf5abe6f,0x3f063f793f5a3e6f
.quad 0xbf4fbf4fbf4fbf4f,0xbf4fbf4fbf4fbf4f,0x3f163f163f163f16,0x3f163f163f163f16,0x3f7d3f4f3e20bf16,0xbf7dbf4fbe203f16,0xbe203f163f7d3f4f,0x3e20bf16bf7dbf4f
.quad 0xbf733e9e3f73be9e,0xbf733e9e3f73be9e,0xbe9ebf733e9e3f73,0xbe9ebf733e9e3f73,0x3f35bf803f350000,0xbf353f80bf350000,0x3f358000bf353f80,0xbf3580003f35bf80
.quad 0xbe9e3e9ebe9e3e9e,0xbe9e3e9ebe9e3e9e,0xbf733f73bf733f73,0xbf733f73bf733f73,0xbe203f4fbf7d3f16,0x3e20bf4f3f7dbf16,0x3f7dbf16be203f4f,0xbf7d3f163e20bf4f
.quad 0x3f16bf4fbf163f4f,0x3f16bf4fbf163f4f,0xbf4fbf163f4f3f16,0xbf4fbf163f4f3f16,0xbf64be9e3ee83f73,0x3f643e9ebee8bf73,0x3ee83f733f643e9e,0xbee8bf73bf64be9e
.quad 0x3f803f803f803f80,0x3f803f803f803f80,0x8000800080008000,0x8000800080008000,0xbf6dbec43ec43f6d,0x3f6d3ec4bec4bf6d,0xbec4bf6dbf6dbec4,0x3ec43f6d3f6d3ec4
.quad 0x3f35bf35bf353f35,0x3f35bf35bf353f35,0x3f353f35bf35bf35,0x3f353f35bf35bf35,0xbec43f6dbf6d3ec4,0x3ec4bf6d3f6dbec4,0xbf6d3ec43ec4bf6d,0x3f6dbec4bec43f6d
.quad 0x0,0x0,0x3f80bf803f80bf80,0x3f80bf803f80bf80,0x3ec4bf6d3f6dbec4,0xbec43f6dbf6d3ec4,0xbf6d3ec43ec4bf6d,0x3f6dbec4bec43f6d
.quad 0xbf353f353f35bf35,0xbf353f353f35bf35,0x3f353f35bf35bf35,0x3f353f35bf35bf35,0x3f6d3ec4bec4bf6d,0xbf6dbec43ec43f6d,0xbec4bf6dbf6dbec4,0x3ec43f6d3f6d3ec4
.quad 0xbf4fbf4fbf4fbf4f,0xbf4fbf4fbf4fbf4f,0xbf16bf16bf16bf16,0xbf16bf16bf16bf16,0x3f16be20bf4fbf7d,0xbf163e203f4f3f7d,0x3f4f3f7d3f16be20,0xbf4fbf7dbf163e20
.quad 0xbe9e3f733e9ebf73,0xbe9e3f733e9ebf73,0xbf73be9e3f733e9e,0xbf73be9e3f733e9e,0xbf353f80bf35,0x3f35bf803f35,0x3f80bf3580003f35,0xbf803f358000bf35
.quad 0x3e9ebe9e3e9ebe9e,0x3e9ebe9e3e9ebe9e,0xbf733f73bf733f73,0xbf733f73bf733f73,0xbf163f7dbf4f3e20,0x3f16bf7d3f4fbe20,0x3f4fbe20bf163f7d,0xbf4f3e203f16bf7d
.quad 0x3f4fbf16bf4f3f16,0x3f4fbf16bf4f3f16,0xbf16bf4f3f163f4f,0xbf16bf4f3f163f4f,0xbf73bee83e9e3f64,0x3f733ee8be9ebf64,0x3e9e3f643f733ee8,0xbe9ebf64bf73bee8
.quad 0x3e9e3e9e3e9e3e9e,0x3e9e3e9e3e9e3e9e,0x3f733f733f733f73,0x3f733f733f733f73,0xbda13f263f7f3f43,0x3da1bf26bf7fbf43,0xbf7fbf43bda13f26,0x3f7f3f433da1bf26
.quad 0xbe20bf7d3e203f7d,0xbe20bf7d3e203f7d,0x3f7dbe20bf7d3e20,0x3f7dbe20bf7d3e20,0x3ec43ec4bf6d3f6d,0xbec4bec43f6dbf6d,0xbf6d3f6dbec4bec4,0x3f6dbf6d3ec43ec4
.quad 0xbf163f16bf163f16,0xbf163f16bf163f16,0x3f4fbf4f3f4fbf4f,0x3f4fbf4f3f4fbf4f,0x3f43bf7f3f263da1,0xbf433f7fbf26bda1,0xbf26bda13f43bf7f,0x3f263da1bf433f7f
.quad 0xbf643ee83f64bee8,0xbf643ee83f64bee8,0x3ee83f64bee8bf64,0x3ee83f64bee8bf64,0x3f793f06be6fbf5a,0xbf79bf063e6f3f5a,0xbe6fbf5abf79bf06,0x3e6f3f5a3f793f06
.quad 0x3f803f803f803f80,0x3e9e3e9e3e9e3e9e,0x3f803f803f803f80,0x3f733f733f733f73,0xbf7dbf163e203f4f,0xbe203f163f7d3f4f,0xbe20bf4fbf7dbf16,0xbf7dbf4fbe203f16
.quad 0x3f73be9ebf733e9e,0xbf8000003f80,0x3e9e3f73be9ebf73,0x3f808000bf808000,0xbf643f73bee8be9e,0x3e203f16bf7d3f4f,0xbee8be9e3f64bf73,0xbf7d3f4fbe20bf16
.quad 0x3f4fbf4f3f4fbf4f,0xbe9e3e9ebe9e3e9e,0x3f16bf163f16bf16,0x3f73bf733f73bf73,0xbf3500003f35bf80,0x3ee8bf733f64be9e,0xbf353f80bf358000,0xbf643e9e3ee8bf73
.quad 0x3f163f4fbf16bf4f,0xbf163f4f3f16bf4f,0x3f4fbf16bf4f3f16,0x3f4f3f16bf4fbf16,0xbee8bf73bf64be9e,0x3f350000bf35bf80,0xbf64be9e3ee83f73,0xbf35bf80bf358000
.quad 0x3f803f803f803f80,0x3e9e3e9e3e9e3e9e,0x3f803f803f803f80,0x3f733f733f733f73,0x3f7d3f16be20bf4f,0x3e20bf16bf7dbf4f,0x3e203f4f3f7d3f16,0x3f7d3f4f3e20bf16
.quad 0x3f73be9ebf733e9e,0xbf8000003f80,0x3e9e3f73be9ebf73,0x3f808000bf808000,0x3f64bf733ee83e9e,0xbe20bf163f7dbf4f,0x3ee83e9ebf643f73,0x3f7dbf4f3e203f16
.quad 0x3f4fbf4f3f4fbf4f,0xbe9e3e9ebe9e3e9e,0x3f16bf163f16bf16,0x3f73bf733f73bf73,0x3f350000bf353f80,0xbee83f73bf643e9e,0x3f35bf803f358000,0x3f64be9ebee83f73
.quad 0x3f163f4fbf16bf4f,0xbf163f4f3f16bf4f,0x3f4fbf16bf4f3f16,0x3f4f3f16bf4fbf16,0x3ee83f733f643e9e,0xbf3500003f353f80,0x3f643e9ebee8bf73,0x3f353f803f358000
.quad 0x3f803f803f803f80,0x3f4f3f4f3f4f3f4f,0xbf80bf80bf80bf80,0x3f163f163f163f16,0xbf7fbf263da13f43,0xbf43bda13f263f7f,0xbda1bf43bf7fbf26,0xbf26bf7fbf43bda1
.quad 0x3f7dbe20bf7d3e20,0x3f35bf35bf353f35,0x3e203f7dbe20bf7d,0x3f353f35bf35bf35,0xbf793f5abe6fbf06,0xbf263f7fbf433da1,0xbe6fbf063f79bf5a,0xbf433da13f26bf7f
.quad 0x3f73bf733f73bf73,0x3f16bf163f16bf16,0x3e9ebe9e3e9ebe9e,0x3f4fbf4f3f4fbf4f,0xbf6d3ec43ec4bf6d,0xbf06be6f3f5abf79,0xbec43f6dbf6d3ec4,0xbf5a3f79bf06be6f
.quad 0x3f643ee8bf64bee8,0x3ee83f64bee8bf64,0x3ee8bf64bee83f64,0x3f64bee8bf643ee8,0xbf5abf79bf063e6f,0xbec4bf6dbf6dbec4,0xbf063e6f3f5a3f79,0xbf6dbec43ec43f6d
.quad 0x3f803f803f803f80,0x3f4f3f4f3f4f3f4f,0xbf80bf80bf80bf80,0x3f163f163f163f16,0x3f7f3f26bda1bf43,0x3f433da1bf26bf7f,0x3da13f433f7f3f26,0x3f263f7f3f433da1
.quad 0x3f7dbe20bf7d3e20,0x3f35bf35bf353f35,0x3e203f7dbe20bf7d,0x3f353f35bf35bf35,0x3f79bf5a3e6f3f06,0x3f26bf7f3f43bda1,0x3e6f3f06bf793f5a,0x3f43bda1bf263f7f
.quad 0x3f73bf733f73bf73,0x3f16bf163f16bf16,0x3e9ebe9e3e9ebe9e,0x3f4fbf4f3f4fbf4f,0x3f6dbec4bec43f6d,0x3f063e6fbf5a3f79,0x3ec4bf6d3f6dbec4,0x3f5abf793f063e6f
.quad 0x3f643ee8bf64bee8,0x3ee83f64bee8bf64,0x3ee8bf64bee83f64,0x3f64bee8bf643ee8,0x3f5a3f793f06be6f,0x3ec43f6d3f6d3ec4,0x3f06be6fbf5abf79,0x3f6d3ec4bec4bf6d
.quad 0xbf4fbf4fbf4fbf4f,0xbf4fbf4fbf4fbf4f,0x3f163f163f163f16,0xbf16bf16bf16bf16,0x3f643f733ee8be9e,0x3f350000bf35bf80,0xbee83e9e3f643f73,0x3f353f803f358000
.quad 0xbf73be9e3f733e9e,0xbf163f4f3f16bf4f,0x3e9ebf73be9e3f73,0xbf4fbf163f4f3f16,0x3f7dbf16be203f4f,0x3ee8bf733f64be9e,0xbe203f4fbf7d3f16,0x3f64be9ebee83f73
.quad 0xbf803f80bf803f80,0xbe9e3e9ebe9e3e9e,0x8000800080008000,0xbf733f73bf733f73,0x3f7dbf16be203f4f,0x3e203f16bf7d3f4f,0x3e20bf4f3f7dbf16,0x3f7dbf4f3e203f16
.quad 0xbf73be9e3f733e9e,0xbf8000003f80,0xbe9e3f733e9ebf73,0xbf8080003f808000,0x3f643f733ee8be9e,0xbe203f163f7d3f4f,0x3ee8be9ebf64bf73,0x3f7d3f4f3e20bf16
.quad 0xbf4fbf4fbf4fbf4f,0xbf4fbf4fbf4fbf4f,0x3f163f163f163f16,0xbf16bf16bf16bf16,0xbf64bf73bee83e9e,0xbf3500003f353f80,0x3ee8be9ebf64bf73,0xbf35bf80bf358000
.quad 0xbf73be9e3f733e9e,0xbf163f4f3f16bf4f,0x3e9ebf73be9e3f73,0xbf4fbf163f4f3f16,0xbf7d3f163e20bf4f,0xbee83f73bf643e9e,0x3e20bf4f3f7dbf16,0xbf643e9e3ee8bf73
.quad 0xbf803f80bf803f80,0xbe9e3e9ebe9e3e9e,0x8000800080008000,0xbf733f73bf733f73,0xbf7d3f163e20bf4f,0xbe20bf163f7dbf4f,0xbe203f4fbf7d3f16,0xbf7d3f4fbe20bf16
.quad 0xbf73be9e3f733e9e,0xbf8000003f80,0xbe9e3f733e9ebf73,0xbf8080003f808000,0xbf64bf73bee83e9e,0x3e20bf16bf7dbf4f,0xbee83e9e3f643f73,0xbf7dbf4fbe203f16
.quad 0x3e9e3e9e3e9e3e9e,0xbe9ebe9ebe9ebe9e,0x3f733f733f733f73,0x3f733f733f733f73,0xbe6f3f063f793f5a,0x3ec43f6d3f6d3ec4,0xbf79bf5abe6f3f06,0xbf6dbec43ec43f6d
.quad 0x3e20bf7dbe203f7d,0xbee8bf643ee83f64,0x3f7d3e20bf7dbe20,0x3f64bee8bf643ee8,0xbda13f43bf7f3f26,0x3f063e6fbf5a3f79,0xbf7f3f263da1bf43,0xbf5a3f79bf06be6f
.quad 0x0,0xbf163f16bf163f16,0x3f80bf803f80bf80,0x3f4fbf4f3f4fbf4f,0x3da1bf433f7fbf26,0x3f26bf7f3f43bda1,0xbf7f3f263da1bf43,0xbf433da13f26bf7f
.quad 0xbe203f7d3e20bf7d,0xbf353f353f35bf35,0x3f7d3e20bf7dbe20,0x3f353f35bf35bf35,0x3e6fbf06bf79bf5a,0x3f433da1bf26bf7f,0xbf79bf5abe6f3f06,0xbf26bf7fbf43bda1
.quad 0x3e9e3e9e3e9e3e9e,0xbe9ebe9ebe9ebe9e,0x3f733f733f733f73,0x3f733f733f733f73,0x3e6fbf06bf79bf5a,0xbec4bf6dbf6dbec4,0x3f793f5a3e6fbf06,0x3f6d3ec4bec4bf6d
.quad 0x3e20bf7dbe203f7d,0xbee8bf643ee83f64,0x3f7d3e20bf7dbe20,0x3f64bee8bf643ee8,0x3da1bf433f7fbf26,0xbf06be6f3f5abf79,0x3f7fbf26bda13f43,0x3f5abf793f063e6f
.quad 0x0,0xbf163f16bf163f16,0x3f80bf803f80bf80,0x3f4fbf4f3f4fbf4f,0xbda13f43bf7f3f26,0xbf263f7fbf433da1,0x3f7fbf26bda13f43,0x3f43bda1bf263f7f
.quad 0xbe203f7d3e20bf7d,0xbf353f353f35bf35,0x3f7d3e20bf7dbe20,0x3f353f35bf35bf35,0xbe6f3f063f793f5a,0xbf43bda13f263f7f,0x3f793f5a3e6fbf06,0x3f263f7f3f433da1
.quad 0x3e9e3e9e3e9e3e9e,0x0,0xbf73bf73bf73bf73,0x0,0xbee8bf73bf64be9e,0x0,0x3f643e9ebee8bf73,0x0
.quad 0x3f163f4fbf16bf4f,0x0,0xbf4f3f163f4fbf16,0x0,0xbf3500003f35bf80,0x0,0x3f35bf803f358000,0x0
.quad 0x3f4fbf4f3f4fbf4f,0x0,0xbf163f16bf163f16,0x0,0xbf643f73bee8be9e,0x0,0x3ee83e9ebf643f73,0x0
.quad 0x3f73be9ebf733e9e,0x0,0xbe9ebf733e9e3f73,0x0,0xbf7dbf163e203f4f,0x0,0x3e203f4f3f7d3f16,0x0
.quad 0x3e9e3e9e3e9e3e9e,0x0,0xbf73bf73bf73bf73,0x0,0x3ee83f733f643e9e,0x0,0xbf64be9e3ee83f73,0x0
.quad 0x3f163f4fbf16bf4f,0x0,0xbf4f3f163f4fbf16,0x0,0x3f350000bf353f80,0x0,0xbf353f80bf358000,0x0
.quad 0x3f4fbf4f3f4fbf4f,0x0,0xbf163f16bf163f16,0x0,0x3f64bf733ee83e9e,0x0,0xbee8be9e3f64bf73,0x0
.quad 0x3f73be9ebf733e9e,0x0,0xbe9ebf733e9e3f73,0x0,0x3f7d3f16be20bf4f,0x0,0xbe20bf4fbf7dbf16,0x0
.quad 0xbf4fbf4fbf4fbf4f,0x0,0x3f163f163f163f16,0x0,0x3f5a3f793f06be6f,0x0,0xbf063e6f3f5a3f79,0x0
.quad 0xbf64bee83f643ee8,0x0,0x3ee8bf64bee83f64,0x0,0x3f6dbec4bec43f6d,0x0,0xbec43f6dbf6d3ec4,0x0
.quad 0xbf733f73bf733f73,0x0,0x3e9ebe9e3e9ebe9e,0x0,0x3f79bf5a3e6f3f06,0x0,0xbe6fbf063f79bf5a,0x0
.quad 0xbf7d3e203f7dbe20,0x0,0x3e203f7dbe20bf7d,0x0,0x3f7f3f26bda1bf43,0x0,0xbda1bf43bf7fbf26,0x0
.quad 0xbf4fbf4fbf4fbf4f,0x0,0x3f163f163f163f16,0x0,0xbf5abf79bf063e6f,0x0,0x3f06be6fbf5abf79,0x0
.quad 0xbf64bee83f643ee8,0x0,0x3ee8bf64bee83f64,0x0,0xbf6d3ec43ec4bf6d,0x0,0x3ec4bf6d3f6dbec4,0x0
.quad 0xbf733f73bf733f73,0x0,0x3e9ebe9e3e9ebe9e,0x0,0xbf793f5abe6fbf06,0x0,0x3e6f3f06bf793f5a,0x0
.quad 0xbf7d3e203f7dbe20,0x0,0x3e203f7dbe20bf7d,0x0,0xbf7fbf263da13f43,0x0,0x3da13f433f7f3f26,0x0
.quad 0x3f8000003f80,0x3f8000003f80,0x3f353f3500003f80,0x3f35bf353f800000,0x3f80000000003f80,0xbf8000000000bf80,0x3f35bf3500003f80,0x3f353f35bf800000
.quad 0xbf8000003f80,0xbf8000003f80,0xbf35bf3500003f80,0xbf353f353f800000,0xbf80000000003f80,0x3f8000000000bf80,0xbf353f3500003f80,0xbf35bf35bf800000
.quad 0x3f8000003f80,0x3f8000003f80,0x3f353f3500003f80,0x3f35bf353f800000,0x3f80000000003f80,0xbf8000000000bf80,0x3f35bf3500003f80,0x3f353f35bf800000
.quad 0xbf8000003f80,0xbf8000003f80,0xbf35bf3500003f80,0xbf353f353f800000,0xbf80000000003f80,0x3f8000000000bf80,0xbf353f3500003f80,0xbf35bf35bf800000
.quad 0x3f8000003f80,0x3f8000003f80,0xbf35bf350000bf80,0xbf353f35bf800000,0x3f80000000003f80,0xbf8000000000bf80,0xbf353f350000bf80,0xbf35bf353f800000
.quad 0xbf8000003f80,0xbf8000003f80,0x3f353f350000bf80,0x3f35bf35bf800000,0xbf80000000003f80,0x3f8000000000bf80,0x3f35bf350000bf80,0x3f353f353f800000
.quad 0x3f8000003f80,0x3f8000003f80,0xbf35bf350000bf80,0xbf353f35bf800000,0x3f80000000003f80,0xbf8000000000bf80,0xbf353f350000bf80,0xbf35bf353f800000
.quad 0xbf8000003f80,0xbf8000003f80,0x3f353f350000bf80,0x3f35bf35bf800000,0xbf80000000003f80,0x3f8000000000bf80,0x3f35bf350000bf80,0x3f353f353f800000
.quad 0x3f8000003f80,0x3f8000003f80,0x3f6d3ec43ec43f6d,0x3ec4bf6d3f6dbec4,0x3f35bf353f353f35,0xbf353f35bf35bf35,0xbec4bf6d3f6d3ec4,0x3f6dbec4bec43f6d
.quad 0xbf8000003f800000,0xbf8000003f800000,0xbec43f6d3f6dbec4,0x3f6d3ec4bec4bf6d,0x3f353f353f35bf35,0xbf35bf35bf353f35,0x3f6dbec43ec4bf6d,0x3ec43f6d3f6d3ec4
.quad 0xbf800000bf80,0xbf800000bf80,0xbf6dbec4bec4bf6d,0xbec43f6dbf6d3ec4,0xbf353f35bf35bf35,0x3f35bf353f353f35,0x3ec43f6dbf6dbec4,0xbf6d3ec43ec4bf6d
.quad 0x3f800000bf800000,0x3f800000bf800000,0x3ec4bf6dbf6d3ec4,0xbf6dbec43ec43f6d,0xbf35bf35bf353f35,0x3f353f353f35bf35,0xbf6d3ec4bec43f6d,0xbec4bf6dbf6dbec4
.quad 0x3f8000003f80,0x3f8000003f80,0xbf6dbec4bec4bf6d,0xbec43f6dbf6d3ec4,0x3f35bf353f353f35,0xbf353f35bf35bf35,0x3ec43f6dbf6dbec4,0xbf6d3ec43ec4bf6d
.quad 0xbf8000003f800000,0xbf8000003f800000,0x3ec4bf6dbf6d3ec4,0xbf6dbec43ec43f6d,0x3f353f353f35bf35,0xbf35bf35bf353f35,0xbf6d3ec4bec43f6d,0xbec4bf6dbf6dbec4
.quad 0xbf800000bf80,0xbf800000bf80,0x3f6d3ec43ec43f6d,0x3ec4bf6d3f6dbec4,0xbf353f35bf35bf35,0x3f35bf353f353f35,0xbec4bf6d3f6d3ec4,0x3f6dbec4bec43f6d
.quad 0x3f800000bf800000,0x3f800000bf800000,0xbec43f6d3f6dbec4,0x3f6d3ec4bec4bf6d,0xbf35bf35bf353f35,0x3f353f353f35bf35,0x3f6dbec43ec4bf6d,0x3ec43f6d3f6d3ec4
.quad 0x3f8080003f808000,0x3f8080003f808000,0x3f35bf353f808000,0xbf35bf350000bf80,0xbf803f808000,0x3f80bf808000,0xbf35bf353f808000,0x3f35bf3500003f80
.quad 0xbf8080003f808000,0xbf8080003f808000,0xbf353f353f808000,0x3f353f350000bf80,0x3f803f808000,0xbf80bf808000,0x3f353f353f808000,0xbf353f3500003f80
.quad 0x3f8080003f808000,0x3f8080003f808000,0x3f35bf353f808000,0xbf35bf350000bf80,0xbf803f808000,0x3f80bf808000,0xbf35bf353f808000,0x3f35bf3500003f80
.quad 0xbf8080003f808000,0xbf8080003f808000,0xbf353f353f808000,0x3f353f350000bf80,0x3f803f808000,0xbf80bf808000,0x3f353f353f808000,0xbf353f3500003f80
.quad 0x3f8080003f808000,0x3f8080003f808000,0xbf353f35bf808000,0x3f353f3500003f80,0xbf803f808000,0x3f80bf808000,0x3f353f35bf808000,0xbf353f350000bf80
.quad 0xbf8080003f808000,0xbf8080003f808000,0x3f35bf35bf808000,0xbf35bf3500003f80,0x3f803f808000,0xbf80bf808000,0xbf35bf35bf808000,0x3f35bf350000bf80
.quad 0x3f8080003f808000,0x3f8080003f808000,0xbf353f35bf808000,0x3f353f3500003f80,0xbf803f808000,0x3f80bf808000,0x3f353f35bf808000,0xbf353f350000bf80
.quad 0xbf8080003f808000,0xbf8080003f808000,0x3f35bf35bf808000,0xbf35bf3500003f80,0x3f803f808000,0xbf80bf808000,0xbf35bf35bf808000,0x3f35bf350000bf80
.quad 0x3f8080003f808000,0x3f8080003f808000,0x3ec4bf6d3f6dbec4,0xbf6dbec4bec4bf6d,0xbf35bf353f35bf35,0x3f353f35bf353f35,0xbf6d3ec43ec4bf6d,0xbec4bf6d3f6d3ec4
.quad 0x3f800000bf80,0x3f800000bf80,0x3f6d3ec4bec4bf6d,0x3ec4bf6dbf6d3ec4,0x3f35bf35bf35bf35,0xbf353f353f353f35,0xbec4bf6dbf6dbec4,0x3f6dbec43ec4bf6d
.quad 0xbf808000bf808000,0xbf808000bf808000,0xbec43f6dbf6d3ec4,0x3f6d3ec43ec43f6d,0x3f353f35bf353f35,0xbf35bf353f35bf35,0x3f6dbec4bec43f6d,0x3ec43f6dbf6dbec4
.quad 0xbf8000003f80,0xbf8000003f80,0xbf6dbec43ec43f6d,0xbec43f6d3f6dbec4,0xbf353f353f353f35,0x3f35bf35bf35bf35,0x3ec43f6d3f6d3ec4,0xbf6d3ec4bec43f6d
.quad 0x3f8080003f808000,0x3f8080003f808000,0xbec43f6dbf6d3ec4,0x3f6d3ec43ec43f6d,0xbf35bf353f35bf35,0x3f353f35bf353f35,0x3f6dbec4bec43f6d,0x3ec43f6dbf6dbec4
.quad 0x3f800000bf80,0x3f800000bf80,0xbf6dbec43ec43f6d,0xbec43f6d3f6dbec4,0x3f35bf35bf35bf35,0xbf353f353f353f35,0x3ec43f6d3f6d3ec4,0xbf6d3ec4bec43f6d
.quad 0xbf808000bf808000,0xbf808000bf808000,0x3ec4bf6d3f6dbec4,0xbf6dbec4bec4bf6d,0x3f353f35bf353f35,0xbf35bf353f35bf35,0xbf6d3ec43ec4bf6d,0xbec4bf6d3f6d3ec4
.quad 0xbf8000003f80,0xbf8000003f80,0x3f6d3ec4bec4bf6d,0x3ec4bf6dbf6d3ec4,0xbf353f353f353f35,0x3f35bf35bf35bf35,0xbec4bf6dbf6dbec4,0x3f6dbec43ec4bf6d
.quad 0x3e483f7b00003f80,0x3f0e3f553ec43f6d,0x3f553f0e00003f80,0x3e48bf7b3f6dbec4,0x3f7bbe4800003f80,0xbf553f0ebec4bf6d,0x3f0ebf5500003f80,0x3f7b3e48bf6d3ec4
.quad 0xbe48bf7b00003f80,0xbf0ebf553ec43f6d,0xbf55bf0e00003f80,0xbe483f7b3f6dbec4,0xbf7b3e4800003f80,0x3f55bf0ebec4bf6d,0xbf0e3f5500003f80,0xbf7bbe48bf6d3ec4
.quad 0x3e483f7b00003f80,0x3f0e3f553ec43f6d,0x3f553f0e00003f80,0x3e48bf7b3f6dbec4,0x3f7bbe4800003f80,0xbf553f0ebec4bf6d,0x3f0ebf5500003f80,0x3f7b3e48bf6d3ec4
.quad 0xbe48bf7b00003f80,0xbf0ebf553ec43f6d,0xbf55bf0e00003f80,0xbe483f7b3f6dbec4,0xbf7b3e4800003f80,0x3f55bf0ebec4bf6d,0xbf0e3f5500003f80,0xbf7bbe48bf6d3ec4
.quad 0x3f553f0e3f353f35,0x3f7b3e483f6d3ec4,0xbf7b3e48bf35bf35,0x3f0e3f55bec43f6d,0x3f0ebf553f353f35,0xbe483f7bbf6dbec4,0x3e483f7bbf35bf35,0xbf553f0e3ec4bf6d
.quad 0xbf55bf0e3f353f35,0xbf7bbe483f6d3ec4,0x3f7bbe48bf35bf35,0xbf0ebf55bec43f6d,0xbf0e3f553f353f35,0x3e48bf7bbf6dbec4,0xbe48bf7bbf35bf35,0x3f55bf0e3ec4bf6d
.quad 0x3f553f0e3f353f35,0x3f7b3e483f6d3ec4,0xbf7b3e48bf35bf35,0x3f0e3f55bec43f6d,0x3f0ebf553f353f35,0xbe483f7bbf6dbec4,0x3e483f7bbf35bf35,0xbf553f0e3ec4bf6d
.quad 0xbf55bf0e3f353f35,0xbf7bbe483f6d3ec4,0x3f7bbe48bf35bf35,0xbf0ebf55bec43f6d,0xbf0e3f553f353f35,0x3e48bf7bbf6dbec4,0xbe48bf7bbf35bf35,0x3f55bf0e3ec4bf6d
.quad 0x3e953f753dc93f7f,0x3f223f463ef13f62,0x3f7f3dc93ef13f62,0xbe95bf753f22bf46,0x3ef1bf623f463f22,0xbdc93f7fbf75be95,0xbf22bf463f753e95,0x3ef1bf623dc93f7f
.quad 0xbf753e953f7fbdc9,0xbf463f223f62bef1,0xbdc93f7f3f62bef1,0x3f75be95bf46bf22,0x3f623ef13f22bf46,0xbf7fbdc9be953f75,0x3f46bf223e95bf75,0x3f623ef13f7fbdc9
.quad 0xbe95bf75bdc9bf7f,0xbf22bf46bef1bf62,0xbf7fbdc9bef1bf62,0x3e953f75bf223f46,0xbef13f62bf46bf22,0x3dc9bf7f3f753e95,0x3f223f46bf75be95,0xbef13f62bdc9bf7f
.quad 0x3f75be95bf7f3dc9,0x3f46bf22bf623ef1,0x3dc9bf7fbf623ef1,0xbf753e953f463f22,0xbf62bef1bf223f46,0x3f7f3dc93e95bf75,0xbf463f22be953f75,0xbf62bef1bf7f3dc9
.quad 0x3f623ef13f463f22,0x3f7f3dc93f753e95,0xbf463f22bf75be95,0x3f623ef13dc93f7f,0xbe95bf753f7fbdc9,0x3f223f46bf623ef1,0x3f7f3dc9bf623ef1,0x3e953f75bf46bf22
.quad 0xbef13f623f22bf46,0xbdc93f7f3e95bf75,0xbf22bf46be953f75,0xbef13f623f7fbdc9,0x3f75be95bdc9bf7f,0xbf463f223ef13f62,0xbdc93f7f3ef13f62,0xbf753e95bf223f46
.quad 0xbf62bef1bf46bf22,0xbf7fbdc9bf75be95,0x3f46bf223f753e95,0xbf62bef1bdc9bf7f,0x3e953f75bf7f3dc9,0xbf22bf463f62bef1,0xbf7fbdc93f62bef1,0xbe95bf753f463f22
.quad 0x3ef1bf62bf223f46,0x3dc9bf7fbe953f75,0x3f223f463e95bf75,0x3ef1bf62bf7f3dc9,0xbf753e953dc93f7f,0x3f46bf22bef1bf62,0x3dc9bf7fbef1bf62,0x3f75be953f22bf46
.quad 0x3f7bbe483f808000,0x3f55bf0e3f6dbec4,0x3f0ebf553f808000,0xbf7bbe48bec4bf6d,0xbe48bf7b3f808000,0x3f0e3f55bf6d3ec4,0xbf55bf0e3f808000,0x3e48bf7b3ec43f6d
.quad 0xbf7b3e483f808000,0xbf553f0e3f6dbec4,0xbf0e3f553f808000,0x3f7b3e48bec4bf6d,0x3e483f7b3f808000,0xbf0ebf55bf6d3ec4,0x3f553f0e3f808000,0xbe483f7b3ec43f6d
.quad 0x3f7bbe483f808000,0x3f55bf0e3f6dbec4,0x3f0ebf553f808000,0xbf7bbe48bec4bf6d,0xbe48bf7b3f808000,0x3f0e3f55bf6d3ec4,0xbf55bf0e3f808000,0x3e48bf7b3ec43f6d
.quad 0xbf7b3e483f808000,0xbf553f0e3f6dbec4,0xbf0e3f553f808000,0x3f7b3e48bec4bf6d,0x3e483f7b3f808000,0xbf0ebf55bf6d3ec4,0x3f553f0e3f808000,0xbe483f7b3ec43f6d
.quad 0x3f0ebf553f35bf35,0x3e48bf7b3ec4bf6d,0x3e483f7bbf353f35,0x3f55bf0e3f6d3ec4,0xbf55bf0e3f35bf35,0x3f7b3e48bec43f6d,0x3f7bbe48bf353f35,0x3f0e3f55bf6dbec4
.quad 0xbf0e3f553f35bf35,0xbe483f7b3ec4bf6d,0xbe48bf7bbf353f35,0xbf553f0e3f6d3ec4,0x3f553f0e3f35bf35,0xbf7bbe48bec43f6d,0xbf7b3e48bf353f35,0xbf0ebf55bf6dbec4
.quad 0x3f0ebf553f35bf35,0x3e48bf7b3ec4bf6d,0x3e483f7bbf353f35,0x3f55bf0e3f6d3ec4,0xbf55bf0e3f35bf35,0x3f7b3e48bec43f6d,0x3f7bbe48bf353f35,0x3f0e3f55bf6dbec4
.quad 0xbf0e3f553f35bf35,0xbe483f7b3ec4bf6d,0xbe48bf7bbf353f35,0xbf553f0e3f6d3ec4,0x3f553f0e3f35bf35,0xbf7bbe48bec43f6d,0xbf7b3e48bf353f35,0xbf0ebf55bf6dbec4
.quad 0x3f75be953f7fbdc9,0x3f46bf223f62bef1,0x3dc9bf7f3f62bef1,0xbf753e95bf46bf22,0xbf62bef13f22bf46,0x3f7f3dc9be953f75,0xbf463f223e95bf75,0xbf62bef13f7fbdc9
.quad 0x3e953f75bdc9bf7f,0x3f223f46bef1bf62,0x3f7f3dc9bef1bf62,0xbe95bf75bf223f46,0x3ef1bf62bf46bf22,0xbdc93f7f3f753e95,0xbf22bf46bf75be95,0x3ef1bf62bdc9bf7f
.quad 0xbf753e95bf7f3dc9,0xbf463f22bf623ef1,0xbdc93f7fbf623ef1,0x3f75be953f463f22,0x3f623ef1bf223f46,0xbf7fbdc93e95bf75,0x3f46bf22be953f75,0x3f623ef1bf7f3dc9
.quad 0xbe95bf753dc93f7f,0xbf22bf463ef13f62,0xbf7fbdc93ef13f62,0x3e953f753f22bf46,0xbef13f623f463f22,0x3dc9bf7fbf75be95,0x3f223f463f753e95,0xbef13f623dc93f7f
.quad 0x3ef1bf623f22bf46,0x3dc9bf7f3e95bf75,0x3f223f46be953f75,0x3ef1bf623f7fbdc9,0xbf753e95bdc9bf7f,0x3f46bf223ef13f62,0x3dc9bf7f3ef13f62,0x3f75be95bf223f46
.quad 0x3f623ef1bf46bf22,0x3f7f3dc9bf75be95,0xbf463f223f753e95,0x3f623ef1bdc9bf7f,0xbe95bf75bf7f3dc9,0x3f223f463f62bef1,0x3f7f3dc93f62bef1,0x3e953f753f463f22
.quad 0xbef13f62bf223f46,0xbdc93f7fbe953f75,0xbf22bf463e95bf75,0xbef13f62bf7f3dc9,0x3f75be953dc93f7f,0xbf463f22bef1bf62,0xbdc93f7fbef1bf62,0xbf753e953f22bf46
.quad 0xbf62bef13f463f22,0xbf7fbdc93f753e95,0x3f46bf22bf75be95,0xbf62bef13dc93f7f,0x3e953f753f7fbdc9,0xbf22bf46bf623ef1,0xbf7fbdc9bf623ef1,0xbe95bf75bf46bf22
.quad 0x3ec43f6d00003f80,0x3f6d3ec43f353f35,0x3f6d3ec400003f80,0xbec4bf6d3f35bf35,0x3f6dbec400003f80,0xbec43f6dbf35bf35,0x3ec4bf6d00003f80,0x3f6dbec4bf353f35
.quad 0xbec4bf6d00003f80,0xbf6dbec43f353f35,0xbf6dbec400003f80,0x3ec43f6d3f35bf35,0xbf6d3ec400003f80,0x3ec4bf6dbf35bf35,0xbec43f6d00003f80,0xbf6d3ec4bf353f35
.quad 0x3ec43f6d00003f80,0x3f6d3ec43f353f35,0x3f6d3ec400003f80,0xbec4bf6d3f35bf35,0x3f6dbec400003f80,0xbec43f6dbf35bf35,0x3ec4bf6d00003f80,0x3f6dbec4bf353f35
.quad 0xbec4bf6d00003f80,0xbf6dbec43f353f35,0xbf6dbec400003f80,0x3ec43f6d3f35bf35,0xbf6d3ec400003f80,0x3ec4bf6dbf35bf35,0xbec43f6d00003f80,0xbf6d3ec4bf353f35
.quad 0x3f6dbec43f800000,0x3ec4bf6d3f35bf35,0xbec43f6dbf800000,0x3f6dbec43f353f35,0xbec4bf6d3f800000,0x3f6d3ec4bf353f35,0x3f6d3ec4bf800000,0x3ec43f6dbf35bf35
.quad 0xbf6d3ec43f800000,0xbec43f6d3f35bf35,0x3ec4bf6dbf800000,0xbf6d3ec43f353f35,0x3ec43f6d3f800000,0xbf6dbec4bf353f35,0xbf6dbec4bf800000,0xbec4bf6dbf35bf35
.quad 0x3f6dbec43f800000,0x3ec4bf6d3f35bf35,0xbec43f6dbf800000,0x3f6dbec43f353f35,0xbec4bf6d3f800000,0x3f6d3ec4bf353f35,0x3f6d3ec4bf800000,0x3ec43f6dbf35bf35
.quad 0xbf6d3ec43f800000,0xbec43f6d3f35bf35,0x3ec4bf6dbf800000,0xbf6d3ec43f353f35,0x3ec43f6d3f800000,0xbf6dbec4bf353f35,0xbf6dbec4bf800000,0xbec4bf6dbf35bf35
.quad 0x3f0e3f553e483f7b,0x3f7b3e483f553f0e,0x3f7bbe483f0e3f55,0xbf55bf0e3e48bf7b,0x3e48bf7b3f553f0e,0x3f0e3f55bf7b3e48,0xbf55bf0e3f7b3e48,0xbe48bf7b3f0e3f55
.quad 0xbf553f0e3f7bbe48,0xbe483f7b3f0ebf55,0x3e483f7b3f55bf0e,0x3f0ebf55bf7bbe48,0x3f7b3e483f0ebf55,0xbf553f0e3e483f7b,0x3f0ebf553e48bf7b,0x3f7bbe483f55bf0e
.quad 0xbf0ebf55be48bf7b,0xbf7bbe48bf55bf0e,0xbf7b3e48bf0ebf55,0x3f553f0ebe483f7b,0xbe483f7bbf55bf0e,0xbf0ebf553f7bbe48,0x3f553f0ebf7bbe48,0x3e483f7bbf0ebf55
.quad 0x3f55bf0ebf7b3e48,0x3e48bf7bbf0e3f55,0xbe48bf7bbf553f0e,0xbf0e3f553f7b3e48,0xbf7bbe48bf0e3f55,0x3f55bf0ebe48bf7b,0xbf0e3f55be483f7b,0xbf7b3e48bf553f0e
.quad 0x3f55bf0e3f7bbe48,0x3e48bf7b3f0ebf55,0x3e483f7bbf553f0e,0x3f0ebf553f7b3e48,0xbf7bbe483f0ebf55,0x3f55bf0e3e483f7b,0x3f0ebf55be483f7b,0x3f7bbe48bf553f0e
.quad 0x3f0e3f55be48bf7b,0x3f7b3e48bf55bf0e,0xbf7b3e483f0e3f55,0x3f553f0e3e48bf7b,0x3e48bf7bbf55bf0e,0x3f0e3f553f7bbe48,0x3f553f0e3f7b3e48,0x3e483f7b3f0e3f55
.quad 0xbf553f0ebf7b3e48,0xbe483f7bbf0e3f55,0xbe48bf7b3f55bf0e,0xbf0e3f55bf7bbe48,0x3f7b3e48bf0e3f55,0xbf553f0ebe48bf7b,0xbf0e3f553e48bf7b,0xbf7b3e483f55bf0e
.quad 0xbf0ebf553e483f7b,0xbf7bbe483f553f0e,0x3f7bbe48bf0ebf55,0xbf55bf0ebe483f7b,0xbe483f7b3f553f0e,0xbf0ebf55bf7b3e48,0xbf55bf0ebf7bbe48,0xbe48bf7bbf0ebf55
.quad 0x3f6dbec43f808000,0x3ec4bf6d3f35bf35,0x3ec4bf6d3f808000,0xbf6d3ec4bf35bf35,0xbec4bf6d3f808000,0x3f6d3ec4bf353f35,0xbf6dbec43f808000,0xbec4bf6d3f353f35
.quad 0xbf6d3ec43f808000,0xbec43f6d3f35bf35,0xbec43f6d3f808000,0x3f6dbec4bf35bf35,0x3ec43f6d3f808000,0xbf6dbec4bf353f35,0x3f6d3ec43f808000,0x3ec43f6d3f353f35
.quad 0x3f6dbec43f808000,0x3ec4bf6d3f35bf35,0x3ec4bf6d3f808000,0xbf6d3ec4bf35bf35,0xbec4bf6d3f808000,0x3f6d3ec4bf353f35,0xbf6dbec43f808000,0xbec4bf6d3f353f35
.quad 0xbf6d3ec43f808000,0xbec43f6d3f35bf35,0xbec43f6d3f808000,0x3f6dbec4bf35bf35,0x3ec43f6d3f808000,0xbf6dbec4bf353f35,0x3f6d3ec43f808000,0x3ec43f6d3f353f35
.quad 0xbec4bf6d0000bf80,0xbf6dbec4bf35bf35,0x3f6d3ec400003f80,0xbec4bf6d3f35bf35,0xbf6d3ec40000bf80,0x3ec4bf6d3f353f35,0x3ec4bf6d00003f80,0x3f6dbec4bf353f35
.quad 0x3ec43f6d0000bf80,0x3f6d3ec4bf35bf35,0xbf6dbec400003f80,0x3ec43f6d3f35bf35,0x3f6dbec40000bf80,0xbec43f6d3f353f35,0xbec43f6d00003f80,0xbf6d3ec4bf353f35
.quad 0xbec4bf6d0000bf80,0xbf6dbec4bf35bf35,0x3f6d3ec400003f80,0xbec4bf6d3f35bf35,0xbf6d3ec40000bf80,0x3ec4bf6d3f353f35,0x3ec4bf6d00003f80,0x3f6dbec4bf353f35
.quad 0x3ec43f6d0000bf80,0x3f6d3ec4bf35bf35,0xbf6dbec400003f80,0x3ec43f6d3f35bf35,0x3f6dbec40000bf80,0xbec43f6d3f353f35,0xbec43f6d00003f80,0xbf6d3ec4bf353f35
.quad 0x3f55bf0e3f7bbe48,0x3e48bf7b3f0ebf55,0xbe48bf7b3f55bf0e,0xbf0e3f55bf7bbe48,0xbf7bbe483f0ebf55,0x3f55bf0e3e483f7b,0xbf0e3f553e48bf7b,0xbf7b3e483f55bf0e
.quad 0x3f0e3f55be48bf7b,0x3f7b3e48bf55bf0e,0x3f7bbe48bf0ebf55,0xbf55bf0ebe483f7b,0x3e48bf7bbf55bf0e,0x3f0e3f553f7bbe48,0xbf55bf0ebf7bbe48,0xbe48bf7bbf0ebf55
.quad 0xbf553f0ebf7b3e48,0xbe483f7bbf0e3f55,0x3e483f7bbf553f0e,0x3f0ebf553f7b3e48,0x3f7b3e48bf0e3f55,0xbf553f0ebe48bf7b,0x3f0ebf55be483f7b,0x3f7bbe48bf553f0e
.quad 0xbf0ebf553e483f7b,0xbf7bbe483f553f0e,0xbf7b3e483f0e3f55,0x3f553f0e3e48bf7b,0xbe483f7b3f553f0e,0xbf0ebf55bf7b3e48,0x3f553f0e3f7b3e48,0x3e483f7b3f0e3f55
.quad 0xbf0ebf55be48bf7b,0xbf7bbe48bf55bf0e,0x3f7bbe483f0e3f55,0xbf55bf0e3e48bf7b,0xbe483f7bbf55bf0e,0xbf0ebf553f7bbe48,0xbf55bf0e3f7b3e48,0xbe48bf7b3f0e3f55
.quad 0x3f55bf0ebf7b3e48,0x3e48bf7bbf0e3f55,0x3e483f7b3f55bf0e,0x3f0ebf55bf7bbe48,0xbf7bbe48bf0e3f55,0x3f55bf0ebe48bf7b,0x3f0ebf553e48bf7b,0x3f7bbe483f55bf0e
.quad 0x3f0e3f553e483f7b,0x3f7b3e483f553f0e,0xbf7b3e48bf0ebf55,0x3f553f0ebe483f7b,0x3e48bf7b3f553f0e,0x3f0e3f55bf7b3e48,0x3f553f0ebf7bbe48,0x3e483f7bbf0ebf55
.quad 0xbf553f0e3f7bbe48,0xbe483f7b3f0ebf55,0xbe48bf7bbf553f0e,0xbf0e3f553f7b3e48,0x3f7b3e483f0ebf55,0xbf553f0e3e483f7b,0xbf0e3f55be483f7b,0xbf7b3e48bf553f0e
.quad 0x3f0e3f5500003f80,0x3f7bbe483f6d3ec4,0x3f7b3e4800003f80,0xbf55bf0e3ec4bf6d,0x3f55bf0e00003f80,0x3e483f7bbf6dbec4,0x3e48bf7b00003f80,0x3f0ebf55bec43f6d
.quad 0xbf0ebf5500003f80,0xbf7b3e483f6d3ec4,0xbf7bbe4800003f80,0x3f553f0e3ec4bf6d,0xbf553f0e00003f80,0xbe48bf7bbf6dbec4,0xbe483f7b00003f80,0xbf0e3f55bec43f6d
.quad 0x3f0e3f5500003f80,0x3f7bbe483f6d3ec4,0x3f7b3e4800003f80,0xbf55bf0e3ec4bf6d,0x3f55bf0e00003f80,0x3e483f7bbf6dbec4,0x3e48bf7b00003f80,0x3f0ebf55bec43f6d
.quad 0xbf0ebf5500003f80,0xbf7b3e483f6d3ec4,0xbf7bbe4800003f80,0x3f553f0e3ec4bf6d,0xbf553f0e00003f80,0xbe48bf7bbf6dbec4,0xbe483f7b00003f80,0xbf0e3f55bec43f6d
.quad 0x3e48bf7b3f35bf35,0xbf55bf0ebec4bf6d,0x3f0e3f55bf353f35,0xbe48bf7b3f6dbec4,0xbf7bbe483f35bf35,0x3f0ebf553ec43f6d,0x3f55bf0ebf353f35,0x3f7bbe48bf6d3ec4
.quad 0xbe483f7b3f35bf35,0x3f553f0ebec4bf6d,0xbf0ebf55bf353f35,0x3e483f7b3f6dbec4,0x3f7b3e483f35bf35,0xbf0e3f553ec43f6d,0xbf553f0ebf353f35,0xbf7b3e48bf6d3ec4
.quad 0x3e48bf7b3f35bf35,0xbf55bf0ebec4bf6d,0x3f0e3f55bf353f35,0xbe48bf7b3f6dbec4,0xbf7bbe483f35bf35,0x3f0ebf553ec43f6d,0x3f55bf0ebf353f35,0x3f7bbe48bf6d3ec4
.quad 0xbe483f7b3f35bf35,0x3f553f0ebec4bf6d,0xbf0ebf55bf353f35,0x3e483f7b3f6dbec4,0x3f7b3e483f35bf35,0xbf0e3f553ec43f6d,0xbf553f0ebf353f35,0xbf7b3e48bf6d3ec4
.quad 0x3f463f223e953f75,0x3f62bef13f7f3dc9,0x3f62bef13f223f46,0xbf7f3dc9be95bf75,0xbdc9bf7f3f623ef1,0x3f753e95bf463f22,0xbf75be953f7f3dc9,0xbf46bf223f623ef1
.quad 0xbf223f463f75be95,0x3ef13f623dc9bf7f,0x3ef13f623f46bf22,0xbdc9bf7fbf753e95,0x3f7fbdc93ef1bf62,0xbe953f753f223f46,0x3e95bf753dc9bf7f,0x3f22bf463ef1bf62
.quad 0xbf46bf22be95bf75,0xbf623ef1bf7fbdc9,0xbf623ef1bf22bf46,0x3f7fbdc93e953f75,0x3dc93f7fbf62bef1,0xbf75be953f46bf22,0x3f753e95bf7fbdc9,0x3f463f22bf62bef1
.quad 0x3f22bf46bf753e95,0xbef1bf62bdc93f7f,0xbef1bf62bf463f22,0x3dc93f7f3f75be95,0xbf7f3dc9bef13f62,0x3e95bf75bf22bf46,0xbe953f75bdc93f7f,0xbf223f46bef13f62
.quad 0xbdc9bf7f3ef1bf62,0xbf75be95bf22bf46,0x3f753e95bdc93f7f,0xbf46bf223ef1bf62,0xbf223f46be95bf75,0xbef1bf623f7f3dc9,0xbef1bf623f223f46,0xbdc9bf7f3e953f75
.quad 0x3f7fbdc9bf62bef1,0x3e95bf75bf463f22,0xbe953f753f7f3dc9,0x3f22bf46bf62bef1,0xbf46bf22bf753e95,0x3f62bef13dc9bf7f,0x3f62bef13f46bf22,0x3f7fbdc93f75be95
.quad 0x3dc93f7fbef13f62,0x3f753e953f223f46,0xbf75be953dc9bf7f,0x3f463f22bef13f62,0x3f22bf463e953f75,0x3ef13f62bf7fbdc9,0x3ef13f62bf22bf46,0x3dc93f7fbe95bf75
.quad 0xbf7f3dc93f623ef1,0xbe953f753f46bf22,0x3e95bf75bf7fbdc9,0xbf223f463f623ef1,0x3f463f223f75be95,0xbf623ef1bdc93f7f,0xbf623ef1bf463f22,0xbf7f3dc9bf753e95
.quad 0x3f55bf0e3f808000,0xbe48bf7b3ec4bf6d,0x3e48bf7b3f808000,0xbf0e3f55bf6dbec4,0xbf0ebf553f808000,0x3f7bbe48bec43f6d,0xbf7bbe483f808000,0xbf55bf0e3f6d3ec4
.quad 0xbf553f0e3f808000,0x3e483f7b3ec4bf6d,0xbe483f7b3f808000,0x3f0ebf55bf6dbec4,0x3f0e3f553f808000,0xbf7b3e48bec43f6d,0x3f7b3e483f808000,0x3f553f0e3f6d3ec4
.quad 0x3f55bf0e3f808000,0xbe48bf7b3ec4bf6d,0x3e48bf7b3f808000,0xbf0e3f55bf6dbec4,0xbf0ebf553f808000,0x3f7bbe48bec43f6d,0xbf7bbe483f808000,0xbf55bf0e3f6d3ec4
.quad 0xbf553f0e3f808000,0x3e483f7b3ec4bf6d,0xbe483f7b3f808000,0x3f0ebf55bf6dbec4,0x3f0e3f553f808000,0xbf7b3e48bec43f6d,0x3f7b3e483f808000,0x3f553f0e3f6d3ec4
.quad 0xbf7bbe48bf35bf35,0xbf0e3f55bf6d3ec4,0x3f55bf0e3f353f35,0xbf7b3e48bec4bf6d,0xbe483f7bbf35bf35,0xbf55bf0e3f6dbec4,0xbf0ebf553f353f35,0xbe48bf7b3ec43f6d
.quad 0x3f7b3e48bf35bf35,0x3f0ebf55bf6d3ec4,0xbf553f0e3f353f35,0x3f7bbe48bec4bf6d,0x3e48bf7bbf35bf35,0x3f553f0e3f6dbec4,0x3f0e3f553f353f35,0x3e483f7b3ec43f6d
.quad 0xbf7bbe48bf35bf35,0xbf0e3f55bf6d3ec4,0x3f55bf0e3f353f35,0xbf7b3e48bec4bf6d,0xbe483f7bbf35bf35,0xbf55bf0e3f6dbec4,0xbf0ebf553f353f35,0xbe48bf7b3ec43f6d
.quad 0x3f7b3e48bf35bf35,0x3f0ebf55bf6d3ec4,0xbf553f0e3f353f35,0x3f7bbe48bec4bf6d,0x3e48bf7bbf35bf35,0x3f553f0e3f6dbec4,0x3f0e3f553f353f35,0x3e483f7b3ec43f6d
.quad 0x3f22bf463f75be95,0xbef1bf623dc9bf7f,0xbef1bf623f46bf22,0x3dc93f7fbf753e95,0xbf7f3dc93ef1bf62,0x3e95bf753f223f46,0xbe953f753dc9bf7f,0xbf223f463ef1bf62
.quad 0x3f463f22be95bf75,0x3f62bef1bf7fbdc9,0x3f62bef1bf22bf46,0xbf7f3dc93e953f75,0xbdc9bf7fbf62bef1,0x3f753e953f46bf22,0xbf75be95bf7fbdc9,0xbf46bf22bf62bef1
.quad 0xbf223f46bf753e95,0x3ef13f62bdc93f7f,0x3ef13f62bf463f22,0xbdc9bf7f3f75be95,0x3f7fbdc9bef13f62,0xbe953f75bf22bf46,0x3e95bf75bdc93f7f,0x3f22bf46bef13f62
.quad 0xbf46bf223e953f75,0xbf623ef13f7f3dc9,0xbf623ef13f223f46,0x3f7fbdc9be95bf75,0x3dc93f7f3f623ef1,0xbf75be95bf463f22,0x3f753e953f7f3dc9,0x3f463f223f623ef1
.quad 0xbf7f3dc9bf62bef1,0xbe953f75bf463f22,0x3e95bf753f7f3dc9,0xbf223f46bf62bef1,0x3f463f22bf753e95,0xbf623ef13dc9bf7f,0xbf623ef13f46bf22,0xbf7f3dc93f75be95
.quad 0xbdc9bf7fbef13f62,0xbf75be953f223f46,0x3f753e953dc9bf7f,0xbf46bf22bef13f62,0xbf223f463e953f75,0xbef1bf62bf7fbdc9,0xbef1bf62bf22bf46,0xbdc9bf7fbe95bf75
.quad 0x3f7fbdc93f623ef1,0x3e95bf753f46bf22,0xbe953f75bf7fbdc9,0x3f22bf463f623ef1,0xbf46bf223f75be95,0x3f62bef1bdc93f7f,0x3f62bef1bf463f22,0x3f7fbdc9bf753e95
.quad 0x3dc93f7f3ef1bf62,0x3f753e95bf22bf46,0xbf75be95bdc93f7f,0x3f463f223ef1bf62,0x3f22bf46be95bf75,0x3ef13f623f7f3dc9,0x3ef13f623f223f46,0x3dc93f7f3e953f75
.quad 0x3f8000003f80,0x3f8000003f80,0x3ec43f6d00003f80,0x3f6d3ec43f353f35,0x3f353f3500003f80,0x3f35bf353f800000,0x3f6d3ec400003f80,0xbec4bf6d3f35bf35
.quad 0x3f80000000003f80,0xbf8000000000bf80,0x3f6dbec400003f80,0xbec43f6dbf35bf35,0x3f35bf3500003f80,0x3f353f35bf800000,0x3ec4bf6d00003f80,0x3f6dbec4bf353f35
.quad 0xbf8000003f80,0xbf8000003f80,0xbec4bf6d00003f80,0xbf6dbec43f353f35,0xbf35bf3500003f80,0xbf353f353f800000,0xbf6dbec400003f80,0x3ec43f6d3f35bf35
.quad 0xbf80000000003f80,0x3f8000000000bf80,0xbf6d3ec400003f80,0x3ec4bf6dbf35bf35,0xbf353f3500003f80,0xbf35bf35bf800000,0xbec43f6d00003f80,0xbf6d3ec4bf353f35
.quad 0x3f8000003f80,0x3f8000003f80,0x3f0e3f553e483f7b,0x3f7b3e483f553f0e,0x3f6d3ec43ec43f6d,0x3ec4bf6d3f6dbec4,0x3f7bbe483f0e3f55,0xbf55bf0e3e48bf7b
.quad 0x3f35bf353f353f35,0xbf353f35bf35bf35,0x3e48bf7b3f553f0e,0x3f0e3f55bf7b3e48,0xbec4bf6d3f6d3ec4,0x3f6dbec4bec43f6d,0xbf55bf0e3f7b3e48,0xbe48bf7b3f0e3f55
.quad 0xbf8000003f800000,0xbf8000003f800000,0xbf553f0e3f7bbe48,0xbe483f7b3f0ebf55,0xbec43f6d3f6dbec4,0x3f6d3ec4bec4bf6d,0x3e483f7b3f55bf0e,0x3f0ebf55bf7bbe48
.quad 0x3f353f353f35bf35,0xbf35bf35bf353f35,0x3f7b3e483f0ebf55,0xbf553f0e3e483f7b,0x3f6dbec43ec4bf6d,0x3ec43f6d3f6d3ec4,0x3f0ebf553e48bf7b,0x3f7bbe483f55bf0e
.quad 0x3f8000003f80,0x3f8000003f80,0x3f6dbec43f800000,0x3ec4bf6d3f35bf35,0xbf35bf350000bf80,0xbf353f35bf800000,0xbec43f6dbf800000,0x3f6dbec43f353f35
.quad 0x3f80000000003f80,0xbf8000000000bf80,0xbec4bf6d3f800000,0x3f6d3ec4bf353f35,0xbf353f350000bf80,0xbf35bf353f800000,0x3f6d3ec4bf800000,0x3ec43f6dbf35bf35
.quad 0xbf8000003f80,0xbf8000003f80,0xbf6d3ec43f800000,0xbec43f6d3f35bf35,0x3f353f350000bf80,0x3f35bf35bf800000,0x3ec4bf6dbf800000,0xbf6d3ec43f353f35
.quad 0xbf80000000003f80,0x3f8000000000bf80,0x3ec43f6d3f800000,0xbf6dbec4bf353f35,0x3f35bf350000bf80,0x3f353f353f800000,0xbf6dbec4bf800000,0xbec4bf6dbf35bf35
.quad 0x3f8000003f80,0x3f8000003f80,0x3f55bf0e3f7bbe48,0x3e48bf7b3f0ebf55,0xbf6dbec4bec4bf6d,0xbec43f6dbf6d3ec4,0x3e483f7bbf553f0e,0x3f0ebf553f7b3e48
.quad 0x3f35bf353f353f35,0xbf353f35bf35bf35,0xbf7bbe483f0ebf55,0x3f55bf0e3e483f7b,0x3ec43f6dbf6dbec4,0xbf6d3ec43ec4bf6d,0x3f0ebf55be483f7b,0x3f7bbe48bf553f0e
.quad 0xbf8000003f800000,0xbf8000003f800000,0x3f0e3f55be48bf7b,0x3f7b3e48bf55bf0e,0x3ec4bf6dbf6d3ec4,0xbf6dbec43ec43f6d,0xbf7b3e483f0e3f55,0x3f553f0e3e48bf7b
.quad 0x3f353f353f35bf35,0xbf35bf35bf353f35,0x3e48bf7bbf55bf0e,0x3f0e3f553f7bbe48,0xbf6d3ec4bec43f6d,0xbec4bf6dbf6dbec4,0x3f553f0e3f7b3e48,0x3e483f7b3f0e3f55
.quad 0x3f8000003f80,0x3f8000003f80,0x3ec43f6d00003f80,0x3f6d3ec43f353f35,0x3f353f3500003f80,0x3f35bf353f800000,0x3f6d3ec400003f80,0xbec4bf6d3f35bf35
.quad 0x3f80000000003f80,0xbf8000000000bf80,0x3f6dbec400003f80,0xbec43f6dbf35bf35,0x3f35bf3500003f80,0x3f353f35bf800000,0x3ec4bf6d00003f80,0x3f6dbec4bf353f35
.quad 0xbf8000003f80,0xbf8000003f80,0xbec4bf6d00003f80,0xbf6dbec43f353f35,0xbf35bf3500003f80,0xbf353f353f800000,0xbf6dbec400003f80,0x3ec43f6d3f35bf35
.quad 0xbf80000000003f80,0x3f8000000000bf80,0xbf6d3ec400003f80,0x3ec4bf6dbf35bf35,0xbf353f3500003f80,0xbf35bf35bf800000,0xbec43f6d00003f80,0xbf6d3ec4bf353f35
.quad 0xbf800000bf80,0xbf800000bf80,0xbf0ebf55be48bf7b,0xbf7bbe48bf55bf0e,0xbf6dbec4bec4bf6d,0xbec43f6dbf6d3ec4,0xbf7b3e48bf0ebf55,0x3f553f0ebe483f7b
.quad 0xbf353f35bf35bf35,0x3f35bf353f353f35,0xbe483f7bbf55bf0e,0xbf0ebf553f7bbe48,0x3ec43f6dbf6dbec4,0xbf6d3ec43ec4bf6d,0x3f553f0ebf7bbe48,0x3e483f7bbf0ebf55
.quad 0x3f800000bf800000,0x3f800000bf800000,0x3f55bf0ebf7b3e48,0x3e48bf7bbf0e3f55,0x3ec4bf6dbf6d3ec4,0xbf6dbec43ec43f6d,0xbe48bf7bbf553f0e,0xbf0e3f553f7b3e48
.quad 0xbf35bf35bf353f35,0x3f353f353f35bf35,0xbf7bbe48bf0e3f55,0x3f55bf0ebe48bf7b,0xbf6d3ec4bec43f6d,0xbec4bf6dbf6dbec4,0xbf0e3f55be483f7b,0xbf7b3e48bf553f0e
.quad 0x3f8000003f80,0x3f8000003f80,0x3f6dbec43f800000,0x3ec4bf6d3f35bf35,0xbf35bf350000bf80,0xbf353f35bf800000,0xbec43f6dbf800000,0x3f6dbec43f353f35
.quad 0x3f80000000003f80,0xbf8000000000bf80,0xbec4bf6d3f800000,0x3f6d3ec4bf353f35,0xbf353f350000bf80,0xbf35bf353f800000,0x3f6d3ec4bf800000,0x3ec43f6dbf35bf35
.quad 0xbf8000003f80,0xbf8000003f80,0xbf6d3ec43f800000,0xbec43f6d3f35bf35,0x3f353f350000bf80,0x3f35bf35bf800000,0x3ec4bf6dbf800000,0xbf6d3ec43f353f35
.quad 0xbf80000000003f80,0x3f8000000000bf80,0x3ec43f6d3f800000,0xbf6dbec4bf353f35,0x3f35bf350000bf80,0x3f353f353f800000,0xbf6dbec4bf800000,0xbec4bf6dbf35bf35
.quad 0xbf800000bf80,0xbf800000bf80,0xbf553f0ebf7b3e48,0xbe483f7bbf0e3f55,0x3f6d3ec43ec43f6d,0x3ec4bf6d3f6dbec4,0xbe48bf7b3f55bf0e,0xbf0e3f55bf7bbe48
.quad 0xbf353f35bf35bf35,0x3f35bf353f353f35,0x3f7b3e48bf0e3f55,0xbf553f0ebe48bf7b,0xbec4bf6d3f6d3ec4,0x3f6dbec4bec43f6d,0xbf0e3f553e48bf7b,0xbf7b3e483f55bf0e
.quad 0x3f800000bf800000,0x3f800000bf800000,0xbf0ebf553e483f7b,0xbf7bbe483f553f0e,0xbec43f6d3f6dbec4,0x3f6d3ec4bec4bf6d,0x3f7bbe48bf0ebf55,0xbf55bf0ebe483f7b
.quad 0xbf35bf35bf353f35,0x3f353f353f35bf35,0xbe483f7b3f553f0e,0xbf0ebf55bf7b3e48,0x3f6dbec43ec4bf6d,0x3ec43f6d3f6d3ec4,0xbf55bf0ebf7bbe48,0xbe48bf7bbf0ebf55
.quad 0x3f8000003f80,0x3f8000003f80,0xbec4bf6d0000bf80,0xbf6dbec4bf35bf35,0x3f353f3500003f80,0x3f35bf353f800000,0xbf6dbec40000bf80,0x3ec43f6dbf353f35
.quad 0x3f80000000003f80,0xbf8000000000bf80,0xbf6d3ec40000bf80,0x3ec4bf6d3f353f35,0x3f35bf3500003f80,0x3f353f35bf800000,0xbec43f6d0000bf80,0xbf6d3ec43f35bf35
.quad 0xbf8000003f80,0xbf8000003f80,0x3ec43f6d0000bf80,0x3f6d3ec4bf35bf35,0xbf35bf3500003f80,0xbf353f353f800000,0x3f6d3ec40000bf80,0xbec4bf6dbf353f35
.quad 0xbf80000000003f80,0x3f8000000000bf80,0x3f6dbec40000bf80,0xbec43f6d3f353f35,0xbf353f3500003f80,0xbf35bf35bf800000,0x3ec4bf6d0000bf80,0x3f6dbec43f35bf35
.quad 0x3f8000003f80,0x3f8000003f80,0xbf0ebf55be48bf7b,0xbf7bbe48bf55bf0e,0x3f6d3ec43ec43f6d,0x3ec4bf6d3f6dbec4,0xbf7b3e48bf0ebf55,0x3f553f0ebe483f7b
.quad 0x3f35bf353f353f35,0xbf353f35bf35bf35,0xbe483f7bbf55bf0e,0xbf0ebf553f7bbe48,0xbec4bf6d3f6d3ec4,0x3f6dbec4bec43f6d,0x3f553f0ebf7bbe48,0x3e483f7bbf0ebf55
.quad 0xbf8000003f800000,0xbf8000003f800000,0x3f55bf0ebf7b3e48,0x3e48bf7bbf0e3f55,0xbec43f6d3f6dbec4,0x3f6d3ec4bec4bf6d,0xbe48bf7bbf553f0e,0xbf0e3f553f7b3e48
.quad 0x3f353f353f35bf35,0xbf35bf35bf353f35,0xbf7bbe48bf0e3f55,0x3f55bf0ebe48bf7b,0x3f6dbec43ec4bf6d,0x3ec43f6d3f6d3ec4,0xbf0e3f55be483f7b,0xbf7b3e48bf553f0e
.quad 0x3f8000003f80,0x3f8000003f80,0xbf6d3ec4bf800000,0xbec43f6dbf353f35,0xbf35bf350000bf80,0xbf353f35bf800000,0x3ec4bf6d3f800000,0xbf6d3ec4bf35bf35
.quad 0x3f80000000003f80,0xbf8000000000bf80,0x3ec43f6dbf800000,0xbf6dbec43f35bf35,0xbf353f350000bf80,0xbf35bf353f800000,0xbf6dbec43f800000,0xbec4bf6d3f353f35
.quad 0xbf8000003f80,0xbf8000003f80,0x3f6dbec4bf800000,0x3ec4bf6dbf353f35,0x3f353f350000bf80,0x3f35bf35bf800000,0xbec43f6d3f800000,0x3f6dbec4bf35bf35
.quad 0xbf80000000003f80,0x3f8000000000bf80,0xbec4bf6dbf800000,0x3f6d3ec43f35bf35,0x3f35bf350000bf80,0x3f353f353f800000,0x3f6d3ec43f800000,0x3ec43f6d3f353f35
.quad 0x3f8000003f80,0x3f8000003f80,0xbf553f0ebf7b3e48,0xbe483f7bbf0e3f55,0xbf6dbec4bec4bf6d,0xbec43f6dbf6d3ec4,0xbe48bf7b3f55bf0e,0xbf0e3f55bf7bbe48
.quad 0x3f35bf353f353f35,0xbf353f35bf35bf35,0x3f7b3e48bf0e3f55,0xbf553f0ebe48bf7b,0x3ec43f6dbf6dbec4,0xbf6d3ec43ec4bf6d,0xbf0e3f553e48bf7b,0xbf7b3e483f55bf0e
.quad 0xbf8000003f800000,0xbf8000003f800000,0xbf0ebf553e483f7b,0xbf7bbe483f553f0e,0x3ec4bf6dbf6d3ec4,0xbf6dbec43ec43f6d,0x3f7bbe48bf0ebf55,0xbf55bf0ebe483f7b
.quad 0x3f353f353f35bf35,0xbf35bf35bf353f35,0xbe483f7b3f553f0e,0xbf0ebf55bf7b3e48,0xbf6d3ec4bec43f6d,0xbec4bf6dbf6dbec4,0xbf55bf0ebf7bbe48,0xbe48bf7bbf0ebf55
.quad 0x3f8000003f80,0x3f8000003f80,0xbec4bf6d0000bf80,0xbf6dbec4bf35bf35,0x3f353f3500003f80,0x3f35bf353f800000,0xbf6dbec40000bf80,0x3ec43f6dbf353f35
.quad 0x3f80000000003f80,0xbf8000000000bf80,0xbf6d3ec40000bf80,0x3ec4bf6d3f353f35,0x3f35bf3500003f80,0x3f353f35bf800000,0xbec43f6d0000bf80,0xbf6d3ec43f35bf35
.quad 0xbf8000003f80,0xbf8000003f80,0x3ec43f6d0000bf80,0x3f6d3ec4bf35bf35,0xbf35bf3500003f80,0xbf353f353f800000,0x3f6d3ec40000bf80,0xbec4bf6dbf353f35
.quad 0xbf80000000003f80,0x3f8000000000bf80,0x3f6dbec40000bf80,0xbec43f6d3f353f35,0xbf353f3500003f80,0xbf35bf35bf800000,0x3ec4bf6d0000bf80,0x3f6dbec43f35bf35
.quad 0xbf800000bf80,0xbf800000bf80,0x3f0e3f553e483f7b,0x3f7b3e483f553f0e,0xbf6dbec4bec4bf6d,0xbec43f6dbf6d3ec4,0x3f7bbe483f0e3f55,0xbf55bf0e3e48bf7b
.quad 0xbf353f35bf35bf35,0x3f35bf353f353f35,0x3e48bf7b3f553f0e,0x3f0e3f55bf7b3e48,0x3ec43f6dbf6dbec4,0xbf6d3ec43ec4bf6d,0xbf55bf0e3f7b3e48,0xbe48bf7b3f0e3f55
.quad 0x3f800000bf800000,0x3f800000bf800000,0xbf553f0e3f7bbe48,0xbe483f7b3f0ebf55,0x3ec4bf6dbf6d3ec4,0xbf6dbec43ec43f6d,0x3e483f7b3f55bf0e,0x3f0ebf55bf7bbe48
.quad 0xbf35bf35bf353f35,0x3f353f353f35bf35,0x3f7b3e483f0ebf55,0xbf553f0e3e483f7b,0xbf6d3ec4bec43f6d,0xbec4bf6dbf6dbec4,0x3f0ebf553e48bf7b,0x3f7bbe483f55bf0e
.quad 0x3f8000003f80,0x3f8000003f80,0xbf6d3ec4bf800000,0xbec43f6dbf353f35,0xbf35bf350000bf80,0xbf353f35bf800000,0x3ec4bf6d3f800000,0xbf6d3ec4bf35bf35
.quad 0x3f80000000003f80,0xbf8000000000bf80,0x3ec43f6dbf800000,0xbf6dbec43f35bf35,0xbf353f350000bf80,0xbf35bf353f800000,0xbf6dbec43f800000,0xbec4bf6d3f353f35
.quad 0xbf8000003f80,0xbf8000003f80,0x3f6dbec4bf800000,0x3ec4bf6dbf353f35,0x3f353f350000bf80,0x3f35bf35bf800000,0xbec43f6d3f800000,0x3f6dbec4bf35bf35
.quad 0xbf80000000003f80,0x3f8000000000bf80,0xbec4bf6dbf800000,0x3f6d3ec43f35bf35,0x3f35bf350000bf80,0x3f353f353f800000,0x3f6d3ec43f800000,0x3ec43f6d3f353f35
.quad 0xbf800000bf80,0xbf800000bf80,0x3f55bf0e3f7bbe48,0x3e48bf7b3f0ebf55,0x3f6d3ec43ec43f6d,0x3ec4bf6d3f6dbec4,0x3e483f7bbf553f0e,0x3f0ebf553f7b3e48
.quad 0xbf353f35bf35bf35,0x3f35bf353f353f35,0xbf7bbe483f0ebf55,0x3f55bf0e3e483f7b,0xbec4bf6d3f6d3ec4,0x3f6dbec4bec43f6d,0x3f0ebf55be483f7b,0x3f7bbe48bf553f0e
.quad 0x3f800000bf800000,0x3f800000bf800000,0x3f0e3f55be48bf7b,0x3f7b3e48bf55bf0e,0xbec43f6d3f6dbec4,0x3f6d3ec4bec4bf6d,0xbf7b3e483f0e3f55,0x3f553f0e3e48bf7b
.quad 0xbf35bf35bf353f35,0x3f353f353f35bf35,0x3e48bf7bbf55bf0e,0x3f0e3f553f7bbe48,0x3f6dbec43ec4bf6d,0x3ec43f6d3f6d3ec4,0x3f553f0e3f7b3e48,0x3e483f7b3f0e3f55
.quad 0x800000003f800000,0x800000003f800000,0x800000003f800000,0x800000003f800000,0x800000003f800000,0x800000003f800000,0x800000003f800000,0x800000003f800000
.quad 0x800000003f800000,0x800000003f800000,0x800000003f800000,0x800000003f800000,0x800000003f800000,0x800000003f800000,0x800000003f800000,0x800000003f800000
.quad 0x800000003f800000,0xbc490e903f7ffb11,0xbcc90ab03f7fec43,0xbd16c32c3f7fd397,0xbd48fb303f7fb10f,0xbd7b2b743f7f84ab,0xbd96a9053f7f4e6d,0xbdafb6803f7f0e58
.quad 0xbdc8bd363f7ec46d,0xbde1bc2e3f7e70b0,0xbdfab2733f7e1324,0xbe09cf863f7dabcc,0xbe1640833f7d3aac,0xbe22abb63f7cbfc9,0xbe2f10a23f7c3b28,0xbe3b6ecf3f7baccd
.quad 0x800000003f800000,0xbcc90ab03f7fec43,0xbd48fb303f7fb10f,0xbd96a9053f7f4e6d,0xbdc8bd363f7ec46d,0xbdfab2733f7e1324,0xbe1640833f7d3aac,0xbe2f10a23f7c3b28
.quad 0xbe47c5c23f7b14be,0xbe605c133f79c79d,0xbe78cfcc3f7853f8,0xbe888e933f76ba07,0xbe94a0313f74fa0b,0xbea09ae53f731447,0xbeac7cd43f710908,0xbeb8442a3f6ed89e
.quad 0x800000003f800000,0xbd16c32c3f7fd397,0xbd96a9053f7f4e6d,0xbde1bc2e3f7e70b0,0xbe1640833f7d3aac,0xbe3b6ecf3f7baccd,0xbe605c133f79c79d,0xbe827dc03f778bc5
.quad 0xbe94a0313f74fa0b,0xbea68f123f721352,0xbeb8442a3f6ed89e,0xbec9b9533f6b4b0c,0xbedae8803f676bd8,0xbeebcbbb3f633c5a,0xbefc5d273f5ebe05,0xbf064b823f59f26a
.quad 0x800000003f800000,0xbd48fb303f7fb10f,0xbdc8bd363f7ec46d,0xbe1640833f7d3aac,0xbe47c5c23f7b14be,0xbe78cfcc3f7853f8,0xbe94a0313f74fa0b,0xbeac7cd43f710908
.quad 0xbec3ef153f6c835e,0xbedae8803f676bd8,0xbef15aea3f61c598,0xbf039c3d3f5b941a,0xbf0e39da3f54db31,0xbf187fc03f4d9f02,0xbf2267993f45e403,0xbf2beb4a3f3daef9
.quad 0x800000003f800000,0xbd7b2b743f7f84ab,0xbdfab2733f7e1324,0xbe3b6ecf3f7baccd,0xbe78cfcc3f7853f8,0xbe9aa0863f740bdd,0xbeb8442a3f6ed89e,0xbed536413f68bf3c
.quad 0xbef15aea3f61c598,0xbf064b823f59f26a,0xbf13682a3f514d3d,0xbf1ff6cb3f47de65,0xbf2beb4a3f3daef9,0xbf373a233f32c8c9,0xbf41d8703f273656,0xbf4bbbf83f1b02c6
.quad 0x800000003f800000,0xbd96a9053f7f4e6d,0xbe1640833f7d3aac,0xbe605c133f79c79d,0xbe94a0313f74fa0b,0xbeb8442a3f6ed89e,0xbedae8803f676bd8,0xbefc5d273f5ebe05
.quad 0xbf0e39da3f54db31,0xbf1d7fd13f49d112,0xbf2beb4a3f3daef9,0xbf3968423f3085bb,0xbf45e4033f226799,0xbf514d3d3f13682a,0xbf5b941a3f039c3d,0xbf64aa593ee63375
.quad 0x800000003f800000,0xbdafb6803f7f0e58,0xbe2f10a23f7c3b28,0xbe827dc03f778bc5,0xbeac7cd43f710908,0xbed536413f68bf3c,0xbefc5d273f5ebe05,0xbf10d3cd3f531849
.quad 0xbf2267993f45e403,0xbf32c8c93f373a23,0xbf41d8703f273656,0xbf4f7a1f3f15f6d9,0xbf5b941a3f039c3d,0xbf660f883ee0924f,0xbf6ed89e3eb8442a,0xbf75dec63e8e9a22
.quad 0x800000003f800000,0xbdc8bd363f7ec46d,0xbe47c5c23f7b14be,0xbe94a0313f74fa0b,0xbec3ef153f6c835e,0xbef15aea3f61c598,0xbf0e39da3f54db31,0xbf2267993f45e403
.quad 0xbf3504f33f3504f3,0xbf45e4033f226799,0xbf54db313f0e39da,0xbf61c5983ef15aea,0xbf6c835e3ec3ef15,0xbf74fa0b3e94a031,0xbf7b14be3e47c5c2,0xbf7ec46d3dc8bd36
.quad 0x800000003f800000,0xbde1bc2e3f7e70b0,0xbe605c133f79c79d,0xbea68f123f721352,0xbedae8803f676bd8,0xbf064b823f59f26a,0xbf1d7fd13f49d112,0xbf32c8c93f373a23
.quad 0xbf45e4033f226799,0xbf5695e53f0b9a6b,0xbf64aa593ee63375,0xbf6ff5733eb263ef,0xbf7853f83e78cfcc,0xbf7dabcc3e09cf86,0xbf7fec433cc90ab0,0xbf7f0e58bdafb680
.quad 0x800000003f800000,0xbdfab2733f7e1324,0xbe78cfcc3f7853f8,0xbeb8442a3f6ed89e,0xbef15aea3f61c598,0xbf13682a3f514d3d,0xbf2beb4a3f3daef9,0xbf41d8703f273656
.quad 0xbf54db313f0e39da,0xbf64aa593ee63375,0xbf7109083eac7cd4,0xbf79c79d3e605c13,0xbf7ec46d3dc8bd36,0xbf7fec43bcc90ab0,0xbf7d3aacbe164083,0xbf76ba07be888e93
.quad 0x800000003f800000,0xbe09cf863f7dabcc,0xbe888e933f76ba07,0xbec9b9533f6b4b0c,0xbf039c3d3f5b941a,0xbf1ff6cb3f47de65,0xbf3968423f3085bb,0xbf4f7a1f3f15f6d9
.quad 0xbf61c5983ef15aea,0xbf6ff5733eb263ef,0xbf79c79d3e605c13,0xbf7f0e583dafb680,0xbf7fb10fbd48fb30,0xbf7baccdbe3b6ecf,0xbf731447bea09ae5,0xbf660f88bee0924f
.quad 0x800000003f800000,0xbe1640833f7d3aac,0xbe94a0313f74fa0b,0xbedae8803f676bd8,0xbf0e39da3f54db31,0xbf2beb4a3f3daef9,0xbf45e4033f226799,0xbf5b941a3f039c3d
.quad 0xbf6c835e3ec3ef15,0xbf7853f83e78cfcc,0xbf7ec46d3dc8bd36,0xbf7fb10fbd48fb30,0xbf7b14bebe47c5c2,0xbf710908beac7cd4,0xbf61c598bef15aea,0xbf4d9f02bf187fc0
.quad 0x800000003f800000,0xbe22abb63f7cbfc9,0xbea09ae53f731447,0xbeebcbbb3f633c5a,0xbf187fc03f4d9f02,0xbf373a233f32c8c9,0xbf514d3d3f13682a,0xbf660f883ee0924f
.quad 0xbf74fa0b3e94a031,0xbf7dabcc3e09cf86,0xbf7fec43bcc90ab0,0xbf7baccdbe3b6ecf,0xbf710908beac7cd4,0xbf604621bef6e0cb,0xbf49d112bf1d7fd1,0xbf2e3bdebf3b8f3b
.quad 0x800000003f800000,0xbe2f10a23f7c3b28,0xbeac7cd43f710908,0xbefc5d273f5ebe05,0xbf2267993f45e403,0xbf41d8703f273656,0xbf5b941a3f039c3d,0xbf6ed89e3eb8442a
.quad 0xbf7b14be3e47c5c2,0xbf7fec433cc90ab0,0xbf7d3aacbe164083,0xbf731447bea09ae5,0xbf61c598bef15aea,0xbf49d112bf1d7fd1,0xbf2beb4abf3daef9,0xbf08f59bbf584853
.quad 0x800000003f800000,0xbe3b6ecf3f7baccd,0xbeb8442a3f6ed89e,0xbf064b823f59f26a,0xbf2beb4a3f3daef9,0xbf4bbbf83f1b02c6,0xbf64aa593ee63375,0xbf75dec63e8e9a22
.quad 0xbf7ec46d3dc8bd36,0xbf7f0e58bdafb680,0xbf76ba07be888e93,0xbf660f88bee0924f,0xbf4d9f02bf187fc0,0xbf2e3bdebf3b8f3b,0xbf08f59bbf584853,0xbebe1d4abf6db293
.quad 0x800000003f800000,0xbe47c5c23f7b14be,0xbec3ef153f6c835e,0xbf0e39da3f54db31,0xbf3504f33f3504f3,0xbf54db313f0e39da,0xbf6c835e3ec3ef15,0xbf7b14be3e47c5c2
.quad 0xbf80000000000000,0xbf7b14bebe47c5c2,0xbf6c835ebec3ef15,0xbf54db31bf0e39da,0xbf3504f3bf3504f3,0xbf0e39dabf54db31,0xbec3ef15bf6c835e,0xbe47c5c2bf7b14be
.quad 0x800000003f800000,0xbe5415013f7a7302,0xbecf7bca3f6a09a7,0xbf15f6d93f4f7a1f,0xbf3daef93f2beb4a,0xbf5d2d533f00e7e4,0xbf7314473ea09ae5,0xbf7e70b03de1bc2e
.quad 0xbf7ec46dbdc8bd36,0xbf740bddbe9aa086,0xbf5ebe05befc5d27,0xbf3fc767bf299415,0xbf187fc0bf4d9f02,0xbed53641bf68bf3c,0xbe605c13bf79c79d,0xbc490e90bf7ffb11
.quad 0x800000003f800000,0xbe605c133f79c79d,0xbedae8803f676bd8,0xbf1d7fd13f49d112,0xbf45e4033f226799,0xbf64aa593ee63375,0xbf7853f83e78cfcc,0xbf7fec433cc90ab0
.quad 0xbf7b14bebe47c5c2,0xbf6a09a7becf7bca,0xbf4d9f02bf187fc0,0xbf273656bf41d870,0xbef15aeabf61c598,0xbe888e93bf76ba07,0xbd48fb30bf7fb10f,0x3e2f10a2bf7c3b28
.quad 0x800000003f800000,0xbe6c9a7f3f791298,0xbee633753f64aa59,0xbf24d2253f43e200,0xbf4d9f023f187fc0,0xbf6b4b0c3ec9b953,0xbf7c3b283e2f10a2,0xbf7f84abbd7b2b74
.quad 0xbf74fa0bbe94a031,0xbf5d2d53bf00e7e4,0xbf396842bf3085bb,0xbf0b9a6bbf5695e5,0xbeac7cd4bf710908,0xbde1bc2ebf7e70b0,0x3dfab273bf7e1324,0x3eb263efbf6ff573
.quad 0x800000003f800000,0xbe78cfcc3f7853f8,0xbef15aea3f61c598,0xbf2beb4a3f3daef9,0xbf54db313f0e39da,0xbf7109083eac7cd4,0xbf7ec46d3dc8bd36,0xbf7d3aacbe164083
.quad 0xbf6c835ebec3ef15,0xbf4d9f02bf187fc0,0xbf226799bf45e403,0xbedae880bf676bd8,0xbe47c5c2bf7b14be,0x3d48fb30bf7fb10f,0x3e94a031bf74fa0b,0x3f039c3dbf5b941a
.quad 0x800000003f800000,0xbe827dc03f778bc5,0xbefc5d273f5ebe05,0xbf32c8c93f373a23,0xbf5b941a3f039c3d,0xbf75dec63e8e9a22,0xbf7fec433cc90ab0,0xbf791298be6c9a7f
.quad 0xbf61c598bef15aea,0xbf3b8f3bbf2e3bde,0xbf08f59bbf584853,0xbe9aa086bf740bdd,0xbd48fb30bf7fb10f,0x3e541501bf7a7302,0x3ee63375bf64aa59,0x3f299415bf3fc767
.quad 0x800000003f800000,0xbe888e933f76ba07,0xbf039c3d3f5b941a,0xbf3968423f3085bb,0xbf61c5983ef15aea,0xbf79c79d3e605c13,0xbf7fb10fbd48fb30,0xbf731447bea09ae5
.quad 0xbf54db31bf0e39da,0xbf273656bf41d870,0xbedae880bf676bd8,0xbe2f10a2bf7c3b28,0x3dc8bd36bf7ec46d,0x3eb8442abf6ed89e,0x3f187fc0bf4d9f02,0x3f49d112bf1d7fd1
.quad 0x800000003f800000,0xbe8e9a223f75dec6,0xbf08f59b3f584853,0xbf3fc7673f299415,0xbf676bd83edae880,0xbf7cbfc93e22abb6,0xbf7e1324bdfab273,0xbf6b4b0cbec9b953
.quad 0xbf45e403bf226799,0xbf10d3cdbf531849,0xbea09ae5bf731447,0xbd16c32cbf7fd397,0x3e78cfccbf7853f8,0x3f00e7e4bf5d2d53,0x3f396842bf3085bb,0x3f633c5abeebcbbb
.quad 0x800000003f800000,0xbe94a0313f74fa0b,0xbf0e39da3f54db31,0xbf45e4033f226799,0xbf6c835e3ec3ef15,0xbf7ec46d3dc8bd36,0xbf7b14bebe47c5c2,0xbf61c598bef15aea
.quad 0xbf3504f3bf3504f3,0xbef15aeabf61c598,0xbe47c5c2bf7b14be,0x3dc8bd36bf7ec46d,0x3ec3ef15bf6c835e,0x3f226799bf45e403,0x3f54db31bf0e39da,0x3f74fa0bbe94a031
.quad 0x800000003f800000,0xbe9aa0863f740bdd,0xbf13682a3f514d3d,0xbf4bbbf83f1b02c6,0xbf7109083eac7cd4,0xbf7fd3973d16c32c,0xbf76ba07be888e93,0xbf5695e5bf0b9a6b
.quad 0xbf226799bf45e403,0xbebe1d4abf6db293,0xbd96a905bf7f4e6d,0x3e6c9a7fbf791298,0x3f039c3dbf5b941a,0x3f3fc767bf299415,0x3f6a09a7becf7bca,0x3f7e70b0bde1bc2e
.quad 0x800000003f800000,0xbea09ae53f731447,0xbf187fc03f4d9f02,0xbf514d3d3f13682a,0xbf74fa0b3e94a031,0xbf7fec43bcc90ab0,0xbf710908beac7cd4,0xbf49d112bf1d7fd1
.quad 0xbf0e39dabf54db31,0xbe888e93bf76ba07,0x3d48fb30bf7fb10f,0x3eb8442abf6ed89e,0x3f226799bf45e403,0x3f584853bf08f59b,0x3f7853f8be78cfcc,0x3f7f4e6d3d96a905
.quad 0x800000003f800000,0xbea68f123f721352,0xbf1d7fd13f49d112,0xbf5695e53f0b9a6b,0xbf7853f83e78cfcc,0xbf7f0e58bdafb680,0xbf6a09a7becf7bca,0xbf3b8f3bbf2e3bde
.quad 0xbef15aeabf61c598,0xbe22abb6bf7cbfc9,0x3e2f10a2bf7c3b28,0x3ef6e0cbbf604621,0x3f3daef9bf2beb4a,0x3f6b4b0cbec9b953,0x3f7f4e6dbd96a905,0x3f778bc53e827dc0
.quad 0x800000003f800000,0xbeac7cd43f710908,0xbf2267993f45e403,0xbf5b941a3f039c3d,0xbf7b14be3e47c5c2,0xbf7d3aacbe164083,0xbf61c598bef15aea,0xbf2beb4abf3daef9
.quad 0xbec3ef15bf6c835e,0xbd48fb30bf7fb10f,0x3e94a031bf74fa0b,0x3f187fc0bf4d9f02,0x3f54db31bf0e39da,0x3f7853f8be78cfcc,0x3f7ec46d3dc8bd36,0x3f676bd83edae880
.quad 0x800000003f800000,0xbeb263ef3f6ff573,0xbf2736563f41d870,0xbf6046213ef6e0cb,0xbf7d3aac3e164083,0xbf7a7302be541501,0xbf584853bf08f59b,0xbf1b02c6bf4bbbf8
.quad 0xbe94a031bf74fa0b,0x3d7b2b74bf7f84ab,0x3ecf7bcabf6a09a7,0x3f32c8c9bf373a23,0x3f676bd8bedae880,0x3f7f0e58bdafb680,0x3f76ba073e888e93,0x3f4f7a1f3f15f6d9
.quad 0x800000003f800000,0xbeb8442a3f6ed89e,0xbf2beb4a3f3daef9,0xbf64aa593ee63375,0xbf7ec46d3dc8bd36,0xbf76ba07be888e93,0xbf4d9f02bf187fc0,0xbf08f59bbf584853
.quad 0xbe47c5c2bf7b14be,0x3e2f10a2bf7c3b28,0x3f039c3dbf5b941a,0x3f49d112bf1d7fd1,0x3f74fa0bbe94a031,0x3f7f4e6d3d96a905,0x3f676bd83edae880,0x3f3085bb3f396842
.quad 0x800000003f800000,0xbebe1d4a3f6db293,0xbf3085bb3f396842,0xbf68bf3c3ed53641,0xbf7fb10f3d48fb30,0xbf721352bea68f12,0xbf41d870bf273656,0xbeebcbbbbf633c5a
.quad 0xbdc8bd36bf7ec46d,0x3e8e9a22bf75dec6,0x3f1d7fd1bf49d112,0x3f5d2d53bf00e7e4,0x3f7d3aacbe164083,0x3f7912983e6c9a7f,0x3f514d3d3f13682a,0x3f0b9a6b3f5695e5
.quad 0x800000003f800000,0x800000003f800000,0x800000003f800000,0x800000003f800000,0x800000003f800000,0x800000003f800000,0x800000003f800000,0x800000003f800000
.quad 0x800000003f800000,0x800000003f800000,0x800000003f800000,0x800000003f800000,0x800000003f800000,0x800000003f800000,0x800000003f800000,0x800000003f800000
.quad 0xbb490fc63f7fffb1,0xbc7b514b3f7ff84a,0xbce22a7a3f7fe705,0xbd2351cb3f7fcbe2,0xbd55880e3f7fa6e3,0xbd83db0a3f7f7808,0xbd9cecf93f7f3f54,0xbdb5f8da3f7efcc9
.quad 0xbdcefdb73f7eb069,0xbde7fa9a3f7e5a38,0xbe0077453f7dfa38,0xbe0cec4a3f7d906e,0xbe195be03f7d1cdd,0xbe25c58c3f7c9f8a,0xbe3228d43f7c187a,0xbe3e853e3f7b87b2
.quad 0xbbc90f883f7ffec4,0xbcfb49ba3f7fe129,0xbd6214693f7f9c18,0xbda3308c3f7f2f9d,0xbdd53db93f7e9bc9,0xbe0395023f7de0b1,0xbe1c76de3f7cfe73,0xbe3540983f7bf531
.quad 0xbe4dee603f7ac516,0xbe667c663f796e4e,0xbe7ee6e13f77f110,0xbe8b95073f764d97,0xbe97a1173f748422,0xbea395c53f7294f8,0xbeaf713a3f708066,0xbebb31a03f6e46be
.quad 0xbc16cb583f7ffd39,0xbd3c6dd53f7fba9e,0xbda973ba3f7f1f49,0xbdf475c03f7e2b72,0xbe1f917b3f7cdf6c,0xbe44b0b93f7b3bab,0xbe698bba3f7940c0,0xbe870ada3f76ef5b
.quad 0xbe9920fe3f74484b,0xbeab02013f714c7a,0xbebca7af3f6dfcf2,0xbece0bea3f6a5ad9,0xbedf28a93f666771,0xbeeff7fb3f62241a,0xbf003a063f5d924d,0xbf084b923f58b3a1
.quad 0xbc490e903f7ffb11,0xbd7b2b743f7f84ab,0xbde1bc2e3f7e70b0,0xbe22abb63f7cbfc9,0xbe5415013f7a7302,0xbe827dc03f778bc5,0xbe9aa0863f740bdd,0xbeb263ef3f6ff573
.quad 0xbec9b9533f6b4b0c,0xbee0924f3f660f88,0xbef6e0cb3f604621,0xbf064b823f59f26a,0xbf10d3cd3f531849,0xbf1b02c63f4bbbf8,0xbf24d2253f43e200,0xbf2e3bde3f3b8f3b
.quad 0xbc7b514b3f7ff84a,0xbd9cecf93f7f3f54,0xbe0cec4a3f7d906e,0xbe4ada4f3f7aed37,0xbe8402703f77583a,0xbea218873f72d4eb,0xbebf926f3f6d67a1,0xbedc53c13f671599
.quad 0xbef840c83f5fe4e9,0xbf099f4e3f57dc7f,0xbf16999f3f4f0417,0xbf2302d33f456439,0xbf2ecef73f3b0629,0xbf39f2ac3f2ff3e6,0xbf4463373f24381a,0xbf4e16893f17de12
.quad 0xbc96c9b63f7ff4e6,0xbdbc3ac33f7eea9d,0xbe28defc3f7c7eb0,0xbe72b6513f78b47b,0xbe9d9e783f73913f,0xbec1071e3f6d1c1d,0xbee363fa3f655e0b,0xbf0242b13f5c61c7
.quad 0xbf121eb03f5233c6,0xbf212ff93f46e22a,0xbf2f61a53f3a7ca4,0xbf3ca0033f2d1469,0xbf48d8b33f1ebc12,0xbf53fac33f0f8784,0xbf5df6be3eff17b2,0xbf66becc3eddbe79
.quad 0xbcafea693f7ff0e3,0xbddb7d373f7e868b,0xbe44b0b93f7b3bab,0xbe8d17c03f76167a,0xbeb6ccc33f6f20b0,0xbedf28a93f666771,0xbf02ef9f3f5bfb34,0xbf1553b73f4fefa8
.quad 0xbf269de33f425b89,0xbf36ad7f3f33587a,0xbf4564393f2302d3,0xbf52a6493f11796b,0xbf5e5aa63efdbabb,0xbf686b393ed6a399,0xbf70c5013eadf73c,0xbf77583a3e840270
.quad 0xbcc90ab03f7fec43,0xbdfab2733f7e1324,0xbe605c133f79c79d,0xbea09ae53f731447,0xbecf7bca3f6a09a7,0xbefc5d273f5ebe05,0xbf13682a3f514d3d,0xbf2736563f41d870
.quad 0xbf3968423f3085bb,0xbf49d1123f1d7fd1,0xbf5848533f08f59b,0xbf64aa593ee63375,0xbf6ed89e3eb8442a,0xbf76ba073e888e93,0xbf7c3b283e2f10a2,0xbf7f4e6d3d96a905
.quad 0xbce22a7a3f7fe705,0xbe0cec4a3f7d906e,0xbe7bdba43f7822d1,0xbeb3dca53f6faf1b,0xbee79a5d3f644fac,0xbf0c42c93f5627fe,0xbf2302d33f456439,0xbf37c6553f3238aa
.quad 0xbf4a4c873f1ce11f,0xbf5a5ba03f05a02c,0xbf67c1873ed97cb9,0xbf7254703ea5129f,0xbf79f35e3e5d4b1a,0xbf7e868b3ddb7d37,0xbf7fffb1bb490fc6,0xbf7e5a38bde7fa9a
.quad 0xbcfb49ba3f7fe129,0xbe1c76de3f7cfe73,0xbe8b95073f764d97,0xbec6d5293f6be858,0xbeff17b23f5df6be,0xbf19c2003f4cae79,0xbf31a81d3f385216,0xbf46e22a3f212ff9
.quad 0xbf591e6a3f07a136,0xbf6816a83ed8106b,0xbf73913f3e9d9e78,0xbf7b61fc3e419b37,0xbf7f6ac73d8a200a,0xbf7f9c18bd621469,0xbf7bf531be354098,0xbf748422be97a117
.quad 0xbd0a342f3f7fdaaf,0xbe2bf8043f7c5d3a,0xbe9920fe3f74484b,0xbed97cb93f67c187,0xbf0af1b73f570348,0xbf269de33f425b89,0xbf3f41fc3f2a2a80,0xbf546b3b3f0ee0db
.quad 0xbf65b7103ee1fb6a,0xbf72d4eb3ea21887,0xbf7b87b23e3e853e,0xbf7fa6e33d55880e,0xbf7f1f49bda973ba,0xbf79f35ebe5d4b1a,0xbf703b37beb0eacb,0xbf62241abeeff7fb
.quad 0xbd16c32c3f7fd397,0xbe3b6ecf3f7baccd,0xbea68f123f721352,0xbeebcbbb3f633c5a,0xbf15f6d93f4f7a1f,0xbf32c8c93f373a23,0xbf4bbbf83f1b02c6,0xbf6046213ef6e0cb
.quad 0xbf6ff5733eb263ef,0xbf7a73023e541501,0xbf7f84ab3d7b2b74,0xbf7f0e58bdafb680,0xbf791298be6c9a7f,0xbf6db293bebe1d4a,0xbf5d2d53bf00e7e4,0xbf47de65bf1ff6cb
.quad 0xbd2351cb3f7fcbe2,0xbe4ada4f3f7aed37,0xbeb3dca53f6faf1b,0xbefdbabb3f5e5aa6,0xbf2093933f476085,0xbf3e35c53f2b561b,0xbf5703483f0af1b7,0xbf6a5ad93ece0bea
.quad 0xbf77beb73e80f8c0,0xbf7ed7d43dc27c39,0xbf7f7808bd83db0a,0xbf799b43be636c83,0xbf6d67a1bebf926f,0xbf5b2c79bf044889,0xbf436051bf256bcb,0xbf269de3bf425b89
.quad 0xbd2fe0073f7fc38f,0xbe5a39973f7a1e84,0xbec1071e3f6d1c1d,0xbf07a1363f591e6a,0xbf2ac0823f3ebc1b,0xbf48d8b33f1ebc12,0xbf6106f23ef41f07,0xbf7294f83ea395c5
.quad 0xbf7cfe733e1c76de,0xbf7ff4e6bc96c9b6,0xbf7b61fcbe419b37,0xbf6f6830beb554ec,0xbf5c61c7bf0242b1,0xbf42de29bf26050a,0xbf239da9bf44e3f5,0xbeff17b2bf5df6be
.quad 0xbd3c6dd53f7fba9e,0xbe698bba3f7940c0,0xbece0bea3f6a5ad9,0xbf102dd53f5389c7,0xbf34768f3f3592e7,0xbf52a6493f11796b,0xbf69b7e43ed0eb2a,0xbf78e3d63e6fa8b2
.quad 0xbf7fa6e33d55880e,0xbf7dc68cbe06b26e,0xbf73530ebe9f1cdf,0xbf60a6cfbef58035,0xbf466354bf21cbfb,0xbf256bcbbf436051,0xbefdbabbbf5e5aa6,0xbea80b1fbf71d19f
.quad 0xbd48fb303f7fb10f,0xbe78cfcc3f7853f8,0xbedae8803f676bd8,0xbf187fc03f4d9f02,0xbf3daef93f2beb4a,0xbf5b941a3f039c3d,0xbf7109083eac7cd4,0xbf7d3aac3e164083
.quad 0xbf7fb10fbd48fb30,0xbf7853f8be78cfcc,0xbf676bd8bedae880,0xbf4d9f02bf187fc0,0xbf2beb4abf3daef9,0xbf039c3dbf5b941a,0xbeac7cd4bf710908,0xbe164083bf7d3aac
.quad 0xbd55880e3f7fa6e3,0xbe8402703f77583a,0xbee79a5d3f644fac,0xbf2093933f476085,0xbf4663543f21cbfb,0xbf6398ac3eea6681,0xbf76ef5b3e870ada,0xbf7f90b13d6ea038
.quad 0xbf7d1cddbe195be0,0xbf6faf1bbeb3dca5,0xbf57dc7fbf099f4e,0xbf36ad7fbf33587a,0xbf0d9281bf554aa4,0xbebca7afbf6dfcf2,0xbe2bf804bf7c5d3a,0x3d2351cbbf7fcbe2
.quad 0xbd6214693f7f9c18,0xbe8b95073f764d97,0xbef41f073f6106f2,0xbf2866053f40d0da,0xbf4e8d903f173c07,0xbf6aab7b3ecc9b8b,0xbf7b61fc3e419b37,0xbf7fe129bcfb49ba
.quad 0xbf77f110be7ee6e1,0xbf63f473bee900b7,0xbf44e3f5bf239da9,0xbf1c420cbf4ac77f,0xbed8106bbf6816a8,0xbe5a3997bf7a1e84,0x3bc90f88bf7ffec4,0x3e667c66bf796e4e
.quad 0xbd6ea0383f7f90b1,0xbe931f353f75341d,0xbf003a063f5d924d,0xbf2ff3e63f39f2ac,0xbf5627fe3f0c42c9,0xbf70c5013eadf73c,0xbf7e5a383de7fa9a,0xbf7e2b72bdf475c0
.quad 0xbf703b37beb0eacb,0xbf554aa4bf0d9281,0xbf2ecef7bf3b0629,0xbefdbabbbf5e5aa6,0xbe901c2cbf75a67b,0xbd55880ebf7fa6e3,0x3e3857ecbf7bd14d,0x3ece0beabf6a5ad9
.quad 0xbd7b2b743f7f84ab,0xbe9aa0863f740bdd,0xbf064b823f59f26a,0xbf373a233f32c8c9,0xbf5d2d533f00e7e4,0xbf75dec63e8e9a22,0xbf7fd3973d16c32c,0xbf7a7302be541501
.quad 0xbf660f88bee0924f,0xbf43e200bf24d225,0xbf15f6d9bf4f7a1f,0xbebe1d4abf6db293,0xbe09cf86bf7dabcc,0x3de1bc2ebf7e70b0,0x3eb263efbf6ff573,0x3f10d3cdbf531849
.quad 0xbd83db0a3f7f7808,0xbea218873f72d4eb,0xbf0c42c93f5627fe,0xbf3e35c53f2b561b,0xbf6398ac3eea6681,0xbf79f35e3e5d4b1a,0xbf7fcbe2bd2351cb,0xbf74bf62be9620d2
.quad 0xbf5988adbf06f686,0xbf2ff3e6bf39f2ac,0xbef58035bf60a6cf,0xbe75c35abf788486,0x3c7b514bbf7ff84a,0x3e8a11f7bf76841b,0x3f019573bf5cc7d1,0x3f3592e7bf34768f
.quad 0xbd8a200a3f7f6ac7,0xbea986c43f718f57,0xbf121eb03f5233c6,0xbf44e3f53f239da9,0xbf6965913ed25a09,0xbf7cfe733e1c76de,0xbf7e4323bdee3876,0xbf6d1c1dbec1071e
.quad 0xbf4ac77fbf1c420c,0xbf19c200bf4cae79,0xbebb31a0bf6e46be,0xbdd53db9bf7e9bc9,0x3e28defcbf7c7eb0,0x3ed8106bbf6816a8,0x3f26050abf42de29,0x3f53fac3bf0f8784
.quad 0xbd9064b43f7f5ce9,0xbeb0eacb3f703b37,0xbf17de123f4e1689,0xbf4b41fa3f1ba299,0xbf6e8ff83eb9bb1e,0xbf7efcc93db5f8da,0xbf7b3babbe44b0b9,0xbf6398acbeea6681
.quad 0xbf39f2acbf2ff3e6,0xbf019573bf5cc7d1,0xbe7bdba4bf7822d1,0x3d0a342fbf7fdaaf,0x3e9f1cdfbf73530e,0x3f102dd5bf5389c7,0x3f456439bf2302d3,0x3f6afb8cbecb2aae
.quad 0xbd96a9053f7f4e6d,0xbeb8442a3f6ed89e,0xbf1d7fd13f49d112,0xbf514d3d3f13682a,0xbf7314473ea09ae5,0xbf7fec433cc90ab0,0xbf76ba07be888e93,0xbf584853bf08f59b
.quad 0xbf273656bf41d870,0xbecf7bcabf6a09a7,0xbdfab273bf7e1324,0x3e2f10a2bf7c3b28,0x3ee63375bf64aa59,0x3f3085bbbf396842,0x3f5ebe05befc5d27,0x3f79c79dbe605c13
.quad 0xbd9cecf93f7f3f54,0xbebf926f3f6d67a1,0xbf2302d33f456439,0xbf5703483f0af1b7,0xbf76ef5b3e870ada,0xbf7fcbe2bd2351cb,0xbf70c501beadf73c,0xbf4b41fabf1ba299
.quad 0xbf12c39abf51c0c2,0xbe9920febf74484b,0x3b490fc6bf7fffb1,0x3e9c1fafbf73ced9,0x3f140c5fbf50d937,0x3f4c3578bf1a6293,0x3f714c7abeab0201,0x3f7fdaafbd0a342f
.quad 0xbda3308c3f7f2f9d,0xbec6d5293f6be858,0xbf2866053f40d0da,0xbf5c61c73f0242b1,0xbf7a1e843e5a3997,0xbf7e9bc9bdd53db9,0xbf696591bed25a09,0xbf3ca003bf2d1469
.quad 0xbef9a02dbf5f8327,0xbe419b37bf7b61fc,0x3e039502bf7de0b1,0x3eddbe79bf66becc,0x3f31a81dbf385216,0x3f628210beee9479,0x3f7c7eb0be28defc,0x3f7cfe733e1c76de
.quad 0xbda973ba3f7f1f49,0xbece0bea3f6a5ad9,0xbf2da8593f3c17d9,0xbf61668a3ef2bd43,0xbf7c9f8a3e25c58c,0xbf7c5d3abe2bf804,0xbf60a6cfbef58035,0xbf2c800fbf3d27b8
.quad 0xbecb2aaebf6afb8c,0xbd9cecf9bf7f3f54,0x3e80f8c0bf77beb7,0x3f0d9281bf554aa4,0x3f4b41fabf1ba299,0x3f72d4ebbea21887,0x3f7ffd393c16cb58,0x3f714c7a3eab0201
.quad 0xbdafb6803f7f0e58,0xbed536413f68bf3c,0xbf32c8c93f373a23,0xbf660f883ee0924f,0xbf7e70b03de1bc2e,0xbf791298be6c9a7f,0xbf5695e5bf0b9a6b,0xbf1b02c6bf4bbbf8
.quad 0xbe9aa086bf740bdd,0x3d16c32cbf7fd397,0x3ebe1d4abf6db293,0x3f299415bf3fc767,0x3f604621bef6e0cb,0x3f7cbfc9be22abb6,0x3f7baccd3e3b6ecf,0x3f5d2d533f00e7e4
.quad 0xbdb5f8da3f7efcc9,0xbedc53c13f671599,0xbf37c6553f3238aa,0xbf6a5ad93ece0bea,0xbf7f90b13d6ea038,0xbf74bf62be9620d2,0xbf4b41fabf1ba299,0xbf084b92bf58b3a1
.quad 0xbe5101f1bf7a9c59,0x3e195be0bf7d1cdd,0x3ef840c8bf5fe4e9,0x3f425b89bf269de3,0x3f703b37beb0eacb,0x3f7fffb13b490fc6,0x3f6faf1b3eb3dca5,0x3f4154e13f27ce61
.quad 0xbdbc3ac33f7eea9d,0xbee363fa3f655e0b,0xbf3ca0033f2d1469,0xbf6e46be3ebb31a0,0xbf7ffec43bc90f88,0xbf6f6830beb554ec,0xbf3ebc1bbf2ac082,0xbee900b7bf63f473
.quad 0xbdd53db9bf7e9bc9,0x3e8586cebf772417,0x3f173c07bf4e8d90,0x3f577026bf0a48ad,0x3f7ac516be4dee60,0x3f7c7eb03e28defc,0x3f5c61c73f0242b1,0x3f1ebc123f48d8b3
.quad 0xbdc27c393f7ed7d4,0xbeea66813f6398ac,0xbf4154e13f27ce61,0xbf71d19f3ea80b1f,0xbf7fba9ebd3c6dd5,0xbf6912aebed3c867,0xbf311722bf38dd65,0xbebf926fbf6d67a1
.quad 0xbb490fc6bf7fffb1,0x3ebca7afbf6dfcf2,0x3f2ff3e6bf39f2ac,0x3f686b39bed6a399,0x3f7fa6e3bd55880e,0x3f7254703ea5129f,0x3f425b893f269de3,0x3eed30633f62df7b
.quad 0x800000003f800000,0x800000003f800000,0x800000003f800000,0x800000003f800000,0x800000003f800000,0x800000003f800000,0x800000003f800000,0x800000003f800000
.quad 0x800000003f800000,0x800000003f800000,0x800000003f800000,0x800000003f800000,0x800000003f800000,0x800000003f800000,0x800000003f800000,0x800000003f800000
.quad 0xbbc90f883f7ffec4,0xbc96c9b63f7ff4e6,0xbcfb49ba3f7fe129,0xbd2fe0073f7fc38f,0xbd6214693f7f9c18,0xbd8a200a3f7f6ac7,0xbda3308c3f7f2f9d,0xbdbc3ac33f7eea9d
.quad 0xbdd53db93f7e9bc9,0xbdee38763f7e4323,0xbe0395023f7de0b1,0xbe1008b73f7d7474,0xbe1c76de3f7cfe73,0xbe28defc3f7c7eb0,0xbe3540983f7bf531,0xbe419b373f7b61fc
.quad 0xbc490e903f7ffb11,0xbd16c32c3f7fd397,0xbd7b2b743f7f84ab,0xbdafb6803f7f0e58,0xbde1bc2e3f7e70b0,0xbe09cf863f7dabcc,0xbe22abb63f7cbfc9,0xbe3b6ecf3f7baccd
.quad 0xbe5415013f7a7302,0xbe6c9a7f3f791298,0xbe827dc03f778bc5,0xbe8e9a223f75dec6,0xbe9aa0863f740bdd,0xbea68f123f721352,0xbeb263ef3f6ff573,0xbebe1d4a3f6db293
.quad 0xbc96c9b63f7ff4e6,0xbd6214693f7f9c18,0xbdbc3ac33f7eea9d,0xbe0395023f7de0b1,0xbe28defc3f7c7eb0,0xbe4dee603f7ac516,0xbe72b6513f78b47b,0xbe8b95073f764d97
.quad 0xbe9d9e783f73913f,0xbeaf713a3f708066,0xbec1071e3f6d1c1d,0xbed25a093f696591,0xbee363fa3f655e0b,0xbef41f073f6106f2,0xbf0242b13f5c61c7,0xbf0a48ad3f577026
.quad 0xbcc90ab03f7fec43,0xbd96a9053f7f4e6d,0xbdfab2733f7e1324,0xbe2f10a23f7c3b28,0xbe605c133f79c79d,0xbe888e933f76ba07,0xbea09ae53f731447,0xbeb8442a3f6ed89e
.quad 0xbecf7bca3f6a09a7,0xbee633753f64aa59,0xbefc5d273f5ebe05,0xbf08f59b3f584853,0xbf13682a3f514d3d,0xbf1d7fd13f49d112,0xbf2736563f41d870,0xbf3085bb3f396842
.quad 0xbcfb49ba3f7fe129,0xbdbc3ac33f7eea9d,0xbe1c76de3f7cfe73,0xbe5a39973f7a1e84,0xbe8b95073f764d97,0xbea986c43f718f57,0xbec6d5293f6be858,0xbee363fa3f655e0b
.quad 0xbeff17b23f5df6be,0xbf0cead03f55b993,0xbf19c2003f4cae79,0xbf26050a3f42de29,0xbf31a81d3f385216,0xbf3ca0033f2d1469,0xbf46e22a3f212ff9,0xbf5064af3f14b039
.quad 0xbd16c32c3f7fd397,0xbde1bc2e3f7e70b0,0xbe3b6ecf3f7baccd,0xbe827dc03f778bc5,0xbea68f123f721352,0xbec9b9533f6b4b0c,0xbeebcbbb3f633c5a,0xbf064b823f59f26a
.quad 0xbf15f6d93f4f7a1f,0xbf24d2253f43e200,0xbf32c8c93f373a23,0xbf3fc7673f299415,0xbf4bbbf83f1b02c6,0xbf5695e53f0b9a6b,0xbf6046213ef6e0cb,0xbf68bf3c3ed53641
.quad 0xbd2fe0073f7fc38f,0xbe0395023f7de0b1,0xbe5a39973f7a1e84,0xbe97a1173f748422,0xbec1071e3f6d1c1d,0xbee900b73f63f473,0xbf07a1363f591e6a,0xbf19c2003f4cae79
.quad 0xbf2ac0823f3ebc1b,0xbf3a7ca43f2f61a5,0xbf48d8b33f1ebc12,0xbf55b9933f0cead0,0xbf6106f23ef41f07,0xbf6aab7b3ecc9b8b,0xbf7294f83ea395c5,0xbf78b47b3e72b651
.quad 0xbd48fb303f7fb10f,0xbe1640833f7d3aac,0xbe78cfcc3f7853f8,0xbeac7cd43f710908,0xbedae8803f676bd8,0xbf039c3d3f5b941a,0xbf187fc03f4d9f02,0xbf2beb4a3f3daef9
.quad 0xbf3daef93f2beb4a,0xbf4d9f023f187fc0,0xbf5b941a3f039c3d,0xbf676bd83edae880,0xbf7109083eac7cd4,0xbf7853f83e78cfcc,0xbf7d3aac3e164083,0xbf7fb10f3d48fb30
.quad 0xbd6214693f7f9c18,0xbe28defc3f7c7eb0,0xbe8b95073f764d97,0xbec1071e3f6d1c1d,0xbef41f073f6106f2,0xbf121eb03f5233c6,0xbf2866053f40d0da,0xbf3ca0033f2d1469
.quad 0xbf4e8d903f173c07,0xbf5df6be3eff17b2,0xbf6aab7b3ecc9b8b,0xbf7484223e97a117,0xbf7b61fc3e419b37,0xbf7f2f9d3da3308c,0xbf7fe129bcfb49ba,0xbf7d7474be1008b7
.quad 0xbd7b2b743f7f84ab,0xbe3b6ecf3f7baccd,0xbe9aa0863f740bdd,0xbed536413f68bf3c,0xbf064b823f59f26a,0xbf1ff6cb3f47de65,0xbf373a233f32c8c9,0xbf4bbbf83f1b02c6
.quad 0xbf5d2d533f00e7e4,0xbf6b4b0c3ec9b953,0xbf75dec63e8e9a22,0xbf7cbfc93e22abb6,0xbf7fd3973d16c32c,0xbf7f0e58bdafb680,0xbf7a7302be541501,0xbf721352bea68f12
.quad 0xbd8a200a3f7f6ac7,0xbe4dee603f7ac516,0xbea986c43f718f57,0xbee900b73f63f473,0xbf121eb03f5233c6,0xbf2d14693f3ca003,0xbf44e3f53f239da9,0xbf591e6a3f07a136
.quad 0xbf6965913ed25a09,0xbf756d973e919ddd,0xbf7cfe733e1c76de,0xbf7ff4e63c96c9b6,0xbf7e4323bdee3876,0xbf77f110be7ee6e1,0xbf6d1c1dbec1071e,0xbf5df6bebeff17b2
.quad 0xbd96a9053f7f4e6d,0xbe605c133f79c79d,0xbeb8442a3f6ed89e,0xbefc5d273f5ebe05,0xbf1d7fd13f49d112,0xbf3968423f3085bb,0xbf514d3d3f13682a,0xbf64aa593ee63375
.quad 0xbf7314473ea09ae5,0xbf7c3b283e2f10a2,0xbf7fec433cc90ab0,0xbf7e1324bdfab273,0xbf76ba07be888e93,0xbf6a09a7becf7bca,0xbf584853bf08f59b,0xbf41d870bf273656
.quad 0xbda3308c3f7f2f9d,0xbe72b6513f78b47b,0xbec6d5293f6be858,0xbf07a1363f591e6a,0xbf2866053f40d0da,0xbf44e3f53f239da9,0xbf5c61c73f0242b1,0xbf6e46be3ebb31a0
.quad 0xbf7a1e843e5a3997,0xbf7f9c183d621469,0xbf7e9bc9bdd53db9,0xbf772417be8586ce,0xbf696591bed25a09,0xbf55b993bf0cead0,0xbf3ca003bf2d1469,0xbf1ebc12bf48d8b3
.quad 0xbdafb6803f7f0e58,0xbe827dc03f778bc5,0xbed536413f68bf3c,0xbf10d3cd3f531849,0xbf32c8c93f373a23,0xbf4f7a1f3f15f6d9,0xbf660f883ee0924f,0xbf75dec63e8e9a22
.quad 0xbf7e70b03de1bc2e,0xbf7f84abbd7b2b74,0xbf791298be6c9a7f,0xbf6b4b0cbec9b953,0xbf5695e5bf0b9a6b,0xbf3b8f3bbf2e3bde,0xbf1b02c6bf4bbbf8,0xbeebcbbbbf633c5a
.quad 0xbdbc3ac33f7eea9d,0xbe8b95073f764d97,0xbee363fa3f655e0b,0xbf19c2003f4cae79,0xbf3ca0033f2d1469,0xbf591e6a3f07a136,0xbf6e46be3ebb31a0,0xbf7b61fc3e419b37
.quad 0xbf7ffec43bc90f88,0xbf7bf531be354098,0xbf6f6830beb554ec,0xbf5ac450bf04f484,0xbf3ebc1bbf2ac082,0xbf1c420cbf4ac77f,0xbee900b7bf63f473,0xbe919dddbf756d97
.quad 0xbdc8bd363f7ec46d,0xbe94a0313f74fa0b,0xbef15aea3f61c598,0xbf2267993f45e403,0xbf45e4033f226799,0xbf61c5983ef15aea,0xbf74fa0b3e94a031,0xbf7ec46d3dc8bd36
.quad 0xbf7ec46dbdc8bd36,0xbf74fa0bbe94a031,0xbf61c598bef15aea,0xbf45e403bf226799,0xbf226799bf45e403,0xbef15aeabf61c598,0xbe94a031bf74fa0b,0xbdc8bd36bf7ec46d
.quad 0xbdd53db93f7e9bc9,0xbe9d9e783f73913f,0xbeff17b23f5df6be,0xbf2ac0823f3ebc1b,0xbf4e8d903f173c07,0xbf6965913ed25a09,0xbf7a1e843e5a3997,0xbf7ffec43bc90f88
.quad 0xbf7ac516be4dee60,0xbf6aab7bbecc9b8b,0xbf5064afbf14b039,0xbf2d1469bf3ca003,0xbf0242b1bf5c61c7,0xbea395c5bf7294f8,0xbdee3876bf7e4323,0x3dbc3ac3bf7eea9d
.quad 0xbde1bc2e3f7e70b0,0xbea68f123f721352,0xbf064b823f59f26a,0xbf32c8c93f373a23,0xbf5695e53f0b9a6b,0xbf6ff5733eb263ef,0xbf7dabcc3e09cf86,0xbf7f0e58bdafb680
.quad 0xbf740bddbe9aa086,0xbf5d2d53bf00e7e4,0xbf3b8f3bbf2e3bde,0xbf10d3cdbf531849,0xbebe1d4abf6db293,0xbe22abb6bf7cbfc9,0x3d7b2b74bf7f84ab,0x3e8e9a22bf75dec6
.quad 0xbdee38763f7e4323,0xbeaf713a3f708066,0xbf0cead03f55b993,0xbf3a7ca43f2f61a5,0xbf5df6be3eff17b2,0xbf756d973e919ddd,0xbf7f9c183d621469,0xbf7bf531be354098
.quad 0xbf6aab7bbecc9b8b,0xbf4cae79bf19c200,0xbf239da9bf44e3f5,0xbee363fabf655e0b,0xbe667c66bf796e4e,0x3bc90f88bf7ffec4,0x3e72b651bf78b47b,0x3ee900b7bf63f473
.quad 0xbdfab2733f7e1324,0xbeb8442a3f6ed89e,0xbf13682a3f514d3d,0xbf41d8703f273656,0xbf64aa593ee63375,0xbf79c79d3e605c13,0xbf7fec43bcc90ab0,0xbf76ba07be888e93
.quad 0xbf5ebe05befc5d27,0xbf396842bf3085bb,0xbf08f59bbf584853,0xbea09ae5bf731447,0xbd96a905bf7f4e6d,0x3e2f10a2bf7c3b28,0x3ecf7bcabf6a09a7,0x3f1d7fd1bf49d112
.quad 0xbe0395023f7de0b1,0xbec1071e3f6d1c1d,0xbf19c2003f4cae79,0xbf48d8b33f1ebc12,0xbf6aab7b3ecc9b8b,0xbf7cfe733e1c76de,0xbf7e9bc9bdd53db9,0xbf6f6830beb554ec
.quad 0xbf5064afbf14b039,0xbf239da9bf44e3f5,0xbed8106bbf6816a8,0xbe354098bf7bf531,0x3da3308cbf7f2f9d,0x3ea986c4bf718f57,0x3f0f8784bf53fac3,0x3f40d0dabf286605
.quad 0xbe09cf863f7dabcc,0xbec9b9533f6b4b0c,0xbf1ff6cb3f47de65,0xbf4f7a1f3f15f6d9,0xbf6ff5733eb263ef,0xbf7f0e583dafb680,0xbf7baccdbe3b6ecf,0xbf660f88bee0924f
.quad 0xbf3fc767bf299415,0xbf0b9a6bbf5695e5,0xbe9aa086bf740bdd,0xbd16c32cbf7fd397,0x3e6c9a7fbf791298,0x3ef6e0cbbf604621,0x3f32c8c9bf373a23,0x3f5d2d53bf00e7e4
.quad 0xbe1008b73f7d7474,0xbed25a093f696591,0xbf26050a3f42de29,0xbf55b9933f0cead0,0xbf7484223e97a117,0xbf7ff4e63c96c9b6,0xbf772417be8586ce,0xbf5ac450bf04f484
.quad 0xbf2d1469bf3ca003,0xbee363fabf655e0b,0xbe354098bf7bf531,0x3dd53db9bf7e9bc9,0x3ec1071ebf6d1c1d,0x3f1ebc12bf48d8b3,0x3f5064afbf14b039,0x3f718f57bea986c4
.quad 0xbe1640833f7d3aac,0xbedae8803f676bd8,0xbf2beb4a3f3daef9,0xbf5b941a3f039c3d,0xbf7853f83e78cfcc,0xbf7fb10fbd48fb30,0xbf710908beac7cd4,0xbf4d9f02bf187fc0
.quad 0xbf187fc0bf4d9f02,0xbeac7cd4bf710908,0xbd48fb30bf7fb10f,0x3e78cfccbf7853f8,0x3f039c3dbf5b941a,0x3f3daef9bf2beb4a,0x3f676bd8bedae880,0x3f7d3aacbe164083
.quad 0xbe1c76de3f7cfe73,0xbee363fa3f655e0b,0xbf31a81d3f385216,0xbf6106f23ef41f07,0xbf7b61fc3e419b37,0xbf7e4323bdee3876,0xbf696591bed25a09,0xbf3ebc1bbf2ac082
.quad 0xbf0242b1bf5c61c7,0xbe667c66bf796e4e,0x3da3308cbf7f2f9d,0x3ec1071ebf6d1c1d,0x3f239da9bf44e3f5,0x3f577026bf0a48ad,0x3f772417be8586ce,0x3f7fc38f3d2fe007
.quad 0xbe22abb63f7cbfc9,0xbeebcbbb3f633c5a,0xbf373a233f32c8c9,0xbf660f883ee0924f,0xbf7dabcc3e09cf86,0xbf7baccdbe3b6ecf,0xbf604621bef6e0cb,0xbf2e3bdebf3b8f3b
.quad 0xbed53641bf68bf3c,0xbde1bc2ebf7e70b0,0x3e541501bf7a7302,0x3f00e7e4bf5d2d53,0x3f3fc767bf299415,0x3f6b4b0cbec9b953,0x3f7f0e58bdafb680,0x3f7912983e6c9a7f
.quad 0xbe28defc3f7c7eb0,0xbef41f073f6106f2,0xbf3ca0033f2d1469,0xbf6aab7b3ecc9b8b,0xbf7f2f9d3da3308c,0xbf77f110be7ee6e1,0xbf55b993bf0cead0,0xbf1c420cbf4ac77f
.quad 0xbea395c5bf7294f8,0x3bc90f88bf7ffec4,0x3ea986c4bf718f57,0x3f1ebc12bf48d8b3,0x3f577026bf0a48ad,0x3f78b47bbe72b651,0x3f7eea9d3dbc3ac3,0x3f6965913ed25a09
.quad 0xbe2f10a23f7c3b28,0xbefc5d273f5ebe05,0xbf41d8703f273656,0xbf6ed89e3eb8442a,0xbf7fec433cc90ab0,0xbf731447bea09ae5,0xbf49d112bf1d7fd1,0xbf08f59bbf584853
.quad 0xbe605c13bf79c79d,0x3dfab273bf7e1324,0x3ee63375bf64aa59,0x3f396842bf3085bb,0x3f6a09a7becf7bca,0x3f7f4e6dbd96a905,0x3f76ba073e888e93,0x3f514d3d3f13682a
.quad 0xbe3540983f7bf531,0xbf0242b13f5c61c7,0xbf46e22a3f212ff9,0xbf7294f83ea395c5,0xbf7fe129bcfb49ba,0xbf6d1c1dbec1071e,0xbf3ca003bf2d1469,0xbee900b7bf63f473
.quad 0xbdee3876bf7e4323,0x3e72b651bf78b47b,0x3f0f8784bf53fac3,0x3f5064afbf14b039,0x3f772417be8586ce,0x3f7eea9d3dbc3ac3,0x3f66becc3eddbe79,0x3f31a81d3f385216
.quad 0xbe3b6ecf3f7baccd,0xbf064b823f59f26a,0xbf4bbbf83f1b02c6,0xbf75dec63e8e9a22,0xbf7f0e58bdafb680,0xbf660f88bee0924f,0xbf2e3bdebf3b8f3b,0xbebe1d4abf6db293
.quad 0xbc490e90bf7ffb11,0x3eb263efbf6ff573,0x3f299415bf3fc767,0x3f633c5abeebcbbb,0x3f7e70b0bde1bc2e,0x3f778bc53e827dc0,0x3f4f7a1f3f15f6d9,0x3f0b9a6b3f5695e5
.quad 0xbe419b373f7b61fc,0xbf0a48ad3f577026,0xbf5064af3f14b039,0xbf78b47b3e72b651,0xbf7d7474be1008b7,0xbf5df6bebeff17b2,0xbf1ebc12bf48d8b3,0xbe919dddbf756d97
.quad 0x3dbc3ac3bf7eea9d,0x3ee900b7bf63f473,0x3f40d0dabf286605,0x3f718f57bea986c4,0x3f7fc38f3d2fe007,0x3f6965913ed25a09,0x3f31a81d3f385216,0x3ec1071e3f6d1c1d
.quad 0x800000003f800000,0x800000003f800000,0x800000003f800000,0x800000003f800000,0x800000003f800000,0x800000003f800000,0x800000003f800000,0x800000003f800000
.quad 0x800000003f800000,0x800000003f800000,0x800000003f800000,0x800000003f800000,0x800000003f800000,0x800000003f800000,0x800000003f800000,0x800000003f800000
.quad 0xbc16cb583f7ffd39,0xbcafea693f7ff0e3,0xbd0a342f3f7fdaaf,0xbd3c6dd53f7fba9e,0xbd6ea0383f7f90b1,0xbd9064b43f7f5ce9,0xbda973ba3f7f1f49,0xbdc27c393f7ed7d4
.quad 0xbddb7d373f7e868b,0xbdf475c03f7e2b72,0xbe06b26e3f7dc68c,0xbe1324ca3f7d57de,0xbe1f917b3f7cdf6c,0xbe2bf8043f7c5d3a,0xbe3857ec3f7bd14d,0xbe44b0b93f7b3bab
.quad 0xbc96c9b63f7ff4e6,0xbd2fe0073f7fc38f,0xbd8a200a3f7f6ac7,0xbdbc3ac33f7eea9d,0xbdee38763f7e4323,0xbe1008b73f7d7474,0xbe28defc3f7c7eb0,0xbe419b373f7b61fc
.quad 0xbe5a39973f7a1e84,0xbe72b6513f78b47b,0xbe8586ce3f772417,0xbe919ddd3f756d97,0xbe9d9e783f73913f,0xbea986c43f718f57,0xbeb554ec3f6f6830,0xbec1071e3f6d1c1d
.quad 0xbce22a7a3f7fe705,0xbd83db0a3f7f7808,0xbdcefdb73f7eb069,0xbe0cec4a3f7d906e,0xbe3228d43f7c187a,0xbe57278f3f7a4910,0xbe7bdba43f7822d1,0xbe901c2c3f75a67b
.quad 0xbea218873f72d4eb,0xbeb3dca53f6faf1b,0xbec5625c3f6c3624,0xbed6a3993f686b39,0xbee79a5d3f644fac,0xbef840c83f5fe4e9,0xbf0448893f5b2c79,0xbf0c42c93f5627fe
.quad 0xbd16c32c3f7fd397,0xbdafb6803f7f0e58,0xbe09cf863f7dabcc,0xbe3b6ecf3f7baccd,0xbe6c9a7f3f791298,0xbe8e9a223f75dec6,0xbea68f123f721352,0xbebe1d4a3f6db293
.quad 0xbed536413f68bf3c,0xbeebcbbb3f633c5a,0xbf00e7e43f5d2d53,0xbf0b9a6b3f5695e5,0xbf15f6d93f4f7a1f,0xbf1ff6cb3f47de65,0xbf2994153f3fc767,0xbf32c8c93f373a23
.quad 0xbd3c6dd53f7fba9e,0xbddb7d373f7e868b,0xbe2bf8043f7c5d3a,0xbe698bba3f7940c0,0xbe931f353f75341d,0xbeb0eacb3f703b37,0xbece0bea3f6a5ad9,0xbeea66813f6398ac
.quad 0xbf02ef9f3f5bfb34,0xbf102dd53f5389c7,0xbf1ce11f3f4a4c87,0xbf28fd413f404c5c,0xbf34768f3f3592e7,0xbf3f41fc3f2a2a80,0xbf4955213f1e1e22,0xbf52a6493f11796b
.quad 0xbd6214693f7f9c18,0xbe0395023f7de0b1,0xbe4dee603f7ac516,0xbe8b95073f764d97,0xbeaf713a3f708066,0xbed25a093f696591,0xbef41f073f6106f2,0xbf0a48ad3f577026
.quad 0xbf19c2003f4cae79,0xbf2866053f40d0da,0xbf36206c3f33e7bc,0xbf42de293f26050a,0xbf4e8d903f173c07,0xbf591e6a3f07a136,0xbf6282103eee9479,0xbf6aab7b3ecc9b8b
.quad 0xbd83db0a3f7f7808,0xbe195be03f7d1cdd,0xbe6fa8b23f78e3d6,0xbea218873f72d4eb,0xbecb2aae3f6afb8c,0xbef2bd433f61668a,0xbf0c42c93f5627fe,0xbf1e1e223f495521
.quad 0xbf2ecef73f3b0629,0xbf3e35c53f2b561b,0xbf4c35783f1a6293,0xbf58b3a13f084b92,0xbf6398ac3eea6681,0xbf6cd0073ec27b55,0xbf74484b3e9920fe,0xbf79f35e3e5d4b1a
.quad 0xbd96a9053f7f4e6d,0xbe2f10a23f7c3b28,0xbe888e933f76ba07,0xbeb8442a3f6ed89e,0xbee633753f64aa59,0xbf08f59b3f584853,0xbf1d7fd13f49d112,0xbf3085bb3f396842
.quad 0xbf41d8703f273656,0xbf514d3d3f13682a,0xbf5ebe053efc5d27,0xbf6a09a73ecf7bca,0xbf7314473ea09ae5,0xbf79c79d3e605c13,0xbf7e13243dfab273,0xbf7fec433cc90ab0
.quad 0xbda973ba3f7f1f49,0xbe44b0b93f7b3bab,0xbe9920fe3f74484b,0xbece0bea3f6a5ad9,0xbf003a063f5d924d,0xbf17de123f4e1689,0xbf2da8593f3c17d9,0xbf4154e13f27ce61
.quad 0xbf52a6493f11796b,0xbf61668a3ef2bd43,0xbf6d67a13ebf926f,0xbf76841b3e8a11f7,0xbf7c9f8a3e25c58c,0xbf7fa6e33d55880e,0xbf7f90b1bd6ea038,0xbf7c5d3abe2bf804
.quad 0xbdbc3ac33f7eea9d,0xbe5a39973f7a1e84,0xbea986c43f718f57,0xbee363fa3f655e0b,0xbf0cead03f55b993,0xbf26050a3f42de29,0xbf3ca0033f2d1469,0xbf5064af3f14b039
.quad 0xbf6106f23ef41f07,0xbf6e46be3ebb31a0,0xbf77f1103e7ee6e1,0xbf7de0b13e039502,0xbf7ffec43bc90f88,0xbf7e4323bdee3876,0xbf78b47bbe72b651,0xbf6f6830beb554ec
.quad 0xbdcefdb73f7eb069,0xbe6fa8b23f78e3d6,0xbeb9bb1e3f6e8ff8,0xbef840c83f5fe4e9,0xbf19210f3f4d26fd,0xbf33587a3f36ad7f,0xbf4a4c873f1ce11f,0xbf5d924d3f003a06
.quad 0xbf6cd0073ec27b55,0xbf77beb73e80f8c0,0xbf7e2b723df475c0,0xbf7ff84abc7b514b,0xbf7d1cddbe195be0,0xbf75a67bbe901c2c,0xbf69b7e4bed0eb2a,0xbf5988adbf06f686
.quad 0xbde1bc2e3f7e70b0,0xbe827dc03f778bc5,0xbec9b9533f6b4b0c,0xbf064b823f59f26a,0xbf24d2253f43e200,0xbf3fc7673f299415,0xbf5695e53f0b9a6b,0xbf68bf3c3ed53641
.quad 0xbf75dec63e8e9a22,0xbf7dabcc3e09cf86,0xbf7ffb11bc490e90,0xbf7cbfc9be22abb6,0xbf740bddbe9aa086,0xbf660f88bee0924f,0xbf531849bf10d3cd,0xbf3b8f3bbf2e3bde
.quad 0xbdf475c03f7e2b72,0xbe8d17c03f76167a,0xbed97cb93f67c187,0xbf102dd53f5389c7,0xbf2ff3e63f39f2ac,0xbf4b41fa3f1ba299,0xbf61668a3ef2bd43,0xbf71d19f3ea80b1f
.quad 0xbf7c187a3e3228d4,0xbf7ff84a3c7b514b,0xbf7d57debe1324ca,0xbf74484bbe9920fe,0xbf650479bee4cbfe,0xbf4fefa8bf1553b7,0xbf3592e7bf34768f,0xbf16999fbf4f0417
.quad 0xbe0395023f7de0b1,0xbe97a1173f748422,0xbee900b73f63f473,0xbf19c2003f4cae79,0xbf3a7ca43f2f61a5,0xbf55b9933f0cead0,0xbf6aab7b3ecc9b8b,0xbf78b47b3e72b651
.quad 0xbf7f6ac73d8a200a,0xbf7e9bc9bdd53db9,0xbf764d97be8b9507,0xbf66beccbeddbe79,0xbf5064afbf14b039,0xbf33e7bcbf36206c,0xbf121eb0bf5233c6,0xbed8106bbf6816a8
.quad 0xbe0cec4a3f7d906e,0xbea218873f72d4eb,0xbef840c83f5fe4e9,0xbf2302d33f456439,0xbf4463373f24381a,0xbf5f20db3efafef7,0xbf7254703ea5129f,0xbf7d57de3e1324ca
.quad 0xbf7fcbe2bd2351cb,0xbf799b43be636c83,0xbf6afb8cbecb2aae,0xbf546b3bbf0ee0db,0xbf36ad7fbf33587a,0xbf12c39abf51c0c2,0xbed3c867bf6912ae,0xbe75c35abf788486
.quad 0xbe1640833f7d3aac,0xbeac7cd43f710908,0xbf039c3d3f5b941a,0xbf2beb4a3f3daef9,0xbf4d9f023f187fc0,0xbf676bd83edae880,0xbf7853f83e78cfcc,0xbf7fb10f3d48fb30
.quad 0xbf7d3aacbe164083,0xbf710908beac7cd4,0xbf5b941abf039c3d,0xbf3daef9bf2beb4a,0xbf187fc0bf4d9f02,0xbedae880bf676bd8,0xbe78cfccbf7853f8,0xbd48fb30bf7fb10f
.quad 0xbe1f917b3f7cdf6c,0xbeb6ccc33f6f20b0,0xbf0af1b73f570348,0xbf34768f3f3592e7,0xbf5627fe3f0c42c9,0xbf6e8ff83eb9bb1e,0xbf7c9f8a3e25c58c,0xbf7fba9ebd3c6dd5
.quad 0xbf77beb7be80f8c0,0xbf650479bee4cbfe,0xbf485bcabf1f599f,0xbf2302d3bf456439,0xbeed3063bf62df7b,0xbe8a11f7bf76841b,0xbd83db0abf7f7808,0x3e1324cabf7d57de
.quad 0xbe28defc3f7c7eb0,0xbec1071e3f6d1c1d,0xbf121eb03f5233c6,0xbf3ca0033f2d1469,0xbf5df6be3eff17b2,0xbf7484223e97a117,0xbf7f2f9d3da3308c,0xbf7d7474be1008b7
.quad 0xbf6f6830beb554ec,0xbf55b993bf0cead0,0xbf31a81dbf385216,0xbf04f484bf5ac450,0xbea395c5bf7294f8,0xbdd53db9bf7e9bc9,0x3dee3876bf7e4323,0x3ea986c4bf718f57
.quad 0xbe3228d43f7c187a,0xbecb2aae3f6afb8c,0xbf19210f3f4d26fd,0xbf4463373f24381a,0xbf6504793ee4cbfe,0xbf7940c03e698bba,0xbf7fffb1bb490fc6,0xbf78e3d6be6fa8b2
.quad 0xbf644facbee79a5d,0xbf436051bf256bcb,0xbf17de12bf4e1689,0xbec8477cbf6b99fb,0xbe2bf804bf7c5d3a,0x3d83db0abf7f7808,0x3e9620d2bf74bf62,0x3f019573bf5cc7d1
.quad 0xbe3b6ecf3f7baccd,0xbed536413f68bf3c,0xbf1ff6cb3f47de65,0xbf4bbbf83f1b02c6,0xbf6b4b0c3ec9b953,0xbf7cbfc93e22abb6,0xbf7f0e58bdafb680,0xbf721352bea68f12
.quad 0xbf5695e5bf0b9a6b,0xbf2e3bdebf3b8f3b,0xbef6e0cbbf604621,0xbe827dc0bf778bc5,0xbc490e90bf7ffb11,0x3e6c9a7fbf791298,0x3eebcbbbbf633c5a,0x3f299415bf3fc767
.quad 0xbe44b0b93f7b3bab,0xbedf28a93f666771,0xbf269de33f425b89,0xbf52a6493f11796b,0xbf70c5013eadf73c,0xbf7efcc93db5f8da,0xbf7c5d3abe2bf804,0xbf6912aebed3c867
.quad 0xbf466354bf21cbfb,0xbf16999fbf4f0417,0xbeb9bb1ebf6e8ff8,0xbde7fa9abf7e5a38,0x3e1324cabf7d57de,0x3ec8477cbf6b99fb,0x3f1ce11fbf4a4c87,0x3f4b41fabf1ba299
.quad 0xbe4dee603f7ac516,0xbee900b73f63f473,0xbf2d14693f3ca003,0xbf591e6a3f07a136,0xbf756d973e919ddd,0xbf7ff4e63c96c9b6,0xbf77f110be7ee6e1,0xbf5df6bebeff17b2
.quad 0xbf33e7bcbf36206c,0xbef9a02dbf5f8327,0xbe72b651bf78b47b,0x3cfb49babf7fe129,0x3e97a117bf748422,0x3f0a48adbf577026,0x3f3ebc1bbf2ac082,0x3f655e0bbee363fa
.quad 0xbe57278f3f7a4910,0xbef2bd433f61668a,0xbf33587a3f36ad7f,0xbf5f20db3efafef7,0xbf7940c03e698bba,0xbf7fa6e3bd55880e,0xbf71d19fbea80b1f,0xbf50d937bf140c5f
.quad 0xbf1f599fbf485bca,0xbec27b55bf6cd007,0xbddb7d37bf7e868b,0x3e3228d4bf7c187a,0x3ee1fb6abf65b710,0x3f2c800fbf3d27b8,0x3f5a5ba0bf05a02c,0x3f76ef5bbe870ada
.quad 0xbe605c133f79c79d,0xbefc5d273f5ebe05,0xbf3968423f3085bb,0xbf64aa593ee63375,0xbf7c3b283e2f10a2,0xbf7e1324bdfab273,0xbf6a09a7becf7bca,0xbf41d870bf273656
.quad 0xbf08f59bbf584853,0xbe888e93bf76ba07,0x3cc90ab0bf7fec43,0x3ea09ae5bf731447,0x3f13682abf514d3d,0x3f49d112bf1d7fd1,0x3f6ed89ebeb8442a,0x3f7f4e6dbd96a905
.quad 0xbe698bba3f7940c0,0xbf02ef9f3f5bfb34,0xbf3f41fc3f2a2a80,0xbf69b7e43ed0eb2a,0xbf7e5a383de7fa9a,0xbf7b3babbe44b0b9,0xbf60a6cfbef58035,0xbf311722bf38dd65
.quad 0xbee1fb6abf65b710,0xbe195be0bf7d1cdd,0x3e1f917bbf7cdf6c,0x3ee4cbfebf650479,0x3f3238aabf37c655,0x3f61668abef2bd43,0x3f7b87b2be3e853e,0x3f7e2b723df475c0
.quad 0xbe72b6513f78b47b,0xbf07a1363f591e6a,0xbf44e3f53f239da9,0xbf6e46be3ebb31a0,0xbf7f9c183d621469,0xbf772417be8586ce,0xbf55b993bf0cead0,0xbf1ebc12bf48d8b3
.quad 0xbeaf713abf708066,0xbcfb49babf7fe129,0x3e919dddbf756d97,0x3f121eb0bf5233c6,0x3f4cae79bf19c200,0x3f7294f8bea395c5,0x3f7ffec4bbc90f88,0x3f73913f3e9d9e78
.quad 0xbe7bdba43f7822d1,0xbf0c42c93f5627fe,0xbf4a4c873f1ce11f,0xbf7254703ea5129f,0xbf7fffb1bb490fc6,0xbf71d19fbea80b1f,0xbf495521bf1e1e22,0xbf0af1b7bf570348
.quad 0xbe75c35abf788486,0x3db5f8dabf7efcc9,0x3ed0eb2abf69b7e4,0x3f2ecef7bf3b0629,0x3f62241abeeff7fb,0x3f7cdf6cbe1f917b,0x3f7c187a3e3228d4,0x3f5fe4e93ef840c8
.quad 0xbe827dc03f778bc5,0xbf10d3cd3f531849,0xbf4f7a1f3f15f6d9,0xbf75dec63e8e9a22,0xbf7f84abbd7b2b74,0xbf6b4b0cbec9b953,0xbf3b8f3bbf2e3bde,0xbeebcbbbbf633c5a
.quad 0xbe09cf86bf7dabcc,0x3e541501bf7a7302,0x3f064b82bf59f26a,0x3f47de65bf1ff6cb,0x3f721352bea68f12,0x3f7ffb113c490e90,0x3f6ff5733eb263ef,0x3f43e2003f24d225
.quad 0xbe870ada3f76ef5b,0xbf1553b73f4fefa8,0xbf546b3b3f0ee0db,0xbf78e3d63e6fa8b2,0xbf7e2b72bdf475c0,0xbf6398acbeea6681,0xbf2c800fbf3d27b8,0xbebf926fbf6d67a1
.quad 0xbce22a7abf7fe705,0x3ea5129fbf725470,0x3f21cbfbbf466354,0x3f5cc7d1bf019573,0x3f7c187abe3228d4,0x3f7bd14d3e3857ec,0x3f5bfb343f02ef9f,0x3f2093933f476085
.quad 0xbe8b95073f764d97,0xbf19c2003f4cae79,0xbf591e6a3f07a136,0xbf7b61fc3e419b37,0xbf7bf531be354098,0xbf5ac450bf04f484,0xbf1c420cbf4ac77f,0xbe919dddbf756d97
.quad 0x3da3308cbf7f2f9d,0x3eddbe79bf66becc,0x3f3a7ca4bf2f61a5,0x3f6d1c1dbec1071e,0x3f7ff4e6bc96c9b6,0x3f7080663eaf713a,0x3f40d0da3f286605,0x3eee94793f628210
.quad 0xbe901c2c3f75a67b,0xbf1e1e223f495521,0xbf5d924d3f003a06,0xbf7d57de3e1324ca,0xbf78e3d6be6fa8b2,0xbf50d937bf140c5f,0xbf0af1b7bf570348,0xbe44b0b9bf7b3bab
.quad 0x3e3e853ebf7b87b2,0x3f099f4ebf57dc7f,0x3f4fefa8bf1553b7,0x3f788486be75c35a,0x3f7d906e3e0cec4a,0x3f5e5aa63efdbabb,0x3f1f599f3f485bca,0x3e931f353f75341d
.quad 0x0,0x0,0x3f803f80,0xbf35bf353f353f35,0xbf80bf803f803f80,0x0,0x3f803f80,0x3f353f35bf35bf35
.quad 0x3f803f803f803f80,0xbf80bf80bf80bf80,0x3f803f80,0x3f353f35bf35bf35,0xbf80bf803f803f80,0x0,0x3f803f80,0xbf35bf353f353f35
.quad 0x0,0x0,0xbf80bf80,0x3f353f35bf35bf35,0xbf80bf803f803f80,0x0,0xbf80bf80,0xbf35bf353f353f35
.quad 0x3f803f803f803f80,0xbf80bf80bf80bf80,0xbf80bf80,0xbf35bf353f353f35,0xbf80bf803f803f80,0x0,0xbf80bf80,0x3f353f35bf35bf35
.quad 0x0,0x0,0xbf80bf8000000000,0xbf35bf35bf35bf35,0x0,0x3f803f80bf80bf80,0x3f803f8000000000,0xbf35bf35bf35bf35
.quad 0x0,0x0,0xbf80bf8000000000,0x3f353f353f353f35,0x0,0xbf80bf803f803f80,0x3f803f8000000000,0x3f353f353f353f35
.quad 0x0,0x0,0x3f803f8000000000,0x3f353f353f353f35,0x0,0x3f803f80bf80bf80,0xbf80bf8000000000,0x3f353f353f353f35
.quad 0x0,0x0,0x3f803f8000000000,0xbf35bf35bf35bf35,0x0,0xbf80bf803f803f80,0xbf80bf8000000000,0xbf35bf35bf35bf35
.quad 0x0,0x0,0xbf80bf80,0x3f353f35bf35bf35,0x3f803f80bf80bf80,0x0,0xbf80bf80,0xbf35bf353f353f35
.quad 0xbf80bf80bf80bf80,0x3f803f803f803f80,0xbf80bf80,0xbf35bf353f353f35,0x3f803f80bf80bf80,0x0,0xbf80bf80,0x3f353f35bf35bf35
.quad 0x0,0x0,0x3f803f80,0xbf35bf353f353f35,0x3f803f80bf80bf80,0x0,0x3f803f80,0x3f353f35bf35bf35
.quad 0xbf80bf80bf80bf80,0x3f803f803f803f80,0x3f803f80,0x3f353f35bf35bf35,0x3f803f80bf80bf80,0x0,0x3f803f80,0xbf35bf353f353f35
.quad 0x0,0x0,0x3f803f8000000000,0x3f353f353f353f35,0x0,0xbf80bf803f803f80,0xbf80bf8000000000,0x3f353f353f353f35
.quad 0x0,0x0,0x3f803f8000000000,0xbf35bf35bf35bf35,0x0,0x3f803f80bf80bf80,0xbf80bf8000000000,0xbf35bf35bf35bf35
.quad 0x0,0x0,0xbf80bf8000000000,0xbf35bf35bf35bf35,0x0,0xbf80bf803f803f80,0x3f803f8000000000,0xbf35bf35bf35bf35
.quad 0x0,0x0,0xbf80bf8000000000,0x3f353f353f353f35,0x0,0x3f803f80bf80bf80,0x3f803f8000000000,0x3f353f353f353f35
.quad 0x3ca13f8000003f80,0x3cf13f803c213f80,0x3f80bca100003f80,0x3f30bf3a3f373f33,0xbca1bf8000003f80,0xbf803cf13f80bc21,0xbf803ca100003f80,0x3f3a3f303f33bf37
.quad 0x3ca13f8000003f80,0xbcf1bf80bc21bf80,0x3f80bca100003f80,0xbf303f3abf37bf33,0xbca1bf8000003f80,0x3f80bcf1bf803c21,0xbf803ca100003f80,0xbf3abf30bf333f37
.quad 0x3d713f803d213f80,0x3d8d3f7f3d493f80,0xbf803d71bd21bf80,0xbf283f41bf3ebf2c,0xbd71bf803d213f80,0xbf7f3d8d3f80bd49,0x3f80bd71bd21bf80,0xbf41bf28bf2c3f3e
.quad 0x3d713f803d213f80,0xbd8dbf7fbd49bf80,0xbf803d71bd21bf80,0x3f28bf413f3e3f2c,0xbd71bf803d213f80,0x3f7fbd8dbf803d49,0x3f80bd71bd21bf80,0x3f413f283f2cbf3e
.quad 0x3f80bca13f800000,0x3f80bcf13f80bc21,0xbca1bf803f800000,0xbf3abf303f33bf37,0xbf803ca13f800000,0x3cf13f80bc21bf80,0x3ca13f803f800000,0x3f30bf3abf37bf33
.quad 0x3f80bca13f800000,0xbf803cf1bf803c21,0xbca1bf803f800000,0x3f3a3f30bf333f37,0xbf803ca13f800000,0xbcf1bf803c213f80,0x3ca13f803f800000,0xbf303f3a3f373f33
.quad 0x3f80bd713f80bd21,0x3f7fbd8d3f80bd49,0x3d713f80bf803d21,0x3f413f28bf2c3f3e,0xbf803d713f80bd21,0x3d8d3f7fbd49bf80,0xbd71bf80bf803d21,0xbf283f413f3e3f2c
.quad 0x3f80bd713f80bd21,0xbf7f3d8dbf803d49,0x3d713f80bf803d21,0xbf41bf283f2cbf3e,0xbf803d713f80bd21,0xbd8dbf7f3d493f80,0xbd71bf80bf803d21,0x3f28bf41bf3ebf2c
.quad 0xbca1bf800000bf80,0xbcf1bf80bc21bf80,0xbf803ca10000bf80,0xbf303f3abf37bf33,0x3ca13f800000bf80,0x3f80bcf1bf803c21,0x3f80bca10000bf80,0xbf3abf30bf333f37
.quad 0xbca1bf800000bf80,0x3cf13f803c213f80,0xbf803ca10000bf80,0x3f30bf3a3f373f33,0x3ca13f800000bf80,0xbf803cf13f80bc21,0x3f80bca10000bf80,0x3f3a3f303f33bf37
.quad 0xbd71bf80bd21bf80,0xbd8dbf7fbd49bf80,0x3f80bd713d213f80,0x3f28bf413f3e3f2c,0x3d713f80bd21bf80,0x3f7fbd8dbf803d49,0xbf803d713d213f80,0x3f413f283f2cbf3e
.quad 0xbd71bf80bd21bf80,0x3d8d3f7f3d493f80,0x3f80bd713d213f80,0xbf283f41bf3ebf2c,0x3d713f80bd21bf80,0xbf7f3d8d3f80bd49,0xbf803d713d213f80,0xbf41bf28bf2c3f3e
.quad 0xbf803ca1bf800000,0xbf803cf1bf803c21,0x3ca13f80bf800000,0x3f3a3f30bf333f37,0x3f80bca1bf800000,0xbcf1bf803c213f80,0xbca1bf80bf800000,0xbf303f3a3f373f33
.quad 0xbf803ca1bf800000,0x3f80bcf13f80bc21,0x3ca13f80bf800000,0xbf3abf303f33bf37,0x3f80bca1bf800000,0x3cf13f80bc21bf80,0xbca1bf80bf800000,0x3f30bf3abf37bf33
.quad 0xbf803d71bf803d21,0xbf7f3d8dbf803d49,0xbd71bf803f80bd21,0xbf41bf283f2cbf3e,0x3f80bd71bf803d21,0xbd8dbf7f3d493f80,0x3d713f803f80bd21,0x3f28bf41bf3ebf2c
.quad 0xbf803d71bf803d21,0x3f7fbd8d3f80bd49,0xbd71bf803f80bd21,0x3f413f28bf2c3f3e,0x3f80bd71bf803d21,0x3d8d3f7fbd49bf80,0x3d713f803f80bd21,0xbf283f413f3e3f2c
.quad 0x3d213f8000003f80,0x3d713f803ca13f80,0x3f80bd2100003f80,0x3f2abf3f3f393f31,0xbd21bf8000003f80,0xbf803d713f80bca1,0xbf803d2100003f80,0x3f3f3f2a3f31bf39
.quad 0x3d213f8000003f80,0xbd71bf80bca1bf80,0x3f80bd2100003f80,0xbf2a3f3fbf39bf31,0xbd21bf8000003f80,0x3f80bd71bf803ca1,0xbf803d2100003f80,0xbf3fbf2abf313f39
.quad 0x3df13f7e3da13f7f,0x3e0c3f7e3dc93f7f,0xbf7e3df1bda1bf7f,0xbf1b3f4cbf46bf22,0xbdf1bf7e3da13f7f,0xbf7e3e0c3f7fbdc9,0x3f7ebdf1bda1bf7f,0xbf4cbf1bbf223f46
.quad 0x3df13f7e3da13f7f,0xbe0cbf7ebdc9bf7f,0xbf7e3df1bda1bf7f,0x3f1bbf4c3f463f22,0xbdf1bf7e3da13f7f,0x3f7ebe0cbf7f3dc9,0x3f7ebdf1bda1bf7f,0x3f4c3f1b3f22bf46
.quad 0x3f80bd213f800000,0x3f80bd713f80bca1,0xbd21bf803f800000,0xbf3fbf2a3f31bf39,0xbf803d213f800000,0x3d713f80bca1bf80,0x3d213f803f800000,0x3f2abf3fbf39bf31
.quad 0x3f80bd213f800000,0xbf803d71bf803ca1,0xbd21bf803f800000,0x3f3f3f2abf313f39,0xbf803d213f800000,0xbd71bf803ca13f80,0x3d213f803f800000,0xbf2a3f3f3f393f31
.quad 0x3f7ebdf13f7fbda1,0x3f7ebe0c3f7fbdc9,0x3df13f7ebf7f3da1,0x3f4c3f1bbf223f46,0xbf7e3df13f7fbda1,0x3e0c3f7ebdc9bf7f,0xbdf1bf7ebf7f3da1,0xbf1b3f4c3f463f22
.quad 0x3f7ebdf13f7fbda1,0xbf7e3e0cbf7f3dc9,0x3df13f7ebf7f3da1,0xbf4cbf1b3f22bf46,0xbf7e3df13f7fbda1,0xbe0cbf7e3dc93f7f,0xbdf1bf7ebf7f3da1,0x3f1bbf4cbf46bf22
.quad 0xbd21bf800000bf80,0xbd71bf80bca1bf80,0xbf803d210000bf80,0xbf2a3f3fbf39bf31,0x3d213f800000bf80,0x3f80bd71bf803ca1,0x3f80bd210000bf80,0xbf3fbf2abf313f39
.quad 0xbd21bf800000bf80,0x3d713f803ca13f80,0xbf803d210000bf80,0x3f2abf3f3f393f31,0x3d213f800000bf80,0xbf803d713f80bca1,0x3f80bd210000bf80,0x3f3f3f2a3f31bf39
.quad 0xbdf1bf7ebda1bf7f,0xbe0cbf7ebdc9bf7f,0x3f7ebdf13da13f7f,0x3f1bbf4c3f463f22,0x3df13f7ebda1bf7f,0x3f7ebe0cbf7f3dc9,0xbf7e3df13da13f7f,0x3f4c3f1b3f22bf46
.quad 0xbdf1bf7ebda1bf7f,0x3e0c3f7e3dc93f7f,0x3f7ebdf13da13f7f,0xbf1b3f4cbf46bf22,0x3df13f7ebda1bf7f,0xbf7e3e0c3f7fbdc9,0xbf7e3df13da13f7f,0xbf4cbf1bbf223f46
.quad 0xbf803d21bf800000,0xbf803d71bf803ca1,0x3d213f80bf800000,0x3f3f3f2abf313f39,0x3f80bd21bf800000,0xbd71bf803ca13f80,0xbd21bf80bf800000,0xbf2a3f3f3f393f31
.quad 0xbf803d21bf800000,0x3f80bd713f80bca1,0x3d213f80bf800000,0xbf3fbf2a3f31bf39,0x3f80bd21bf800000,0x3d713f80bca1bf80,0xbd21bf80bf800000,0x3f2abf3fbf39bf31
.quad 0xbf7e3df1bf7f3da1,0xbf7e3e0cbf7f3dc9,0xbdf1bf7e3f7fbda1,0xbf4cbf1b3f22bf46,0x3f7ebdf1bf7f3da1,0xbe0cbf7e3dc93f7f,0x3df13f7e3f7fbda1,0x3f1bbf4cbf46bf22
.quad 0xbf7e3df1bf7f3da1,0x3f7ebe0c3f7fbdc9,0xbdf1bf7e3f7fbda1,0x3f4c3f1bbf223f46,0x3f7ebdf1bf7f3da1,0x3e0c3f7ebdc9bf7f,0x3df13f7e3f7fbda1,0xbf1b3f4c3f463f22
.quad 0x3d713f8000003f80,0x3db53f7f3cf13f80,0x3f80bd7100003f80,0x3f24bf443f3a3f30,0xbd71bf8000003f80,0xbf7f3db53f80bcf1,0xbf803d7100003f80,0x3f443f243f30bf3a
.quad 0x3d713f8000003f80,0xbdb5bf7fbcf1bf80,0x3f80bd7100003f80,0xbf243f44bf3abf30,0xbd71bf8000003f80,0x3f7fbdb5bf803cf1,0xbf803d7100003f80,0xbf44bf24bf303f3a
.quad 0x3e343f7c3df13f7e,0x3e523f7b3e163f7d,0xbf7c3e34bdf1bf7e,0xbf0c3f56bf4ebf18,0xbe34bf7c3df13f7e,0xbf7b3e523f7dbe16,0x3f7cbe34bdf1bf7e,0xbf56bf0cbf183f4e
.quad 0x3e343f7c3df13f7e,0xbe52bf7bbe16bf7d,0xbf7c3e34bdf1bf7e,0x3f0cbf563f4e3f18,0xbe34bf7c3df13f7e,0x3f7bbe52bf7d3e16,0x3f7cbe34bdf1bf7e,0x3f563f0c3f18bf4e
.quad 0x3f80bd713f800000,0x3f7fbdb53f80bcf1,0xbd71bf803f800000,0xbf44bf243f30bf3a,0xbf803d713f800000,0x3db53f7fbcf1bf80,0x3d713f803f800000,0x3f24bf44bf3abf30
.quad 0x3f80bd713f800000,0xbf7f3db5bf803cf1,0xbd71bf803f800000,0x3f443f24bf303f3a,0xbf803d713f800000,0xbdb5bf7f3cf13f80,0x3d713f803f800000,0xbf243f443f3a3f30
.quad 0x3f7cbe343f7ebdf1,0x3f7bbe523f7dbe16,0x3e343f7cbf7e3df1,0x3f563f0cbf183f4e,0xbf7c3e343f7ebdf1,0x3e523f7bbe16bf7d,0xbe34bf7cbf7e3df1,0xbf0c3f563f4e3f18
.quad 0x3f7cbe343f7ebdf1,0xbf7b3e52bf7d3e16,0x3e343f7cbf7e3df1,0xbf56bf0c3f18bf4e,0xbf7c3e343f7ebdf1,0xbe52bf7b3e163f7d,0xbe34bf7cbf7e3df1,0x3f0cbf56bf4ebf18
.quad 0xbd71bf800000bf80,0xbdb5bf7fbcf1bf80,0xbf803d710000bf80,0xbf243f44bf3abf30,0x3d713f800000bf80,0x3f7fbdb5bf803cf1,0x3f80bd710000bf80,0xbf44bf24bf303f3a
.quad 0xbd71bf800000bf80,0x3db53f7f3cf13f80,0xbf803d710000bf80,0x3f24bf443f3a3f30,0x3d713f800000bf80,0xbf7f3db53f80bcf1,0x3f80bd710000bf80,0x3f443f243f30bf3a
.quad 0xbe34bf7cbdf1bf7e,0xbe52bf7bbe16bf7d,0x3f7cbe343df13f7e,0x3f0cbf563f4e3f18,0x3e343f7cbdf1bf7e,0x3f7bbe52bf7d3e16,0xbf7c3e343df13f7e,0x3f563f0c3f18bf4e
.quad 0xbe34bf7cbdf1bf7e,0x3e523f7b3e163f7d,0x3f7cbe343df13f7e,0xbf0c3f56bf4ebf18,0x3e343f7cbdf1bf7e,0xbf7b3e523f7dbe16,0xbf7c3e343df13f7e,0xbf56bf0cbf183f4e
.quad 0xbf803d71bf800000,0xbf7f3db5bf803cf1,0x3d713f80bf800000,0x3f443f24bf303f3a,0x3f80bd71bf800000,0xbdb5bf7f3cf13f80,0xbd71bf80bf800000,0xbf243f443f3a3f30
.quad 0xbf803d71bf800000,0x3f7fbdb53f80bcf1,0x3d713f80bf800000,0xbf44bf243f30bf3a,0x3f80bd71bf800000,0x3db53f7fbcf1bf80,0xbd71bf80bf800000,0x3f24bf44bf3abf30
.quad 0xbf7c3e34bf7e3df1,0xbf7b3e52bf7d3e16,0xbe34bf7c3f7ebdf1,0xbf56bf0c3f18bf4e,0x3f7cbe34bf7e3df1,0xbe52bf7b3e163f7d,0x3e343f7c3f7ebdf1,0x3f0cbf56bf4ebf18
.quad 0xbf7c3e34bf7e3df1,0x3f7bbe523f7dbe16,0xbe34bf7c3f7ebdf1,0x3f563f0cbf183f4e,0x3f7cbe34bf7e3df1,0x3e523f7bbe16bf7d,0x3e343f7c3f7ebdf1,0xbf0c3f563f4e3f18
.quad 0x3da13f7f00003f80,0x3df13f7e3d213f80,0x3f7fbda100003f80,0x3f1ebf493f3c3f2e,0xbda1bf7f00003f80,0xbf7e3df13f80bd21,0xbf7f3da100003f80,0x3f493f1e3f2ebf3c
.quad 0x3da13f7f00003f80,0xbdf1bf7ebd21bf80,0x3f7fbda100003f80,0xbf1e3f49bf3cbf2e,0xbda1bf7f00003f80,0x3f7ebdf1bf803d21,0xbf7f3da100003f80,0xbf49bf1ebf2e3f3c
.quad 0x3e6f3f793e203f7d,0x3e8b3f763e483f7b,0xbf793e6fbe20bf7d,0xbefa3f5fbf55bf0e,0xbe6fbf793e203f7d,0xbf763e8b3f7bbe48,0x3f79be6fbe20bf7d,0xbf5fbefabf0e3f55
.quad 0x3e6f3f793e203f7d,0xbe8bbf76be48bf7b,0xbf793e6fbe20bf7d,0x3efabf5f3f553f0e,0xbe6fbf793e203f7d,0x3f76be8bbf7b3e48,0x3f79be6fbe20bf7d,0x3f5f3efa3f0ebf55
.quad 0x3f7fbda13f800000,0x3f7ebdf13f80bd21,0xbda1bf7f3f800000,0xbf49bf1e3f2ebf3c,0xbf7f3da13f800000,0x3df13f7ebd21bf80,0x3da13f7f3f800000,0x3f1ebf49bf3cbf2e
.quad 0x3f7fbda13f800000,0xbf7e3df1bf803d21,0xbda1bf7f3f800000,0x3f493f1ebf2e3f3c,0xbf7f3da13f800000,0xbdf1bf7e3d213f80,0x3da13f7f3f800000,0xbf1e3f493f3c3f2e
.quad 0x3f79be6f3f7dbe20,0x3f76be8b3f7bbe48,0x3e6f3f79bf7d3e20,0x3f5f3efabf0e3f55,0xbf793e6f3f7dbe20,0x3e8b3f76be48bf7b,0xbe6fbf79bf7d3e20,0xbefa3f5f3f553f0e
.quad 0x3f79be6f3f7dbe20,0xbf763e8bbf7b3e48,0x3e6f3f79bf7d3e20,0xbf5fbefa3f0ebf55,0xbf793e6f3f7dbe20,0xbe8bbf763e483f7b,0xbe6fbf79bf7d3e20,0x3efabf5fbf55bf0e
.quad 0xbda1bf7f0000bf80,0xbdf1bf7ebd21bf80,0xbf7f3da10000bf80,0xbf1e3f49bf3cbf2e,0x3da13f7f0000bf80,0x3f7ebdf1bf803d21,0x3f7fbda10000bf80,0xbf49bf1ebf2e3f3c
.quad 0xbda1bf7f0000bf80,0x3df13f7e3d213f80,0xbf7f3da10000bf80,0x3f1ebf493f3c3f2e,0x3da13f7f0000bf80,0xbf7e3df13f80bd21,0x3f7fbda10000bf80,0x3f493f1e3f2ebf3c
.quad 0xbe6fbf79be20bf7d,0xbe8bbf76be48bf7b,0x3f79be6f3e203f7d,0x3efabf5f3f553f0e,0x3e6f3f79be20bf7d,0x3f76be8bbf7b3e48,0xbf793e6f3e203f7d,0x3f5f3efa3f0ebf55
.quad 0xbe6fbf79be20bf7d,0x3e8b3f763e483f7b,0x3f79be6f3e203f7d,0xbefa3f5fbf55bf0e,0x3e6f3f79be20bf7d,0xbf763e8b3f7bbe48,0xbf793e6f3e203f7d,0xbf5fbefabf0e3f55
.quad 0xbf7f3da1bf800000,0xbf7e3df1bf803d21,0x3da13f7fbf800000,0x3f493f1ebf2e3f3c,0x3f7fbda1bf800000,0xbdf1bf7e3d213f80,0xbda1bf7fbf800000,0xbf1e3f493f3c3f2e
.quad 0xbf7f3da1bf800000,0x3f7ebdf13f80bd21,0x3da13f7fbf800000,0xbf49bf1e3f2ebf3c,0x3f7fbda1bf800000,0x3df13f7ebd21bf80,0xbda1bf7fbf800000,0x3f1ebf49bf3cbf2e
.quad 0xbf793e6fbf7d3e20,0xbf763e8bbf7b3e48,0xbe6fbf793f7dbe20,0xbf5fbefa3f0ebf55,0x3f79be6fbf7d3e20,0xbe8bbf763e483f7b,0x3e6f3f793f7dbe20,0x3efabf5fbf55bf0e
.quad 0xbf793e6fbf7d3e20,0x3f76be8b3f7bbe48,0xbe6fbf793f7dbe20,0x3f5f3efabf0e3f55,0x3f79be6fbf7d3e20,0x3e8b3f76be48bf7b,0x3e6f3f793f7dbe20,0xbefa3f5f3f553f0e
.quad 0x3dc93f7f00003f80,0x3e163f7d3d493f80,0x3f7fbdc900003f80,0x3f18bf4e3f3e3f2c,0xbdc9bf7f00003f80,0xbf7d3e163f80bd49,0xbf7f3dc900003f80,0x3f4e3f183f2cbf3e
.quad 0x3dc93f7f00003f80,0xbe16bf7dbd49bf80,0x3f7fbdc900003f80,0xbf183f4ebf3ebf2c,0xbdc9bf7f00003f80,0x3f7dbe16bf803d49,0xbf7f3dc900003f80,0xbf4ebf18bf2c3f3e
.quad 0x3e953f753e483f7b,0x3eac3f713e793f78,0xbf753e95be48bf7b,0xbedb3f67bf5cbf04,0xbe95bf753e483f7b,0xbf713eac3f78be79,0x3f75be95be48bf7b,0xbf67bedbbf043f5c
.quad 0x3e953f753e483f7b,0xbeacbf71be79bf78,0xbf753e95be48bf7b,0x3edbbf673f5c3f04,0xbe95bf753e483f7b,0x3f71beacbf783e79,0x3f75be95be48bf7b,0x3f673edb3f04bf5c
.quad 0x3f7fbdc93f800000,0x3f7dbe163f80bd49,0xbdc9bf7f3f800000,0xbf4ebf183f2cbf3e,0xbf7f3dc93f800000,0x3e163f7dbd49bf80,0x3dc93f7f3f800000,0x3f18bf4ebf3ebf2c
.quad 0x3f7fbdc93f800000,0xbf7d3e16bf803d49,0xbdc9bf7f3f800000,0x3f4e3f18bf2c3f3e,0xbf7f3dc93f800000,0xbe16bf7d3d493f80,0x3dc93f7f3f800000,0xbf183f4e3f3e3f2c
.quad 0x3f75be953f7bbe48,0x3f71beac3f78be79,0x3e953f75bf7b3e48,0x3f673edbbf043f5c,0xbf753e953f7bbe48,0x3eac3f71be79bf78,0xbe95bf75bf7b3e48,0xbedb3f673f5c3f04
.quad 0x3f75be953f7bbe48,0xbf713eacbf783e79,0x3e953f75bf7b3e48,0xbf67bedb3f04bf5c,0xbf753e953f7bbe48,0xbeacbf713e793f78,0xbe95bf75bf7b3e48,0x3edbbf67bf5cbf04
.quad 0xbdc9bf7f0000bf80,0xbe16bf7dbd49bf80,0xbf7f3dc90000bf80,0xbf183f4ebf3ebf2c,0x3dc93f7f0000bf80,0x3f7dbe16bf803d49,0x3f7fbdc90000bf80,0xbf4ebf18bf2c3f3e
.quad 0xbdc9bf7f0000bf80,0x3e163f7d3d493f80,0xbf7f3dc90000bf80,0x3f18bf4e3f3e3f2c,0x3dc93f7f0000bf80,0xbf7d3e163f80bd49,0x3f7fbdc90000bf80,0x3f4e3f183f2cbf3e
.quad 0xbe95bf75be48bf7b,0xbeacbf71be79bf78,0x3f75be953e483f7b,0x3edbbf673f5c3f04,0x3e953f75be48bf7b,0x3f71beacbf783e79,0xbf753e953e483f7b,0x3f673edb3f04bf5c
.quad 0xbe95bf75be48bf7b,0x3eac3f713e793f78,0x3f75be953e483f7b,0xbedb3f67bf5cbf04,0x3e953f75be48bf7b,0xbf713eac3f78be79,0xbf753e953e483f7b,0xbf67bedbbf043f5c
.quad 0xbf7f3dc9bf800000,0xbf7d3e16bf803d49,0x3dc93f7fbf800000,0x3f4e3f18bf2c3f3e,0x3f7fbdc9bf800000,0xbe16bf7d3d493f80,0xbdc9bf7fbf800000,0xbf183f4e3f3e3f2c
.quad 0xbf7f3dc9bf800000,0x3f7dbe163f80bd49,0x3dc93f7fbf800000,0xbf4ebf183f2cbf3e,0x3f7fbdc9bf800000,0x3e163f7dbd49bf80,0xbdc9bf7fbf800000,0x3f18bf4ebf3ebf2c
.quad 0xbf753e95bf7b3e48,0xbf713eacbf783e79,0xbe95bf753f7bbe48,0xbf67bedb3f04bf5c,0x3f75be95bf7b3e48,0xbeacbf713e793f78,0x3e953f753f7bbe48,0x3edbbf67bf5cbf04
.quad 0xbf753e95bf7b3e48,0x3f71beac3f78be79,0xbe95bf753f7bbe48,0x3f673edbbf043f5c,0x3f75be95bf7b3e48,0x3eac3f71be79bf78,0x3e953f753f7bbe48,0xbedb3f673f5c3f04
.quad 0x3df13f7e00003f80,0x3e343f7c3d713f80,0x3f7ebdf100003f80,0x3f12bf523f3f3f2a,0xbdf1bf7e00003f80,0xbf7c3e343f80bd71,0xbf7e3df100003f80,0x3f523f123f2abf3f
.quad 0x3df13f7e00003f80,0xbe34bf7cbd71bf80,0x3f7ebdf100003f80,0xbf123f52bf3fbf2a,0xbdf1bf7e00003f80,0x3f7cbe34bf803d71,0xbf7e3df100003f80,0xbf52bf12bf2a3f3f
.quad 0x3eb13f703e6f3f79,0x3ecd3f6b3e953f75,0xbf703eb1be6fbf79,0xbebb3f6ebf62bef1,0xbeb1bf703e6f3f79,0xbf6b3ecd3f75be95,0x3f70beb1be6fbf79,0xbf6ebebbbef13f62
.quad 0x3eb13f703e6f3f79,0xbecdbf6bbe95bf75,0xbf703eb1be6fbf79,0x3ebbbf6e3f623ef1,0xbeb1bf703e6f3f79,0x3f6bbecdbf753e95,0x3f70beb1be6fbf79,0x3f6e3ebb3ef1bf62
.quad 0x3f7ebdf13f800000,0x3f7cbe343f80bd71,0xbdf1bf7e3f800000,0xbf52bf123f2abf3f,0xbf7e3df13f800000,0x3e343f7cbd71bf80,0x3df13f7e3f800000,0x3f12bf52bf3fbf2a
.quad 0x3f7ebdf13f800000,0xbf7c3e34bf803d71,0xbdf1bf7e3f800000,0x3f523f12bf2a3f3f,0xbf7e3df13f800000,0xbe34bf7c3d713f80,0x3df13f7e3f800000,0xbf123f523f3f3f2a
.quad 0x3f70beb13f79be6f,0x3f6bbecd3f75be95,0x3eb13f70bf793e6f,0x3f6e3ebbbef13f62,0xbf703eb13f79be6f,0x3ecd3f6bbe95bf75,0xbeb1bf70bf793e6f,0xbebb3f6e3f623ef1
.quad 0x3f70beb13f79be6f,0xbf6b3ecdbf753e95,0x3eb13f70bf793e6f,0xbf6ebebb3ef1bf62,0xbf703eb13f79be6f,0xbecdbf6b3e953f75,0xbeb1bf70bf793e6f,0x3ebbbf6ebf62bef1
.quad 0xbdf1bf7e0000bf80,0xbe34bf7cbd71bf80,0xbf7e3df10000bf80,0xbf123f52bf3fbf2a,0x3df13f7e0000bf80,0x3f7cbe34bf803d71,0x3f7ebdf10000bf80,0xbf52bf12bf2a3f3f
.quad 0xbdf1bf7e0000bf80,0x3e343f7c3d713f80,0xbf7e3df10000bf80,0x3f12bf523f3f3f2a,0x3df13f7e0000bf80,0xbf7c3e343f80bd71,0x3f7ebdf10000bf80,0x3f523f123f2abf3f
.quad 0xbeb1bf70be6fbf79,0xbecdbf6bbe95bf75,0x3f70beb13e6f3f79,0x3ebbbf6e3f623ef1,0x3eb13f70be6fbf79,0x3f6bbecdbf753e95,0xbf703eb13e6f3f79,0x3f6e3ebb3ef1bf62
.quad 0xbeb1bf70be6fbf79,0x3ecd3f6b3e953f75,0x3f70beb13e6f3f79,0xbebb3f6ebf62bef1,0x3eb13f70be6fbf79,0xbf6b3ecd3f75be95,0xbf703eb13e6f3f79,0xbf6ebebbbef13f62
.quad 0xbf7e3df1bf800000,0xbf7c3e34bf803d71,0x3df13f7ebf800000,0x3f523f12bf2a3f3f,0x3f7ebdf1bf800000,0xbe34bf7c3d713f80,0xbdf1bf7ebf800000,0xbf123f523f3f3f2a
.quad 0xbf7e3df1bf800000,0x3f7cbe343f80bd71,0x3df13f7ebf800000,0xbf52bf123f2abf3f,0x3f7ebdf1bf800000,0x3e343f7cbd71bf80,0xbdf1bf7ebf800000,0x3f12bf52bf3fbf2a
.quad 0xbf703eb1bf793e6f,0xbf6b3ecdbf753e95,0xbeb1bf703f79be6f,0xbf6ebebb3ef1bf62,0x3f70beb1bf793e6f,0xbecdbf6b3e953f75,0x3eb13f703f79be6f,0x3ebbbf6ebf62bef1
.quad 0xbf703eb1bf793e6f,0x3f6bbecd3f75be95,0xbeb1bf703f79be6f,0x3f6e3ebbbef13f62,0x3f70beb1bf793e6f,0x3ecd3f6bbe95bf75,0x3eb13f703f79be6f,0xbebb3f6e3f623ef1
.quad 0x3e0c3f7e00003f80,0x3e523f7b3d8d3f7f,0x3f7ebe0c00003f80,0x3f0cbf563f413f28,0xbe0cbf7e00003f80,0xbf7b3e523f7fbd8d,0xbf7e3e0c00003f80,0x3f563f0c3f28bf41
.quad 0x3e0c3f7e00003f80,0xbe52bf7bbd8dbf7f,0x3f7ebe0c00003f80,0xbf0c3f56bf41bf28,0xbe0cbf7e00003f80,0x3f7bbe52bf7f3d8d,0xbf7e3e0c00003f80,0xbf56bf0cbf283f41
.quad 0x3ecd3f6b3e8b3f76,0x3eed3f633eac3f71,0xbf6b3ecdbe8bbf76,0xbe993f74bf67bedb,0xbecdbf6b3e8b3f76,0xbf633eed3f71beac,0x3f6bbecdbe8bbf76,0xbf74be99bedb3f67
.quad 0x3ecd3f6b3e8b3f76,0xbeedbf63beacbf71,0xbf6b3ecdbe8bbf76,0x3e99bf743f673edb,0xbecdbf6b3e8b3f76,0x3f63beedbf713eac,0x3f6bbecdbe8bbf76,0x3f743e993edbbf67
.quad 0x3f7ebe0c3f800000,0x3f7bbe523f7fbd8d,0xbe0cbf7e3f800000,0xbf56bf0c3f28bf41,0xbf7e3e0c3f800000,0x3e523f7bbd8dbf7f,0x3e0c3f7e3f800000,0x3f0cbf56bf41bf28
.quad 0x3f7ebe0c3f800000,0xbf7b3e52bf7f3d8d,0xbe0cbf7e3f800000,0x3f563f0cbf283f41,0xbf7e3e0c3f800000,0xbe52bf7b3d8d3f7f,0x3e0c3f7e3f800000,0xbf0c3f563f413f28
.quad 0x3f6bbecd3f76be8b,0x3f63beed3f71beac,0x3ecd3f6bbf763e8b,0x3f743e99bedb3f67,0xbf6b3ecd3f76be8b,0x3eed3f63beacbf71,0xbecdbf6bbf763e8b,0xbe993f743f673edb
.quad 0x3f6bbecd3f76be8b,0xbf633eedbf713eac,0x3ecd3f6bbf763e8b,0xbf74be993edbbf67,0xbf6b3ecd3f76be8b,0xbeedbf633eac3f71,0xbecdbf6bbf763e8b,0x3e99bf74bf67bedb
.quad 0xbe0cbf7e0000bf80,0xbe52bf7bbd8dbf7f,0xbf7e3e0c0000bf80,0xbf0c3f56bf41bf28,0x3e0c3f7e0000bf80,0x3f7bbe52bf7f3d8d,0x3f7ebe0c0000bf80,0xbf56bf0cbf283f41
.quad 0xbe0cbf7e0000bf80,0x3e523f7b3d8d3f7f,0xbf7e3e0c0000bf80,0x3f0cbf563f413f28,0x3e0c3f7e0000bf80,0xbf7b3e523f7fbd8d,0x3f7ebe0c0000bf80,0x3f563f0c3f28bf41
.quad 0xbecdbf6bbe8bbf76,0xbeedbf63beacbf71,0x3f6bbecd3e8b3f76,0x3e99bf743f673edb,0x3ecd3f6bbe8bbf76,0x3f63beedbf713eac,0xbf6b3ecd3e8b3f76,0x3f743e993edbbf67
.quad 0xbecdbf6bbe8bbf76,0x3eed3f633eac3f71,0x3f6bbecd3e8b3f76,0xbe993f74bf67bedb,0x3ecd3f6bbe8bbf76,0xbf633eed3f71beac,0xbf6b3ecd3e8b3f76,0xbf74be99bedb3f67
.quad 0xbf7e3e0cbf800000,0xbf7b3e52bf7f3d8d,0x3e0c3f7ebf800000,0x3f563f0cbf283f41,0x3f7ebe0cbf800000,0xbe52bf7b3d8d3f7f,0xbe0cbf7ebf800000,0xbf0c3f563f413f28
.quad 0xbf7e3e0cbf800000,0x3f7bbe523f7fbd8d,0x3e0c3f7ebf800000,0xbf56bf0c3f28bf41,0x3f7ebe0cbf800000,0x3e523f7bbd8dbf7f,0xbe0cbf7ebf800000,0x3f0cbf56bf41bf28
.quad 0xbf6b3ecdbf763e8b,0xbf633eedbf713eac,0xbecdbf6b3f76be8b,0xbf74be993edbbf67,0x3f6bbecdbf763e8b,0xbeedbf633eac3f71,0x3ecd3f6b3f76be8b,0x3e99bf74bf67bedb
.quad 0xbf6b3ecdbf763e8b,0x3f63beed3f71beac,0xbecdbf6b3f76be8b,0x3f743e99bedb3f67,0x3f6bbecdbf763e8b,0x3eed3f63beacbf71,0x3ecd3f6b3f76be8b,0xbe993f743f673edb
.quad 0x3e203f7d00003f80,0x3e6f3f793da13f7f,0x3f7dbe2000003f80,0x3f06bf5a3f433f26,0xbe20bf7d00003f80,0xbf793e6f3f7fbda1,0xbf7d3e2000003f80,0x3f5a3f063f26bf43
.quad 0x3e203f7d00003f80,0xbe6fbf79bda1bf7f,0x3f7dbe2000003f80,0xbf063f5abf43bf26,0xbe20bf7d00003f80,0x3f79be6fbf7f3da1,0xbf7d3e2000003f80,0xbf5abf06bf263f43
.quad 0x3ee83f643e9e3f73,0x3f063f5a3ec43f6d,0xbf643ee8be9ebf73,0xbe6f3f79bf6dbec4,0xbee8bf643e9e3f73,0xbf5a3f063f6dbec4,0x3f64bee8be9ebf73,0xbf79be6fbec43f6d
.quad 0x3ee83f643e9e3f73,0xbf06bf5abec4bf6d,0xbf643ee8be9ebf73,0x3e6fbf793f6d3ec4,0xbee8bf643e9e3f73,0x3f5abf06bf6d3ec4,0x3f64bee8be9ebf73,0x3f793e6f3ec4bf6d
.quad 0x3f7dbe203f800000,0x3f79be6f3f7fbda1,0xbe20bf7d3f800000,0xbf5abf063f26bf43,0xbf7d3e203f800000,0x3e6f3f79bda1bf7f,0x3e203f7d3f800000,0x3f06bf5abf43bf26
.quad 0x3f7dbe203f800000,0xbf793e6fbf7f3da1,0xbe20bf7d3f800000,0x3f5a3f06bf263f43,0xbf7d3e203f800000,0xbe6fbf793da13f7f,0x3e203f7d3f800000,0xbf063f5a3f433f26
.quad 0x3f64bee83f73be9e,0x3f5abf063f6dbec4,0x3ee83f64bf733e9e,0x3f793e6fbec43f6d,0xbf643ee83f73be9e,0x3f063f5abec4bf6d,0xbee8bf64bf733e9e,0xbe6f3f793f6d3ec4
.quad 0x3f64bee83f73be9e,0xbf5a3f06bf6d3ec4,0x3ee83f64bf733e9e,0xbf79be6f3ec4bf6d,0xbf643ee83f73be9e,0xbf06bf5a3ec43f6d,0xbee8bf64bf733e9e,0x3e6fbf79bf6dbec4
.quad 0xbe20bf7d0000bf80,0xbe6fbf79bda1bf7f,0xbf7d3e200000bf80,0xbf063f5abf43bf26,0x3e203f7d0000bf80,0x3f79be6fbf7f3da1,0x3f7dbe200000bf80,0xbf5abf06bf263f43
.quad 0xbe20bf7d0000bf80,0x3e6f3f793da13f7f,0xbf7d3e200000bf80,0x3f06bf5a3f433f26,0x3e203f7d0000bf80,0xbf793e6f3f7fbda1,0x3f7dbe200000bf80,0x3f5a3f063f26bf43
.quad 0xbee8bf64be9ebf73,0xbf06bf5abec4bf6d,0x3f64bee83e9e3f73,0x3e6fbf793f6d3ec4,0x3ee83f64be9ebf73,0x3f5abf06bf6d3ec4,0xbf643ee83e9e3f73,0x3f793e6f3ec4bf6d
.quad 0xbee8bf64be9ebf73,0x3f063f5a3ec43f6d,0x3f64bee83e9e3f73,0xbe6f3f79bf6dbec4,0x3ee83f64be9ebf73,0xbf5a3f063f6dbec4,0xbf643ee83e9e3f73,0xbf79be6fbec43f6d
.quad 0xbf7d3e20bf800000,0xbf793e6fbf7f3da1,0x3e203f7dbf800000,0x3f5a3f06bf263f43,0x3f7dbe20bf800000,0xbe6fbf793da13f7f,0xbe20bf7dbf800000,0xbf063f5a3f433f26
.quad 0xbf7d3e20bf800000,0x3f79be6f3f7fbda1,0x3e203f7dbf800000,0xbf5abf063f26bf43,0x3f7dbe20bf800000,0x3e6f3f79bda1bf7f,0xbe20bf7dbf800000,0x3f06bf5abf43bf26
.quad 0xbf643ee8bf733e9e,0xbf5a3f06bf6d3ec4,0xbee8bf643f73be9e,0xbf79be6f3ec4bf6d,0x3f64bee8bf733e9e,0xbf06bf5a3ec43f6d,0x3ee83f643f73be9e,0x3e6fbf79bf6dbec4
.quad 0xbf643ee8bf733e9e,0x3f5abf063f6dbec4,0xbee8bf643f73be9e,0x3f793e6fbec43f6d,0x3f64bee8bf733e9e,0x3f063f5abec4bf6d,0x3ee83f643f73be9e,0xbe6f3f793f6d3ec4
.quad 0x3e343f7c00003f80,0x3e863f773db53f7f,0x3f7cbe3400003f80,0x3effbf5e3f443f24,0xbe34bf7c00003f80,0xbf773e863f7fbdb5,0xbf7c3e3400003f80,0x3f5e3eff3f24bf44
.quad 0x3e343f7c00003f80,0xbe86bf77bdb5bf7f,0x3f7cbe3400003f80,0xbeff3f5ebf44bf24,0xbe34bf7c00003f80,0x3f77be86bf7f3db5,0xbf7c3e3400003f80,0xbf5ebeffbf243f44
.quad 0x3f013f5d3eb13f70,0x3f143f513edb3f67,0xbf5d3f01beb1bf70,0xbe2a3f7cbf71beac,0xbf01bf5d3eb13f70,0xbf513f143f67bedb,0x3f5dbf01beb1bf70,0xbf7cbe2abeac3f71
.quad 0x3f013f5d3eb13f70,0xbf14bf51bedbbf67,0xbf5d3f01beb1bf70,0x3e2abf7c3f713eac,0xbf01bf5d3eb13f70,0x3f51bf14bf673edb,0x3f5dbf01beb1bf70,0x3f7c3e2a3eacbf71
.quad 0x3f7cbe343f800000,0x3f77be863f7fbdb5,0xbe34bf7c3f800000,0xbf5ebeff3f24bf44,0xbf7c3e343f800000,0x3e863f77bdb5bf7f,0x3e343f7c3f800000,0x3effbf5ebf44bf24
.quad 0x3f7cbe343f800000,0xbf773e86bf7f3db5,0xbe34bf7c3f800000,0x3f5e3effbf243f44,0xbf7c3e343f800000,0xbe86bf773db53f7f,0x3e343f7c3f800000,0xbeff3f5e3f443f24
.quad 0x3f5dbf013f70beb1,0x3f51bf143f67bedb,0x3f013f5dbf703eb1,0x3f7c3e2abeac3f71,0xbf5d3f013f70beb1,0x3f143f51bedbbf67,0xbf01bf5dbf703eb1,0xbe2a3f7c3f713eac
.quad 0x3f5dbf013f70beb1,0xbf513f14bf673edb,0x3f013f5dbf703eb1,0xbf7cbe2a3eacbf71,0xbf5d3f013f70beb1,0xbf14bf513edb3f67,0xbf01bf5dbf703eb1,0x3e2abf7cbf71beac
.quad 0xbe34bf7c0000bf80,0xbe86bf77bdb5bf7f,0xbf7c3e340000bf80,0xbeff3f5ebf44bf24,0x3e343f7c0000bf80,0x3f77be86bf7f3db5,0x3f7cbe340000bf80,0xbf5ebeffbf243f44
.quad 0xbe34bf7c0000bf80,0x3e863f773db53f7f,0xbf7c3e340000bf80,0x3effbf5e3f443f24,0x3e343f7c0000bf80,0xbf773e863f7fbdb5,0x3f7cbe340000bf80,0x3f5e3eff3f24bf44
.quad 0xbf01bf5dbeb1bf70,0xbf14bf51bedbbf67,0x3f5dbf013eb13f70,0x3e2abf7c3f713eac,0x3f013f5dbeb1bf70,0x3f51bf14bf673edb,0xbf5d3f013eb13f70,0x3f7c3e2a3eacbf71
.quad 0xbf01bf5dbeb1bf70,0x3f143f513edb3f67,0x3f5dbf013eb13f70,0xbe2a3f7cbf71beac,0x3f013f5dbeb1bf70,0xbf513f143f67bedb,0xbf5d3f013eb13f70,0xbf7cbe2abeac3f71
.quad 0xbf7c3e34bf800000,0xbf773e86bf7f3db5,0x3e343f7cbf800000,0x3f5e3effbf243f44,0x3f7cbe34bf800000,0xbe86bf773db53f7f,0xbe34bf7cbf800000,0xbeff3f5e3f443f24
.quad 0xbf7c3e34bf800000,0x3f77be863f7fbdb5,0x3e343f7cbf800000,0xbf5ebeff3f24bf44,0x3f7cbe34bf800000,0x3e863f77bdb5bf7f,0xbe34bf7cbf800000,0x3effbf5ebf44bf24
.quad 0xbf5d3f01bf703eb1,0xbf513f14bf673edb,0xbf01bf5d3f70beb1,0xbf7cbe2a3eacbf71,0x3f5dbf01bf703eb1,0xbf14bf513edb3f67,0x3f013f5d3f70beb1,0x3e2abf7cbf71beac
.quad 0xbf5d3f01bf703eb1,0x3f51bf143f67bedb,0xbf01bf5d3f70beb1,0x3f7c3e2abeac3f71,0x3f5dbf01bf703eb1,0x3f143f51bedbbf67,0x3f013f5d3f70beb1,0xbe2a3f7c3f713eac
.quad 0x3e483f7b00003f80,0x3e953f753dc93f7f,0x3f7bbe4800003f80,0x3ef1bf623f463f22,0xbe48bf7b00003f80,0xbf753e953f7fbdc9,0xbf7b3e4800003f80,0x3f623ef13f22bf46
.quad 0x3e483f7b00003f80,0xbe95bf75bdc9bf7f,0x3f7bbe4800003f80,0xbef13f62bf46bf22,0xbe48bf7b00003f80,0x3f75be95bf7f3dc9,0xbf7b3e4800003f80,0xbf62bef1bf223f46
.quad 0x3f0e3f553ec43f6d,0x3f223f463ef13f62,0xbf553f0ebec4bf6d,0xbdc93f7fbf75be95,0xbf0ebf553ec43f6d,0xbf463f223f62bef1,0x3f55bf0ebec4bf6d,0xbf7fbdc9be953f75
.quad 0x3f0e3f553ec43f6d,0xbf22bf46bef1bf62,0xbf553f0ebec4bf6d,0x3dc9bf7f3f753e95,0xbf0ebf553ec43f6d,0x3f46bf22bf623ef1,0x3f55bf0ebec4bf6d,0x3f7f3dc93e95bf75
.quad 0x3f7bbe483f800000,0x3f75be953f7fbdc9,0xbe48bf7b3f800000,0xbf62bef13f22bf46,0xbf7b3e483f800000,0x3e953f75bdc9bf7f,0x3e483f7b3f800000,0x3ef1bf62bf46bf22
.quad 0x3f7bbe483f800000,0xbf753e95bf7f3dc9,0xbe48bf7b3f800000,0x3f623ef1bf223f46,0xbf7b3e483f800000,0xbe95bf753dc93f7f,0x3e483f7b3f800000,0xbef13f623f463f22
.quad 0x3f55bf0e3f6dbec4,0x3f46bf223f62bef1,0x3f0e3f55bf6d3ec4,0x3f7f3dc9be953f75,0xbf553f0e3f6dbec4,0x3f223f46bef1bf62,0xbf0ebf55bf6d3ec4,0xbdc93f7f3f753e95
.quad 0x3f55bf0e3f6dbec4,0xbf463f22bf623ef1,0x3f0e3f55bf6d3ec4,0xbf7fbdc93e95bf75,0xbf553f0e3f6dbec4,0xbf22bf463ef13f62,0xbf0ebf55bf6d3ec4,0x3dc9bf7fbf75be95
.quad 0xbe48bf7b0000bf80,0xbe95bf75bdc9bf7f,0xbf7b3e480000bf80,0xbef13f62bf46bf22,0x3e483f7b0000bf80,0x3f75be95bf7f3dc9,0x3f7bbe480000bf80,0xbf62bef1bf223f46
.quad 0xbe48bf7b0000bf80,0x3e953f753dc93f7f,0xbf7b3e480000bf80,0x3ef1bf623f463f22,0x3e483f7b0000bf80,0xbf753e953f7fbdc9,0x3f7bbe480000bf80,0x3f623ef13f22bf46
.quad 0xbf0ebf55bec4bf6d,0xbf22bf46bef1bf62,0x3f55bf0e3ec43f6d,0x3dc9bf7f3f753e95,0x3f0e3f55bec4bf6d,0x3f46bf22bf623ef1,0xbf553f0e3ec43f6d,0x3f7f3dc93e95bf75
.quad 0xbf0ebf55bec4bf6d,0x3f223f463ef13f62,0x3f55bf0e3ec43f6d,0xbdc93f7fbf75be95,0x3f0e3f55bec4bf6d,0xbf463f223f62bef1,0xbf553f0e3ec43f6d,0xbf7fbdc9be953f75
.quad 0xbf7b3e48bf800000,0xbf753e95bf7f3dc9,0x3e483f7bbf800000,0x3f623ef1bf223f46,0x3f7bbe48bf800000,0xbe95bf753dc93f7f,0xbe48bf7bbf800000,0xbef13f623f463f22
.quad 0xbf7b3e48bf800000,0x3f75be953f7fbdc9,0x3e483f7bbf800000,0xbf62bef13f22bf46,0x3f7bbe48bf800000,0x3e953f75bdc9bf7f,0xbe48bf7bbf800000,0x3ef1bf62bf46bf22
.quad 0xbf553f0ebf6d3ec4,0xbf463f22bf623ef1,0xbf0ebf553f6dbec4,0xbf7fbdc93e95bf75,0x3f55bf0ebf6d3ec4,0xbf22bf463ef13f62,0x3f0e3f553f6dbec4,0x3dc9bf7fbf75be95
.quad 0xbf553f0ebf6d3ec4,0x3f46bf223f62bef1,0xbf0ebf553f6dbec4,0x3f7f3dc9be953f75,0x3f55bf0ebf6d3ec4,0x3f223f46bef1bf62,0x3f0e3f553f6dbec4,0xbdc93f7f3f753e95
.quad 0x3e5b3f7a00003f80,0x3ea33f733ddd3f7f,0x3f7abe5b00003f80,0x3ee4bf653f473f20,0xbe5bbf7a00003f80,0xbf733ea33f7fbddd,0xbf7a3e5b00003f80,0x3f653ee43f20bf47
.quad 0x3e5b3f7a00003f80,0xbea3bf73bdddbf7f,0x3f7abe5b00003f80,0xbee43f65bf47bf20,0xbe5bbf7a00003f80,0x3f73bea3bf7f3ddd,0xbf7a3e5b00003f80,0xbf65bee4bf203f47
.quad 0x3f1b3f4c3ed63f68,0x3f303f3a3f043f5c,0xbf4c3f1bbed6bf68,0xbcf13f80bf78be79,0xbf1bbf4c3ed63f68,0xbf3a3f303f5cbf04,0x3f4cbf1bbed6bf68,0xbf80bcf1be793f78
.quad 0x3f1b3f4c3ed63f68,0xbf30bf3abf04bf5c,0xbf4c3f1bbed6bf68,0x3cf1bf803f783e79,0xbf1bbf4c3ed63f68,0x3f3abf30bf5c3f04,0x3f4cbf1bbed6bf68,0x3f803cf13e79bf78
.quad 0x3f7abe5b3f800000,0x3f73bea33f7fbddd,0xbe5bbf7a3f800000,0xbf65bee43f20bf47,0xbf7a3e5b3f800000,0x3ea33f73bdddbf7f,0x3e5b3f7a3f800000,0x3ee4bf65bf47bf20
.quad 0x3f7abe5b3f800000,0xbf733ea3bf7f3ddd,0xbe5bbf7a3f800000,0x3f653ee4bf203f47,0xbf7a3e5b3f800000,0xbea3bf733ddd3f7f,0x3e5b3f7a3f800000,0xbee43f653f473f20
.quad 0x3f4cbf1b3f68bed6,0x3f3abf303f5cbf04,0x3f1b3f4cbf683ed6,0x3f803cf1be793f78,0xbf4c3f1b3f68bed6,0x3f303f3abf04bf5c,0xbf1bbf4cbf683ed6,0xbcf13f803f783e79
.quad 0x3f4cbf1b3f68bed6,0xbf3a3f30bf5c3f04,0x3f1b3f4cbf683ed6,0xbf80bcf13e79bf78,0xbf4c3f1b3f68bed6,0xbf30bf3a3f043f5c,0xbf1bbf4cbf683ed6,0x3cf1bf80bf78be79
.quad 0xbe5bbf7a0000bf80,0xbea3bf73bdddbf7f,0xbf7a3e5b0000bf80,0xbee43f65bf47bf20,0x3e5b3f7a0000bf80,0x3f73bea3bf7f3ddd,0x3f7abe5b0000bf80,0xbf65bee4bf203f47
.quad 0xbe5bbf7a0000bf80,0x3ea33f733ddd3f7f,0xbf7a3e5b0000bf80,0x3ee4bf653f473f20,0x3e5b3f7a0000bf80,0xbf733ea33f7fbddd,0x3f7abe5b0000bf80,0x3f653ee43f20bf47
.quad 0xbf1bbf4cbed6bf68,0xbf30bf3abf04bf5c,0x3f4cbf1b3ed63f68,0x3cf1bf803f783e79,0x3f1b3f4cbed6bf68,0x3f3abf30bf5c3f04,0xbf4c3f1b3ed63f68,0x3f803cf13e79bf78
.quad 0xbf1bbf4cbed6bf68,0x3f303f3a3f043f5c,0x3f4cbf1b3ed63f68,0xbcf13f80bf78be79,0x3f1b3f4cbed6bf68,0xbf3a3f303f5cbf04,0xbf4c3f1b3ed63f68,0xbf80bcf1be793f78
.quad 0xbf7a3e5bbf800000,0xbf733ea3bf7f3ddd,0x3e5b3f7abf800000,0x3f653ee4bf203f47,0x3f7abe5bbf800000,0xbea3bf733ddd3f7f,0xbe5bbf7abf800000,0xbee43f653f473f20
.quad 0xbf7a3e5bbf800000,0x3f73bea33f7fbddd,0x3e5b3f7abf800000,0xbf65bee43f20bf47,0x3f7abe5bbf800000,0x3ea33f73bdddbf7f,0xbe5bbf7abf800000,0x3ee4bf65bf47bf20
.quad 0xbf4c3f1bbf683ed6,0xbf3a3f30bf5c3f04,0xbf1bbf4c3f68bed6,0xbf80bcf13e79bf78,0x3f4cbf1bbf683ed6,0xbf30bf3a3f043f5c,0x3f1b3f4c3f68bed6,0x3cf1bf80bf78be79
.quad 0xbf4c3f1bbf683ed6,0x3f3abf303f5cbf04,0xbf1bbf4c3f68bed6,0x3f803cf1be793f78,0x3f4cbf1bbf683ed6,0x3f303f3abf04bf5c,0x3f1b3f4c3f68bed6,0xbcf13f803f783e79
.quad 0x3e6f3f7900003f80,0x3eb13f703df13f7e,0x3f79be6f00003f80,0x3ed6bf683f493f1e,0xbe6fbf7900003f80,0xbf703eb13f7ebdf1,0xbf793e6f00003f80,0x3f683ed63f1ebf49
.quad 0x3e6f3f7900003f80,0xbeb1bf70bdf1bf7e,0x3f79be6f00003f80,0xbed63f68bf49bf1e,0xbe6fbf7900003f80,0x3f70beb1bf7e3df1,0xbf793e6f00003f80,0xbf68bed6bf1e3f49
.quad 0x3f263f433ee83f64,0x3f3c3f2e3f0e3f55,0xbf433f26bee8bf64,0x3d213f80bf7bbe48,0xbf26bf433ee83f64,0xbf2e3f3c3f55bf0e,0x3f43bf26bee8bf64,0xbf803d21be483f7b
.quad 0x3f263f433ee83f64,0xbf3cbf2ebf0ebf55,0xbf433f26bee8bf64,0xbd21bf803f7b3e48,0xbf26bf433ee83f64,0x3f2ebf3cbf553f0e,0x3f43bf26bee8bf64,0x3f80bd213e48bf7b
.quad 0x3f79be6f3f800000,0x3f70beb13f7ebdf1,0xbe6fbf793f800000,0xbf68bed63f1ebf49,0xbf793e6f3f800000,0x3eb13f70bdf1bf7e,0x3e6f3f793f800000,0x3ed6bf68bf49bf1e
.quad 0x3f79be6f3f800000,0xbf703eb1bf7e3df1,0xbe6fbf793f800000,0x3f683ed6bf1e3f49,0xbf793e6f3f800000,0xbeb1bf703df13f7e,0x3e6f3f793f800000,0xbed63f683f493f1e
.quad 0x3f43bf263f64bee8,0x3f2ebf3c3f55bf0e,0x3f263f43bf643ee8,0x3f80bd21be483f7b,0xbf433f263f64bee8,0x3f3c3f2ebf0ebf55,0xbf26bf43bf643ee8,0x3d213f803f7b3e48
.quad 0x3f43bf263f64bee8,0xbf2e3f3cbf553f0e,0x3f263f43bf643ee8,0xbf803d213e48bf7b,0xbf433f263f64bee8,0xbf3cbf2e3f0e3f55,0xbf26bf43bf643ee8,0xbd21bf80bf7bbe48
.quad 0xbe6fbf790000bf80,0xbeb1bf70bdf1bf7e,0xbf793e6f0000bf80,0xbed63f68bf49bf1e,0x3e6f3f790000bf80,0x3f70beb1bf7e3df1,0x3f79be6f0000bf80,0xbf68bed6bf1e3f49
.quad 0xbe6fbf790000bf80,0x3eb13f703df13f7e,0xbf793e6f0000bf80,0x3ed6bf683f493f1e,0x3e6f3f790000bf80,0xbf703eb13f7ebdf1,0x3f79be6f0000bf80,0x3f683ed63f1ebf49
.quad 0xbf26bf43bee8bf64,0xbf3cbf2ebf0ebf55,0x3f43bf263ee83f64,0xbd21bf803f7b3e48,0x3f263f43bee8bf64,0x3f2ebf3cbf553f0e,0xbf433f263ee83f64,0x3f80bd213e48bf7b
.quad 0xbf26bf43bee8bf64,0x3f3c3f2e3f0e3f55,0x3f43bf263ee83f64,0x3d213f80bf7bbe48,0x3f263f43bee8bf64,0xbf2e3f3c3f55bf0e,0xbf433f263ee83f64,0xbf803d21be483f7b
.quad 0xbf793e6fbf800000,0xbf703eb1bf7e3df1,0x3e6f3f79bf800000,0x3f683ed6bf1e3f49,0x3f79be6fbf800000,0xbeb1bf703df13f7e,0xbe6fbf79bf800000,0xbed63f683f493f1e
.quad 0xbf793e6fbf800000,0x3f70beb13f7ebdf1,0x3e6f3f79bf800000,0xbf68bed63f1ebf49,0x3f79be6fbf800000,0x3eb13f70bdf1bf7e,0xbe6fbf79bf800000,0x3ed6bf68bf49bf1e
.quad 0xbf433f26bf643ee8,0xbf2e3f3cbf553f0e,0xbf26bf433f64bee8,0xbf803d213e48bf7b,0x3f43bf26bf643ee8,0xbf3cbf2e3f0e3f55,0x3f263f433f64bee8,0xbd21bf80bf7bbe48
.quad 0xbf433f26bf643ee8,0x3f2ebf3c3f55bf0e,0xbf26bf433f64bee8,0x3f80bd21be483f7b,0x3f43bf26bf643ee8,0x3f3c3f2ebf0ebf55,0x3f263f433f64bee8,0x3d213f803f7b3e48
.quad 0x3e813f7800003f80,0x3ebf3f6d3e023f7e,0x3f78be8100003f80,0x3ec9bf6c3f4b3f1d,0xbe81bf7800003f80,0xbf6d3ebf3f7ebe02,0xbf783e8100003f80,0x3f6c3ec93f1dbf4b
.quad 0x3e813f7800003f80,0xbebfbf6dbe02bf7e,0x3f78be8100003f80,0xbec93f6cbf4bbf1d,0xbe81bf7800003f80,0x3f6dbebfbf7e3e02,0xbf783e8100003f80,0xbf6cbec9bf1d3f4b
.quad 0x3f313f393efa3f5f,0x3f473f203f183f4e,0xbf393f31befabf5f,0x3ddd3f7fbf7dbe16,0xbf31bf393efa3f5f,0xbf203f473f4ebf18,0x3f39bf31befabf5f,0xbf7f3dddbe163f7d
.quad 0x3f313f393efa3f5f,0xbf47bf20bf18bf4e,0xbf393f31befabf5f,0xbdddbf7f3f7d3e16,0xbf31bf393efa3f5f,0x3f20bf47bf4e3f18,0x3f39bf31befabf5f,0x3f7fbddd3e16bf7d
.quad 0x3f78be813f800000,0x3f6dbebf3f7ebe02,0xbe81bf783f800000,0xbf6cbec93f1dbf4b,0xbf783e813f800000,0x3ebf3f6dbe02bf7e,0x3e813f783f800000,0x3ec9bf6cbf4bbf1d
.quad 0x3f78be813f800000,0xbf6d3ebfbf7e3e02,0xbe81bf783f800000,0x3f6c3ec9bf1d3f4b,0xbf783e813f800000,0xbebfbf6d3e023f7e,0x3e813f783f800000,0xbec93f6c3f4b3f1d
.quad 0x3f39bf313f5fbefa,0x3f20bf473f4ebf18,0x3f313f39bf5f3efa,0x3f7fbdddbe163f7d,0xbf393f313f5fbefa,0x3f473f20bf18bf4e,0xbf31bf39bf5f3efa,0x3ddd3f7f3f7d3e16
.quad 0x3f39bf313f5fbefa,0xbf203f47bf4e3f18,0x3f313f39bf5f3efa,0xbf7f3ddd3e16bf7d,0xbf393f313f5fbefa,0xbf47bf203f183f4e,0xbf31bf39bf5f3efa,0xbdddbf7fbf7dbe16
.quad 0xbe81bf780000bf80,0xbebfbf6dbe02bf7e,0xbf783e810000bf80,0xbec93f6cbf4bbf1d,0x3e813f780000bf80,0x3f6dbebfbf7e3e02,0x3f78be810000bf80,0xbf6cbec9bf1d3f4b
.quad 0xbe81bf780000bf80,0x3ebf3f6d3e023f7e,0xbf783e810000bf80,0x3ec9bf6c3f4b3f1d,0x3e813f780000bf80,0xbf6d3ebf3f7ebe02,0x3f78be810000bf80,0x3f6c3ec93f1dbf4b
.quad 0xbf31bf39befabf5f,0xbf47bf20bf18bf4e,0x3f39bf313efa3f5f,0xbdddbf7f3f7d3e16,0x3f313f39befabf5f,0x3f20bf47bf4e3f18,0xbf393f313efa3f5f,0x3f7fbddd3e16bf7d
.quad 0xbf31bf39befabf5f,0x3f473f203f183f4e,0x3f39bf313efa3f5f,0x3ddd3f7fbf7dbe16,0x3f313f39befabf5f,0xbf203f473f4ebf18,0xbf393f313efa3f5f,0xbf7f3dddbe163f7d
.quad 0xbf783e81bf800000,0xbf6d3ebfbf7e3e02,0x3e813f78bf800000,0x3f6c3ec9bf1d3f4b,0x3f78be81bf800000,0xbebfbf6d3e023f7e,0xbe81bf78bf800000,0xbec93f6c3f4b3f1d
.quad 0xbf783e81bf800000,0x3f6dbebf3f7ebe02,0x3e813f78bf800000,0xbf6cbec93f1dbf4b,0x3f78be81bf800000,0x3ebf3f6dbe02bf7e,0xbe81bf78bf800000,0x3ec9bf6cbf4bbf1d
.quad 0xbf393f31bf5f3efa,0xbf203f47bf4e3f18,0xbf31bf393f5fbefa,0xbf7f3ddd3e16bf7d,0x3f39bf31bf5f3efa,0xbf47bf203f183f4e,0x3f313f393f5fbefa,0xbdddbf7fbf7dbe16
.quad 0xbf393f31bf5f3efa,0x3f20bf473f4ebf18,0xbf31bf393f5fbefa,0x3f7fbdddbe163f7d,0x3f39bf31bf5f3efa,0x3f473f20bf18bf4e,0x3f313f393f5fbefa,0x3ddd3f7f3f7d3e16
.quad 0x3e8b3f7600003f80,0x3ecd3f6b3e0c3f7e,0x3f76be8b00003f80,0x3ebbbf6e3f4c3f1b,0xbe8bbf7600003f80,0xbf6b3ecd3f7ebe0c,0xbf763e8b00003f80,0x3f6e3ebb3f1bbf4c
.quad 0x3e8b3f7600003f80,0xbecdbf6bbe0cbf7e,0x3f76be8b00003f80,0xbebb3f6ebf4cbf1b,0xbe8bbf7600003f80,0x3f6bbecdbf7e3e0c,0xbf763e8b00003f80,0xbf6ebebbbf1b3f4c
.quad 0x3f3c3f2e3f063f5a,0x3f523f123f223f46,0xbf2e3f3cbf06bf5a,0x3e343f7cbf7fbdc9,0xbf3cbf2e3f063f5a,0xbf123f523f46bf22,0x3f2ebf3cbf06bf5a,0xbf7c3e34bdc93f7f
.quad 0x3f3c3f2e3f063f5a,0xbf52bf12bf22bf46,0xbf2e3f3cbf06bf5a,0xbe34bf7c3f7f3dc9,0xbf3cbf2e3f063f5a,0x3f12bf52bf463f22,0x3f2ebf3cbf06bf5a,0x3f7cbe343dc9bf7f
.quad 0x3f76be8b3f800000,0x3f6bbecd3f7ebe0c,0xbe8bbf763f800000,0xbf6ebebb3f1bbf4c,0xbf763e8b3f800000,0x3ecd3f6bbe0cbf7e,0x3e8b3f763f800000,0x3ebbbf6ebf4cbf1b
.quad 0x3f76be8b3f800000,0xbf6b3ecdbf7e3e0c,0xbe8bbf763f800000,0x3f6e3ebbbf1b3f4c,0xbf763e8b3f800000,0xbecdbf6b3e0c3f7e,0x3e8b3f763f800000,0xbebb3f6e3f4c3f1b
.quad 0x3f2ebf3c3f5abf06,0x3f12bf523f46bf22,0x3f3c3f2ebf5a3f06,0x3f7cbe34bdc93f7f,0xbf2e3f3c3f5abf06,0x3f523f12bf22bf46,0xbf3cbf2ebf5a3f06,0x3e343f7c3f7f3dc9
.quad 0x3f2ebf3c3f5abf06,0xbf123f52bf463f22,0x3f3c3f2ebf5a3f06,0xbf7c3e343dc9bf7f,0xbf2e3f3c3f5abf06,0xbf52bf123f223f46,0xbf3cbf2ebf5a3f06,0xbe34bf7cbf7fbdc9
.quad 0xbe8bbf760000bf80,0xbecdbf6bbe0cbf7e,0xbf763e8b0000bf80,0xbebb3f6ebf4cbf1b,0x3e8b3f760000bf80,0x3f6bbecdbf7e3e0c,0x3f76be8b0000bf80,0xbf6ebebbbf1b3f4c
.quad 0xbe8bbf760000bf80,0x3ecd3f6b3e0c3f7e,0xbf763e8b0000bf80,0x3ebbbf6e3f4c3f1b,0x3e8b3f760000bf80,0xbf6b3ecd3f7ebe0c,0x3f76be8b0000bf80,0x3f6e3ebb3f1bbf4c
.quad 0xbf3cbf2ebf06bf5a,0xbf52bf12bf22bf46,0x3f2ebf3c3f063f5a,0xbe34bf7c3f7f3dc9,0x3f3c3f2ebf06bf5a,0x3f12bf52bf463f22,0xbf2e3f3c3f063f5a,0x3f7cbe343dc9bf7f
.quad 0xbf3cbf2ebf06bf5a,0x3f523f123f223f46,0x3f2ebf3c3f063f5a,0x3e343f7cbf7fbdc9,0x3f3c3f2ebf06bf5a,0xbf123f523f46bf22,0xbf2e3f3c3f063f5a,0xbf7c3e34bdc93f7f
.quad 0xbf763e8bbf800000,0xbf6b3ecdbf7e3e0c,0x3e8b3f76bf800000,0x3f6e3ebbbf1b3f4c,0x3f76be8bbf800000,0xbecdbf6b3e0c3f7e,0xbe8bbf76bf800000,0xbebb3f6e3f4c3f1b
.quad 0xbf763e8bbf800000,0x3f6bbecd3f7ebe0c,0x3e8b3f76bf800000,0xbf6ebebb3f1bbf4c,0x3f76be8bbf800000,0x3ecd3f6bbe0cbf7e,0xbe8bbf76bf800000,0x3ebbbf6ebf4cbf1b
.quad 0xbf2e3f3cbf5a3f06,0xbf123f52bf463f22,0xbf3cbf2e3f5abf06,0xbf7c3e343dc9bf7f,0x3f2ebf3cbf5a3f06,0xbf52bf123f223f46,0x3f3c3f2e3f5abf06,0xbe34bf7cbf7fbdc9
.quad 0xbf2e3f3cbf5a3f06,0x3f12bf523f46bf22,0xbf3cbf2e3f5abf06,0x3f7cbe34bdc93f7f,0x3f2ebf3cbf5a3f06,0x3f523f12bf22bf46,0x3f3c3f2e3f5abf06,0x3e343f7c3f7f3dc9
.quad 0x3e953f7500003f80,0x3edb3f673e163f7d,0x3f75be9500003f80,0x3eacbf713f4e3f18,0xbe95bf7500003f80,0xbf673edb3f7dbe16,0xbf753e9500003f80,0x3f713eac3f18bf4e
.quad 0x3e953f7500003f80,0xbedbbf67be16bf7d,0x3f75be9500003f80,0xbeac3f71bf4ebf18,0xbe95bf7500003f80,0x3f67bedbbf7d3e16,0xbf753e9500003f80,0xbf71beacbf183f4e
.quad 0x3f463f223f0e3f55,0x3f5c3f043f2c3f3e,0xbf223f46bf0ebf55,0x3e793f78bf80bd49,0xbf46bf223f0e3f55,0xbf043f5c3f3ebf2c,0x3f22bf46bf0ebf55,0xbf783e79bd493f80
.quad 0x3f463f223f0e3f55,0xbf5cbf04bf2cbf3e,0xbf223f46bf0ebf55,0xbe79bf783f803d49,0xbf46bf223f0e3f55,0x3f04bf5cbf3e3f2c,0x3f22bf46bf0ebf55,0x3f78be793d49bf80
.quad 0x3f75be953f800000,0x3f67bedb3f7dbe16,0xbe95bf753f800000,0xbf71beac3f18bf4e,0xbf753e953f800000,0x3edb3f67be16bf7d,0x3e953f753f800000,0x3eacbf71bf4ebf18
.quad 0x3f75be953f800000,0xbf673edbbf7d3e16,0xbe95bf753f800000,0x3f713eacbf183f4e,0xbf753e953f800000,0xbedbbf673e163f7d,0x3e953f753f800000,0xbeac3f713f4e3f18
.quad 0x3f22bf463f55bf0e,0x3f04bf5c3f3ebf2c,0x3f463f22bf553f0e,0x3f78be79bd493f80,0xbf223f463f55bf0e,0x3f5c3f04bf2cbf3e,0xbf46bf22bf553f0e,0x3e793f783f803d49
.quad 0x3f22bf463f55bf0e,0xbf043f5cbf3e3f2c,0x3f463f22bf553f0e,0xbf783e793d49bf80,0xbf223f463f55bf0e,0xbf5cbf043f2c3f3e,0xbf46bf22bf553f0e,0xbe79bf78bf80bd49
.quad 0xbe95bf750000bf80,0xbedbbf67be16bf7d,0xbf753e950000bf80,0xbeac3f71bf4ebf18,0x3e953f750000bf80,0x3f67bedbbf7d3e16,0x3f75be950000bf80,0xbf71beacbf183f4e
.quad 0xbe95bf750000bf80,0x3edb3f673e163f7d,0xbf753e950000bf80,0x3eacbf713f4e3f18,0x3e953f750000bf80,0xbf673edb3f7dbe16,0x3f75be950000bf80,0x3f713eac3f18bf4e
.quad 0xbf46bf22bf0ebf55,0xbf5cbf04bf2cbf3e,0x3f22bf463f0e3f55,0xbe79bf783f803d49,0x3f463f22bf0ebf55,0x3f04bf5cbf3e3f2c,0xbf223f463f0e3f55,0x3f78be793d49bf80
.quad 0xbf46bf22bf0ebf55,0x3f5c3f043f2c3f3e,0x3f22bf463f0e3f55,0x3e793f78bf80bd49,0x3f463f22bf0ebf55,0xbf043f5c3f3ebf2c,0xbf223f463f0e3f55,0xbf783e79bd493f80
.quad 0xbf753e95bf800000,0xbf673edbbf7d3e16,0x3e953f75bf800000,0x3f713eacbf183f4e,0x3f75be95bf800000,0xbedbbf673e163f7d,0xbe95bf75bf800000,0xbeac3f713f4e3f18
.quad 0xbf753e95bf800000,0x3f67bedb3f7dbe16,0x3e953f75bf800000,0xbf71beac3f18bf4e,0x3f75be95bf800000,0x3edb3f67be16bf7d,0xbe95bf75bf800000,0x3eacbf71bf4ebf18
.quad 0xbf223f46bf553f0e,0xbf043f5cbf3e3f2c,0xbf46bf223f55bf0e,0xbf783e793d49bf80,0x3f22bf46bf553f0e,0xbf5cbf043f2c3f3e,0x3f463f223f55bf0e,0xbe79bf78bf80bd49
.quad 0xbf223f46bf553f0e,0x3f04bf5c3f3ebf2c,0xbf46bf223f55bf0e,0x3f78be79bd493f80,0x3f22bf46bf553f0e,0x3f5c3f04bf2cbf3e,0x3f463f223f55bf0e,0x3e793f783f803d49
.quad 0x3e9e3f7300003f80,0x3ee83f643e203f7d,0x3f73be9e00003f80,0x3e9ebf733f4f3f16,0xbe9ebf7300003f80,0xbf643ee83f7dbe20,0xbf733e9e00003f80,0x3f733e9e3f16bf4f
.quad 0x3e9e3f7300003f80,0xbee8bf64be20bf7d,0x3f73be9e00003f80,0xbe9e3f73bf4fbf16,0xbe9ebf7300003f80,0x3f64bee8bf7d3e20,0xbf733e9e00003f80,0xbf73be9ebf163f4f
.quad 0x3f4f3f163f163f4f,0x3f643ee83f353f35,0xbf163f4fbf16bf4f,0x3e9e3f73bf800000,0xbf4fbf163f163f4f,0xbee83f643f35bf35,0x3f16bf4fbf16bf4f,0xbf733e9e00003f80
.quad 0x3f4f3f163f163f4f,0xbf64bee8bf35bf35,0xbf163f4fbf16bf4f,0xbe9ebf733f800000,0xbf4fbf163f163f4f,0x3ee8bf64bf353f35,0x3f16bf4fbf16bf4f,0x3f73be9e0000bf80
.quad 0x3f73be9e3f800000,0x3f64bee83f7dbe20,0xbe9ebf733f800000,0xbf73be9e3f16bf4f,0xbf733e9e3f800000,0x3ee83f64be20bf7d,0x3e9e3f733f800000,0x3e9ebf73bf4fbf16
.quad 0x3f73be9e3f800000,0xbf643ee8bf7d3e20,0xbe9ebf733f800000,0x3f733e9ebf163f4f,0xbf733e9e3f800000,0xbee8bf643e203f7d,0x3e9e3f733f800000,0xbe9e3f733f4f3f16
.quad 0x3f16bf4f3f4fbf16,0x3ee8bf643f35bf35,0x3f4f3f16bf4f3f16,0x3f73be9e00003f80,0xbf163f4f3f4fbf16,0x3f643ee8bf35bf35,0xbf4fbf16bf4f3f16,0x3e9e3f733f800000
.quad 0x3f16bf4f3f4fbf16,0xbee83f64bf353f35,0x3f4f3f16bf4f3f16,0xbf733e9e0000bf80,0xbf163f4f3f4fbf16,0xbf64bee83f353f35,0xbf4fbf16bf4f3f16,0xbe9ebf73bf800000
.quad 0xbe9ebf730000bf80,0xbee8bf64be20bf7d,0xbf733e9e0000bf80,0xbe9e3f73bf4fbf16,0x3e9e3f730000bf80,0x3f64bee8bf7d3e20,0x3f73be9e0000bf80,0xbf73be9ebf163f4f
.quad 0xbe9ebf730000bf80,0x3ee83f643e203f7d,0xbf733e9e0000bf80,0x3e9ebf733f4f3f16,0x3e9e3f730000bf80,0xbf643ee83f7dbe20,0x3f73be9e0000bf80,0x3f733e9e3f16bf4f
.quad 0xbf4fbf16bf16bf4f,0xbf64bee8bf35bf35,0x3f16bf4f3f163f4f,0xbe9ebf733f800000,0x3f4f3f16bf16bf4f,0x3ee8bf64bf353f35,0xbf163f4f3f163f4f,0x3f73be9e0000bf80
.quad 0xbf4fbf16bf16bf4f,0x3f643ee83f353f35,0x3f16bf4f3f163f4f,0x3e9e3f73bf800000,0x3f4f3f16bf16bf4f,0xbee83f643f35bf35,0xbf163f4f3f163f4f,0xbf733e9e00003f80
.quad 0xbf733e9ebf800000,0xbf643ee8bf7d3e20,0x3e9e3f73bf800000,0x3f733e9ebf163f4f,0x3f73be9ebf800000,0xbee8bf643e203f7d,0xbe9ebf73bf800000,0xbe9e3f733f4f3f16
.quad 0xbf733e9ebf800000,0x3f64bee83f7dbe20,0x3e9e3f73bf800000,0xbf73be9e3f16bf4f,0x3f73be9ebf800000,0x3ee83f64be20bf7d,0xbe9ebf73bf800000,0x3e9ebf73bf4fbf16
.quad 0xbf163f4fbf4f3f16,0xbee83f64bf353f35,0xbf4fbf163f4fbf16,0xbf733e9e0000bf80,0x3f16bf4fbf4f3f16,0xbf64bee83f353f35,0x3f4f3f163f4fbf16,0xbe9ebf73bf800000
.quad 0xbf163f4fbf4f3f16,0x3ee8bf643f35bf35,0xbf4fbf163f4fbf16,0x3f73be9e00003f80,0x3f16bf4fbf4f3f16,0x3f643ee8bf35bf35,0x3f4f3f163f4fbf16,0x3e9e3f733f800000
.quad 0x3ea83f7200003f80,0x3ef63f613e2a3f7c,0x3f72bea800003f80,0x3e90bf763f513f14,0xbea8bf7200003f80,0xbf613ef63f7cbe2a,0xbf723ea800003f80,0x3f763e903f14bf51
.quad 0x3ea83f7200003f80,0xbef6bf61be2abf7c,0x3f72bea800003f80,0xbe903f76bf51bf14,0xbea8bf7200003f80,0x3f61bef6bf7c3e2a,0xbf723ea800003f80,0xbf76be90bf143f51
.quad 0x3f583f0a3f1e3f49,0x3f6c3ec93f3e3f2c,0xbf0a3f58bf1ebf49,0x3ebf3f6dbf803d49,0xbf58bf0a3f1e3f49,0xbec93f6c3f2cbf3e,0x3f0abf58bf1ebf49,0xbf6d3ebf3d493f80
.quad 0x3f583f0a3f1e3f49,0xbf6cbec9bf3ebf2c,0xbf0a3f58bf1ebf49,0xbebfbf6d3f80bd49,0xbf58bf0a3f1e3f49,0x3ec9bf6cbf2c3f3e,0x3f0abf58bf1ebf49,0x3f6dbebfbd49bf80
.quad 0x3f72bea83f800000,0x3f61bef63f7cbe2a,0xbea8bf723f800000,0xbf76be903f14bf51,0xbf723ea83f800000,0x3ef63f61be2abf7c,0x3ea83f723f800000,0x3e90bf76bf51bf14
.quad 0x3f72bea83f800000,0xbf613ef6bf7c3e2a,0xbea8bf723f800000,0x3f763e90bf143f51,0xbf723ea83f800000,0xbef6bf613e2a3f7c,0x3ea83f723f800000,0xbe903f763f513f14
.quad 0x3f0abf583f49bf1e,0x3ec9bf6c3f2cbf3e,0x3f583f0abf493f1e,0x3f6dbebf3d493f80,0xbf0a3f583f49bf1e,0x3f6c3ec9bf3ebf2c,0xbf58bf0abf493f1e,0x3ebf3f6d3f80bd49
.quad 0x3f0abf583f49bf1e,0xbec93f6cbf2c3f3e,0x3f583f0abf493f1e,0xbf6d3ebfbd49bf80,0xbf0a3f583f49bf1e,0xbf6cbec93f3e3f2c,0xbf58bf0abf493f1e,0xbebfbf6dbf803d49
.quad 0xbea8bf720000bf80,0xbef6bf61be2abf7c,0xbf723ea80000bf80,0xbe903f76bf51bf14,0x3ea83f720000bf80,0x3f61bef6bf7c3e2a,0x3f72bea80000bf80,0xbf76be90bf143f51
.quad 0xbea8bf720000bf80,0x3ef63f613e2a3f7c,0xbf723ea80000bf80,0x3e90bf763f513f14,0x3ea83f720000bf80,0xbf613ef63f7cbe2a,0x3f72bea80000bf80,0x3f763e903f14bf51
.quad 0xbf58bf0abf1ebf49,0xbf6cbec9bf3ebf2c,0x3f0abf583f1e3f49,0xbebfbf6d3f80bd49,0x3f583f0abf1ebf49,0x3ec9bf6cbf2c3f3e,0xbf0a3f583f1e3f49,0x3f6dbebfbd49bf80
.quad 0xbf58bf0abf1ebf49,0x3f6c3ec93f3e3f2c,0x3f0abf583f1e3f49,0x3ebf3f6dbf803d49,0x3f583f0abf1ebf49,0xbec93f6c3f2cbf3e,0xbf0a3f583f1e3f49,0xbf6d3ebf3d493f80
.quad 0xbf723ea8bf800000,0xbf613ef6bf7c3e2a,0x3ea83f72bf800000,0x3f763e90bf143f51,0x3f72bea8bf800000,0xbef6bf613e2a3f7c,0xbea8bf72bf800000,0xbe903f763f513f14
.quad 0xbf723ea8bf800000,0x3f61bef63f7cbe2a,0x3ea83f72bf800000,0xbf76be903f14bf51,0x3f72bea8bf800000,0x3ef63f61be2abf7c,0xbea8bf72bf800000,0x3e90bf76bf51bf14
.quad 0xbf0a3f58bf493f1e,0xbec93f6cbf2c3f3e,0xbf58bf0a3f49bf1e,0xbf6d3ebfbd49bf80,0x3f0abf58bf493f1e,0xbf6cbec93f3e3f2c,0x3f583f0a3f49bf1e,0xbebfbf6dbf803d49
.quad 0xbf0a3f58bf493f1e,0x3ec9bf6c3f2cbf3e,0xbf58bf0a3f49bf1e,0x3f6dbebf3d493f80,0x3f0abf58bf493f1e,0x3f6c3ec9bf3ebf2c,0x3f583f0a3f49bf1e,0x3ebf3f6d3f80bd49
.quad 0x3eb13f7000003f80,0x3f013f5d3e343f7c,0x3f70beb100003f80,0x3e81bf783f523f12,0xbeb1bf7000003f80,0xbf5d3f013f7cbe34,0xbf703eb100003f80,0x3f783e813f12bf52
.quad 0x3eb13f7000003f80,0xbf01bf5dbe34bf7c,0x3f70beb100003f80,0xbe813f78bf52bf12,0xbeb1bf7000003f80,0x3f5dbf01bf7c3e34,0xbf703eb100003f80,0xbf78be81bf123f52
.quad 0x3f5f3efa3f263f43,0x3f723ea83f463f22,0xbefa3f5fbf26bf43,0x3edf3f66bf7f3dc9,0xbf5fbefa3f263f43,0xbea83f723f22bf46,0x3efabf5fbf26bf43,0xbf663edf3dc93f7f
.quad 0x3f5f3efa3f263f43,0xbf72bea8bf46bf22,0xbefa3f5fbf26bf43,0xbedfbf663f7fbdc9,0xbf5fbefa3f263f43,0x3ea8bf72bf223f46,0x3efabf5fbf26bf43,0x3f66bedfbdc9bf7f
.quad 0x3f70beb13f800000,0x3f5dbf013f7cbe34,0xbeb1bf703f800000,0xbf78be813f12bf52,0xbf703eb13f800000,0x3f013f5dbe34bf7c,0x3eb13f703f800000,0x3e81bf78bf52bf12
.quad 0x3f70beb13f800000,0xbf5d3f01bf7c3e34,0xbeb1bf703f800000,0x3f783e81bf123f52,0xbf703eb13f800000,0xbf01bf5d3e343f7c,0x3eb13f703f800000,0xbe813f783f523f12
.quad 0x3efabf5f3f43bf26,0x3ea8bf723f22bf46,0x3f5f3efabf433f26,0x3f66bedf3dc93f7f,0xbefa3f5f3f43bf26,0x3f723ea8bf46bf22,0xbf5fbefabf433f26,0x3edf3f663f7fbdc9
.quad 0x3efabf5f3f43bf26,0xbea83f72bf223f46,0x3f5f3efabf433f26,0xbf663edfbdc9bf7f,0xbefa3f5f3f43bf26,0xbf72bea83f463f22,0xbf5fbefabf433f26,0xbedfbf66bf7f3dc9
.quad 0xbeb1bf700000bf80,0xbf01bf5dbe34bf7c,0xbf703eb10000bf80,0xbe813f78bf52bf12,0x3eb13f700000bf80,0x3f5dbf01bf7c3e34,0x3f70beb10000bf80,0xbf78be81bf123f52
.quad 0xbeb1bf700000bf80,0x3f013f5d3e343f7c,0xbf703eb10000bf80,0x3e81bf783f523f12,0x3eb13f700000bf80,0xbf5d3f013f7cbe34,0x3f70beb10000bf80,0x3f783e813f12bf52
.quad 0xbf5fbefabf26bf43,0xbf72bea8bf46bf22,0x3efabf5f3f263f43,0xbedfbf663f7fbdc9,0x3f5f3efabf26bf43,0x3ea8bf72bf223f46,0xbefa3f5f3f263f43,0x3f66bedfbdc9bf7f
.quad 0xbf5fbefabf26bf43,0x3f723ea83f463f22,0x3efabf5f3f263f43,0x3edf3f66bf7f3dc9,0x3f5f3efabf26bf43,0xbea83f723f22bf46,0xbefa3f5f3f263f43,0xbf663edf3dc93f7f
.quad 0xbf703eb1bf800000,0xbf5d3f01bf7c3e34,0x3eb13f70bf800000,0x3f783e81bf123f52,0x3f70beb1bf800000,0xbf01bf5d3e343f7c,0xbeb1bf70bf800000,0xbe813f783f523f12
.quad 0xbf703eb1bf800000,0x3f5dbf013f7cbe34,0x3eb13f70bf800000,0xbf78be813f12bf52,0x3f70beb1bf800000,0x3f013f5dbe34bf7c,0xbeb1bf70bf800000,0x3e81bf78bf52bf12
.quad 0xbefa3f5fbf433f26,0xbea83f72bf223f46,0xbf5fbefa3f43bf26,0xbf663edfbdc9bf7f,0x3efabf5fbf433f26,0xbf72bea83f463f22,0x3f5f3efa3f43bf26,0xbedfbf66bf7f3dc9
.quad 0xbefa3f5fbf433f26,0x3ea8bf723f22bf46,0xbf5fbefa3f43bf26,0x3f66bedf3dc93f7f,0x3efabf5fbf433f26,0x3f723ea8bf46bf22,0x3f5f3efa3f43bf26,0x3edf3f663f7fbdc9
.quad 0x3ebb3f6e00003f80,0x3f083f593e3e3f7c,0x3f6ebebb00003f80,0x3e65bf7a3f533f10,0xbebbbf6e00003f80,0xbf593f083f7cbe3e,0xbf6e3ebb00003f80,0x3f7a3e653f10bf53
.quad 0x3ebb3f6e00003f80,0xbf08bf59be3ebf7c,0x3f6ebebb00003f80,0xbe653f7abf53bf10,0xbebbbf6e00003f80,0x3f59bf08bf7c3e3e,0xbf6e3ebb00003f80,0xbf7abe65bf103f53
.quad 0x3f663edf3f2e3f3c,0x3f773e863f4e3f18,0xbedf3f66bf2ebf3c,0x3eff3f5ebf7d3e16,0xbf66bedf3f2e3f3c,0xbe863f773f18bf4e,0x3edfbf66bf2ebf3c,0xbf5e3eff3e163f7d
.quad 0x3f663edf3f2e3f3c,0xbf77be86bf4ebf18,0xbedf3f66bf2ebf3c,0xbeffbf5e3f7dbe16,0xbf66bedf3f2e3f3c,0x3e86bf77bf183f4e,0x3edfbf66bf2ebf3c,0x3f5ebeffbe16bf7d
.quad 0x3f6ebebb3f800000,0x3f59bf083f7cbe3e,0xbebbbf6e3f800000,0xbf7abe653f10bf53,0xbf6e3ebb3f800000,0x3f083f59be3ebf7c,0x3ebb3f6e3f800000,0x3e65bf7abf53bf10
.quad 0x3f6ebebb3f800000,0xbf593f08bf7c3e3e,0xbebbbf6e3f800000,0x3f7a3e65bf103f53,0xbf6e3ebb3f800000,0xbf08bf593e3e3f7c,0x3ebb3f6e3f800000,0xbe653f7a3f533f10
.quad 0x3edfbf663f3cbf2e,0x3e86bf773f18bf4e,0x3f663edfbf3c3f2e,0x3f5ebeff3e163f7d,0xbedf3f663f3cbf2e,0x3f773e86bf4ebf18,0xbf66bedfbf3c3f2e,0x3eff3f5e3f7dbe16
.quad 0x3edfbf663f3cbf2e,0xbe863f77bf183f4e,0x3f663edfbf3c3f2e,0xbf5e3effbe16bf7d,0xbedf3f663f3cbf2e,0xbf77be863f4e3f18,0xbf66bedfbf3c3f2e,0xbeffbf5ebf7d3e16
.quad 0xbebbbf6e0000bf80,0xbf08bf59be3ebf7c,0xbf6e3ebb0000bf80,0xbe653f7abf53bf10,0x3ebb3f6e0000bf80,0x3f59bf08bf7c3e3e,0x3f6ebebb0000bf80,0xbf7abe65bf103f53
.quad 0xbebbbf6e0000bf80,0x3f083f593e3e3f7c,0xbf6e3ebb0000bf80,0x3e65bf7a3f533f10,0x3ebb3f6e0000bf80,0xbf593f083f7cbe3e,0x3f6ebebb0000bf80,0x3f7a3e653f10bf53
.quad 0xbf66bedfbf2ebf3c,0xbf77be86bf4ebf18,0x3edfbf663f2e3f3c,0xbeffbf5e3f7dbe16,0x3f663edfbf2ebf3c,0x3e86bf77bf183f4e,0xbedf3f663f2e3f3c,0x3f5ebeffbe16bf7d
.quad 0xbf66bedfbf2ebf3c,0x3f773e863f4e3f18,0x3edfbf663f2e3f3c,0x3eff3f5ebf7d3e16,0x3f663edfbf2ebf3c,0xbe863f773f18bf4e,0xbedf3f663f2e3f3c,0xbf5e3eff3e163f7d
.quad 0xbf6e3ebbbf800000,0xbf593f08bf7c3e3e,0x3ebb3f6ebf800000,0x3f7a3e65bf103f53,0x3f6ebebbbf800000,0xbf08bf593e3e3f7c,0xbebbbf6ebf800000,0xbe653f7a3f533f10
.quad 0xbf6e3ebbbf800000,0x3f59bf083f7cbe3e,0x3ebb3f6ebf800000,0xbf7abe653f10bf53,0x3f6ebebbbf800000,0x3f083f59be3ebf7c,0xbebbbf6ebf800000,0x3e65bf7abf53bf10
.quad 0xbedf3f66bf3c3f2e,0xbe863f77bf183f4e,0xbf66bedf3f3cbf2e,0xbf5e3effbe16bf7d,0x3edfbf66bf3c3f2e,0xbf77be863f4e3f18,0x3f663edf3f3cbf2e,0xbeffbf5ebf7d3e16
.quad 0xbedf3f66bf3c3f2e,0x3e86bf773f18bf4e,0xbf66bedf3f3cbf2e,0x3f5ebeff3e163f7d,0x3edfbf66bf3c3f2e,0x3f773e86bf4ebf18,0x3f663edf3f3cbf2e,0x3eff3f5e3f7dbe16
.quad 0x3ec43f6d00003f80,0x3f0e3f553e483f7b,0x3f6dbec400003f80,0x3e48bf7b3f553f0e,0xbec4bf6d00003f80,0xbf553f0e3f7bbe48,0xbf6d3ec400003f80,0x3f7b3e483f0ebf55
.quad 0x3ec43f6d00003f80,0xbf0ebf55be48bf7b,0x3f6dbec400003f80,0xbe483f7bbf55bf0e,0xbec4bf6d00003f80,0x3f55bf0ebf7b3e48,0xbf6d3ec400003f80,0xbf7bbe48bf0e3f55
.quad 0x3f6d3ec43f353f35,0x3f7b3e483f553f0e,0xbec43f6dbf35bf35,0x3f0e3f55bf7b3e48,0xbf6dbec43f353f35,0xbe483f7b3f0ebf55,0x3ec4bf6dbf35bf35,0xbf553f0e3e483f7b
.quad 0x3f6d3ec43f353f35,0xbf7bbe48bf55bf0e,0xbec43f6dbf35bf35,0xbf0ebf553f7bbe48,0xbf6dbec43f353f35,0x3e48bf7bbf0e3f55,0x3ec4bf6dbf35bf35,0x3f55bf0ebe48bf7b
.quad 0x3f6dbec43f800000,0x3f55bf0e3f7bbe48,0xbec4bf6d3f800000,0xbf7bbe483f0ebf55,0xbf6d3ec43f800000,0x3f0e3f55be48bf7b,0x3ec43f6d3f800000,0x3e48bf7bbf55bf0e
.quad 0x3f6dbec43f800000,0xbf553f0ebf7b3e48,0xbec4bf6d3f800000,0x3f7b3e48bf0e3f55,0xbf6d3ec43f800000,0xbf0ebf553e483f7b,0x3ec43f6d3f800000,0xbe483f7b3f553f0e
.quad 0x3ec4bf6d3f35bf35,0x3e48bf7b3f0ebf55,0x3f6d3ec4bf353f35,0x3f55bf0e3e483f7b,0xbec43f6d3f35bf35,0x3f7b3e48bf55bf0e,0xbf6dbec4bf353f35,0x3f0e3f553f7bbe48
.quad 0x3ec4bf6d3f35bf35,0xbe483f7bbf0e3f55,0x3f6d3ec4bf353f35,0xbf553f0ebe48bf7b,0xbec43f6d3f35bf35,0xbf7bbe483f553f0e,0xbf6dbec4bf353f35,0xbf0ebf55bf7b3e48
.quad 0xbec4bf6d0000bf80,0xbf0ebf55be48bf7b,0xbf6d3ec40000bf80,0xbe483f7bbf55bf0e,0x3ec43f6d0000bf80,0x3f55bf0ebf7b3e48,0x3f6dbec40000bf80,0xbf7bbe48bf0e3f55
.quad 0xbec4bf6d0000bf80,0x3f0e3f553e483f7b,0xbf6d3ec40000bf80,0x3e48bf7b3f553f0e,0x3ec43f6d0000bf80,0xbf553f0e3f7bbe48,0x3f6dbec40000bf80,0x3f7b3e483f0ebf55
.quad 0xbf6dbec4bf35bf35,0xbf7bbe48bf55bf0e,0x3ec4bf6d3f353f35,0xbf0ebf553f7bbe48,0x3f6d3ec4bf35bf35,0x3e48bf7bbf0e3f55,0xbec43f6d3f353f35,0x3f55bf0ebe48bf7b
.quad 0xbf6dbec4bf35bf35,0x3f7b3e483f553f0e,0x3ec4bf6d3f353f35,0x3f0e3f55bf7b3e48,0x3f6d3ec4bf35bf35,0xbe483f7b3f0ebf55,0xbec43f6d3f353f35,0xbf553f0e3e483f7b
.quad 0xbf6d3ec4bf800000,0xbf553f0ebf7b3e48,0x3ec43f6dbf800000,0x3f7b3e48bf0e3f55,0x3f6dbec4bf800000,0xbf0ebf553e483f7b,0xbec4bf6dbf800000,0xbe483f7b3f553f0e
.quad 0xbf6d3ec4bf800000,0x3f55bf0e3f7bbe48,0x3ec43f6dbf800000,0xbf7bbe483f0ebf55,0x3f6dbec4bf800000,0x3f0e3f55be48bf7b,0xbec4bf6dbf800000,0x3e48bf7bbf55bf0e
.quad 0xbec43f6dbf353f35,0xbe483f7bbf0e3f55,0xbf6dbec43f35bf35,0xbf553f0ebe48bf7b,0x3ec4bf6dbf353f35,0xbf7bbe483f553f0e,0x3f6d3ec43f35bf35,0xbf0ebf55bf7b3e48
.quad 0xbec43f6dbf353f35,0x3e48bf7b3f0ebf55,0xbf6dbec43f35bf35,0x3f55bf0e3e483f7b,0x3ec4bf6dbf353f35,0x3f7b3e48bf55bf0e,0x3f6d3ec43f35bf35,0x3f0e3f553f7bbe48
.quad 0x3ecd3f6b00003f80,0x3f143f513e523f7b,0x3f6bbecd00003f80,0x3e2abf7c3f563f0c,0xbecdbf6b00003f80,0xbf513f143f7bbe52,0xbf6b3ecd00003f80,0x3f7c3e2a3f0cbf56
.quad 0x3ecd3f6b00003f80,0xbf14bf51be52bf7b,0x3f6bbecd00003f80,0xbe2a3f7cbf56bf0c,0xbecdbf6b00003f80,0x3f51bf14bf7b3e52,0xbf6b3ecd00003f80,0xbf7cbe2abf0c3f56
.quad 0x3f723ea83f3c3f2e,0x3f7e3e023f5c3f04,0xbea83f72bf3cbf2e,0x3f1d3f4bbf783e79,0xbf72bea83f3c3f2e,0xbe023f7e3f04bf5c,0x3ea8bf72bf3cbf2e,0xbf4b3f1d3e793f78
.quad 0x3f723ea83f3c3f2e,0xbf7ebe02bf5cbf04,0xbea83f72bf3cbf2e,0xbf1dbf4b3f78be79,0xbf72bea83f3c3f2e,0x3e02bf7ebf043f5c,0x3ea8bf72bf3cbf2e,0x3f4bbf1dbe79bf78
.quad 0x3f6bbecd3f800000,0x3f51bf143f7bbe52,0xbecdbf6b3f800000,0xbf7cbe2a3f0cbf56,0xbf6b3ecd3f800000,0x3f143f51be52bf7b,0x3ecd3f6b3f800000,0x3e2abf7cbf56bf0c
.quad 0x3f6bbecd3f800000,0xbf513f14bf7b3e52,0xbecdbf6b3f800000,0x3f7c3e2abf0c3f56,0xbf6b3ecd3f800000,0xbf14bf513e523f7b,0x3ecd3f6b3f800000,0xbe2a3f7c3f563f0c
.quad 0x3ea8bf723f2ebf3c,0x3e02bf7e3f04bf5c,0x3f723ea8bf2e3f3c,0x3f4bbf1d3e793f78,0xbea83f723f2ebf3c,0x3f7e3e02bf5cbf04,0xbf72bea8bf2e3f3c,0x3f1d3f4b3f78be79
.quad 0x3ea8bf723f2ebf3c,0xbe023f7ebf043f5c,0x3f723ea8bf2e3f3c,0xbf4b3f1dbe79bf78,0xbea83f723f2ebf3c,0xbf7ebe023f5c3f04,0xbf72bea8bf2e3f3c,0xbf1dbf4bbf783e79
.quad 0xbecdbf6b0000bf80,0xbf14bf51be52bf7b,0xbf6b3ecd0000bf80,0xbe2a3f7cbf56bf0c,0x3ecd3f6b0000bf80,0x3f51bf14bf7b3e52,0x3f6bbecd0000bf80,0xbf7cbe2abf0c3f56
.quad 0xbecdbf6b0000bf80,0x3f143f513e523f7b,0xbf6b3ecd0000bf80,0x3e2abf7c3f563f0c,0x3ecd3f6b0000bf80,0xbf513f143f7bbe52,0x3f6bbecd0000bf80,0x3f7c3e2a3f0cbf56
.quad 0xbf72bea8bf3cbf2e,0xbf7ebe02bf5cbf04,0x3ea8bf723f3c3f2e,0xbf1dbf4b3f78be79,0x3f723ea8bf3cbf2e,0x3e02bf7ebf043f5c,0xbea83f723f3c3f2e,0x3f4bbf1dbe79bf78
.quad 0xbf72bea8bf3cbf2e,0x3f7e3e023f5c3f04,0x3ea8bf723f3c3f2e,0x3f1d3f4bbf783e79,0x3f723ea8bf3cbf2e,0xbe023f7e3f04bf5c,0xbea83f723f3c3f2e,0xbf4b3f1d3e793f78
.quad 0xbf6b3ecdbf800000,0xbf513f14bf7b3e52,0x3ecd3f6bbf800000,0x3f7c3e2abf0c3f56,0x3f6bbecdbf800000,0xbf14bf513e523f7b,0xbecdbf6bbf800000,0xbe2a3f7c3f563f0c
.quad 0xbf6b3ecdbf800000,0x3f51bf143f7bbe52,0x3ecd3f6bbf800000,0xbf7cbe2a3f0cbf56,0x3f6bbecdbf800000,0x3f143f51be52bf7b,0xbecdbf6bbf800000,0x3e2abf7cbf56bf0c
.quad 0xbea83f72bf2e3f3c,0xbe023f7ebf043f5c,0xbf72bea83f2ebf3c,0xbf4b3f1dbe79bf78,0x3ea8bf72bf2e3f3c,0xbf7ebe023f5c3f04,0x3f723ea83f2ebf3c,0xbf1dbf4bbf783e79
.quad 0xbea83f72bf2e3f3c,0x3e02bf7e3f04bf5c,0xbf72bea83f2ebf3c,0x3f4bbf1d3e793f78,0x3ea8bf72bf2e3f3c,0x3f7e3e02bf5cbf04,0x3f723ea83f2ebf3c,0x3f1d3f4b3f78be79
.quad 0x3ed63f6800003f80,0x3f1b3f4c3e5b3f7a,0x3f68bed600003f80,0x3e0cbf7e3f583f0a,0xbed6bf6800003f80,0xbf4c3f1b3f7abe5b,0xbf683ed600003f80,0x3f7e3e0c3f0abf58
.quad 0x3ed63f6800003f80,0xbf1bbf4cbe5bbf7a,0x3f68bed600003f80,0xbe0c3f7ebf58bf0a,0xbed6bf6800003f80,0x3f4cbf1bbf7a3e5b,0xbf683ed600003f80,0xbf7ebe0cbf0a3f58
.quad 0x3f763e8b3f433f26,0x3f803d713f623ef1,0xbe8b3f76bf43bf26,0x3f2a3f3fbf753e95,0xbf76be8b3f433f26,0xbd713f803ef1bf62,0x3e8bbf76bf43bf26,0xbf3f3f2a3e953f75
.quad 0x3f763e8b3f433f26,0xbf80bd71bf62bef1,0xbe8b3f76bf43bf26,0xbf2abf3f3f75be95,0xbf76be8b3f433f26,0x3d71bf80bef13f62,0x3e8bbf76bf43bf26,0x3f3fbf2abe95bf75
.quad 0x3f68bed63f800000,0x3f4cbf1b3f7abe5b,0xbed6bf683f800000,0xbf7ebe0c3f0abf58,0xbf683ed63f800000,0x3f1b3f4cbe5bbf7a,0x3ed63f683f800000,0x3e0cbf7ebf58bf0a
.quad 0x3f68bed63f800000,0xbf4c3f1bbf7a3e5b,0xbed6bf683f800000,0x3f7e3e0cbf0a3f58,0xbf683ed63f800000,0xbf1bbf4c3e5b3f7a,0x3ed63f683f800000,0xbe0c3f7e3f583f0a
.quad 0x3e8bbf763f26bf43,0x3d71bf803ef1bf62,0x3f763e8bbf263f43,0x3f3fbf2a3e953f75,0xbe8b3f763f26bf43,0x3f803d71bf62bef1,0xbf76be8bbf263f43,0x3f2a3f3f3f75be95
.quad 0x3e8bbf763f26bf43,0xbd713f80bef13f62,0x3f763e8bbf263f43,0xbf3f3f2abe95bf75,0xbe8b3f763f26bf43,0xbf80bd713f623ef1,0xbf76be8bbf263f43,0xbf2abf3fbf753e95
.quad 0xbed6bf680000bf80,0xbf1bbf4cbe5bbf7a,0xbf683ed60000bf80,0xbe0c3f7ebf58bf0a,0x3ed63f680000bf80,0x3f4cbf1bbf7a3e5b,0x3f68bed60000bf80,0xbf7ebe0cbf0a3f58
.quad 0xbed6bf680000bf80,0x3f1b3f4c3e5b3f7a,0xbf683ed60000bf80,0x3e0cbf7e3f583f0a,0x3ed63f680000bf80,0xbf4c3f1b3f7abe5b,0x3f68bed60000bf80,0x3f7e3e0c3f0abf58
.quad 0xbf76be8bbf43bf26,0xbf80bd71bf62bef1,0x3e8bbf763f433f26,0xbf2abf3f3f75be95,0x3f763e8bbf43bf26,0x3d71bf80bef13f62,0xbe8b3f763f433f26,0x3f3fbf2abe95bf75
.quad 0xbf76be8bbf43bf26,0x3f803d713f623ef1,0x3e8bbf763f433f26,0x3f2a3f3fbf753e95,0x3f763e8bbf43bf26,0xbd713f803ef1bf62,0xbe8b3f763f433f26,0xbf3f3f2a3e953f75
.quad 0xbf683ed6bf800000,0xbf4c3f1bbf7a3e5b,0x3ed63f68bf800000,0x3f7e3e0cbf0a3f58,0x3f68bed6bf800000,0xbf1bbf4c3e5b3f7a,0xbed6bf68bf800000,0xbe0c3f7e3f583f0a
.quad 0xbf683ed6bf800000,0x3f4cbf1b3f7abe5b,0x3ed63f68bf800000,0xbf7ebe0c3f0abf58,0x3f68bed6bf800000,0x3f1b3f4cbe5bbf7a,0xbed6bf68bf800000,0x3e0cbf7ebf58bf0a
.quad 0xbe8b3f76bf263f43,0xbd713f80bef13f62,0xbf76be8b3f26bf43,0xbf3f3f2abe95bf75,0x3e8bbf76bf263f43,0xbf80bd713f623ef1,0x3f763e8b3f26bf43,0xbf2abf3fbf753e95
.quad 0xbe8b3f76bf263f43,0x3d71bf803ef1bf62,0xbf76be8b3f26bf43,0x3f3fbf2a3e953f75,0x3e8bbf76bf263f43,0x3f803d71bf62bef1,0x3f763e8b3f26bf43,0x3f2a3f3f3f75be95
.quad 0x3edf3f6600003f80,0x3f203f473e653f7a,0x3f66bedf00003f80,0x3dddbf7f3f593f08,0xbedfbf6600003f80,0xbf473f203f7abe65,0xbf663edf00003f80,0x3f7f3ddd3f08bf59
.quad 0x3edf3f6600003f80,0xbf20bf47be65bf7a,0x3f66bedf00003f80,0xbddd3f7fbf59bf08,0xbedfbf6600003f80,0x3f47bf20bf7a3e65,0xbf663edf00003f80,0xbf7fbdddbf083f59
.quad 0x3f7a3e5b3f493f1e,0x3f80bc213f673edb,0xbe5b3f7abf49bf1e,0x3f373f33bf713eac,0xbf7abe5b3f493f1e,0x3c213f803edbbf67,0x3e5bbf7abf49bf1e,0xbf333f373eac3f71
.quad 0x3f7a3e5b3f493f1e,0xbf803c21bf67bedb,0xbe5b3f7abf49bf1e,0xbf37bf333f71beac,0xbf7abe5b3f493f1e,0xbc21bf80bedb3f67,0x3e5bbf7abf49bf1e,0x3f33bf37beacbf71
.quad 0x3f66bedf3f800000,0x3f47bf203f7abe65,0xbedfbf663f800000,0xbf7fbddd3f08bf59,0xbf663edf3f800000,0x3f203f47be65bf7a,0x3edf3f663f800000,0x3dddbf7fbf59bf08
.quad 0x3f66bedf3f800000,0xbf473f20bf7a3e65,0xbedfbf663f800000,0x3f7f3dddbf083f59,0xbf663edf3f800000,0xbf20bf473e653f7a,0x3edf3f663f800000,0xbddd3f7f3f593f08
.quad 0x3e5bbf7a3f1ebf49,0xbc21bf803edbbf67,0x3f7a3e5bbf1e3f49,0x3f33bf373eac3f71,0xbe5b3f7a3f1ebf49,0x3f80bc21bf67bedb,0xbf7abe5bbf1e3f49,0x3f373f333f71beac
.quad 0x3e5bbf7a3f1ebf49,0x3c213f80bedb3f67,0x3f7a3e5bbf1e3f49,0xbf333f37beacbf71,0xbe5b3f7a3f1ebf49,0xbf803c213f673edb,0xbf7abe5bbf1e3f49,0xbf37bf33bf713eac
.quad 0xbedfbf660000bf80,0xbf20bf47be65bf7a,0xbf663edf0000bf80,0xbddd3f7fbf59bf08,0x3edf3f660000bf80,0x3f47bf20bf7a3e65,0x3f66bedf0000bf80,0xbf7fbdddbf083f59
.quad 0xbedfbf660000bf80,0x3f203f473e653f7a,0xbf663edf0000bf80,0x3dddbf7f3f593f08,0x3edf3f660000bf80,0xbf473f203f7abe65,0x3f66bedf0000bf80,0x3f7f3ddd3f08bf59
.quad 0xbf7abe5bbf49bf1e,0xbf803c21bf67bedb,0x3e5bbf7a3f493f1e,0xbf37bf333f71beac,0x3f7a3e5bbf49bf1e,0xbc21bf80bedb3f67,0xbe5b3f7a3f493f1e,0x3f33bf37beacbf71
.quad 0xbf7abe5bbf49bf1e,0x3f80bc213f673edb,0x3e5bbf7a3f493f1e,0x3f373f33bf713eac,0x3f7a3e5bbf49bf1e,0x3c213f803edbbf67,0xbe5b3f7a3f493f1e,0xbf333f373eac3f71
.quad 0xbf663edfbf800000,0xbf473f20bf7a3e65,0x3edf3f66bf800000,0x3f7f3dddbf083f59,0x3f66bedfbf800000,0xbf20bf473e653f7a,0xbedfbf66bf800000,0xbddd3f7f3f593f08
.quad 0xbf663edfbf800000,0x3f47bf203f7abe65,0x3edf3f66bf800000,0xbf7fbddd3f08bf59,0x3f66bedfbf800000,0x3f203f47be65bf7a,0xbedfbf66bf800000,0x3dddbf7fbf59bf08
.quad 0xbe5b3f7abf1e3f49,0x3c213f80bedb3f67,0xbf7abe5b3f1ebf49,0xbf333f37beacbf71,0x3e5bbf7abf1e3f49,0xbf803c213f673edb,0x3f7a3e5b3f1ebf49,0xbf37bf33bf713eac
.quad 0xbe5b3f7abf1e3f49,0xbc21bf803edbbf67,0xbf7abe5b3f1ebf49,0x3f33bf373eac3f71,0x3e5bbf7abf1e3f49,0x3f80bc21bf67bedb,0x3f7a3e5b3f1ebf49,0x3f373f333f71beac
.quad 0x3ee83f6400003f80,0x3f263f433e6f3f79,0x3f64bee800003f80,0x3da1bf7f3f5a3f06,0xbee8bf6400003f80,0xbf433f263f79be6f,0xbf643ee800003f80,0x3f7f3da13f06bf5a
.quad 0x3ee83f6400003f80,0xbf26bf43be6fbf79,0x3f64bee800003f80,0xbda13f7fbf5abf06,0xbee8bf6400003f80,0x3f43bf26bf793e6f,0xbf643ee800003f80,0xbf7fbda1bf063f5a
.quad 0x3f7d3e203f4f3f16,0x3f7fbda13f6d3ec4,0xbe203f7dbf4fbf16,0x3f433f26bf6d3ec4,0xbf7dbe203f4f3f16,0x3da13f7f3ec4bf6d,0x3e20bf7dbf4fbf16,0xbf263f433ec43f6d
.quad 0x3f7d3e203f4f3f16,0xbf7f3da1bf6dbec4,0xbe203f7dbf4fbf16,0xbf43bf263f6dbec4,0xbf7dbe203f4f3f16,0xbda1bf7fbec43f6d,0x3e20bf7dbf4fbf16,0x3f26bf43bec4bf6d
.quad 0x3f64bee83f800000,0x3f43bf263f79be6f,0xbee8bf643f800000,0xbf7fbda13f06bf5a,0xbf643ee83f800000,0x3f263f43be6fbf79,0x3ee83f643f800000,0x3da1bf7fbf5abf06
.quad 0x3f64bee83f800000,0xbf433f26bf793e6f,0xbee8bf643f800000,0x3f7f3da1bf063f5a,0xbf643ee83f800000,0xbf26bf433e6f3f79,0x3ee83f643f800000,0xbda13f7f3f5a3f06
.quad 0x3e20bf7d3f16bf4f,0xbda1bf7f3ec4bf6d,0x3f7d3e20bf163f4f,0x3f26bf433ec43f6d,0xbe203f7d3f16bf4f,0x3f7fbda1bf6dbec4,0xbf7dbe20bf163f4f,0x3f433f263f6dbec4
.quad 0x3e20bf7d3f16bf4f,0x3da13f7fbec43f6d,0x3f7d3e20bf163f4f,0xbf263f43bec4bf6d,0xbe203f7d3f16bf4f,0xbf7f3da13f6d3ec4,0xbf7dbe20bf163f4f,0xbf43bf26bf6d3ec4
.quad 0xbee8bf640000bf80,0xbf26bf43be6fbf79,0xbf643ee80000bf80,0xbda13f7fbf5abf06,0x3ee83f640000bf80,0x3f43bf26bf793e6f,0x3f64bee80000bf80,0xbf7fbda1bf063f5a
.quad 0xbee8bf640000bf80,0x3f263f433e6f3f79,0xbf643ee80000bf80,0x3da1bf7f3f5a3f06,0x3ee83f640000bf80,0xbf433f263f79be6f,0x3f64bee80000bf80,0x3f7f3da13f06bf5a
.quad 0xbf7dbe20bf4fbf16,0xbf7f3da1bf6dbec4,0x3e20bf7d3f4f3f16,0xbf43bf263f6dbec4,0x3f7d3e20bf4fbf16,0xbda1bf7fbec43f6d,0xbe203f7d3f4f3f16,0x3f26bf43bec4bf6d
.quad 0xbf7dbe20bf4fbf16,0x3f7fbda13f6d3ec4,0x3e20bf7d3f4f3f16,0x3f433f26bf6d3ec4,0x3f7d3e20bf4fbf16,0x3da13f7f3ec4bf6d,0xbe203f7d3f4f3f16,0xbf263f433ec43f6d
.quad 0xbf643ee8bf800000,0xbf433f26bf793e6f,0x3ee83f64bf800000,0x3f7f3da1bf063f5a,0x3f64bee8bf800000,0xbf26bf433e6f3f79,0xbee8bf64bf800000,0xbda13f7f3f5a3f06
.quad 0xbf643ee8bf800000,0x3f43bf263f79be6f,0x3ee83f64bf800000,0xbf7fbda13f06bf5a,0x3f64bee8bf800000,0x3f263f43be6fbf79,0xbee8bf64bf800000,0x3da1bf7fbf5abf06
.quad 0xbe203f7dbf163f4f,0x3da13f7fbec43f6d,0xbf7dbe203f16bf4f,0xbf263f43bec4bf6d,0x3e20bf7dbf163f4f,0xbf7f3da13f6d3ec4,0x3f7d3e203f16bf4f,0xbf43bf26bf6d3ec4
.quad 0xbe203f7dbf163f4f,0xbda1bf7f3ec4bf6d,0xbf7dbe203f16bf4f,0x3f26bf433ec43f6d,0x3e20bf7dbf163f4f,0x3f7fbda1bf6dbec4,0x3f7d3e203f16bf4f,0x3f433f263f6dbec4
.quad 0x3ef13f6200003f80,0x3f2c3f3e3e793f78,0x3f62bef100003f80,0x3d49bf803f5c3f04,0xbef1bf6200003f80,0xbf3e3f2c3f78be79,0xbf623ef100003f80,0x3f803d493f04bf5c
.quad 0x3ef13f6200003f80,0xbf2cbf3ebe79bf78,0x3f62bef100003f80,0xbd493f80bf5cbf04,0xbef1bf6200003f80,0x3f3ebf2cbf783e79,0xbf623ef100003f80,0xbf80bd49bf043f5c
.quad 0x3f7f3dc93f553f0e,0x3f7dbe163f713eac,0xbdc93f7fbf55bf0e,0x3f4e3f18bf673edb,0xbf7fbdc93f553f0e,0x3e163f7d3eacbf71,0x3dc9bf7fbf55bf0e,0xbf183f4e3edb3f67
.quad 0x3f7f3dc93f553f0e,0xbf7d3e16bf71beac,0xbdc93f7fbf55bf0e,0xbf4ebf183f67bedb,0xbf7fbdc93f553f0e,0xbe16bf7dbeac3f71,0x3dc9bf7fbf55bf0e,0x3f18bf4ebedbbf67
.quad 0x3f62bef13f800000,0x3f3ebf2c3f78be79,0xbef1bf623f800000,0xbf80bd493f04bf5c,0xbf623ef13f800000,0x3f2c3f3ebe79bf78,0x3ef13f623f800000,0x3d49bf80bf5cbf04
.quad 0x3f62bef13f800000,0xbf3e3f2cbf783e79,0xbef1bf623f800000,0x3f803d49bf043f5c,0xbf623ef13f800000,0xbf2cbf3e3e793f78,0x3ef13f623f800000,0xbd493f803f5c3f04
.quad 0x3dc9bf7f3f0ebf55,0xbe16bf7d3eacbf71,0x3f7f3dc9bf0e3f55,0x3f18bf4e3edb3f67,0xbdc93f7f3f0ebf55,0x3f7dbe16bf71beac,0xbf7fbdc9bf0e3f55,0x3f4e3f183f67bedb
.quad 0x3dc9bf7f3f0ebf55,0x3e163f7dbeac3f71,0x3f7f3dc9bf0e3f55,0xbf183f4ebedbbf67,0xbdc93f7f3f0ebf55,0xbf7d3e163f713eac,0xbf7fbdc9bf0e3f55,0xbf4ebf18bf673edb
.quad 0xbef1bf620000bf80,0xbf2cbf3ebe79bf78,0xbf623ef10000bf80,0xbd493f80bf5cbf04,0x3ef13f620000bf80,0x3f3ebf2cbf783e79,0x3f62bef10000bf80,0xbf80bd49bf043f5c
.quad 0xbef1bf620000bf80,0x3f2c3f3e3e793f78,0xbf623ef10000bf80,0x3d49bf803f5c3f04,0x3ef13f620000bf80,0xbf3e3f2c3f78be79,0x3f62bef10000bf80,0x3f803d493f04bf5c
.quad 0xbf7fbdc9bf55bf0e,0xbf7d3e16bf71beac,0x3dc9bf7f3f553f0e,0xbf4ebf183f67bedb,0x3f7f3dc9bf55bf0e,0xbe16bf7dbeac3f71,0xbdc93f7f3f553f0e,0x3f18bf4ebedbbf67
.quad 0xbf7fbdc9bf55bf0e,0x3f7dbe163f713eac,0x3dc9bf7f3f553f0e,0x3f4e3f18bf673edb,0x3f7f3dc9bf55bf0e,0x3e163f7d3eacbf71,0xbdc93f7f3f553f0e,0xbf183f4e3edb3f67
.quad 0xbf623ef1bf800000,0xbf3e3f2cbf783e79,0x3ef13f62bf800000,0x3f803d49bf043f5c,0x3f62bef1bf800000,0xbf2cbf3e3e793f78,0xbef1bf62bf800000,0xbd493f803f5c3f04
.quad 0xbf623ef1bf800000,0x3f3ebf2c3f78be79,0x3ef13f62bf800000,0xbf80bd493f04bf5c,0x3f62bef1bf800000,0x3f2c3f3ebe79bf78,0xbef1bf62bf800000,0x3d49bf80bf5cbf04
.quad 0xbdc93f7fbf0e3f55,0x3e163f7dbeac3f71,0xbf7fbdc93f0ebf55,0xbf183f4ebedbbf67,0x3dc9bf7fbf0e3f55,0xbf7d3e163f713eac,0x3f7f3dc93f0ebf55,0xbf4ebf18bf673edb
.quad 0xbdc93f7fbf0e3f55,0xbe16bf7d3eacbf71,0xbf7fbdc93f0ebf55,0x3f18bf4e3edb3f67,0x3dc9bf7fbf0e3f55,0x3f7dbe16bf71beac,0x3f7f3dc93f0ebf55,0x3f4e3f183f67bedb
.quad 0x3efa3f5f00003f80,0x3f313f393e813f78,0x3f5fbefa00003f80,0x3ca1bf803f5d3f01,0xbefabf5f00003f80,0xbf393f313f78be81,0xbf5f3efa00003f80,0x3f803ca13f01bf5d
.quad 0x3efa3f5f00003f80,0xbf31bf39be81bf78,0x3f5fbefa00003f80,0xbca13f80bf5dbf01,0xbefabf5f00003f80,0x3f39bf31bf783e81,0xbf5f3efa00003f80,0xbf80bca1bf013f5d
.quad 0x3f803d213f5a3f06,0x3f7abe5b3f753e95,0xbd213f80bf5abf06,0x3f583f0abf623ef1,0xbf80bd213f5a3f06,0x3e5b3f7a3e95bf75,0x3d21bf80bf5abf06,0xbf0a3f583ef13f62
.quad 0x3f803d213f5a3f06,0xbf7a3e5bbf75be95,0xbd213f80bf5abf06,0xbf58bf0a3f62bef1,0xbf80bd213f5a3f06,0xbe5bbf7abe953f75,0x3d21bf80bf5abf06,0x3f0abf58bef1bf62
.quad 0x3f5fbefa3f800000,0x3f39bf313f78be81,0xbefabf5f3f800000,0xbf80bca13f01bf5d,0xbf5f3efa3f800000,0x3f313f39be81bf78,0x3efa3f5f3f800000,0x3ca1bf80bf5dbf01
.quad 0x3f5fbefa3f800000,0xbf393f31bf783e81,0xbefabf5f3f800000,0x3f803ca1bf013f5d,0xbf5f3efa3f800000,0xbf31bf393e813f78,0x3efa3f5f3f800000,0xbca13f803f5d3f01
.quad 0x3d21bf803f06bf5a,0xbe5bbf7a3e95bf75,0x3f803d21bf063f5a,0x3f0abf583ef13f62,0xbd213f803f06bf5a,0x3f7abe5bbf75be95,0xbf80bd21bf063f5a,0x3f583f0a3f62bef1
.quad 0x3d21bf803f06bf5a,0x3e5b3f7abe953f75,0x3f803d21bf063f5a,0xbf0a3f58bef1bf62,0xbd213f803f06bf5a,0xbf7a3e5b3f753e95,0xbf80bd21bf063f5a,0xbf58bf0abf623ef1
.quad 0xbefabf5f0000bf80,0xbf31bf39be81bf78,0xbf5f3efa0000bf80,0xbca13f80bf5dbf01,0x3efa3f5f0000bf80,0x3f39bf31bf783e81,0x3f5fbefa0000bf80,0xbf80bca1bf013f5d
.quad 0xbefabf5f0000bf80,0x3f313f393e813f78,0xbf5f3efa0000bf80,0x3ca1bf803f5d3f01,0x3efa3f5f0000bf80,0xbf393f313f78be81,0x3f5fbefa0000bf80,0x3f803ca13f01bf5d
.quad 0xbf80bd21bf5abf06,0xbf7a3e5bbf75be95,0x3d21bf803f5a3f06,0xbf58bf0a3f62bef1,0x3f803d21bf5abf06,0xbe5bbf7abe953f75,0xbd213f803f5a3f06,0x3f0abf58bef1bf62
.quad 0xbf80bd21bf5abf06,0x3f7abe5b3f753e95,0x3d21bf803f5a3f06,0x3f583f0abf623ef1,0x3f803d21bf5abf06,0x3e5b3f7a3e95bf75,0xbd213f803f5a3f06,0xbf0a3f583ef13f62
.quad 0xbf5f3efabf800000,0xbf393f31bf783e81,0x3efa3f5fbf800000,0x3f803ca1bf013f5d,0x3f5fbefabf800000,0xbf31bf393e813f78,0xbefabf5fbf800000,0xbca13f803f5d3f01
.quad 0xbf5f3efabf800000,0x3f39bf313f78be81,0x3efa3f5fbf800000,0xbf80bca13f01bf5d,0x3f5fbefabf800000,0x3f313f39be81bf78,0xbefabf5fbf800000,0x3ca1bf80bf5dbf01
.quad 0xbd213f80bf063f5a,0x3e5b3f7abe953f75,0xbf80bd213f06bf5a,0xbf0a3f58bef1bf62,0x3d21bf80bf063f5a,0xbf7a3e5b3f753e95,0x3f803d213f06bf5a,0xbf58bf0abf623ef1
.quad 0xbd213f80bf063f5a,0xbe5bbf7a3e95bf75,0xbf80bd213f06bf5a,0x3f0abf583ef13f62,0x3d21bf80bf063f5a,0x3f7abe5bbf75be95,0x3f803d213f06bf5a,0x3f583f0a3f62bef1
.quad 0x3f013f5d00003f80,0x3f373f333e863f77,0x3f5dbf0100003f80,0xbc21bf803f5e3eff,0xbf01bf5d00003f80,0xbf333f373f77be86,0xbf5d3f0100003f80,0x3f80bc213effbf5e
.quad 0x3f013f5d00003f80,0xbf37bf33be86bf77,0x3f5dbf0100003f80,0x3c213f80bf5ebeff,0xbf01bf5d00003f80,0x3f33bf37bf773e86,0xbf5d3f0100003f80,0xbf803c21beff3f5e
.quad 0x3f80bca13f5f3efa,0x3f76be903f783e79,0x3ca13f80bf5fbefa,0x3f613ef6bf5c3f04,0xbf803ca13f5f3efa,0x3e903f763e79bf78,0xbca1bf80bf5fbefa,0xbef63f613f043f5c
.quad 0x3f80bca13f5f3efa,0xbf763e90bf78be79,0x3ca13f80bf5fbefa,0xbf61bef63f5cbf04,0xbf803ca13f5f3efa,0xbe90bf76be793f78,0xbca1bf80bf5fbefa,0x3ef6bf61bf04bf5c
.quad 0x3f5dbf013f800000,0x3f33bf373f77be86,0xbf01bf5d3f800000,0xbf803c213effbf5e,0xbf5d3f013f800000,0x3f373f33be86bf77,0x3f013f5d3f800000,0xbc21bf80bf5ebeff
.quad 0x3f5dbf013f800000,0xbf333f37bf773e86,0xbf01bf5d3f800000,0x3f80bc21beff3f5e,0xbf5d3f013f800000,0xbf37bf333e863f77,0x3f013f5d3f800000,0x3c213f803f5e3eff
.quad 0xbca1bf803efabf5f,0xbe90bf763e79bf78,0x3f80bca1befa3f5f,0x3ef6bf613f043f5c,0x3ca13f803efabf5f,0x3f76be90bf78be79,0xbf803ca1befa3f5f,0x3f613ef63f5cbf04
.quad 0xbca1bf803efabf5f,0x3e903f76be793f78,0x3f80bca1befa3f5f,0xbef63f61bf04bf5c,0x3ca13f803efabf5f,0xbf763e903f783e79,0xbf803ca1befa3f5f,0xbf61bef6bf5c3f04
.quad 0xbf01bf5d0000bf80,0xbf37bf33be86bf77,0xbf5d3f010000bf80,0x3c213f80bf5ebeff,0x3f013f5d0000bf80,0x3f33bf37bf773e86,0x3f5dbf010000bf80,0xbf803c21beff3f5e
.quad 0xbf01bf5d0000bf80,0x3f373f333e863f77,0xbf5d3f010000bf80,0xbc21bf803f5e3eff,0x3f013f5d0000bf80,0xbf333f373f77be86,0x3f5dbf010000bf80,0x3f80bc213effbf5e
.quad 0xbf803ca1bf5fbefa,0xbf763e90bf78be79,0xbca1bf803f5f3efa,0xbf61bef63f5cbf04,0x3f80bca1bf5fbefa,0xbe90bf76be793f78,0x3ca13f803f5f3efa,0x3ef6bf61bf04bf5c
.quad 0xbf803ca1bf5fbefa,0x3f76be903f783e79,0xbca1bf803f5f3efa,0x3f613ef6bf5c3f04,0x3f80bca1bf5fbefa,0x3e903f763e79bf78,0x3ca13f803f5f3efa,0xbef63f613f043f5c
.quad 0xbf5d3f01bf800000,0xbf333f37bf773e86,0x3f013f5dbf800000,0x3f80bc21beff3f5e,0x3f5dbf01bf800000,0xbf37bf333e863f77,0xbf01bf5dbf800000,0x3c213f803f5e3eff
.quad 0xbf5d3f01bf800000,0x3f33bf373f77be86,0x3f013f5dbf800000,0xbf803c213effbf5e,0x3f5dbf01bf800000,0x3f373f33be86bf77,0xbf01bf5dbf800000,0xbc21bf80bf5ebeff
.quad 0x3ca13f80befa3f5f,0x3e903f76be793f78,0xbf803ca13efabf5f,0xbef63f61bf04bf5c,0xbca1bf80befa3f5f,0xbf763e903f783e79,0x3f80bca13efabf5f,0xbf61bef6bf5c3f04
.quad 0x3ca13f80befa3f5f,0xbe90bf763e79bf78,0xbf803ca13efabf5f,0x3ef6bf613f043f5c,0xbca1bf80befa3f5f,0x3f76be90bf78be79,0x3f80bca13efabf5f,0x3f613ef63f5cbf04
.quad 0x3f063f5a00003f80,0x3f3c3f2e3e8b3f76,0x3f5abf0600003f80,0xbd21bf803f5f3efa,0xbf06bf5a00003f80,0xbf2e3f3c3f76be8b,0xbf5a3f0600003f80,0x3f80bd213efabf5f
.quad 0x3f063f5a00003f80,0xbf3cbf2ebe8bbf76,0x3f5abf0600003f80,0x3d213f80bf5fbefa,0xbf06bf5a00003f80,0x3f2ebf3cbf763e8b,0xbf5a3f0600003f80,0xbf803d21befa3f5f
.quad 0x3f7fbda13f643ee8,0x3f70beb13f7b3e48,0x3da13f7fbf64bee8,0x3f683ed6bf553f0e,0xbf7f3da13f643ee8,0x3eb13f703e48bf7b,0xbda1bf7fbf64bee8,0xbed63f683f0e3f55
.quad 0x3f7fbda13f643ee8,0xbf703eb1bf7bbe48,0x3da13f7fbf64bee8,0xbf68bed63f55bf0e,0xbf7f3da13f643ee8,0xbeb1bf70be483f7b,0xbda1bf7fbf64bee8,0x3ed6bf68bf0ebf55
.quad 0x3f5abf063f800000,0x3f2ebf3c3f76be8b,0xbf06bf5a3f800000,0xbf803d213efabf5f,0xbf5a3f063f800000,0x3f3c3f2ebe8bbf76,0x3f063f5a3f800000,0xbd21bf80bf5fbefa
.quad 0x3f5abf063f800000,0xbf2e3f3cbf763e8b,0xbf06bf5a3f800000,0x3f80bd21befa3f5f,0xbf5a3f063f800000,0xbf3cbf2e3e8b3f76,0x3f063f5a3f800000,0x3d213f803f5f3efa
.quad 0xbda1bf7f3ee8bf64,0xbeb1bf703e48bf7b,0x3f7fbda1bee83f64,0x3ed6bf683f0e3f55,0x3da13f7f3ee8bf64,0x3f70beb1bf7bbe48,0xbf7f3da1bee83f64,0x3f683ed63f55bf0e
.quad 0xbda1bf7f3ee8bf64,0x3eb13f70be483f7b,0x3f7fbda1bee83f64,0xbed63f68bf0ebf55,0x3da13f7f3ee8bf64,0xbf703eb13f7b3e48,0xbf7f3da1bee83f64,0xbf68bed6bf553f0e
.quad 0xbf06bf5a0000bf80,0xbf3cbf2ebe8bbf76,0xbf5a3f060000bf80,0x3d213f80bf5fbefa,0x3f063f5a0000bf80,0x3f2ebf3cbf763e8b,0x3f5abf060000bf80,0xbf803d21befa3f5f
.quad 0xbf06bf5a0000bf80,0x3f3c3f2e3e8b3f76,0xbf5a3f060000bf80,0xbd21bf803f5f3efa,0x3f063f5a0000bf80,0xbf2e3f3c3f76be8b,0x3f5abf060000bf80,0x3f80bd213efabf5f
.quad 0xbf7f3da1bf64bee8,0xbf703eb1bf7bbe48,0xbda1bf7f3f643ee8,0xbf68bed63f55bf0e,0x3f7fbda1bf64bee8,0xbeb1bf70be483f7b,0x3da13f7f3f643ee8,0x3ed6bf68bf0ebf55
.quad 0xbf7f3da1bf64bee8,0x3f70beb13f7b3e48,0xbda1bf7f3f643ee8,0x3f683ed6bf553f0e,0x3f7fbda1bf64bee8,0x3eb13f703e48bf7b,0x3da13f7f3f643ee8,0xbed63f683f0e3f55
.quad 0xbf5a3f06bf800000,0xbf2e3f3cbf763e8b,0x3f063f5abf800000,0x3f80bd21befa3f5f,0x3f5abf06bf800000,0xbf3cbf2e3e8b3f76,0xbf06bf5abf800000,0x3d213f803f5f3efa
.quad 0xbf5a3f06bf800000,0x3f2ebf3c3f76be8b,0x3f063f5abf800000,0xbf803d213efabf5f,0x3f5abf06bf800000,0x3f3c3f2ebe8bbf76,0xbf06bf5abf800000,0xbd21bf80bf5fbefa
.quad 0x3da13f7fbee83f64,0x3eb13f70be483f7b,0xbf7f3da13ee8bf64,0xbed63f68bf0ebf55,0xbda1bf7fbee83f64,0xbf703eb13f7b3e48,0x3f7fbda13ee8bf64,0xbf68bed6bf553f0e
.quad 0x3da13f7fbee83f64,0xbeb1bf703e48bf7b,0xbf7f3da13ee8bf64,0x3ed6bf683f0e3f55,0xbda1bf7fbee83f64,0x3f70beb1bf7bbe48,0x3f7fbda13ee8bf64,0x3f683ed63f55bf0e
.quad 0x3f0a3f5800003f80,0x3f413f283e903f76,0x3f58bf0a00003f80,0xbd8dbf7f3f613ef6,0xbf0abf5800003f80,0xbf283f413f76be90,0xbf583f0a00003f80,0x3f7fbd8d3ef6bf61
.quad 0x3f0a3f5800003f80,0xbf41bf28be90bf76,0x3f58bf0a00003f80,0x3d8d3f7fbf61bef6,0xbf0abf5800003f80,0x3f28bf41bf763e90,0xbf583f0a00003f80,0xbf7f3d8dbef63f61
.quad 0x3f7ebe0c3f683ed6,0x3f6abed23f7d3e16,0x3e0c3f7ebf68bed6,0x3f6f3eb6bf4e3f18,0xbf7e3e0c3f683ed6,0x3ed23f6a3e16bf7d,0xbe0cbf7ebf68bed6,0xbeb63f6f3f183f4e
.quad 0x3f7ebe0c3f683ed6,0xbf6a3ed2bf7dbe16,0x3e0c3f7ebf68bed6,0xbf6fbeb63f4ebf18,0xbf7e3e0c3f683ed6,0xbed2bf6abe163f7d,0xbe0cbf7ebf68bed6,0x3eb6bf6fbf18bf4e
.quad 0x3f58bf0a3f800000,0x3f28bf413f76be90,0xbf0abf583f800000,0xbf7f3d8d3ef6bf61,0xbf583f0a3f800000,0x3f413f28be90bf76,0x3f0a3f583f800000,0xbd8dbf7fbf61bef6
.quad 0x3f58bf0a3f800000,0xbf283f41bf763e90,0xbf0abf583f800000,0x3f7fbd8dbef63f61,0xbf583f0a3f800000,0xbf41bf283e903f76,0x3f0a3f583f800000,0x3d8d3f7f3f613ef6
.quad 0xbe0cbf7e3ed6bf68,0xbed2bf6a3e16bf7d,0x3f7ebe0cbed63f68,0x3eb6bf6f3f183f4e,0x3e0c3f7e3ed6bf68,0x3f6abed2bf7dbe16,0xbf7e3e0cbed63f68,0x3f6f3eb63f4ebf18
.quad 0xbe0cbf7e3ed6bf68,0x3ed23f6abe163f7d,0x3f7ebe0cbed63f68,0xbeb63f6fbf18bf4e,0x3e0c3f7e3ed6bf68,0xbf6a3ed23f7d3e16,0xbf7e3e0cbed63f68,0xbf6fbeb6bf4e3f18
.quad 0xbf0abf580000bf80,0xbf41bf28be90bf76,0xbf583f0a0000bf80,0x3d8d3f7fbf61bef6,0x3f0a3f580000bf80,0x3f28bf41bf763e90,0x3f58bf0a0000bf80,0xbf7f3d8dbef63f61
.quad 0xbf0abf580000bf80,0x3f413f283e903f76,0xbf583f0a0000bf80,0xbd8dbf7f3f613ef6,0x3f0a3f580000bf80,0xbf283f413f76be90,0x3f58bf0a0000bf80,0x3f7fbd8d3ef6bf61
.quad 0xbf7e3e0cbf68bed6,0xbf6a3ed2bf7dbe16,0xbe0cbf7e3f683ed6,0xbf6fbeb63f4ebf18,0x3f7ebe0cbf68bed6,0xbed2bf6abe163f7d,0x3e0c3f7e3f683ed6,0x3eb6bf6fbf18bf4e
.quad 0xbf7e3e0cbf68bed6,0x3f6abed23f7d3e16,0xbe0cbf7e3f683ed6,0x3f6f3eb6bf4e3f18,0x3f7ebe0cbf68bed6,0x3ed23f6a3e16bf7d,0x3e0c3f7e3f683ed6,0xbeb63f6f3f183f4e
.quad 0xbf583f0abf800000,0xbf283f41bf763e90,0x3f0a3f58bf800000,0x3f7fbd8dbef63f61,0x3f58bf0abf800000,0xbf41bf283e903f76,0xbf0abf58bf800000,0x3d8d3f7f3f613ef6
.quad 0xbf583f0abf800000,0x3f28bf413f76be90,0x3f0a3f58bf800000,0xbf7f3d8d3ef6bf61,0x3f58bf0abf800000,0x3f413f28be90bf76,0xbf0abf58bf800000,0xbd8dbf7fbf61bef6
.quad 0x3e0c3f7ebed63f68,0x3ed23f6abe163f7d,0xbf7e3e0c3ed6bf68,0xbeb63f6fbf18bf4e,0xbe0cbf7ebed63f68,0xbf6a3ed23f7d3e16,0x3f7ebe0c3ed6bf68,0xbf6fbeb6bf4e3f18
.quad 0x3e0c3f7ebed63f68,0xbed2bf6a3e16bf7d,0xbf7e3e0c3ed6bf68,0x3eb6bf6f3f183f4e,0xbe0cbf7ebed63f68,0x3f6abed2bf7dbe16,0x3f7ebe0c3ed6bf68,0x3f6f3eb63f4ebf18
.quad 0x3f0e3f5500003f80,0x3f463f223e953f75,0x3f55bf0e00003f80,0xbdc9bf7f3f623ef1,0xbf0ebf5500003f80,0xbf223f463f75be95,0xbf553f0e00003f80,0x3f7fbdc93ef1bf62
.quad 0x3f0e3f5500003f80,0xbf46bf22be95bf75,0x3f55bf0e00003f80,0x3dc93f7fbf62bef1,0xbf0ebf5500003f80,0x3f22bf46bf753e95,0xbf553f0e00003f80,0xbf7f3dc9bef13f62
.quad 0x3f7bbe483f6d3ec4,0x3f62bef13f7f3dc9,0x3e483f7bbf6dbec4,0x3f753e95bf463f22,0xbf7b3e483f6d3ec4,0x3ef13f623dc9bf7f,0xbe48bf7bbf6dbec4,0xbe953f753f223f46
.quad 0x3f7bbe483f6d3ec4,0xbf623ef1bf7fbdc9,0x3e483f7bbf6dbec4,0xbf75be953f46bf22,0xbf7b3e483f6d3ec4,0xbef1bf62bdc93f7f,0xbe48bf7bbf6dbec4,0x3e95bf75bf22bf46
.quad 0x3f55bf0e3f800000,0x3f22bf463f75be95,0xbf0ebf553f800000,0xbf7f3dc93ef1bf62,0xbf553f0e3f800000,0x3f463f22be95bf75,0x3f0e3f553f800000,0xbdc9bf7fbf62bef1
.quad 0x3f55bf0e3f800000,0xbf223f46bf753e95,0xbf0ebf553f800000,0x3f7fbdc9bef13f62,0xbf553f0e3f800000,0xbf46bf223e953f75,0x3f0e3f553f800000,0x3dc93f7f3f623ef1
.quad 0xbe48bf7b3ec4bf6d,0xbef1bf623dc9bf7f,0x3f7bbe48bec43f6d,0x3e95bf753f223f46,0x3e483f7b3ec4bf6d,0x3f62bef1bf7fbdc9,0xbf7b3e48bec43f6d,0x3f753e953f46bf22
.quad 0xbe48bf7b3ec4bf6d,0x3ef13f62bdc93f7f,0x3f7bbe48bec43f6d,0xbe953f75bf22bf46,0x3e483f7b3ec4bf6d,0xbf623ef13f7f3dc9,0xbf7b3e48bec43f6d,0xbf75be95bf463f22
.quad 0xbf0ebf550000bf80,0xbf46bf22be95bf75,0xbf553f0e0000bf80,0x3dc93f7fbf62bef1,0x3f0e3f550000bf80,0x3f22bf46bf753e95,0x3f55bf0e0000bf80,0xbf7f3dc9bef13f62
.quad 0xbf0ebf550000bf80,0x3f463f223e953f75,0xbf553f0e0000bf80,0xbdc9bf7f3f623ef1,0x3f0e3f550000bf80,0xbf223f463f75be95,0x3f55bf0e0000bf80,0x3f7fbdc93ef1bf62
.quad 0xbf7b3e48bf6dbec4,0xbf623ef1bf7fbdc9,0xbe48bf7b3f6d3ec4,0xbf75be953f46bf22,0x3f7bbe48bf6dbec4,0xbef1bf62bdc93f7f,0x3e483f7b3f6d3ec4,0x3e95bf75bf22bf46
.quad 0xbf7b3e48bf6dbec4,0x3f62bef13f7f3dc9,0xbe48bf7b3f6d3ec4,0x3f753e95bf463f22,0x3f7bbe48bf6dbec4,0x3ef13f623dc9bf7f,0x3e483f7b3f6d3ec4,0xbe953f753f223f46
.quad 0xbf553f0ebf800000,0xbf223f46bf753e95,0x3f0e3f55bf800000,0x3f7fbdc9bef13f62,0x3f55bf0ebf800000,0xbf46bf223e953f75,0xbf0ebf55bf800000,0x3dc93f7f3f623ef1
.quad 0xbf553f0ebf800000,0x3f22bf463f75be95,0x3f0e3f55bf800000,0xbf7f3dc93ef1bf62,0x3f55bf0ebf800000,0x3f463f22be95bf75,0xbf0ebf55bf800000,0xbdc9bf7fbf62bef1
.quad 0x3e483f7bbec43f6d,0x3ef13f62bdc93f7f,0xbf7b3e483ec4bf6d,0xbe953f75bf22bf46,0xbe48bf7bbec43f6d,0xbf623ef13f7f3dc9,0x3f7bbe483ec4bf6d,0xbf75be95bf463f22
.quad 0x3e483f7bbec43f6d,0xbef1bf623dc9bf7f,0xbf7b3e483ec4bf6d,0x3e95bf753f223f46,0xbe48bf7bbec43f6d,0x3f62bef1bf7fbdc9,0x3f7bbe483ec4bf6d,0x3f753e953f46bf22
.quad 0x3f123f5200003f80,0x3f4b3f1d3e993f74,0x3f52bf1200003f80,0xbe02bf7e3f633eed,0xbf12bf5200003f80,0xbf1d3f4b3f74be99,0xbf523f1200003f80,0x3f7ebe023eedbf63
.quad 0x3f123f5200003f80,0xbf4bbf1dbe99bf74,0x3f52bf1200003f80,0x3e023f7ebf63beed,0xbf12bf5200003f80,0x3f1dbf4bbf743e99,0xbf523f1200003f80,0xbf7e3e02beed3f63
.quad 0x3f78be813f703eb1,0x3f59bf083f803d49,0x3e813f78bf70beb1,0x3f7a3e65bf3e3f2c,0xbf783e813f703eb1,0x3f083f593d49bf80,0xbe81bf78bf70beb1,0xbe653f7a3f2c3f3e
.quad 0x3f78be813f703eb1,0xbf593f08bf80bd49,0x3e813f78bf70beb1,0xbf7abe653f3ebf2c,0xbf783e813f703eb1,0xbf08bf59bd493f80,0xbe81bf78bf70beb1,0x3e65bf7abf2cbf3e
.quad 0x3f52bf123f800000,0x3f1dbf4b3f74be99,0xbf12bf523f800000,0xbf7e3e023eedbf63,0xbf523f123f800000,0x3f4b3f1dbe99bf74,0x3f123f523f800000,0xbe02bf7ebf63beed
.quad 0x3f52bf123f800000,0xbf1d3f4bbf743e99,0xbf12bf523f800000,0x3f7ebe02beed3f63,0xbf523f123f800000,0xbf4bbf1d3e993f74,0x3f123f523f800000,0x3e023f7e3f633eed
.quad 0xbe81bf783eb1bf70,0xbf08bf593d49bf80,0x3f78be81beb13f70,0x3e65bf7a3f2c3f3e,0x3e813f783eb1bf70,0x3f59bf08bf80bd49,0xbf783e81beb13f70,0x3f7a3e653f3ebf2c
.quad 0xbe81bf783eb1bf70,0x3f083f59bd493f80,0x3f78be81beb13f70,0xbe653f7abf2cbf3e,0x3e813f783eb1bf70,0xbf593f083f803d49,0xbf783e81beb13f70,0xbf7abe65bf3e3f2c
.quad 0xbf12bf520000bf80,0xbf4bbf1dbe99bf74,0xbf523f120000bf80,0x3e023f7ebf63beed,0x3f123f520000bf80,0x3f1dbf4bbf743e99,0x3f52bf120000bf80,0xbf7e3e02beed3f63
.quad 0xbf12bf520000bf80,0x3f4b3f1d3e993f74,0xbf523f120000bf80,0xbe02bf7e3f633eed,0x3f123f520000bf80,0xbf1d3f4b3f74be99,0x3f52bf120000bf80,0x3f7ebe023eedbf63
.quad 0xbf783e81bf70beb1,0xbf593f08bf80bd49,0xbe81bf783f703eb1,0xbf7abe653f3ebf2c,0x3f78be81bf70beb1,0xbf08bf59bd493f80,0x3e813f783f703eb1,0x3e65bf7abf2cbf3e
.quad 0xbf783e81bf70beb1,0x3f59bf083f803d49,0xbe81bf783f703eb1,0x3f7a3e65bf3e3f2c,0x3f78be81bf70beb1,0x3f083f593d49bf80,0x3e813f783f703eb1,0xbe653f7a3f2c3f3e
.quad 0xbf523f12bf800000,0xbf1d3f4bbf743e99,0x3f123f52bf800000,0x3f7ebe02beed3f63,0x3f52bf12bf800000,0xbf4bbf1d3e993f74,0xbf12bf52bf800000,0x3e023f7e3f633eed
.quad 0xbf523f12bf800000,0x3f1dbf4b3f74be99,0x3f123f52bf800000,0xbf7e3e023eedbf63,0x3f52bf12bf800000,0x3f4b3f1dbe99bf74,0xbf12bf52bf800000,0xbe02bf7ebf63beed
.quad 0x3e813f78beb13f70,0x3f083f59bd493f80,0xbf783e813eb1bf70,0xbe653f7abf2cbf3e,0xbe81bf78beb13f70,0xbf593f083f803d49,0x3f78be813eb1bf70,0xbf7abe65bf3e3f2c
.quad 0x3e813f78beb13f70,0xbf08bf593d49bf80,0xbf783e813eb1bf70,0x3e65bf7a3f2c3f3e,0xbe81bf78beb13f70,0x3f59bf08bf80bd49,0x3f78be813eb1bf70,0x3f7a3e653f3ebf2c
.quad 0x3f163f4f00003f80,0x3f4f3f163e9e3f73,0x3f4fbf1600003f80,0xbe20bf7d3f643ee8,0xbf16bf4f00003f80,0xbf163f4f3f73be9e,0xbf4f3f1600003f80,0x3f7dbe203ee8bf64
.quad 0x3f163f4f00003f80,0xbf4fbf16be9ebf73,0x3f4fbf1600003f80,0x3e203f7dbf64bee8,0xbf16bf4f00003f80,0x3f16bf4fbf733e9e,0xbf4f3f1600003f80,0xbf7d3e20bee83f64
.quad 0x3f73be9e3f733e9e,0x3f4fbf163f800000,0x3e9e3f73bf73be9e,0x3f7d3e20bf353f35,0xbf733e9e3f733e9e,0x3f163f4f0000bf80,0xbe9ebf73bf73be9e,0xbe203f7d3f353f35
.quad 0x3f73be9e3f733e9e,0xbf4f3f16bf800000,0x3e9e3f73bf73be9e,0xbf7dbe203f35bf35,0xbf733e9e3f733e9e,0xbf16bf4f00003f80,0xbe9ebf73bf73be9e,0x3e20bf7dbf35bf35
.quad 0x3f4fbf163f800000,0x3f16bf4f3f73be9e,0xbf16bf4f3f800000,0xbf7d3e203ee8bf64,0xbf4f3f163f800000,0x3f4f3f16be9ebf73,0x3f163f4f3f800000,0xbe20bf7dbf64bee8
.quad 0x3f4fbf163f800000,0xbf163f4fbf733e9e,0xbf16bf4f3f800000,0x3f7dbe20bee83f64,0xbf4f3f163f800000,0xbf4fbf163e9e3f73,0x3f163f4f3f800000,0x3e203f7d3f643ee8
.quad 0xbe9ebf733e9ebf73,0xbf16bf4f0000bf80,0x3f73be9ebe9e3f73,0x3e20bf7d3f353f35,0x3e9e3f733e9ebf73,0x3f4fbf16bf800000,0xbf733e9ebe9e3f73,0x3f7d3e203f35bf35
.quad 0xbe9ebf733e9ebf73,0x3f163f4f00003f80,0x3f73be9ebe9e3f73,0xbe203f7dbf35bf35,0x3e9e3f733e9ebf73,0xbf4f3f163f800000,0xbf733e9ebe9e3f73,0xbf7dbe20bf353f35
.quad 0xbf16bf4f0000bf80,0xbf4fbf16be9ebf73,0xbf4f3f160000bf80,0x3e203f7dbf64bee8,0x3f163f4f0000bf80,0x3f16bf4fbf733e9e,0x3f4fbf160000bf80,0xbf7d3e20bee83f64
.quad 0xbf16bf4f0000bf80,0x3f4f3f163e9e3f73,0xbf4f3f160000bf80,0xbe20bf7d3f643ee8,0x3f163f4f0000bf80,0xbf163f4f3f73be9e,0x3f4fbf160000bf80,0x3f7dbe203ee8bf64
.quad 0xbf733e9ebf73be9e,0xbf4f3f16bf800000,0xbe9ebf733f733e9e,0xbf7dbe203f35bf35,0x3f73be9ebf73be9e,0xbf16bf4f00003f80,0x3e9e3f733f733e9e,0x3e20bf7dbf35bf35
.quad 0xbf733e9ebf73be9e,0x3f4fbf163f800000,0xbe9ebf733f733e9e,0x3f7d3e20bf353f35,0x3f73be9ebf73be9e,0x3f163f4f0000bf80,0x3e9e3f733f733e9e,0xbe203f7d3f353f35
.quad 0xbf4f3f16bf800000,0xbf163f4fbf733e9e,0x3f163f4fbf800000,0x3f7dbe20bee83f64,0x3f4fbf16bf800000,0xbf4fbf163e9e3f73,0xbf16bf4fbf800000,0x3e203f7d3f643ee8
.quad 0xbf4f3f16bf800000,0x3f16bf4f3f73be9e,0x3f163f4fbf800000,0xbf7d3e203ee8bf64,0x3f4fbf16bf800000,0x3f4f3f16be9ebf73,0xbf16bf4fbf800000,0xbe20bf7dbf64bee8
.quad 0x3e9e3f73be9e3f73,0x3f163f4f00003f80,0xbf733e9e3e9ebf73,0xbe203f7dbf35bf35,0xbe9ebf73be9e3f73,0xbf4f3f163f800000,0x3f73be9e3e9ebf73,0xbf7dbe20bf353f35
.quad 0x3e9e3f73be9e3f73,0xbf16bf4f0000bf80,0xbf733e9e3e9ebf73,0x3e20bf7d3f353f35,0xbe9ebf73be9e3f73,0x3f4fbf16bf800000,0x3f73be9e3e9ebf73,0x3f7d3e203f35bf35
.quad 0x3f1b3f4c00003f80,0x3f533f103ea33f73,0x3f4cbf1b00003f80,0xbe3ebf7c3f653ee4,0xbf1bbf4c00003f80,0xbf103f533f73bea3,0xbf4c3f1b00003f80,0x3f7cbe3e3ee4bf65
.quad 0x3f1b3f4c00003f80,0xbf53bf10bea3bf73,0x3f4cbf1b00003f80,0x3e3e3f7cbf65bee4,0xbf1bbf4c00003f80,0x3f10bf53bf733ea3,0xbf4c3f1b00003f80,0xbf7c3e3ebee43f65
.quad 0x3f6ebebb3f763e8b,0x3f44bf243f80bd49,0x3ebb3f6ebf76be8b,0x3f7f3db5bf2c3f3e,0xbf6e3ebb3f763e8b,0x3f243f44bd49bf80,0xbebbbf6ebf76be8b,0xbdb53f7f3f3e3f2c
.quad 0x3f6ebebb3f763e8b,0xbf443f24bf803d49,0x3ebb3f6ebf76be8b,0xbf7fbdb53f2cbf3e,0xbf6e3ebb3f763e8b,0xbf24bf443d493f80,0xbebbbf6ebf76be8b,0x3db5bf7fbf3ebf2c
.quad 0x3f4cbf1b3f800000,0x3f10bf533f73bea3,0xbf1bbf4c3f800000,0xbf7c3e3e3ee4bf65,0xbf4c3f1b3f800000,0x3f533f10bea3bf73,0x3f1b3f4c3f800000,0xbe3ebf7cbf65bee4
.quad 0x3f4cbf1b3f800000,0xbf103f53bf733ea3,0xbf1bbf4c3f800000,0x3f7cbe3ebee43f65,0xbf4c3f1b3f800000,0xbf53bf103ea33f73,0x3f1b3f4c3f800000,0x3e3e3f7c3f653ee4
.quad 0xbebbbf6e3e8bbf76,0xbf24bf44bd49bf80,0x3f6ebebbbe8b3f76,0x3db5bf7f3f3e3f2c,0x3ebb3f6e3e8bbf76,0x3f44bf24bf803d49,0xbf6e3ebbbe8b3f76,0x3f7f3db53f2cbf3e
.quad 0xbebbbf6e3e8bbf76,0x3f243f443d493f80,0x3f6ebebbbe8b3f76,0xbdb53f7fbf3ebf2c,0x3ebb3f6e3e8bbf76,0xbf443f243f80bd49,0xbf6e3ebbbe8b3f76,0xbf7fbdb5bf2c3f3e
.quad 0xbf1bbf4c0000bf80,0xbf53bf10bea3bf73,0xbf4c3f1b0000bf80,0x3e3e3f7cbf65bee4,0x3f1b3f4c0000bf80,0x3f10bf53bf733ea3,0x3f4cbf1b0000bf80,0xbf7c3e3ebee43f65
.quad 0xbf1bbf4c0000bf80,0x3f533f103ea33f73,0xbf4c3f1b0000bf80,0xbe3ebf7c3f653ee4,0x3f1b3f4c0000bf80,0xbf103f533f73bea3,0x3f4cbf1b0000bf80,0x3f7cbe3e3ee4bf65
.quad 0xbf6e3ebbbf76be8b,0xbf443f24bf803d49,0xbebbbf6e3f763e8b,0xbf7fbdb53f2cbf3e,0x3f6ebebbbf76be8b,0xbf24bf443d493f80,0x3ebb3f6e3f763e8b,0x3db5bf7fbf3ebf2c
.quad 0xbf6e3ebbbf76be8b,0x3f44bf243f80bd49,0xbebbbf6e3f763e8b,0x3f7f3db5bf2c3f3e,0x3f6ebebbbf76be8b,0x3f243f44bd49bf80,0x3ebb3f6e3f763e8b,0xbdb53f7f3f3e3f2c
.quad 0xbf4c3f1bbf800000,0xbf103f53bf733ea3,0x3f1b3f4cbf800000,0x3f7cbe3ebee43f65,0x3f4cbf1bbf800000,0xbf53bf103ea33f73,0xbf1bbf4cbf800000,0x3e3e3f7c3f653ee4
.quad 0xbf4c3f1bbf800000,0x3f10bf533f73bea3,0x3f1b3f4cbf800000,0xbf7c3e3e3ee4bf65,0x3f4cbf1bbf800000,0x3f533f10bea3bf73,0xbf1bbf4cbf800000,0xbe3ebf7cbf65bee4
.quad 0x3ebb3f6ebe8b3f76,0x3f243f443d493f80,0xbf6e3ebb3e8bbf76,0xbdb53f7fbf3ebf2c,0xbebbbf6ebe8b3f76,0xbf443f243f80bd49,0x3f6ebebb3e8bbf76,0xbf7fbdb5bf2c3f3e
.quad 0x3ebb3f6ebe8b3f76,0xbf24bf44bd49bf80,0xbf6e3ebb3e8bbf76,0x3db5bf7f3f3e3f2c,0xbebbbf6ebe8b3f76,0x3f44bf24bf803d49,0x3f6ebebb3e8bbf76,0x3f7f3db53f2cbf3e
.quad 0x3f1e3f4900003f80,0x3f583f0a3ea83f72,0x3f49bf1e00003f80,0xbe5bbf7a3f663edf,0xbf1ebf4900003f80,0xbf0a3f583f72bea8,0xbf493f1e00003f80,0x3f7abe5b3edfbf66
.quad 0x3f1e3f4900003f80,0xbf58bf0abea8bf72,0x3f49bf1e00003f80,0x3e5b3f7abf66bedf,0xbf1ebf4900003f80,0x3f0abf58bf723ea8,0xbf493f1e00003f80,0xbf7a3e5bbedf3f66
.quad 0x3f68bed63f793e6f,0x3f39bf313f7fbdc9,0x3ed63f68bf79be6f,0x3f803ca1bf223f46,0xbf683ed63f793e6f,0x3f313f39bdc9bf7f,0xbed6bf68bf79be6f,0xbca13f803f463f22
.quad 0x3f68bed63f793e6f,0xbf393f31bf7f3dc9,0x3ed63f68bf79be6f,0xbf80bca13f22bf46,0xbf683ed63f793e6f,0xbf31bf393dc93f7f,0xbed6bf68bf79be6f,0x3ca1bf80bf46bf22
.quad 0x3f49bf1e3f800000,0x3f0abf583f72bea8,0xbf1ebf493f800000,0xbf7a3e5b3edfbf66,0xbf493f1e3f800000,0x3f583f0abea8bf72,0x3f1e3f493f800000,0xbe5bbf7abf66bedf
.quad 0x3f49bf1e3f800000,0xbf0a3f58bf723ea8,0xbf1ebf493f800000,0x3f7abe5bbedf3f66,0xbf493f1e3f800000,0xbf58bf0a3ea83f72,0x3f1e3f493f800000,0x3e5b3f7a3f663edf
.quad 0xbed6bf683e6fbf79,0xbf31bf39bdc9bf7f,0x3f68bed6be6f3f79,0x3ca1bf803f463f22,0x3ed63f683e6fbf79,0x3f39bf31bf7f3dc9,0xbf683ed6be6f3f79,0x3f803ca13f22bf46
.quad 0xbed6bf683e6fbf79,0x3f313f393dc93f7f,0x3f68bed6be6f3f79,0xbca13f80bf46bf22,0x3ed63f683e6fbf79,0xbf393f313f7fbdc9,0xbf683ed6be6f3f79,0xbf80bca1bf223f46
.quad 0xbf1ebf490000bf80,0xbf58bf0abea8bf72,0xbf493f1e0000bf80,0x3e5b3f7abf66bedf,0x3f1e3f490000bf80,0x3f0abf58bf723ea8,0x3f49bf1e0000bf80,0xbf7a3e5bbedf3f66
.quad 0xbf1ebf490000bf80,0x3f583f0a3ea83f72,0xbf493f1e0000bf80,0xbe5bbf7a3f663edf,0x3f1e3f490000bf80,0xbf0a3f583f72bea8,0x3f49bf1e0000bf80,0x3f7abe5b3edfbf66
.quad 0xbf683ed6bf79be6f,0xbf393f31bf7f3dc9,0xbed6bf683f793e6f,0xbf80bca13f22bf46,0x3f68bed6bf79be6f,0xbf31bf393dc93f7f,0x3ed63f683f793e6f,0x3ca1bf80bf46bf22
.quad 0xbf683ed6bf79be6f,0x3f39bf313f7fbdc9,0xbed6bf683f793e6f,0x3f803ca1bf223f46,0x3f68bed6bf79be6f,0x3f313f39bdc9bf7f,0x3ed63f683f793e6f,0xbca13f803f463f22
.quad 0xbf493f1ebf800000,0xbf0a3f58bf723ea8,0x3f1e3f49bf800000,0x3f7abe5bbedf3f66,0x3f49bf1ebf800000,0xbf58bf0a3ea83f72,0xbf1ebf49bf800000,0x3e5b3f7a3f663edf
.quad 0xbf493f1ebf800000,0x3f0abf583f72bea8,0x3f1e3f49bf800000,0xbf7a3e5b3edfbf66,0x3f49bf1ebf800000,0x3f583f0abea8bf72,0xbf1ebf49bf800000,0xbe5bbf7abf66bedf
.quad 0x3ed63f68be6f3f79,0x3f313f393dc93f7f,0xbf683ed63e6fbf79,0xbca13f80bf46bf22,0xbed6bf68be6f3f79,0xbf393f313f7fbdc9,0x3f68bed63e6fbf79,0xbf80bca1bf223f46
.quad 0x3ed63f68be6f3f79,0xbf31bf39bdc9bf7f,0xbf683ed63e6fbf79,0x3ca1bf803f463f22,0xbed6bf68be6f3f79,0x3f39bf31bf7f3dc9,0x3f68bed63e6fbf79,0x3f803ca13f22bf46
.quad 0x3f223f4600003f80,0x3f5c3f043eac3f71,0x3f46bf2200003f80,0xbe79bf783f673edb,0xbf22bf4600003f80,0xbf043f5c3f71beac,0xbf463f2200003f80,0x3f78be793edbbf67
.quad 0x3f223f4600003f80,0xbf5cbf04beacbf71,0x3f46bf2200003f80,0x3e793f78bf67bedb,0xbf22bf4600003f80,0x3f04bf5cbf713eac,0xbf463f2200003f80,0xbf783e79bedb3f67
.quad 0x3f62bef13f7b3e48,0x3f2cbf3e3f7dbe16,0x3ef13f62bf7bbe48,0x3f80bd49bf183f4e,0xbf623ef13f7b3e48,0x3f3e3f2cbe16bf7d,0xbef1bf62bf7bbe48,0x3d493f803f4e3f18
.quad 0x3f62bef13f7b3e48,0xbf2c3f3ebf7d3e16,0x3ef13f62bf7bbe48,0xbf803d493f18bf4e,0xbf623ef13f7b3e48,0xbf3ebf2c3e163f7d,0xbef1bf62bf7bbe48,0xbd49bf80bf4ebf18
.quad 0x3f46bf223f800000,0x3f04bf5c3f71beac,0xbf22bf463f800000,0xbf783e793edbbf67,0xbf463f223f800000,0x3f5c3f04beacbf71,0x3f223f463f800000,0xbe79bf78bf67bedb
.quad 0x3f46bf223f800000,0xbf043f5cbf713eac,0xbf22bf463f800000,0x3f78be79bedb3f67,0xbf463f223f800000,0xbf5cbf043eac3f71,0x3f223f463f800000,0x3e793f783f673edb
.quad 0xbef1bf623e48bf7b,0xbf3ebf2cbe16bf7d,0x3f62bef1be483f7b,0xbd49bf803f4e3f18,0x3ef13f623e48bf7b,0x3f2cbf3ebf7d3e16,0xbf623ef1be483f7b,0x3f80bd493f18bf4e
.quad 0xbef1bf623e48bf7b,0x3f3e3f2c3e163f7d,0x3f62bef1be483f7b,0x3d493f80bf4ebf18,0x3ef13f623e48bf7b,0xbf2c3f3e3f7dbe16,0xbf623ef1be483f7b,0xbf803d49bf183f4e
.quad 0xbf22bf460000bf80,0xbf5cbf04beacbf71,0xbf463f220000bf80,0x3e793f78bf67bedb,0x3f223f460000bf80,0x3f04bf5cbf713eac,0x3f46bf220000bf80,0xbf783e79bedb3f67
.quad 0xbf22bf460000bf80,0x3f5c3f043eac3f71,0xbf463f220000bf80,0xbe79bf783f673edb,0x3f223f460000bf80,0xbf043f5c3f71beac,0x3f46bf220000bf80,0x3f78be793edbbf67
.quad 0xbf623ef1bf7bbe48,0xbf2c3f3ebf7d3e16,0xbef1bf623f7b3e48,0xbf803d493f18bf4e,0x3f62bef1bf7bbe48,0xbf3ebf2c3e163f7d,0x3ef13f623f7b3e48,0xbd49bf80bf4ebf18
.quad 0xbf623ef1bf7bbe48,0x3f2cbf3e3f7dbe16,0xbef1bf623f7b3e48,0x3f80bd49bf183f4e,0x3f62bef1bf7bbe48,0x3f3e3f2cbe16bf7d,0x3ef13f623f7b3e48,0x3d493f803f4e3f18
.quad 0xbf463f22bf800000,0xbf043f5cbf713eac,0x3f223f46bf800000,0x3f78be79bedb3f67,0x3f46bf22bf800000,0xbf5cbf043eac3f71,0xbf22bf46bf800000,0x3e793f783f673edb
.quad 0xbf463f22bf800000,0x3f04bf5c3f71beac,0x3f223f46bf800000,0xbf783e793edbbf67,0x3f46bf22bf800000,0x3f5c3f04beacbf71,0xbf22bf46bf800000,0xbe79bf78bf67bedb
.quad 0x3ef13f62be483f7b,0x3f3e3f2c3e163f7d,0xbf623ef13e48bf7b,0x3d493f80bf4ebf18,0xbef1bf62be483f7b,0xbf2c3f3e3f7dbe16,0x3f62bef13e48bf7b,0xbf803d49bf183f4e
.quad 0x3ef13f62be483f7b,0xbf3ebf2cbe16bf7d,0xbf623ef13e48bf7b,0xbd49bf803f4e3f18,0xbef1bf62be483f7b,0x3f2cbf3ebf7d3e16,0x3f62bef13e48bf7b,0x3f80bd493f18bf4e
.quad 0x3f263f4300003f80,0x3f5f3efa3eb13f70,0x3f43bf2600003f80,0xbe8bbf763f683ed6,0xbf26bf4300003f80,0xbefa3f5f3f70beb1,0xbf433f2600003f80,0x3f76be8b3ed6bf68
.quad 0x3f263f4300003f80,0xbf5fbefabeb1bf70,0x3f43bf2600003f80,0x3e8b3f76bf68bed6,0xbf26bf4300003f80,0x3efabf5fbf703eb1,0xbf433f2600003f80,0xbf763e8bbed63f68
.quad 0x3f5abf063f7d3e20,0x3f1ebf493f7bbe48,0x3f063f5abf7dbe20,0x3f7ebdf1bf0e3f55,0xbf5a3f063f7d3e20,0x3f493f1ebe48bf7b,0xbf06bf5abf7dbe20,0x3df13f7e3f553f0e
.quad 0x3f5abf063f7d3e20,0xbf1e3f49bf7b3e48,0x3f063f5abf7dbe20,0xbf7e3df13f0ebf55,0xbf5a3f063f7d3e20,0xbf49bf1e3e483f7b,0xbf06bf5abf7dbe20,0xbdf1bf7ebf55bf0e
.quad 0x3f43bf263f800000,0x3efabf5f3f70beb1,0xbf26bf433f800000,0xbf763e8b3ed6bf68,0xbf433f263f800000,0x3f5f3efabeb1bf70,0x3f263f433f800000,0xbe8bbf76bf68bed6
.quad 0x3f43bf263f800000,0xbefa3f5fbf703eb1,0xbf26bf433f800000,0x3f76be8bbed63f68,0xbf433f263f800000,0xbf5fbefa3eb13f70,0x3f263f433f800000,0x3e8b3f763f683ed6
.quad 0xbf06bf5a3e20bf7d,0xbf49bf1ebe48bf7b,0x3f5abf06be203f7d,0xbdf1bf7e3f553f0e,0x3f063f5a3e20bf7d,0x3f1ebf49bf7b3e48,0xbf5a3f06be203f7d,0x3f7ebdf13f0ebf55
.quad 0xbf06bf5a3e20bf7d,0x3f493f1e3e483f7b,0x3f5abf06be203f7d,0x3df13f7ebf55bf0e,0x3f063f5a3e20bf7d,0xbf1e3f493f7bbe48,0xbf5a3f06be203f7d,0xbf7e3df1bf0e3f55
.quad 0xbf26bf430000bf80,0xbf5fbefabeb1bf70,0xbf433f260000bf80,0x3e8b3f76bf68bed6,0x3f263f430000bf80,0x3efabf5fbf703eb1,0x3f43bf260000bf80,0xbf763e8bbed63f68
.quad 0xbf26bf430000bf80,0x3f5f3efa3eb13f70,0xbf433f260000bf80,0xbe8bbf763f683ed6,0x3f263f430000bf80,0xbefa3f5f3f70beb1,0x3f43bf260000bf80,0x3f76be8b3ed6bf68
.quad 0xbf5a3f06bf7dbe20,0xbf1e3f49bf7b3e48,0xbf06bf5a3f7d3e20,0xbf7e3df13f0ebf55,0x3f5abf06bf7dbe20,0xbf49bf1e3e483f7b,0x3f063f5a3f7d3e20,0xbdf1bf7ebf55bf0e
.quad 0xbf5a3f06bf7dbe20,0x3f1ebf493f7bbe48,0xbf06bf5a3f7d3e20,0x3f7ebdf1bf0e3f55,0x3f5abf06bf7dbe20,0x3f493f1ebe48bf7b,0x3f063f5a3f7d3e20,0x3df13f7e3f553f0e
.quad 0xbf433f26bf800000,0xbefa3f5fbf703eb1,0x3f263f43bf800000,0x3f76be8bbed63f68,0x3f43bf26bf800000,0xbf5fbefa3eb13f70,0xbf26bf43bf800000,0x3e8b3f763f683ed6
.quad 0xbf433f26bf800000,0x3efabf5f3f70beb1,0x3f263f43bf800000,0xbf763e8b3ed6bf68,0x3f43bf26bf800000,0x3f5f3efabeb1bf70,0xbf26bf43bf800000,0xbe8bbf76bf68bed6
.quad 0x3f063f5abe203f7d,0x3f493f1e3e483f7b,0xbf5a3f063e20bf7d,0x3df13f7ebf55bf0e,0xbf06bf5abe203f7d,0xbf1e3f493f7bbe48,0x3f5abf063e20bf7d,0xbf7e3df1bf0e3f55
.quad 0x3f063f5abe203f7d,0xbf49bf1ebe48bf7b,0xbf5a3f063e20bf7d,0xbdf1bf7e3f553f0e,0xbf06bf5abe203f7d,0x3f1ebf49bf7b3e48,0x3f5abf063e20bf7d,0x3f7ebdf13f0ebf55
.quad 0x3f2a3f3f00003f80,0x3f633eed3eb63f6f,0x3f3fbf2a00003f80,0xbe99bf743f6a3ed2,0xbf2abf3f00003f80,0xbeed3f633f6fbeb6,0xbf3f3f2a00003f80,0x3f74be993ed2bf6a
.quad 0x3f2a3f3f00003f80,0xbf63beedbeb6bf6f,0x3f3fbf2a00003f80,0x3e993f74bf6abed2,0xbf2abf3f00003f80,0x3eedbf63bf6f3eb6,0xbf3f3f2a00003f80,0xbf743e99bed23f6a
.quad 0x3f52bf123f7e3df1,0x3f10bf533f78be79,0x3f123f52bf7ebdf1,0x3f7cbe3ebf043f5c,0xbf523f123f7e3df1,0x3f533f10be79bf78,0xbf12bf52bf7ebdf1,0x3e3e3f7c3f5c3f04
.quad 0x3f52bf123f7e3df1,0xbf103f53bf783e79,0x3f123f52bf7ebdf1,0xbf7c3e3e3f04bf5c,0xbf523f123f7e3df1,0xbf53bf103e793f78,0xbf12bf52bf7ebdf1,0xbe3ebf7cbf5cbf04
.quad 0x3f3fbf2a3f800000,0x3eedbf633f6fbeb6,0xbf2abf3f3f800000,0xbf743e993ed2bf6a,0xbf3f3f2a3f800000,0x3f633eedbeb6bf6f,0x3f2a3f3f3f800000,0xbe99bf74bf6abed2
.quad 0x3f3fbf2a3f800000,0xbeed3f63bf6f3eb6,0xbf2abf3f3f800000,0x3f74be99bed23f6a,0xbf3f3f2a3f800000,0xbf63beed3eb63f6f,0x3f2a3f3f3f800000,0x3e993f743f6a3ed2
.quad 0xbf12bf523df1bf7e,0xbf53bf10be79bf78,0x3f52bf12bdf13f7e,0xbe3ebf7c3f5c3f04,0x3f123f523df1bf7e,0x3f10bf53bf783e79,0xbf523f12bdf13f7e,0x3f7cbe3e3f04bf5c
.quad 0xbf12bf523df1bf7e,0x3f533f103e793f78,0x3f52bf12bdf13f7e,0x3e3e3f7cbf5cbf04,0x3f123f523df1bf7e,0xbf103f533f78be79,0xbf523f12bdf13f7e,0xbf7c3e3ebf043f5c
.quad 0xbf2abf3f0000bf80,0xbf63beedbeb6bf6f,0xbf3f3f2a0000bf80,0x3e993f74bf6abed2,0x3f2a3f3f0000bf80,0x3eedbf63bf6f3eb6,0x3f3fbf2a0000bf80,0xbf743e99bed23f6a
.quad 0xbf2abf3f0000bf80,0x3f633eed3eb63f6f,0xbf3f3f2a0000bf80,0xbe99bf743f6a3ed2,0x3f2a3f3f0000bf80,0xbeed3f633f6fbeb6,0x3f3fbf2a0000bf80,0x3f74be993ed2bf6a
.quad 0xbf523f12bf7ebdf1,0xbf103f53bf783e79,0xbf12bf523f7e3df1,0xbf7c3e3e3f04bf5c,0x3f52bf12bf7ebdf1,0xbf53bf103e793f78,0x3f123f523f7e3df1,0xbe3ebf7cbf5cbf04
.quad 0xbf523f12bf7ebdf1,0x3f10bf533f78be79,0xbf12bf523f7e3df1,0x3f7cbe3ebf043f5c,0x3f52bf12bf7ebdf1,0x3f533f10be79bf78,0x3f123f523f7e3df1,0x3e3e3f7c3f5c3f04
.quad 0xbf3f3f2abf800000,0xbeed3f63bf6f3eb6,0x3f2a3f3fbf800000,0x3f74be99bed23f6a,0x3f3fbf2abf800000,0xbf63beed3eb63f6f,0xbf2abf3fbf800000,0x3e993f743f6a3ed2
.quad 0xbf3f3f2abf800000,0x3eedbf633f6fbeb6,0x3f2a3f3fbf800000,0xbf743e993ed2bf6a,0x3f3fbf2abf800000,0x3f633eedbeb6bf6f,0xbf2abf3fbf800000,0xbe99bf74bf6abed2
.quad 0x3f123f52bdf13f7e,0x3f533f103e793f78,0xbf523f123df1bf7e,0x3e3e3f7cbf5cbf04,0xbf12bf52bdf13f7e,0xbf103f533f78be79,0x3f52bf123df1bf7e,0xbf7c3e3ebf043f5c
.quad 0x3f123f52bdf13f7e,0xbf53bf10be79bf78,0xbf523f123df1bf7e,0xbe3ebf7c3f5c3f04,0xbf12bf52bdf13f7e,0x3f10bf53bf783e79,0x3f52bf123df1bf7e,0x3f7cbe3e3f04bf5c
.quad 0x3f2e3f3c00003f80,0x3f663edf3ebb3f6e,0x3f3cbf2e00003f80,0xbea8bf723f6b3ecd,0xbf2ebf3c00003f80,0xbedf3f663f6ebebb,0xbf3c3f2e00003f80,0x3f72bea83ecdbf6b
.quad 0x3f2e3f3c00003f80,0xbf66bedfbebbbf6e,0x3f3cbf2e00003f80,0x3ea83f72bf6bbecd,0xbf2ebf3c00003f80,0x3edfbf66bf6e3ebb,0xbf3c3f2e00003f80,0xbf723ea8becd3f6b
.quad 0x3f49bf1e3f7f3da1,0x3f01bf5d3f75be95,0x3f1e3f49bf7fbda1,0x3f78be81bef13f62,0xbf493f1e3f7f3da1,0x3f5d3f01be95bf75,0xbf1ebf49bf7fbda1,0x3e813f783f623ef1
.quad 0x3f49bf1e3f7f3da1,0xbf013f5dbf753e95,0x3f1e3f49bf7fbda1,0xbf783e813ef1bf62,0xbf493f1e3f7f3da1,0xbf5dbf013e953f75,0xbf1ebf49bf7fbda1,0xbe81bf78bf62bef1
.quad 0x3f3cbf2e3f800000,0x3edfbf663f6ebebb,0xbf2ebf3c3f800000,0xbf723ea83ecdbf6b,0xbf3c3f2e3f800000,0x3f663edfbebbbf6e,0x3f2e3f3c3f800000,0xbea8bf72bf6bbecd
.quad 0x3f3cbf2e3f800000,0xbedf3f66bf6e3ebb,0xbf2ebf3c3f800000,0x3f72bea8becd3f6b,0xbf3c3f2e3f800000,0xbf66bedf3ebb3f6e,0x3f2e3f3c3f800000,0x3ea83f723f6b3ecd
.quad 0xbf1ebf493da1bf7f,0xbf5dbf01be95bf75,0x3f49bf1ebda13f7f,0xbe81bf783f623ef1,0x3f1e3f493da1bf7f,0x3f01bf5dbf753e95,0xbf493f1ebda13f7f,0x3f78be813ef1bf62
.quad 0xbf1ebf493da1bf7f,0x3f5d3f013e953f75,0x3f49bf1ebda13f7f,0x3e813f78bf62bef1,0x3f1e3f493da1bf7f,0xbf013f5d3f75be95,0xbf493f1ebda13f7f,0xbf783e81bef13f62
.quad 0xbf2ebf3c0000bf80,0xbf66bedfbebbbf6e,0xbf3c3f2e0000bf80,0x3ea83f72bf6bbecd,0x3f2e3f3c0000bf80,0x3edfbf66bf6e3ebb,0x3f3cbf2e0000bf80,0xbf723ea8becd3f6b
.quad 0xbf2ebf3c0000bf80,0x3f663edf3ebb3f6e,0xbf3c3f2e0000bf80,0xbea8bf723f6b3ecd,0x3f2e3f3c0000bf80,0xbedf3f663f6ebebb,0x3f3cbf2e0000bf80,0x3f72bea83ecdbf6b
.quad 0xbf493f1ebf7fbda1,0xbf013f5dbf753e95,0xbf1ebf493f7f3da1,0xbf783e813ef1bf62,0x3f49bf1ebf7fbda1,0xbf5dbf013e953f75,0x3f1e3f493f7f3da1,0xbe81bf78bf62bef1
.quad 0xbf493f1ebf7fbda1,0x3f01bf5d3f75be95,0xbf1ebf493f7f3da1,0x3f78be81bef13f62,0x3f49bf1ebf7fbda1,0x3f5d3f01be95bf75,0x3f1e3f493f7f3da1,0x3e813f783f623ef1
.quad 0xbf3c3f2ebf800000,0xbedf3f66bf6e3ebb,0x3f2e3f3cbf800000,0x3f72bea8becd3f6b,0x3f3cbf2ebf800000,0xbf66bedf3ebb3f6e,0xbf2ebf3cbf800000,0x3ea83f723f6b3ecd
.quad 0xbf3c3f2ebf800000,0x3edfbf663f6ebebb,0x3f2e3f3cbf800000,0xbf723ea83ecdbf6b,0x3f3cbf2ebf800000,0x3f663edfbebbbf6e,0xbf2ebf3cbf800000,0xbea8bf72bf6bbecd
.quad 0x3f1e3f49bda13f7f,0x3f5d3f013e953f75,0xbf493f1e3da1bf7f,0x3e813f78bf62bef1,0xbf1ebf49bda13f7f,0xbf013f5d3f75be95,0x3f49bf1e3da1bf7f,0xbf783e81bef13f62
.quad 0x3f1e3f49bda13f7f,0xbf5dbf01be95bf75,0xbf493f1e3da1bf7f,0xbe81bf783f623ef1,0xbf1ebf49bda13f7f,0x3f01bf5dbf753e95,0x3f49bf1e3da1bf7f,0x3f78be813ef1bf62
.quad 0x3f313f3900003f80,0x3f6a3ed23ebf3f6d,0x3f39bf3100003f80,0xbeb6bf6f3f6c3ec9,0xbf31bf3900003f80,0xbed23f6a3f6dbebf,0xbf393f3100003f80,0x3f6fbeb63ec9bf6c
.quad 0x3f313f3900003f80,0xbf6abed2bebfbf6d,0x3f39bf3100003f80,0x3eb63f6fbf6cbec9,0xbf31bf3900003f80,0x3ed2bf6abf6d3ebf,0xbf393f3100003f80,0xbf6f3eb6bec93f6c
.quad 0x3f3fbf2a3f803d21,0x3ee4bf653f71beac,0x3f2a3f3fbf80bd21,0x3f73bea3bedb3f67,0xbf3f3f2a3f803d21,0x3f653ee4beacbf71,0xbf2abf3fbf80bd21,0x3ea33f733f673edb
.quad 0x3f3fbf2a3f803d21,0xbee43f65bf713eac,0x3f2a3f3fbf80bd21,0xbf733ea33edbbf67,0xbf3f3f2a3f803d21,0xbf65bee43eac3f71,0xbf2abf3fbf80bd21,0xbea3bf73bf67bedb
.quad 0x3f39bf313f800000,0x3ed2bf6a3f6dbebf,0xbf31bf393f800000,0xbf6f3eb63ec9bf6c,0xbf393f313f800000,0x3f6a3ed2bebfbf6d,0x3f313f393f800000,0xbeb6bf6fbf6cbec9
.quad 0x3f39bf313f800000,0xbed23f6abf6d3ebf,0xbf31bf393f800000,0x3f6fbeb6bec93f6c,0xbf393f313f800000,0xbf6abed23ebf3f6d,0x3f313f393f800000,0x3eb63f6f3f6c3ec9
.quad 0xbf2abf3f3d21bf80,0xbf65bee4beacbf71,0x3f3fbf2abd213f80,0xbea3bf733f673edb,0x3f2a3f3f3d21bf80,0x3ee4bf65bf713eac,0xbf3f3f2abd213f80,0x3f73bea33edbbf67
.quad 0xbf2abf3f3d21bf80,0x3f653ee43eac3f71,0x3f3fbf2abd213f80,0x3ea33f73bf67bedb,0x3f2a3f3f3d21bf80,0xbee43f653f71beac,0xbf3f3f2abd213f80,0xbf733ea3bedb3f67
.quad 0xbf31bf390000bf80,0xbf6abed2bebfbf6d,0xbf393f310000bf80,0x3eb63f6fbf6cbec9,0x3f313f390000bf80,0x3ed2bf6abf6d3ebf,0x3f39bf310000bf80,0xbf6f3eb6bec93f6c
.quad 0xbf31bf390000bf80,0x3f6a3ed23ebf3f6d,0xbf393f310000bf80,0xbeb6bf6f3f6c3ec9,0x3f313f390000bf80,0xbed23f6a3f6dbebf,0x3f39bf310000bf80,0x3f6fbeb63ec9bf6c
.quad 0xbf3f3f2abf80bd21,0xbee43f65bf713eac,0xbf2abf3f3f803d21,0xbf733ea33edbbf67,0x3f3fbf2abf80bd21,0xbf65bee43eac3f71,0x3f2a3f3f3f803d21,0xbea3bf73bf67bedb
.quad 0xbf3f3f2abf80bd21,0x3ee4bf653f71beac,0xbf2abf3f3f803d21,0x3f73bea3bedb3f67,0x3f3fbf2abf80bd21,0x3f653ee4beacbf71,0x3f2a3f3f3f803d21,0x3ea33f733f673edb
.quad 0xbf393f31bf800000,0xbed23f6abf6d3ebf,0x3f313f39bf800000,0x3f6fbeb6bec93f6c,0x3f39bf31bf800000,0xbf6abed23ebf3f6d,0xbf31bf39bf800000,0x3eb63f6f3f6c3ec9
.quad 0xbf393f31bf800000,0x3ed2bf6a3f6dbebf,0x3f313f39bf800000,0xbf6f3eb63ec9bf6c,0x3f39bf31bf800000,0x3f6a3ed2bebfbf6d,0xbf31bf39bf800000,0xbeb6bf6fbf6cbec9
.quad 0x3f2a3f3fbd213f80,0x3f653ee43eac3f71,0xbf3f3f2a3d21bf80,0x3ea33f73bf67bedb,0xbf2abf3fbd213f80,0xbee43f653f71beac,0x3f3fbf2a3d21bf80,0xbf733ea3bedb3f67
.quad 0x3f2a3f3fbd213f80,0xbf65bee4beacbf71,0xbf3f3f2a3d21bf80,0xbea3bf733f673edb,0xbf2abf3fbd213f80,0x3ee4bf65bf713eac,0x3f3fbf2a3d21bf80,0x3f73bea33edbbf67
.quad 0x3f3500003f800000,0x3ec400003f6d0000,0xbf3500003f800000,0xbf6d00003ec40000,0xbf3500003f800000,0x3f6d0000bec40000,0x3f3500003f800000,0xbec40000bf6d0000
.quad 0x3f3500003f800000,0xbec40000bf6d0000,0xbf3500003f800000,0x3f6d0000bec40000,0xbf3500003f800000,0xbf6d00003ec40000,0x3f3500003f800000,0x3ec400003f6d0000
.quad 0xbf35000000000000,0xbf6d0000bec40000,0x3f35000000000000,0xbec400003f6d0000,0x3f35000000000000,0x3ec40000bf6d0000,0xbf35000000000000,0x3f6d00003ec40000
.quad 0xbf35000000000000,0x3f6d00003ec40000,0x3f35000000000000,0x3ec40000bf6d0000,0x3f35000000000000,0xbec400003f6d0000,0xbf35000000000000,0xbf6d0000bec40000
.quad 0xbf35000000000000,0xbf6d0000bec40000,0xbf35000000000000,0x3ec40000bf6d0000,0x3f35000000000000,0x3ec40000bf6d0000,0x3f35000000000000,0xbf6d0000bec40000
.quad 0xbf35000000000000,0x3f6d00003ec40000,0xbf35000000000000,0xbec400003f6d0000,0x3f35000000000000,0xbec400003f6d0000,0x3f35000000000000,0x3f6d00003ec40000
.quad 0xbf350000bf800000,0xbec40000bf6d0000,0xbf3500003f800000,0xbf6d00003ec40000,0x3f350000bf800000,0xbf6d00003ec40000,0x3f3500003f800000,0xbec40000bf6d0000
.quad 0xbf350000bf800000,0x3ec400003f6d0000,0xbf3500003f800000,0x3f6d0000bec40000,0x3f350000bf800000,0x3f6d0000bec40000,0x3f3500003f800000,0x3ec400003f6d0000
.quad 0xbf350000bf800000,0xbec40000bf6d0000,0x3f350000bf800000,0x3f6d0000bec40000,0x3f350000bf800000,0xbf6d00003ec40000,0xbf350000bf800000,0x3ec400003f6d0000
.quad 0xbf350000bf800000,0x3ec400003f6d0000,0x3f350000bf800000,0xbf6d00003ec40000,0x3f350000bf800000,0x3f6d0000bec40000,0xbf350000bf800000,0xbec40000bf6d0000
.quad 0x3f35000000000000,0x3f6d00003ec40000,0xbf35000000000000,0x3ec40000bf6d0000,0xbf35000000000000,0xbec400003f6d0000,0x3f35000000000000,0xbf6d0000bec40000
.quad 0x3f35000000000000,0xbf6d0000bec40000,0xbf35000000000000,0xbec400003f6d0000,0xbf35000000000000,0x3ec40000bf6d0000,0x3f35000000000000,0x3f6d00003ec40000
.quad 0x3f35000000000000,0x3f6d00003ec40000,0x3f35000000000000,0xbec400003f6d0000,0xbf35000000000000,0xbec400003f6d0000,0xbf35000000000000,0x3f6d00003ec40000
.quad 0x3f35000000000000,0xbf6d0000bec40000,0x3f35000000000000,0x3ec40000bf6d0000,0xbf35000000000000,0x3ec40000bf6d0000,0xbf35000000000000,0xbf6d0000bec40000
.quad 0x3f3500003f800000,0x3ec400003f6d0000,0x3f350000bf800000,0x3f6d0000bec40000,0xbf3500003f800000,0x3f6d0000bec40000,0xbf350000bf800000,0x3ec400003f6d0000
.quad 0x3f3500003f800000,0xbec40000bf6d0000,0x3f350000bf800000,0xbf6d00003ec40000,0xbf3500003f800000,0xbf6d00003ec40000,0xbf350000bf800000,0xbec40000bf6d0000
.quad 0x0,0x0,0x3f80,0xbf3500003f35,0xbf8000003f80,0x0,0x3f80,0x3f350000bf35
.quad 0x3f8000003f80,0xbf800000bf80,0x3f80,0x3f350000bf35,0xbf8000003f80,0x0,0x3f80,0xbf3500003f35
.quad 0x0,0x0,0xbf80,0x3f350000bf35,0xbf8000003f80,0x0,0xbf80,0xbf3500003f35
.quad 0x3f8000003f80,0xbf800000bf80,0xbf80,0xbf3500003f35,0xbf8000003f80,0x0,0xbf80,0x3f350000bf35
.quad 0x0,0x0,0xbf8000000000,0xbf350000bf35,0x0,0x3f800000bf80,0x3f8000000000,0xbf350000bf35
.quad 0x0,0x0,0xbf8000000000,0x3f3500003f35,0x0,0xbf8000003f80,0x3f8000000000,0x3f3500003f35
.quad 0x0,0x0,0x3f8000000000,0x3f3500003f35,0x0,0x3f800000bf80,0xbf8000000000,0x3f3500003f35
.quad 0x0,0x0,0x3f8000000000,0xbf350000bf35,0x0,0xbf8000003f80,0xbf8000000000,0xbf350000bf35
.quad 0x0,0x0,0xbf80,0x3f350000bf35,0x3f800000bf80,0x0,0xbf80,0xbf3500003f35
.quad 0xbf800000bf80,0x3f8000003f80,0xbf80,0xbf3500003f35,0x3f800000bf80,0x0,0xbf80,0x3f350000bf35
.quad 0x0,0x0,0x3f80,0xbf3500003f35,0x3f800000bf80,0x0,0x3f80,0x3f350000bf35
.quad 0xbf800000bf80,0x3f8000003f80,0x3f80,0x3f350000bf35,0x3f800000bf80,0x0,0x3f80,0xbf3500003f35
.quad 0x0,0x0,0x3f8000000000,0x3f3500003f35,0x0,0xbf8000003f80,0xbf8000000000,0x3f3500003f35
.quad 0x0,0x0,0x3f8000000000,0xbf350000bf35,0x0,0x3f800000bf80,0xbf8000000000,0xbf350000bf35
.quad 0x0,0x0,0xbf8000000000,0xbf350000bf35,0x0,0xbf8000003f80,0x3f8000000000,0xbf350000bf35
.quad 0x0,0x0,0xbf8000000000,0x3f3500003f35,0x0,0x3f800000bf80,0x3f8000000000,0x3f3500003f35
.size dft_tables, 84992
dft_end:
.section .rodata,"a"
.p2align 6
.amdhsa_kernel interleave_layers__spectral_fnet__dense_activation_squared_relu__prompt_kernel
  .amdhsa_next_free_vgpr 512
  .amdhsa_next_free_sgpr 102
  .amdhsa_accum_offset 256
  .amdhsa_group_segment_fixed_size 0
  .amdhsa_kernarg_size 104
  .amdhsa_user_sgpr_count 2
  .amdhsa_user_sgpr_kernarg_segment_ptr 1
  .amdhsa_system_sgpr_workgroup_id_x 1
  .amdhsa_float_denorm_mode_32 3
.end_amdhsa_kernel
```
